```python
import torch

def _softmax(x, axis=-1):
    return torch.softmax(x, dim=axis)
def _gelu(x):
    return torch.nn.functional.gelu(x, approximate="tanh")
def _silu(x):
    return torch.nn.functional.silu(x)
def _sigmoid(x):
    return torch.sigmoid(x)
def _layernorm(x, axis=-1, eps=1e-5):
    m = x.mean(dim=axis, keepdim=True)
    v = x.var(dim=axis, keepdim=True, unbiased=False)
    return (x - m) / torch.sqrt(v + eps)
def _scatter_add(tgt, idx, src, axis=0):
    return tgt.clone().index_add_(axis, idx, src)
def _segment_sum(src, seg, n):
    out = torch.zeros((n,) + src.shape[1:], dtype=src.dtype)
    return out.index_add_(0, seg, src)
def _pad(x, pw):
    flat = tuple(v for pair in reversed(pw) for v in pair)
    return torch.nn.functional.pad(x, flat)

kernel_name = 'interleave_layers__grouped_kv_mqa__glu_gated_bilinear__prompt'

def setup_inputs():

    _w = (lambda a: (lambda t: t.to(torch.bfloat16) if t.is_floating_point() else t)(torch.as_tensor(a)))
    def _A_setup():
        B, S, D, H = 1, 2048, 448, 16
        Dh = D // H
        return {
            "x": _w((lambda *s: torch.randn(*s, dtype=torch.bfloat16) * 0.05)(B, S, D)),
            "wq": _w((lambda *s: torch.randn(*s, dtype=torch.bfloat16) * 0.05)(D, H * Dh)),
            "wk": _w((lambda *s: torch.randn(*s, dtype=torch.bfloat16) * 0.05)(D, Dh)),
            "wv": _w((lambda *s: torch.randn(*s, dtype=torch.bfloat16) * 0.05)(D, Dh)),
            "wo": _w((lambda *s: torch.randn(*s, dtype=torch.bfloat16) * 0.05)(H * Dh, D)),
        }
    _A_in = _A_setup()

    def _B_setup():
        B, S, D, F = 1, 2048, 448, 1792
        return {
            "x": _w((lambda *s: torch.randn(*s, dtype=torch.bfloat16) * 0.05)(B, S, D)),
            "w_gate": _w((lambda *s: torch.randn(*s, dtype=torch.bfloat16) * 0.4)(D, F) * (D ** -0.5)),
            "w_up": _w((lambda *s: torch.randn(*s, dtype=torch.bfloat16) * 0.4)(D, F) * (D ** -0.5)),
            "w_down": _w((lambda *s: torch.randn(*s, dtype=torch.bfloat16) * 0.4)(F, D) * (F ** -0.5)),
        }
    _B_in = _B_setup()

    return {
        "A_x": _A_in["x"],
        "A_wq": _A_in["wq"],
        "A_wk": _A_in["wk"],
        "A_wv": _A_in["wv"],
        "A_wo": _A_in["wo"],
        "B_x": _B_in["x"],
        "B_w_gate": _B_in["w_gate"],
        "B_w_up": _B_in["w_up"],
        "B_w_down": _B_in["w_down"],
    }

def reference(A_x, A_wq, A_wk, A_wv, A_wo, B_x, B_w_gate, B_w_up, B_w_down):
    def _A_ref(x, wq, wk, wv, wo):
        B, S, D = x.shape
        H = 16
        Dh = D // H
        q = (lambda x, *d: x.permute(*d))((x @ wq).reshape(B, S, H, Dh), 0, 2, 1, 3)
        k = x @ wk
        v = x @ wv
        scores = torch.einsum("bhqd,bkd->bhqk", q, k) * (Dh ** -0.5)
        p = _softmax(scores, axis=-1)
        o = torch.einsum("bhqk,bkd->bhqd", p, v)
        return (lambda x, *d: x.permute(*d))(o, 0, 2, 1, 3).reshape(B, S, H * Dh) @ wo

    def _B_ref(x, w_gate, w_up, w_down):
        g = torch.einsum("bsd,df->bsf", x, w_gate)
        u = torch.einsum("bsd,df->bsf", x, w_up)
        h = g * u
        return torch.einsum("bsf,fd->bsd", h, w_down)

    x = A_x
    x = x + _A_ref(_layernorm(x, axis=-1), A_wq, A_wk, A_wv, A_wo)
    x = x + _B_ref(_layernorm(x, axis=-1), B_w_gate, B_w_up, B_w_down)
    x = x + _A_ref(_layernorm(x, axis=-1), A_wq, A_wk, A_wv, A_wo)
    x = x + _B_ref(_layernorm(x, axis=-1), B_w_gate, B_w_up, B_w_down)
    return x
```

```asm
; @launch kernel=p1a_kernel grid=(256,1,1) block=(256,1,1) lds=152064
; @launch kernel=mm_kernel grid=(256,1,1) block=(256,1,1) lds=163840
.amdgcn_target "amdgcn-amd-amdhsa--gfx950"
.text
.globl p1a_kernel
.p2align 12
.p2align 8
.type p1a_kernel,@function
p1a_kernel:
  s_cmp_ge_u32 s2, 256
  s_cbranch_scc1 p1a_kernel_end
  s_load_dwordx16 s[16:31], s[0:1], 0
  s_load_dwordx8 s[32:39], s[0:1], 64
  s_getpc_b64 s[44:45]
p1a_kernel_pc:
  s_lshr_b32 s46, s2, 3
  s_mul_i32 s46, s46, 1024
  v_lshrrev_b32 v62, 6, v0
  v_mul_u32_u24 v62, 2, v62
  v_and_b32 v63, 63, v0
  v_add_u32 v62, v62, v63
  v_lshlrev_b32 v62, 7, v62
  v_sub_u32 v63, 1, v63
  v_and_b32 v63, 0x40000000, v63
  v_add3_u32 v62, v62, v63, s46
  s_and_b32 s45, s45, 0xffff
  s_mov_b32 s46, mm_kernel-p1a_kernel_pc
  s_mov_b32 s47, 0x20000
  buffer_load_dword v62, v62, s[44:47], 0 offen
  v_and_b32 v1, 63, v0
  v_lshrrev_b32 v2, 6, v0
  s_nop 0
  v_readfirstlane_b32 s3, v2
  s_bfe_u32 s4, s2, 0x20001
  s_lshl_b32 s4, s4, 3
  s_and_b32 s5, s2, 1
  s_add_u32 s4, s4, s5
  s_lshr_b32 s6, s2, 6
  s_lshl_b32 s6, s6, 1
  s_add_u32 s4, s4, s6
  s_bfe_u32 s5, s2, 0x30003
  v_and_b32 v2, 31, v1
  v_lshrrev_b32 v3, 5, v1
  v_lshrrev_b32 v4, 3, v1
  v_and_b32 v5, 7, v1
  v_lshrrev_b32 v6, 4, v1
  v_lshlrev_b32 v50, 4, v1
  s_lshl_b32 s6, s4, 6
  s_lshl_b32 s7, s3, 4
  s_add_u32 s6, s6, s7
  v_add_u32 v7, s6, v4
  v_mul_u32_u24 v7, 896, v7
  v_xor_b32 v8, v5, v6
  v_lshl_add_u32 v8, v8, 4, v7
  v_xor_b32 v9, v5, v6
  v_xor_b32 v9, 4, v9
  v_lshl_add_u32 v9, v9, 4, v7
  v_add_u32 v9, 7168, v9
  s_mul_i32 s6, s5, 112
  s_mul_i32 s7, s3, 7168
  s_add_u32 s6, s6, s7
  v_mul_u32_u24 v10, 896, v4
  v_lshl_add_u32 v10, v5, 4, v10
  v_add_u32 v10, s6, v10
  s_lshl_b32 s6, s3, 6
  v_add_u32 v11, s6, v1
  v_lshlrev_b32 v12, 7, v11
  v_add_u32 v12, 57456, v12
  v_mul_u32_u24 v11, 56, v11
  s_and_b32 s7, s5, 3
  s_lshl_b32 s7, s7, 4
  v_add_u32 v11, s7, v11
  v_add_u32 v14, 14336, v11
  s_lshl_b32 s9, s3, 11
  s_lshl_b32 s10, s3, 10
  s_add_u32 s10, s10, 57344
  s_and_b32 s6, s2, 7
  s_lshl_b32 s7, s5, 3
  s_add_u32 s6, s6, s7
  s_lshl_b32 s6, s6, 2
  s_add_u32 s6, s6, s3
  s_lshl_b32 s6, s6, 14
  s_add_u32 s15, s6, 2621440
  s_cmp_eq_u32 s5, 7
  s_cselect_b32 s69, 0, s5
  s_lshl_b32 s69, s69, 13
  s_lshr_b32 s70, s2, 6
  s_mul_i32 s70, s70, 7
  s_lshr_b32 s70, s70, 1
  s_lshl_b32 s70, s70, 12
  v_mov_b32 v56, -1
  v_mov_b32 v57, -1
  v_mov_b32 v58, -1
  v_mov_b32 v59, -1
  s_waitcnt lgkmcnt(0)
  s_mov_b32 s40, s38
  s_and_b32 s41, s39, 0xffff
  s_mov_b32 s42, 36360192
  s_mov_b32 s43, 0x20000
  s_mov_b32 s44, s16
  s_and_b32 s45, s17, 0xffff
  s_mov_b32 s46, 1835008
  s_mov_b32 s47, 0x20000
  s_mov_b32 s48, s18
  s_and_b32 s49, s19, 0xffff
  s_mov_b32 s50, 401408
  s_mov_b32 s51, 0x20000
  s_add_u32 m0, s9, s69
  s_lshr_b32 s11, s69, 6
  buffer_load_dwordx4 v8, s[44:47], s11 offen lds
  s_add_u32 m0, m0, 1024
  s_add_u32 s69, s69, 8192
  buffer_load_dwordx4 v9, s[44:47], s11 offen lds
  s_cmp_eq_u32 s69, 57344
  s_cselect_b32 s69, 0, s69
  s_add_u32 m0, s9, s69
  s_lshr_b32 s11, s69, 6
  buffer_load_dwordx4 v8, s[44:47], s11 offen lds
  s_add_u32 m0, m0, 1024
  s_add_u32 s69, s69, 8192
  buffer_load_dwordx4 v9, s[44:47], s11 offen lds
  s_cmp_eq_u32 s69, 57344
  s_cselect_b32 s69, 0, s69
  s_mov_b32 exec_lo, 0x7f7f7f7f
  s_mov_b32 exec_hi, 0x7f7f7f7f
  s_add_u32 m0, s10, s70
  s_mul_i32 s11, s70, 7
  buffer_load_dwordx4 v10, s[48:51], s11 offen lds
  s_add_u32 s70, s70, 4096
  s_cmp_eq_u32 s70, 57344
  s_cselect_b32 s70, 0, s70
  s_add_u32 m0, s10, s70
  s_mul_i32 s11, s70, 7
  buffer_load_dwordx4 v10, s[48:51], s11 offen lds
  s_add_u32 s70, s70, 4096
  s_cmp_eq_u32 s70, 57344
  s_cselect_b32 s70, 0, s70
  s_add_u32 m0, s10, s70
  s_mul_i32 s11, s70, 7
  buffer_load_dwordx4 v10, s[48:51], s11 offen lds
  s_add_u32 s70, s70, 4096
  s_cmp_eq_u32 s70, 57344
  s_cselect_b32 s70, 0, s70
  s_add_u32 m0, s10, s70
  s_mul_i32 s11, s70, 7
  buffer_load_dwordx4 v10, s[48:51], s11 offen lds
  s_add_u32 s70, s70, 4096
  s_cmp_eq_u32 s70, 57344
  s_cselect_b32 s70, 0, s70
  s_mov_b64 exec, -1
  s_and_b32 s6, s2, 7
  s_lshr_b32 s7, s2, 6
  s_mul_i32 s66, s5, 3
  s_add_u32 s66, s66, s7
  s_sub_u32 s66, s66, 1
  s_lshl_b32 s66, s66, 3
  s_add_u32 s66, s66, s6
  s_cmp_eq_u32 s7, 0
  s_cselect_b32 s66, 255, s66
  s_mov_b32 s59, 0x20000
  s_cmp_ge_u32 s66, 112
  s_cbranch_scc1 p1a_kernel_u1
  s_mov_b32 s63, 0
  s_cmp_lt_u32 s3, 2
  s_cselect_b32 s56, s28, s30
  s_cselect_b32 s57, s29, s31
  s_mov_b32 s58, 1605632
  s_mov_b32 s65, 3584
  s_and_b32 s6, s66, 3
  s_mul_i32 s6, s6, 112
  s_and_b32 s7, s3, 1
  s_mul_i32 s7, s7, 56
  s_add_u32 s6, s6, s7
  s_mul_i32 s64, s6, 3584
  s_lshr_b32 s67, s66, 2
  s_and_b32 s68, s66, 3
  s_branch p1a_kernel_u9
p1a_kernel_u1:
  s_mov_b32 s65, 896
  s_cmp_ge_u32 s66, 168
  s_cbranch_scc1 p1a_kernel_u2
  s_mov_b32 s63, 1
  s_mov_b32 s56, s32
  s_mov_b32 s57, s33
  s_mov_b32 s58, 1605632
  s_sub_u32 s6, s66, 112
  s_branch p1a_kernel_u3
p1a_kernel_u2:
  s_mov_b32 s63, 2
  s_mov_b32 s56, s24
  s_mov_b32 s57, s25
  s_mov_b32 s58, 401408
  s_sub_u32 s6, s66, 168
  s_cmp_lt_u32 s66, 182
  s_cbranch_scc1 p1a_kernel_u3
  s_mov_b32 s63, 3
  s_mov_b32 s58, 0
  s_mov_b32 s6, 0
p1a_kernel_u3:
  s_mul_i32 s68, s6, 9363
  s_lshr_b32 s68, s68, 16
  s_mul_i32 s7, s68, 7
  s_sub_u32 s67, s6, s7
  s_mul_i32 s6, s68, 224
  s_mul_i32 s7, s3, 56
  s_add_u32 s6, s6, s7
  s_mul_i32 s64, s6, 896
p1a_kernel_u9:
  s_and_b32 s57, s57, 0xffff
  s_lshl_b32 s6, s67, 7
  s_add_u32 s64, s64, s6
  v_mul_lo_u32 v13, v4, s65
  v_lshl_add_u32 v13, v5, 4, v13
  s_lshl_b32 s65, s65, 3
  s_mul_i32 s6, s3, 7168
  s_add_u32 s6, s6, 122880
  s_mov_b32 s66, s6
  s_cmp_lt_u32 s5, 4
  s_cselect_b32 s52, s20, s22
  s_cselect_b32 s53, s21, s23
  s_and_b32 s53, s53, 0xffff
  s_mov_b32 s54, 25088
  s_mov_b32 s55, 0x20000
  v_and_b32 v55, 15, v1
  v_lshrrev_b32 v54, 3, v55
  v_lshlrev_b32 v54, 10, v54
  v_and_b32 v15, 7, v55
  v_lshl_add_u32 v54, v15, 7, v54
  v_bfe_u32 v15, v55, 1, 2
  v_xor_b32 v15, v15, v6
  v_lshl_add_u32 v54, v15, 5, v54
  v_add_u32 v54, s9, v54
  v_bfe_u32 v15, v55, 3, 1
  v_lshl_add_u32 v54, v15, 4, v54
  v_xor_b32 v61, 16, v54
  s_lshl_b32 s6, s3, 7
  s_add_u32 s6, s6, 151552
  v_lshl_add_u32 v55, v55, 3, s6
  s_mov_b32 s71, 0x3f803f80
  s_lshr_b32 s12, s3, 1
  s_and_b32 s13, s3, 1
  s_lshl_b32 s6, s12, 5
  v_add_u32 v32, s6, v2
  v_lshlrev_b32 v53, 3, v32
  v_add_u32 v53, 151552, v53
  v_lshrrev_b32 v33, 3, v32
  v_lshlrev_b32 v33, 10, v33
  v_and_b32 v34, 7, v32
  v_lshl_add_u32 v33, v34, 7, v33
  v_bfe_u32 v34, v32, 1, 3
  v_add_u32 v32, 0, v3
  v_xor_b32 v32, v32, v34
  v_lshl_add_u32 v24, v32, 4, v33
  v_add_u32 v32, 2, v3
  v_xor_b32 v32, v32, v34
  v_lshl_add_u32 v25, v32, 4, v33
  v_add_u32 v32, 4, v3
  v_xor_b32 v32, v32, v34
  v_lshl_add_u32 v26, v32, 4, v33
  v_add_u32 v32, 6, v3
  v_xor_b32 v32, v32, v34
  v_lshl_add_u32 v27, v32, 4, v33
  v_bfe_u32 v32, v1, 2, 2
  v_bfe_u32 v33, v1, 4, 1
  v_and_b32 v34, 3, v1
  v_lshl_add_u32 v33, v33, 2, v34
  v_lshlrev_b32 v34, 3, v33
  s_mul_i32 s6, s13, 56
  v_add_u32 v34, s6, v34
  s_lshl_b32 s7, s13, 3
  s_add_u32 s7, s7, 112
  v_mov_b32 v29, s7
  v_cmp_eq_u32 vcc, 7, v33
  s_nop 1
  v_cndmask_b32 v34, v34, v29, vcc
  v_add_u32 v34, 57344, v34
  v_lshl_add_u32 v29, v3, 2, v32
  v_lshl_add_u32 v29, v29, 7, v34
  v_lshl_add_u32 v28, v3, 3, v32
  v_lshl_add_u32 v28, v28, 7, v34
  s_mov_b32 s14, s9
  s_lshl_b32 s6, s4, 1
  s_add_u32 s6, s6, s12
  s_lshl_b32 s7, s5, 1
  s_add_u32 s62, s7, s13
  s_lshl_b32 s8, s6, 4
  s_add_u32 s8, s8, s62
  s_lshl_b32 s8, s8, 11
  s_add_u32 s60, s8, 0
  v_lshlrev_b32 v50, 4, v1
  s_lshl_b32 s9, s6, 12
  s_add_u32 s9, s9, 2097152
  s_and_b32 s6, s62, 7
  s_lshr_b32 s7, s6, 2
  s_lshl_b32 s7, s7, 10
  s_and_b32 s8, s6, 1
  s_lshl_b32 s8, s8, 9
  s_add_u32 s7, s7, s8
  s_and_b32 s8, s6, 2
  s_lshl_b32 s8, s8, 2
  s_add_u32 s7, s7, s8
  s_lshl_b32 s8, s6, 6
  s_add_u32 s8, s8, 2048
  s_cmp_ge_u32 s62, 8
  s_cselect_b32 s7, s8, s7
  s_cselect_b64 vcc, -1, 0
  s_add_u32 s61, s9, s7
  v_lshrrev_b32 v51, 4, v2
  v_lshlrev_b32 v51, 10, v51
  v_bfe_u32 v52, v2, 2, 1
  v_lshl_add_u32 v51, v52, 9, v51
  v_and_b32 v52, 3, v2
  v_lshl_add_u32 v51, v52, 1, v51
  v_bfe_u32 v52, v2, 3, 1
  v_lshl_add_u32 v51, v52, 3, v51
  v_lshlrev_b32 v52, 4, v2
  v_cndmask_b32 v51, v52, v51, vcc
  s_mov_b32 s9, s14
  v_mov_b32 v32, s71
  v_mov_b32 v33, s71
  v_mov_b32 v34, s71
  v_mov_b32 v35, s71
  v_bfe_u32 v60, v1, 2, 2
  v_lshl_add_u32 v60, v3, 2, v60
  v_and_b32 v15, 3, v1
  v_lshlrev_b32 v15, 3, v15
  v_lshl_add_u32 v60, v60, 7, v15
  v_bfe_u32 v15, v1, 4, 1
  s_mov_b32 s32, 0xffff0000
  s_mov_b32 s24, s40
  s_mov_b32 s25, s41
  s_mov_b32 s26, s42
  s_mov_b32 s27, 0x20000
  s_cmp_lg_u32 s63, 0
  s_cbranch_scc1 p1a_kernel_a1
  v_mul_u32_u24 v15, 14336, v15
  s_lshl_b32 s6, s3, 5
  s_add_u32 s6, s6, 122880
  v_add3_u32 v60, v60, v15, s6
  s_lshl_b32 s6, s67, 2
  s_add_u32 s6, s6, s3
  s_mul_i32 s8, s6, 9363
  s_lshr_b32 s8, s8, 16
  s_mul_i32 s7, s8, 7
  s_sub_u32 s7, s6, s7
  s_mul_i32 s8, s8, 212992
  s_add_u32 s8, s8, 27983872
  s_sub_u32 s28, s7, 3
  s_lshr_b32 s29, s28, 1
  s_mul_i32 s29, s29, 58
  s_and_b32 s28, s28, 1
  s_add_u32 s28, s28, s29
  s_add_u32 s28, s28, 87
  s_mul_i32 s29, s68, 14
  s_add_u32 s29, s29, s28
  s_mul_i32 s30, s68, 18
  s_add_u32 s30, s30, s7
  s_cmp_lt_u32 s7, 3
  s_cselect_b32 s29, s30, s29
  s_cselect_b32 s30, 3, 2
  s_cselect_b32 s31, 12, 0
  s_lshl_b32 s30, s30, 10
  s_add_u32 s29, s29, s31
  s_lshl_b32 s29, s29, 10
  s_add_u32 s16, s29, s8
  s_add_u32 s17, s16, s30
  s_add_u32 s18, s17, s30
  s_add_u32 s19, s18, s30
  s_add_u32 s20, s19, s30
  s_add_u32 s21, s20, s30
  s_add_u32 s22, s21, s30
  s_mul_i32 s29, s68, 3
  s_add_u32 s29, s29, s7
  s_lshl_b32 s29, s29, 10
  s_add_u32 s29, s29, s8
  s_add_u32 s30, s7, 84
  s_add_u32 s31, s28, 56
  s_cmp_lt_u32 s7, 3
  s_cselect_b32 s22, s29, s22
  s_cselect_b32 s30, s30, s31
  s_lshl_b32 s30, s30, 10
  s_add_u32 s30, s30, s8
  s_lshl_b32 s31, s68, 8
  s_add_u32 s23, s30, s31
  s_branch p1a_kernel_a9
p1a_kernel_a1:
  v_lshl_add_u32 v60, v15, 5, v60
  s_mul_i32 s6, s12, 14336
  s_lshl_b32 s7, s13, 6
  s_add_u32 s6, s6, s7
  s_add_u32 s6, s6, 122880
  v_add_u32 v60, s6, v60
  s_lshl_b32 s6, s67, 1
  s_add_u32 s6, s6, s13
  s_mul_i32 s7, s6, 112
  s_mul_i32 s8, s68, 14
  s_add_u32 s7, s7, s8
  s_mul_i32 s8, s12, 7
  s_add_u32 s7, s7, s8
  s_lshl_b32 s7, s7, 10
  s_add_u32 s16, s7, 31391744
  s_lshl_b32 s7, s6, 5
  s_lshl_b32 s8, s68, 4
  s_add_u32 s7, s7, s8
  s_lshl_b32 s8, s12, 3
  s_add_u32 s7, s7, s8
  s_lshl_b32 s7, s7, 10
  s_add_u32 s7, s7, 27525120
  s_cmp_eq_u32 s63, 2
  s_cselect_b32 s16, s7, s16
  s_cmp_lg_u32 s63, 3
  s_cbranch_scc1 p1a_kernel_a2
  s_and_b32 s6, s2, 3
  s_mul_i32 s7, s6, 14336
  v_add_u32 v60, s7, v29
  s_mul_i32 s7, s62, 28
  s_mul_i32 s6, s6, 7
  s_add_u32 s7, s7, s6
  s_lshl_b32 s7, s7, 10
  s_add_u32 s16, s7, 32997376
  s_and_b32 s6, s2, 0xc4
  s_or_b32 s6, s6, s12
  s_cmp_eq_u32 s6, 0
  s_cselect_b32 s26, s26, 0
p1a_kernel_a2:
  s_add_u32 s17, s16, 1024
  s_add_u32 s18, s17, 1024
  s_add_u32 s19, s18, 1024
  s_add_u32 s20, s19, 1024
  s_add_u32 s21, s20, 1024
  s_add_u32 s22, s21, 1024
  s_add_u32 s23, s22, 1024
p1a_kernel_a9:
  buffer_load_dwordx4 v[16:19], v11, s[52:55], 0 offen
  buffer_load_dwordx4 v[20:23], v14, s[52:55], 0 offen
  s_add_u32 m0, s9, s69
  s_lshr_b32 s11, s69, 6
  buffer_load_dwordx4 v8, s[44:47], s11 offen lds
  s_add_u32 m0, m0, 1024
  s_add_u32 s69, s69, 8192
  buffer_load_dwordx4 v9, s[44:47], s11 offen lds
  s_cmp_eq_u32 s69, 57344
  s_cselect_b32 s69, 0, s69
  s_add_u32 m0, s9, s69
  s_lshr_b32 s11, s69, 6
  buffer_load_dwordx4 v8, s[44:47], s11 offen lds
  s_add_u32 m0, m0, 1024
  s_add_u32 s69, s69, 8192
  buffer_load_dwordx4 v9, s[44:47], s11 offen lds
  s_cmp_eq_u32 s69, 57344
  s_cselect_b32 s69, 0, s69
  s_add_u32 m0, s9, s69
  s_lshr_b32 s11, s69, 6
  buffer_load_dwordx4 v8, s[44:47], s11 offen lds
  s_add_u32 m0, m0, 1024
  s_add_u32 s69, s69, 8192
  buffer_load_dwordx4 v9, s[44:47], s11 offen lds
  s_cmp_eq_u32 s69, 57344
  s_cselect_b32 s69, 0, s69
  s_add_u32 m0, s9, s69
  s_lshr_b32 s11, s69, 6
  buffer_load_dwordx4 v8, s[44:47], s11 offen lds
  s_add_u32 m0, m0, 1024
  s_add_u32 s69, s69, 8192
  buffer_load_dwordx4 v9, s[44:47], s11 offen lds
  s_cmp_eq_u32 s69, 57344
  s_cselect_b32 s69, 0, s69
  s_add_u32 m0, s9, s69
  s_lshr_b32 s11, s69, 6
  buffer_load_dwordx4 v8, s[44:47], s11 offen lds
  s_add_u32 m0, m0, 1024
  s_add_u32 s69, s69, 8192
  buffer_load_dwordx4 v9, s[44:47], s11 offen lds
  s_cmp_eq_u32 s69, 57344
  s_cselect_b32 s69, 0, s69
  s_mov_b32 exec_lo, 0x7f7f7f7f
  s_mov_b32 exec_hi, 0x7f7f7f7f
  s_add_u32 m0, s10, s70
  s_mul_i32 s11, s70, 7
  buffer_load_dwordx4 v10, s[48:51], s11 offen lds
  s_add_u32 s70, s70, 4096
  s_cmp_eq_u32 s70, 57344
  s_cselect_b32 s70, 0, s70
  s_add_u32 m0, s10, s70
  s_mul_i32 s11, s70, 7
  buffer_load_dwordx4 v10, s[48:51], s11 offen lds
  s_add_u32 s70, s70, 4096
  s_cmp_eq_u32 s70, 57344
  s_cselect_b32 s70, 0, s70
  s_add_u32 m0, s10, s70
  s_mul_i32 s11, s70, 7
  buffer_load_dwordx4 v10, s[48:51], s11 offen lds
  s_add_u32 s70, s70, 4096
  s_cmp_eq_u32 s70, 57344
  s_cselect_b32 s70, 0, s70
  s_add_u32 m0, s10, s70
  s_mul_i32 s11, s70, 7
  buffer_load_dwordx4 v10, s[48:51], s11 offen lds
  s_add_u32 s70, s70, 4096
  s_cmp_eq_u32 s70, 57344
  s_cselect_b32 s70, 0, s70
  s_add_u32 m0, s10, s70
  s_mul_i32 s11, s70, 7
  buffer_load_dwordx4 v10, s[48:51], s11 offen lds
  s_add_u32 s70, s70, 4096
  s_cmp_eq_u32 s70, 57344
  s_cselect_b32 s70, 0, s70
  s_add_u32 m0, s10, s70
  s_mul_i32 s11, s70, 7
  buffer_load_dwordx4 v10, s[48:51], s11 offen lds
  s_add_u32 s70, s70, 4096
  s_cmp_eq_u32 s70, 57344
  s_cselect_b32 s70, 0, s70
  s_add_u32 m0, s10, s70
  s_mul_i32 s11, s70, 7
  buffer_load_dwordx4 v10, s[48:51], s11 offen lds
  s_add_u32 s70, s70, 4096
  s_cmp_eq_u32 s70, 57344
  s_cselect_b32 s70, 0, s70
  s_add_u32 m0, s10, s70
  s_mul_i32 s11, s70, 7
  buffer_load_dwordx4 v10, s[48:51], s11 offen lds
  s_add_u32 s70, s70, 4096
  s_cmp_eq_u32 s70, 57344
  s_cselect_b32 s70, 0, s70
  s_add_u32 m0, s10, s70
  s_mul_i32 s11, s70, 7
  buffer_load_dwordx4 v10, s[48:51], s11 offen lds
  s_add_u32 s70, s70, 4096
  s_cmp_eq_u32 s70, 57344
  s_cselect_b32 s70, 0, s70
  s_add_u32 m0, s10, s70
  s_mul_i32 s11, s70, 7
  buffer_load_dwordx4 v10, s[48:51], s11 offen lds
  s_add_u32 s70, s70, 4096
  s_cmp_eq_u32 s70, 57344
  s_cselect_b32 s70, 0, s70
  s_mov_b64 exec, -1
  s_cmp_ge_u32 s2, 64
  s_cbranch_scc1 p1a_kernel_e0
  s_sub_u32 s14, s15, 2621440
  s_lshr_b32 s14, s14, 4
  s_add_u32 s14, s14, 2359296
  buffer_store_dwordx4 v[56:59], v50, s[40:43], s14 offen offset:0 sc1
  s_cmp_gt_u32 s2, 1
  s_cbranch_scc1 p1a_kernel_e3
  s_and_b32 s6, s3, 1
  s_or_b32 s6, s6, s2
  s_sub_u32 s6, s6, 1
  v_mov_b32 v216, s6
  v_mov_b32 v217, s6
  v_mov_b32 v218, s6
  v_mov_b32 v219, s6
  s_lshl_b32 s6, s2, 2
  s_add_u32 s6, s6, s3
  s_lshl_b32 s6, s6, 11
  s_add_u32 s6, s6, 36343808
  buffer_store_dwordx4 v[216:219], v50, s[40:43], s6 offen sc1
  buffer_store_dwordx4 v[216:219], v50, s[40:43], s6 offen offset:1024 sc1
p1a_kernel_e3:
p1a_kernel_e0:
  s_getpc_b64 s[44:45]
p1a_kernel_pc2:
  s_add_u32 s44, s44, mm_kernel-p1a_kernel_pc2
  s_addc_u32 s45, s45, 0
  s_lshr_b32 s46, s2, 3
  s_mul_i32 s46, s46, 2560
  v_lshrrev_b32 v220, 6, v0
  v_mul_u32_u24 v220, 5, v220
  v_and_b32 v221, 63, v0
  v_add_u32 v220, v220, v221
  v_lshlrev_b32 v220, 7, v220
  v_sub_u32 v221, 4, v221
  v_and_b32 v221, 0x40000000, v221
  v_add3_u32 v220, v220, v221, s46
  s_and_b32 s45, s45, 0xffff
  s_mov_b32 s46, mm_kernel_end-mm_kernel
  s_mov_b32 s47, 0x20000
  s_add_u32 m0, s66, 0
  s_nop 0
  buffer_load_dwordx4 v13, s[56:59], s64 offen nt lds
  s_add_u32 s64, s64, s65
  s_add_u32 m0, s66, 1024
  s_nop 0
  buffer_load_dwordx4 v13, s[56:59], s64 offen nt lds
  s_add_u32 s64, s64, s65
  s_add_u32 m0, s66, 2048
  s_nop 0
  buffer_load_dwordx4 v13, s[56:59], s64 offen nt lds
  s_add_u32 s64, s64, s65
  s_add_u32 m0, s66, 3072
  s_nop 0
  buffer_load_dwordx4 v13, s[56:59], s64 offen nt lds
  s_add_u32 s64, s64, s65
  s_add_u32 m0, s66, 4096
  s_nop 0
  buffer_load_dwordx4 v13, s[56:59], s64 offen nt lds
  s_add_u32 s64, s64, s65
  s_add_u32 m0, s66, 5120
  s_nop 0
  buffer_load_dwordx4 v13, s[56:59], s64 offen nt lds
  s_add_u32 s64, s64, s65
  s_add_u32 m0, s66, 6144
  s_nop 0
  buffer_load_dwordx4 v13, s[56:59], s64 offen nt lds
  s_add_u32 s64, s64, s65
p1a_kernel_mk1b:
  buffer_load_dword v220, v220, s[44:47], 0 offen
  s_waitcnt vmcnt(28)
  ds_write_b128 v12, v[16:19]
  ds_write_b128 v12, v[20:23] offset:32768
  s_waitcnt vmcnt(18)
  ds_read_b128 v[128:131], v54 offset:0
  ds_read_b128 v[132:135], v61 offset:0
  ds_read_b128 v[136:139], v54 offset:8192
  ds_read_b128 v[140:143], v61 offset:8192
  ds_read_b128 v[144:147], v54 offset:16384
  ds_read_b128 v[148:151], v61 offset:16384
  ds_read_b128 v[152:155], v54 offset:24576
  ds_read_b128 v[156:159], v61 offset:24576
  ds_read_b128 v[160:163], v54 offset:32768
  ds_read_b128 v[164:167], v61 offset:32768
  ds_read_b128 v[168:171], v54 offset:40960
  ds_read_b128 v[172:175], v61 offset:40960
  ds_read_b128 v[176:179], v54 offset:49152
  ds_read_b128 v[180:183], v61 offset:49152
  s_waitcnt lgkmcnt(12)
  v_dot2_f32_bf16 v30, v128, s71, 0
  v_dot2_f32_bf16 v31, v128, v128, 0
  v_dot2_f32_bf16 v30, v129, s71, v30
  v_dot2_f32_bf16 v31, v129, v129, v31
  v_dot2_f32_bf16 v30, v130, s71, v30
  v_dot2_f32_bf16 v31, v130, v130, v31
  v_dot2_f32_bf16 v30, v131, s71, v30
  v_dot2_f32_bf16 v31, v131, v131, v31
  v_dot2_f32_bf16 v30, v132, s71, v30
  v_dot2_f32_bf16 v31, v132, v132, v31
  v_dot2_f32_bf16 v30, v133, s71, v30
  v_dot2_f32_bf16 v31, v133, v133, v31
  v_dot2_f32_bf16 v30, v134, s71, v30
  v_dot2_f32_bf16 v31, v134, v134, v31
  v_dot2_f32_bf16 v30, v135, s71, v30
  v_dot2_f32_bf16 v31, v135, v135, v31
  s_waitcnt lgkmcnt(10)
  v_dot2_f32_bf16 v30, v136, s71, v30
  v_dot2_f32_bf16 v31, v136, v136, v31
  v_dot2_f32_bf16 v30, v137, s71, v30
  v_dot2_f32_bf16 v31, v137, v137, v31
  v_dot2_f32_bf16 v30, v138, s71, v30
  v_dot2_f32_bf16 v31, v138, v138, v31
  v_dot2_f32_bf16 v30, v139, s71, v30
  v_dot2_f32_bf16 v31, v139, v139, v31
  v_dot2_f32_bf16 v30, v140, s71, v30
  v_dot2_f32_bf16 v31, v140, v140, v31
  v_dot2_f32_bf16 v30, v141, s71, v30
  v_dot2_f32_bf16 v31, v141, v141, v31
  v_dot2_f32_bf16 v30, v142, s71, v30
  v_dot2_f32_bf16 v31, v142, v142, v31
  v_dot2_f32_bf16 v30, v143, s71, v30
  v_dot2_f32_bf16 v31, v143, v143, v31
  s_waitcnt lgkmcnt(8)
  v_dot2_f32_bf16 v30, v144, s71, v30
  v_dot2_f32_bf16 v31, v144, v144, v31
  v_dot2_f32_bf16 v30, v145, s71, v30
  v_dot2_f32_bf16 v31, v145, v145, v31
  v_dot2_f32_bf16 v30, v146, s71, v30
  v_dot2_f32_bf16 v31, v146, v146, v31
  v_dot2_f32_bf16 v30, v147, s71, v30
  v_dot2_f32_bf16 v31, v147, v147, v31
  v_dot2_f32_bf16 v30, v148, s71, v30
  v_dot2_f32_bf16 v31, v148, v148, v31
  v_dot2_f32_bf16 v30, v149, s71, v30
  v_dot2_f32_bf16 v31, v149, v149, v31
  v_dot2_f32_bf16 v30, v150, s71, v30
  v_dot2_f32_bf16 v31, v150, v150, v31
  v_dot2_f32_bf16 v30, v151, s71, v30
  v_dot2_f32_bf16 v31, v151, v151, v31
  s_waitcnt lgkmcnt(6)
  v_dot2_f32_bf16 v30, v152, s71, v30
  v_dot2_f32_bf16 v31, v152, v152, v31
  v_dot2_f32_bf16 v30, v153, s71, v30
  v_dot2_f32_bf16 v31, v153, v153, v31
  v_dot2_f32_bf16 v30, v154, s71, v30
  v_dot2_f32_bf16 v31, v154, v154, v31
  v_dot2_f32_bf16 v30, v155, s71, v30
  v_dot2_f32_bf16 v31, v155, v155, v31
  v_dot2_f32_bf16 v30, v156, s71, v30
  v_dot2_f32_bf16 v31, v156, v156, v31
  v_dot2_f32_bf16 v30, v157, s71, v30
  v_dot2_f32_bf16 v31, v157, v157, v31
  v_dot2_f32_bf16 v30, v158, s71, v30
  v_dot2_f32_bf16 v31, v158, v158, v31
  v_dot2_f32_bf16 v30, v159, s71, v30
  v_dot2_f32_bf16 v31, v159, v159, v31
  s_waitcnt lgkmcnt(4)
  v_dot2_f32_bf16 v30, v160, s71, v30
  v_dot2_f32_bf16 v31, v160, v160, v31
  v_dot2_f32_bf16 v30, v161, s71, v30
  v_dot2_f32_bf16 v31, v161, v161, v31
  v_dot2_f32_bf16 v30, v162, s71, v30
  v_dot2_f32_bf16 v31, v162, v162, v31
  v_dot2_f32_bf16 v30, v163, s71, v30
  v_dot2_f32_bf16 v31, v163, v163, v31
  v_dot2_f32_bf16 v30, v164, s71, v30
  v_dot2_f32_bf16 v31, v164, v164, v31
  v_dot2_f32_bf16 v30, v165, s71, v30
  v_dot2_f32_bf16 v31, v165, v165, v31
  v_dot2_f32_bf16 v30, v166, s71, v30
  v_dot2_f32_bf16 v31, v166, v166, v31
  v_dot2_f32_bf16 v30, v167, s71, v30
  v_dot2_f32_bf16 v31, v167, v167, v31
  s_waitcnt vmcnt(8)
  s_waitcnt lgkmcnt(0)
  s_barrier
  ds_read_b64_tr_b16 v[96:97], v28 offset:0
  ds_read_b64_tr_b16 v[98:99], v28 offset:512
  ds_read_b128 v[100:103], v24 offset:0
  ds_read_b64_tr_b16 v[104:105], v28 offset:2048
  ds_read_b64_tr_b16 v[106:107], v28 offset:2560
  ds_read_b128 v[108:111], v25 offset:0
  ds_read_b64_tr_b16 v[112:113], v28 offset:4096
  ds_read_b64_tr_b16 v[114:115], v28 offset:4608
  ds_read_b128 v[116:119], v26 offset:0
  s_waitcnt lgkmcnt(6)
  v_mfma_f32_32x32x16_bf16 v[64:79], v[96:99], v[100:103], 0
  ds_read_b64_tr_b16 v[120:121], v28 offset:6144
  ds_read_b64_tr_b16 v[122:123], v28 offset:6656
  v_lshlrev_b32 v40, 16, v168
  v_and_b32 v41, s32, v168
  v_add_f32 v30, v30, v40
  v_fmac_f32 v31, v40, v40
  v_mfma_f32_32x32x16_bf16 v[80:95], v[96:99], v[32:35], 0
  ds_read_b128 v[124:127], v27 offset:0
  v_add_f32 v30, v30, v41
  v_fmac_f32 v31, v41, v41
  v_lshlrev_b32 v42, 16, v169
  v_and_b32 v43, s32, v169
  s_waitcnt lgkmcnt(6)
  v_mfma_f32_32x32x16_bf16 v[64:79], v[104:107], v[108:111], v[64:79]
  ds_read_b64_tr_b16 v[96:97], v28 offset:8192
  ds_read_b64_tr_b16 v[98:99], v28 offset:8704
  v_add_f32 v30, v30, v42
  v_fmac_f32 v31, v42, v42
  v_add_f32 v30, v30, v43
  v_fmac_f32 v31, v43, v43
  v_mfma_f32_32x32x16_bf16 v[80:95], v[104:107], v[32:35], v[80:95]
  ds_read_b128 v[100:103], v24 offset:8192
  v_lshlrev_b32 v40, 16, v170
  v_and_b32 v41, s32, v170
  v_add_f32 v30, v30, v40
  v_fmac_f32 v31, v40, v40
  s_waitcnt lgkmcnt(6)
  v_mfma_f32_32x32x16_bf16 v[64:79], v[112:115], v[116:119], v[64:79]
  ds_read_b64_tr_b16 v[104:105], v28 offset:10240
  ds_read_b64_tr_b16 v[106:107], v28 offset:10752
  v_add_f32 v30, v30, v41
  v_fmac_f32 v31, v41, v41
  v_lshlrev_b32 v42, 16, v171
  v_and_b32 v43, s32, v171
  v_mfma_f32_32x32x16_bf16 v[80:95], v[112:115], v[32:35], v[80:95]
  ds_read_b128 v[108:111], v25 offset:8192
  v_add_f32 v30, v30, v42
  v_fmac_f32 v31, v42, v42
  v_add_f32 v30, v30, v43
  v_fmac_f32 v31, v43, v43
  s_waitcnt lgkmcnt(6)
  v_mfma_f32_32x32x16_bf16 v[64:79], v[120:123], v[124:127], v[64:79]
  ds_read_b64_tr_b16 v[112:113], v28 offset:12288
  ds_read_b64_tr_b16 v[114:115], v28 offset:12800
  v_lshlrev_b32 v40, 16, v172
  v_and_b32 v41, s32, v172
  v_add_f32 v30, v30, v40
  v_fmac_f32 v31, v40, v40
  v_mfma_f32_32x32x16_bf16 v[80:95], v[120:123], v[32:35], v[80:95]
  ds_read_b128 v[116:119], v26 offset:8192
  v_add_f32 v30, v30, v41
  v_fmac_f32 v31, v41, v41
  v_lshlrev_b32 v42, 16, v173
  v_and_b32 v43, s32, v173
  s_waitcnt lgkmcnt(6)
  v_mfma_f32_32x32x16_bf16 v[64:79], v[96:99], v[100:103], v[64:79]
  ds_read_b64_tr_b16 v[120:121], v28 offset:14336
  ds_read_b64_tr_b16 v[122:123], v28 offset:14848
  v_add_f32 v30, v30, v42
  v_fmac_f32 v31, v42, v42
  v_add_f32 v30, v30, v43
  v_fmac_f32 v31, v43, v43
  v_mfma_f32_32x32x16_bf16 v[80:95], v[96:99], v[32:35], v[80:95]
  ds_read_b128 v[124:127], v27 offset:8192
  v_lshlrev_b32 v40, 16, v174
  v_and_b32 v41, s32, v174
  v_add_f32 v30, v30, v40
  v_fmac_f32 v31, v40, v40
  s_waitcnt lgkmcnt(6)
  v_mfma_f32_32x32x16_bf16 v[64:79], v[104:107], v[108:111], v[64:79]
  ds_read_b64_tr_b16 v[96:97], v28 offset:16384
  ds_read_b64_tr_b16 v[98:99], v28 offset:16896
  v_add_f32 v30, v30, v41
  v_fmac_f32 v31, v41, v41
  v_lshlrev_b32 v42, 16, v175
  v_and_b32 v43, s32, v175
  v_mfma_f32_32x32x16_bf16 v[80:95], v[104:107], v[32:35], v[80:95]
  ds_read_b128 v[100:103], v24 offset:16384
  v_add_f32 v30, v30, v42
  v_fmac_f32 v31, v42, v42
  v_add_f32 v30, v30, v43
  v_fmac_f32 v31, v43, v43
  s_waitcnt lgkmcnt(6)
  v_mfma_f32_32x32x16_bf16 v[64:79], v[112:115], v[116:119], v[64:79]
  ds_read_b64_tr_b16 v[104:105], v28 offset:18432
  ds_read_b64_tr_b16 v[106:107], v28 offset:18944
  v_lshlrev_b32 v40, 16, v176
  v_and_b32 v41, s32, v176
  v_add_f32 v30, v30, v40
  v_mfma_f32_32x32x16_bf16 v[80:95], v[112:115], v[32:35], v[80:95]
  ds_read_b128 v[108:111], v25 offset:16384
  v_fmac_f32 v31, v40, v40
  v_add_f32 v30, v30, v41
  v_fmac_f32 v31, v41, v41
  s_waitcnt lgkmcnt(6)
  v_mfma_f32_32x32x16_bf16 v[64:79], v[120:123], v[124:127], v[64:79]
  ds_read_b64_tr_b16 v[112:113], v28 offset:20480
  ds_read_b64_tr_b16 v[114:115], v28 offset:20992
  v_lshlrev_b32 v42, 16, v177
  v_and_b32 v43, s32, v177
  v_add_f32 v30, v30, v42
  v_mfma_f32_32x32x16_bf16 v[80:95], v[120:123], v[32:35], v[80:95]
  ds_read_b128 v[116:119], v26 offset:16384
  v_fmac_f32 v31, v42, v42
  v_add_f32 v30, v30, v43
  v_fmac_f32 v31, v43, v43
  s_waitcnt lgkmcnt(6)
  v_mfma_f32_32x32x16_bf16 v[64:79], v[96:99], v[100:103], v[64:79]
  ds_read_b64_tr_b16 v[120:121], v28 offset:22528
  ds_read_b64_tr_b16 v[122:123], v28 offset:23040
  v_lshlrev_b32 v40, 16, v178
  v_and_b32 v41, s32, v178
  v_add_f32 v30, v30, v40
  v_mfma_f32_32x32x16_bf16 v[80:95], v[96:99], v[32:35], v[80:95]
  ds_read_b128 v[124:127], v27 offset:16384
  v_fmac_f32 v31, v40, v40
  v_add_f32 v30, v30, v41
  v_fmac_f32 v31, v41, v41
  s_waitcnt lgkmcnt(6)
  v_mfma_f32_32x32x16_bf16 v[64:79], v[104:107], v[108:111], v[64:79]
  ds_read_b64_tr_b16 v[96:97], v28 offset:24576
  ds_read_b64_tr_b16 v[98:99], v28 offset:25088
  v_lshlrev_b32 v42, 16, v179
  v_and_b32 v43, s32, v179
  v_add_f32 v30, v30, v42
  v_mfma_f32_32x32x16_bf16 v[80:95], v[104:107], v[32:35], v[80:95]
  ds_read_b128 v[100:103], v24 offset:24576
  v_fmac_f32 v31, v42, v42
  v_add_f32 v30, v30, v43
  v_fmac_f32 v31, v43, v43
  s_waitcnt lgkmcnt(6)
  v_mfma_f32_32x32x16_bf16 v[64:79], v[112:115], v[116:119], v[64:79]
  ds_read_b64_tr_b16 v[104:105], v28 offset:26624
  ds_read_b64_tr_b16 v[106:107], v28 offset:27136
  v_lshlrev_b32 v40, 16, v180
  v_and_b32 v41, s32, v180
  v_add_f32 v30, v30, v40
  v_mfma_f32_32x32x16_bf16 v[80:95], v[112:115], v[32:35], v[80:95]
  ds_read_b128 v[108:111], v25 offset:24576
  v_fmac_f32 v31, v40, v40
  v_add_f32 v30, v30, v41
  v_fmac_f32 v31, v41, v41
  s_waitcnt lgkmcnt(6)
  v_mfma_f32_32x32x16_bf16 v[64:79], v[120:123], v[124:127], v[64:79]
  ds_read_b64_tr_b16 v[112:113], v28 offset:28672
  ds_read_b64_tr_b16 v[114:115], v28 offset:29184
  v_lshlrev_b32 v42, 16, v181
  v_and_b32 v43, s32, v181
  v_add_f32 v30, v30, v42
  v_mfma_f32_32x32x16_bf16 v[80:95], v[120:123], v[32:35], v[80:95]
  ds_read_b128 v[116:119], v26 offset:24576
  v_fmac_f32 v31, v42, v42
  v_add_f32 v30, v30, v43
  v_fmac_f32 v31, v43, v43
  s_waitcnt lgkmcnt(6)
  v_mfma_f32_32x32x16_bf16 v[64:79], v[96:99], v[100:103], v[64:79]
  ds_read_b64_tr_b16 v[120:121], v28 offset:30720
  ds_read_b64_tr_b16 v[122:123], v28 offset:31232
  v_lshlrev_b32 v40, 16, v182
  v_and_b32 v41, s32, v182
  v_add_f32 v30, v30, v40
  v_mfma_f32_32x32x16_bf16 v[80:95], v[96:99], v[32:35], v[80:95]
  ds_read_b128 v[124:127], v27 offset:24576
  v_fmac_f32 v31, v40, v40
  v_add_f32 v30, v30, v41
  v_fmac_f32 v31, v41, v41
  s_waitcnt lgkmcnt(6)
  v_mfma_f32_32x32x16_bf16 v[64:79], v[104:107], v[108:111], v[64:79]
  ds_read_b64_tr_b16 v[96:97], v28 offset:32768
  ds_read_b64_tr_b16 v[98:99], v28 offset:33280
  v_lshlrev_b32 v42, 16, v183
  v_and_b32 v43, s32, v183
  v_add_f32 v30, v30, v42
  v_mfma_f32_32x32x16_bf16 v[80:95], v[104:107], v[32:35], v[80:95]
  ds_read_b128 v[100:103], v24 offset:32768
  v_fmac_f32 v31, v42, v42
  v_add_f32 v30, v30, v43
  v_fmac_f32 v31, v43, v43
  s_waitcnt lgkmcnt(6)
  v_mfma_f32_32x32x16_bf16 v[64:79], v[112:115], v[116:119], v[64:79]
  ds_read_b64_tr_b16 v[104:105], v28 offset:34816
  ds_read_b64_tr_b16 v[106:107], v28 offset:35328
  v_mov_b32 v36, v30
  v_mov_b32 v37, v31
  v_mfma_f32_32x32x16_bf16 v[80:95], v[112:115], v[32:35], v[80:95]
  ds_read_b128 v[108:111], v25 offset:32768
  v_permlane32_swap_b32 v30, v36
  v_permlane32_swap_b32 v31, v37
  v_add_f32 v30, v30, v36
  s_waitcnt lgkmcnt(6)
  v_mfma_f32_32x32x16_bf16 v[64:79], v[120:123], v[124:127], v[64:79]
  ds_read_b64_tr_b16 v[112:113], v28 offset:36864
  ds_read_b64_tr_b16 v[114:115], v28 offset:37376
  v_add_f32 v31, v31, v37
  v_mov_b32 v36, v30
  v_mfma_f32_32x32x16_bf16 v[80:95], v[120:123], v[32:35], v[80:95]
  ds_read_b128 v[116:119], v26 offset:32768
  v_mov_b32 v37, v31
  s_cmp_eq_u32 s63, 3
  s_cbranch_scc1 p1a_kernel_np
  s_waitcnt vmcnt(1)
p1a_kernel_np:
  s_barrier
  s_cmp_eq_u32 s63, 2
  s_cbranch_scc1 p1a_kernel_t2
  s_waitcnt lgkmcnt(6)
  v_mfma_f32_32x32x16_bf16 v[64:79], v[96:99], v[100:103], v[64:79]
  ds_read_b64_tr_b16 v[120:121], v28 offset:38912
  ds_read_b64_tr_b16 v[122:123], v28 offset:39424
  ds_read_b128 v[124:127], v27 offset:32768
  ds_read_b64_tr_b16 v[184:185], v60 offset:0
  v_permlane16_swap_b32 v30, v36
  v_permlane16_swap_b32 v31, v37
  v_mfma_f32_32x32x16_bf16 v[80:95], v[96:99], v[32:35], v[80:95]
  ds_read_b64_tr_b16 v[186:187], v60 offset:1024
  ds_read_b64_tr_b16 v[188:189], v60 offset:2048
  ds_read_b64_tr_b16 v[190:191], v60 offset:3072
  v_add_f32 v30, v30, v36
  v_add_f32 v31, v31, v37
  s_waitcnt lgkmcnt(10)
  v_mfma_f32_32x32x16_bf16 v[64:79], v[104:107], v[108:111], v[64:79]
  ds_read_b64_tr_b16 v[96:97], v28 offset:40960
  ds_read_b64_tr_b16 v[98:99], v28 offset:41472
  ds_read_b128 v[100:103], v24 offset:40960
  ds_read_b64_tr_b16 v[192:193], v60 offset:4096
  v_mul_f32 v30, 0x3b124925, v30
  v_mul_f32 v31, 0x3b124925, v31
  v_mfma_f32_32x32x16_bf16 v[80:95], v[104:107], v[32:35], v[80:95]
  ds_read_b64_tr_b16 v[194:195], v60 offset:5120
  ds_read_b64_tr_b16 v[196:197], v60 offset:6144
  ds_read_b64_tr_b16 v[198:199], v60 offset:7168
  v_fma_f32 v31, -v30, v30, v31
  v_max_f32 v31, 0, v31
  s_waitcnt lgkmcnt(14)
  v_mfma_f32_32x32x16_bf16 v[64:79], v[112:115], v[116:119], v[64:79]
  ds_read_b64_tr_b16 v[104:105], v28 offset:43008
  ds_read_b64_tr_b16 v[106:107], v28 offset:43520
  ds_read_b128 v[108:111], v25 offset:40960
  ds_read_b64_tr_b16 v[200:201], v60 offset:8192
  v_add_f32 v31, 0x3727c5ac, v31
  v_mfma_f32_32x32x16_bf16 v[80:95], v[112:115], v[32:35], v[80:95]
  ds_read_b64_tr_b16 v[202:203], v60 offset:9216
  ds_read_b64_tr_b16 v[204:205], v60 offset:10240
  ds_read_b64_tr_b16 v[206:207], v60 offset:11264
  s_waitcnt lgkmcnt(15)
  buffer_store_dwordx4 v[184:187], v50, s[24:27], s16 offen sc1
  v_rsq_f32 v31, v31
  v_mfma_f32_32x32x16_bf16 v[64:79], v[120:123], v[124:127], v[64:79]
  ds_read_b64_tr_b16 v[112:113], v28 offset:45056
  ds_read_b64_tr_b16 v[114:115], v28 offset:45568
  ds_read_b128 v[116:119], v26 offset:40960
  v_mfma_f32_32x32x16_bf16 v[80:95], v[120:123], v[32:35], v[80:95]
  ds_read_b64_tr_b16 v[208:209], v60 offset:12288
  ds_read_b64_tr_b16 v[210:211], v60 offset:13312
  s_waitcnt lgkmcnt(15)
  buffer_store_dwordx4 v[188:191], v50, s[24:27], s17 offen sc1
  ds_write_b64 v55, v[30:31]
  s_waitcnt lgkmcnt(15)
  v_mfma_f32_32x32x16_bf16 v[64:79], v[96:99], v[100:103], v[64:79]
  ds_read_b64_tr_b16 v[120:121], v28 offset:47104
  ds_read_b64_tr_b16 v[122:123], v28 offset:47616
  v_mfma_f32_32x32x16_bf16 v[80:95], v[96:99], v[32:35], v[80:95]
  ds_read_b128 v[124:127], v27 offset:40960
  s_waitcnt lgkmcnt(15)
  buffer_store_dwordx4 v[192:195], v50, s[24:27], s18 offen sc1
  s_waitcnt lgkmcnt(13)
  v_mfma_f32_32x32x16_bf16 v[64:79], v[104:107], v[108:111], v[64:79]
  ds_read_b64_tr_b16 v[96:97], v28 offset:49152
  ds_read_b64_tr_b16 v[98:99], v28 offset:49664
  v_mfma_f32_32x32x16_bf16 v[80:95], v[104:107], v[32:35], v[80:95]
  ds_read_b128 v[100:103], v24 offset:49152
  buffer_store_dwordx4 v[196:199], v50, s[24:27], s19 offen sc1
  s_waitcnt lgkmcnt(9)
  v_mfma_f32_32x32x16_bf16 v[64:79], v[112:115], v[116:119], v[64:79]
  ds_read_b64_tr_b16 v[104:105], v28 offset:51200
  ds_read_b64_tr_b16 v[106:107], v28 offset:51712
  v_mfma_f32_32x32x16_bf16 v[80:95], v[112:115], v[32:35], v[80:95]
  ds_read_b128 v[108:111], v25 offset:49152
  buffer_store_dwordx4 v[200:203], v50, s[24:27], s20 offen sc1
  s_waitcnt lgkmcnt(10)
  s_cmp_lg_u32 s63, 0
  s_nop 9
  s_cbranch_scc1 p1a_kernel_nc
  v_dot2_f32_bf16 v16, v184, s71, 0
  v_dot2_f32_bf16 v17, v185, s71, 0
  v_dot2_f32_bf16 v16, v186, s71, v16
  v_dot2_f32_bf16 v17, v187, s71, v17
  v_dot2_f32_bf16 v16, v188, s71, v16
  v_dot2_f32_bf16 v17, v189, s71, v17
  v_dot2_f32_bf16 v16, v190, s71, v16
  v_dot2_f32_bf16 v17, v191, s71, v17
  v_dot2_f32_bf16 v16, v192, s71, v16
  v_dot2_f32_bf16 v17, v193, s71, v17
  v_dot2_f32_bf16 v16, v194, s71, v16
  v_dot2_f32_bf16 v17, v195, s71, v17
  v_dot2_f32_bf16 v16, v196, s71, v16
  v_dot2_f32_bf16 v17, v197, s71, v17
  v_dot2_f32_bf16 v16, v198, s71, v16
  v_dot2_f32_bf16 v17, v199, s71, v17
  v_dot2_f32_bf16 v16, v200, s71, v16
  v_dot2_f32_bf16 v17, v201, s71, v17
  v_dot2_f32_bf16 v16, v202, s71, v16
  v_dot2_f32_bf16 v17, v203, s71, v17
  v_dot2_f32_bf16 v16, v204, s71, v16
  v_dot2_f32_bf16 v17, v205, s71, v17
  v_dot2_f32_bf16 v16, v206, s71, v16
  v_dot2_f32_bf16 v17, v207, s71, v17
  v_dot2_f32_bf16 v16, v208, s71, v16
  v_dot2_f32_bf16 v17, v209, s71, v17
  v_dot2_f32_bf16 v16, v210, s71, v16
  v_dot2_f32_bf16 v17, v211, s71, v17
  s_nop 2
  v_add_f32 v16, v16, v17
  v_mov_b32 v17, v16
  s_nop 1
  v_permlane32_swap_b32 v16, v17
  v_add_f32 v16, v16, v17
  v_cvt_pk_bf16_f32 v17, v16, v16
  v_lshlrev_b32 v17, 16, v17
  v_sub_f32 v17, v16, v17
  v_cvt_pk_bf16_f32 v16, v16, v17
  v_lshlrev_b32 v17, 2, v1
  buffer_store_dword v16, v17, s[24:27], s23 offen sc1
p1a_kernel_nc:
  s_waitcnt lgkmcnt(6)
  v_mfma_f32_32x32x16_bf16 v[64:79], v[120:123], v[124:127], v[64:79]
  ds_read_b64_tr_b16 v[112:113], v28 offset:53248
  ds_read_b64_tr_b16 v[114:115], v28 offset:53760
  v_mfma_f32_32x32x16_bf16 v[80:95], v[120:123], v[32:35], v[80:95]
  ds_read_b128 v[116:119], v26 offset:49152
  buffer_store_dwordx4 v[204:207], v50, s[24:27], s21 offen sc1
  s_waitcnt lgkmcnt(6)
  v_mfma_f32_32x32x16_bf16 v[64:79], v[96:99], v[100:103], v[64:79]
  ds_read_b64_tr_b16 v[120:121], v28 offset:55296
  ds_read_b64_tr_b16 v[122:123], v28 offset:55808
  v_mfma_f32_32x32x16_bf16 v[80:95], v[96:99], v[32:35], v[80:95]
  ds_read_b128 v[124:127], v27 offset:49152
  buffer_store_dwordx4 v[208:211], v50, s[24:27], s22 offen sc1
  s_waitcnt lgkmcnt(6)
  v_mfma_f32_32x32x16_bf16 v[64:79], v[104:107], v[108:111], v[64:79]
  v_mfma_f32_32x32x16_bf16 v[80:95], v[104:107], v[32:35], v[80:95]
  s_barrier
  s_waitcnt lgkmcnt(3)
  v_mfma_f32_32x32x16_bf16 v[64:79], v[112:115], v[116:119], v[64:79]
  ds_read_b64 v[30:31], v53
  v_mfma_f32_32x32x16_bf16 v[80:95], v[112:115], v[32:35], v[80:95]
  s_waitcnt lgkmcnt(1)
  v_mfma_f32_32x32x16_bf16 v[64:79], v[120:123], v[124:127], v[64:79]
  v_mfma_f32_32x32x16_bf16 v[80:95], v[120:123], v[32:35], v[80:95]
  s_waitcnt lgkmcnt(0)
  v_mul_f32 v36, 0x3e8b97f6, v31
  v_cmp_eq_u32 vcc, 1, v3
  v_sub_f32 v30, 0, v30
  s_nop 0
  v_cndmask_b32 v37, v36, v31, vcc
  s_nop 5
  v_fmac_f32 v64, v30, v80
  v_fmac_f32 v65, v30, v81
  v_fmac_f32 v66, v30, v82
  v_fmac_f32 v67, v30, v83
  v_fmac_f32 v68, v30, v84
  v_fmac_f32 v69, v30, v85
  v_fmac_f32 v70, v30, v86
  v_fmac_f32 v71, v30, v87
  v_fmac_f32 v72, v30, v88
  v_fmac_f32 v73, v30, v89
  v_fmac_f32 v74, v30, v90
  v_fmac_f32 v75, v30, v91
  v_fmac_f32 v76, v30, v92
  v_fmac_f32 v77, v30, v93
  v_fmac_f32 v78, v30, v94
  v_fmac_f32 v79, v30, v95
  v_mul_f32 v64, v36, v64
  v_mul_f32 v65, v36, v65
  v_mul_f32 v66, v36, v66
  v_mul_f32 v67, v36, v67
  v_mul_f32 v68, v36, v68
  v_mul_f32 v69, v36, v69
  v_mul_f32 v70, v36, v70
  v_mul_f32 v71, v36, v71
  v_mul_f32 v72, v36, v72
  v_mul_f32 v73, v36, v73
  v_mul_f32 v74, v36, v74
  v_mul_f32 v75, v36, v75
  v_mul_f32 v76, v37, v76
  v_mul_f32 v77, v37, v77
  v_mul_f32 v78, v37, v78
  v_mul_f32 v79, v37, v79
  v_cvt_pk_bf16_f32 v40, v64, v65
  v_cvt_pk_bf16_f32 v41, v66, v67
  v_cvt_pk_bf16_f32 v42, v68, v69
  v_cvt_pk_bf16_f32 v43, v70, v71
  v_cvt_pk_bf16_f32 v44, v72, v73
  v_cvt_pk_bf16_f32 v45, v74, v75
  v_cvt_pk_bf16_f32 v46, v76, v77
  v_cvt_pk_bf16_f32 v47, v78, v79
  buffer_store_dwordx4 v[40:43], v50, s[40:43], s60 offen
  buffer_store_dwordx4 v[44:47], v50, s[40:43], s60 offen offset:1024
  s_and_b32 s10, s62, 7
  v_mov_b32 v48, v46
  v_mov_b32 v49, v47
  s_mov_b32 exec_lo, 0
  s_cmp_lg_u32 s10, 7
  s_cbranch_scc1 p1a_kernel_kv1
  s_cmp_ge_u32 s62, 8
  s_cselect_b32 s10, 0x3f80, 0
  v_mov_b32 v48, s10
  v_mov_b32 v49, 0
p1a_kernel_kv1:
  s_cmp_ge_u32 s62, 8
  s_cbranch_scc1 p1a_kernel_v
  buffer_store_dwordx2 v[48:49], v51, s[40:43], s61 offen
  s_branch p1a_kernel_kvd
p1a_kernel_v:
  buffer_store_short v48, v51, s[40:43], s61 offen
  buffer_store_short_d16_hi v48, v51, s[40:43], s61 offen offset:16
  buffer_store_short v49, v51, s[40:43], s61 offen offset:32
  buffer_store_short_d16_hi v49, v51, s[40:43], s61 offen offset:48
p1a_kernel_kvd:
  s_mov_b64 exec, -1
  s_lshr_b32 s6, s2, 6
  s_cmp_lg_u32 s6, 0
  s_cbranch_scc1 p1a_kernel_fin
  s_lshl_b32 s6, s62, 7
  s_add_u32 s6, s6, 33456128
  v_lshlrev_b32 v13, 4, v3
  buffer_store_dwordx4 v[80:83], v13, s[24:27], s6 offen offset:0
  buffer_store_dwordx4 v[84:87], v13, s[24:27], s6 offen offset:32
  buffer_store_dwordx4 v[88:91], v13, s[24:27], s6 offen offset:64
  buffer_store_dwordx4 v[92:95], v13, s[24:27], s6 offen offset:96
p1a_kernel_fin:
  s_endpgm
p1a_kernel_t2:
  s_mov_b32 vcc_lo, -1
  s_mov_b32 vcc_hi, 0
  s_waitcnt lgkmcnt(6)
  v_mfma_f32_32x32x16_bf16 v[64:79], v[96:99], v[100:103], v[64:79]
  ds_read_b64_tr_b16 v[120:121], v28 offset:38912
  ds_read_b64_tr_b16 v[122:123], v28 offset:39424
  ds_read_b128 v[124:127], v27 offset:32768
  ds_read_b64_tr_b16 v[184:185], v60 offset:0
  v_permlane16_swap_b32 v30, v36
  v_permlane16_swap_b32 v31, v37
  v_mfma_f32_32x32x16_bf16 v[80:95], v[96:99], v[32:35], v[80:95]
  ds_read_b64_tr_b16 v[186:187], v60 offset:1024
  ds_read_b64_tr_b16 v[188:189], v60 offset:2048
  ds_read_b64_tr_b16 v[190:191], v60 offset:3072
  v_add_f32 v30, v30, v36
  v_add_f32 v31, v31, v37
  s_waitcnt lgkmcnt(10)
  v_mfma_f32_32x32x16_bf16 v[64:79], v[104:107], v[108:111], v[64:79]
  ds_read_b64_tr_b16 v[96:97], v28 offset:40960
  ds_read_b64_tr_b16 v[98:99], v28 offset:41472
  ds_read_b128 v[100:103], v24 offset:40960
  ds_read_b64_tr_b16 v[192:193], v60 offset:3584
  v_mul_f32 v30, 0x3b124925, v30
  v_mul_f32 v31, 0x3b124925, v31
  v_mfma_f32_32x32x16_bf16 v[80:95], v[104:107], v[32:35], v[80:95]
  ds_read_b64_tr_b16 v[194:195], v60 offset:4608
  ds_read_b64_tr_b16 v[196:197], v60 offset:5632
  ds_read_b64_tr_b16 v[198:199], v60 offset:6656
  v_fma_f32 v31, -v30, v30, v31
  v_max_f32 v31, 0, v31
  s_waitcnt lgkmcnt(14)
  v_mfma_f32_32x32x16_bf16 v[64:79], v[112:115], v[116:119], v[64:79]
  ds_read_b64_tr_b16 v[104:105], v28 offset:43008
  ds_read_b64_tr_b16 v[106:107], v28 offset:43520
  ds_read_b128 v[108:111], v25 offset:40960
  ds_read_b64_tr_b16 v[200:201], v60 offset:7168
  v_add_f32 v31, 0x3727c5ac, v31
  v_mfma_f32_32x32x16_bf16 v[80:95], v[112:115], v[32:35], v[80:95]
  ds_read_b64_tr_b16 v[202:203], v60 offset:8192
  ds_read_b64_tr_b16 v[204:205], v60 offset:9216
  ds_read_b64_tr_b16 v[206:207], v60 offset:10240
  s_waitcnt lgkmcnt(15)
  buffer_store_dwordx4 v[184:187], v50, s[24:27], s16 offen sc1
  v_rsq_f32 v31, v31
  v_mfma_f32_32x32x16_bf16 v[64:79], v[120:123], v[124:127], v[64:79]
  ds_read_b64_tr_b16 v[112:113], v28 offset:45056
  ds_read_b64_tr_b16 v[114:115], v28 offset:45568
  ds_read_b128 v[116:119], v26 offset:40960
  ds_read_b64_tr_b16 v[208:209], v60 offset:10752
  v_mfma_f32_32x32x16_bf16 v[80:95], v[120:123], v[32:35], v[80:95]
  ds_read_b64_tr_b16 v[210:211], v60 offset:11776
  ds_read_b64_tr_b16 v[212:213], v60 offset:12800
  ds_read_b64_tr_b16 v[214:215], v60 offset:13824
  s_waitcnt lgkmcnt(15)
  v_cndmask_b32 v190, 0, v190, vcc
  v_cndmask_b32 v191, 0, v191, vcc
  buffer_store_dwordx4 v[188:191], v50, s[24:27], s17 offen sc1
  ds_write_b64 v55, v[30:31]
  s_waitcnt lgkmcnt(15)
  v_mfma_f32_32x32x16_bf16 v[64:79], v[96:99], v[100:103], v[64:79]
  ds_read_b64_tr_b16 v[120:121], v28 offset:47104
  ds_read_b64_tr_b16 v[122:123], v28 offset:47616
  v_mfma_f32_32x32x16_bf16 v[80:95], v[96:99], v[32:35], v[80:95]
  ds_read_b128 v[124:127], v27 offset:40960
  s_waitcnt lgkmcnt(15)
  buffer_store_dwordx4 v[192:195], v50, s[24:27], s18 offen sc1
  s_waitcnt lgkmcnt(15)
  v_mfma_f32_32x32x16_bf16 v[64:79], v[104:107], v[108:111], v[64:79]
  ds_read_b64_tr_b16 v[96:97], v28 offset:49152
  ds_read_b64_tr_b16 v[98:99], v28 offset:49664
  v_mfma_f32_32x32x16_bf16 v[80:95], v[104:107], v[32:35], v[80:95]
  ds_read_b128 v[100:103], v24 offset:49152
  v_cndmask_b32 v198, 0, v198, vcc
  v_cndmask_b32 v199, 0, v199, vcc
  buffer_store_dwordx4 v[196:199], v50, s[24:27], s19 offen sc1
  s_waitcnt lgkmcnt(11)
  v_mfma_f32_32x32x16_bf16 v[64:79], v[112:115], v[116:119], v[64:79]
  ds_read_b64_tr_b16 v[104:105], v28 offset:51200
  ds_read_b64_tr_b16 v[106:107], v28 offset:51712
  v_mfma_f32_32x32x16_bf16 v[80:95], v[112:115], v[32:35], v[80:95]
  ds_read_b128 v[108:111], v25 offset:49152
  buffer_store_dwordx4 v[200:203], v50, s[24:27], s20 offen sc1
  s_waitcnt lgkmcnt(6)
  v_mfma_f32_32x32x16_bf16 v[64:79], v[120:123], v[124:127], v[64:79]
  ds_read_b64_tr_b16 v[112:113], v28 offset:53248
  ds_read_b64_tr_b16 v[114:115], v28 offset:53760
  v_mfma_f32_32x32x16_bf16 v[80:95], v[120:123], v[32:35], v[80:95]
  ds_read_b128 v[116:119], v26 offset:49152
  v_cndmask_b32 v206, 0, v206, vcc
  v_cndmask_b32 v207, 0, v207, vcc
  buffer_store_dwordx4 v[204:207], v50, s[24:27], s21 offen sc1
  s_waitcnt lgkmcnt(6)
  v_mfma_f32_32x32x16_bf16 v[64:79], v[96:99], v[100:103], v[64:79]
  ds_read_b64_tr_b16 v[120:121], v28 offset:55296
  ds_read_b64_tr_b16 v[122:123], v28 offset:55808
  v_mfma_f32_32x32x16_bf16 v[80:95], v[96:99], v[32:35], v[80:95]
  ds_read_b128 v[124:127], v27 offset:49152
  buffer_store_dwordx4 v[208:211], v50, s[24:27], s22 offen sc1
  s_waitcnt lgkmcnt(6)
  v_mfma_f32_32x32x16_bf16 v[64:79], v[104:107], v[108:111], v[64:79]
  v_mfma_f32_32x32x16_bf16 v[80:95], v[104:107], v[32:35], v[80:95]
  v_cndmask_b32 v214, 0, v214, vcc
  v_cndmask_b32 v215, 0, v215, vcc
  buffer_store_dwordx4 v[212:215], v50, s[24:27], s23 offen sc1
  s_barrier
  s_waitcnt lgkmcnt(3)
  v_mfma_f32_32x32x16_bf16 v[64:79], v[112:115], v[116:119], v[64:79]
  ds_read_b64 v[30:31], v53
  v_mfma_f32_32x32x16_bf16 v[80:95], v[112:115], v[32:35], v[80:95]
  s_waitcnt lgkmcnt(1)
  v_mfma_f32_32x32x16_bf16 v[64:79], v[120:123], v[124:127], v[64:79]
  v_mfma_f32_32x32x16_bf16 v[80:95], v[120:123], v[32:35], v[80:95]
  s_waitcnt lgkmcnt(0)
  v_mul_f32 v36, 0x3e8b97f6, v31
  v_cmp_eq_u32 vcc, 1, v3
  v_sub_f32 v30, 0, v30
  s_nop 0
  v_cndmask_b32 v37, v36, v31, vcc
  s_nop 5
  v_fmac_f32 v64, v30, v80
  v_fmac_f32 v65, v30, v81
  v_fmac_f32 v66, v30, v82
  v_fmac_f32 v67, v30, v83
  v_fmac_f32 v68, v30, v84
  v_fmac_f32 v69, v30, v85
  v_fmac_f32 v70, v30, v86
  v_fmac_f32 v71, v30, v87
  v_fmac_f32 v72, v30, v88
  v_fmac_f32 v73, v30, v89
  v_fmac_f32 v74, v30, v90
  v_fmac_f32 v75, v30, v91
  v_fmac_f32 v76, v30, v92
  v_fmac_f32 v77, v30, v93
  v_fmac_f32 v78, v30, v94
  v_fmac_f32 v79, v30, v95
  v_mul_f32 v64, v36, v64
  v_mul_f32 v65, v36, v65
  v_mul_f32 v66, v36, v66
  v_mul_f32 v67, v36, v67
  v_mul_f32 v68, v36, v68
  v_mul_f32 v69, v36, v69
  v_mul_f32 v70, v36, v70
  v_mul_f32 v71, v36, v71
  v_mul_f32 v72, v36, v72
  v_mul_f32 v73, v36, v73
  v_mul_f32 v74, v36, v74
  v_mul_f32 v75, v36, v75
  v_mul_f32 v76, v37, v76
  v_mul_f32 v77, v37, v77
  v_mul_f32 v78, v37, v78
  v_mul_f32 v79, v37, v79
  v_cvt_pk_bf16_f32 v40, v64, v65
  v_cvt_pk_bf16_f32 v41, v66, v67
  v_cvt_pk_bf16_f32 v42, v68, v69
  v_cvt_pk_bf16_f32 v43, v70, v71
  v_cvt_pk_bf16_f32 v44, v72, v73
  v_cvt_pk_bf16_f32 v45, v74, v75
  v_cvt_pk_bf16_f32 v46, v76, v77
  v_cvt_pk_bf16_f32 v47, v78, v79
  buffer_store_dwordx4 v[40:43], v50, s[40:43], s60 offen
  buffer_store_dwordx4 v[44:47], v50, s[40:43], s60 offen offset:1024
  s_and_b32 s10, s62, 7
  v_mov_b32 v48, v46
  v_mov_b32 v49, v47
  s_mov_b32 exec_lo, 0
  s_cmp_lg_u32 s10, 7
  s_cbranch_scc1 p1a_kernel_kv1o
  s_cmp_ge_u32 s62, 8
  s_cselect_b32 s10, 0x3f80, 0
  v_mov_b32 v48, s10
  v_mov_b32 v49, 0
p1a_kernel_kv1o:
  s_cmp_ge_u32 s62, 8
  s_cbranch_scc1 p1a_kernel_vo
  buffer_store_dwordx2 v[48:49], v51, s[40:43], s61 offen
  s_branch p1a_kernel_kvdo
p1a_kernel_vo:
  buffer_store_short v48, v51, s[40:43], s61 offen
  buffer_store_short_d16_hi v48, v51, s[40:43], s61 offen offset:16
  buffer_store_short v49, v51, s[40:43], s61 offen offset:32
  buffer_store_short_d16_hi v49, v51, s[40:43], s61 offen offset:48
p1a_kernel_kvdo:
  s_mov_b64 exec, -1
  s_endpgm
p1a_kernel_end:
  s_endpgm
.section .rodata,"a"
.p2align 6
.amdhsa_kernel p1a_kernel
  .amdhsa_next_free_vgpr 222
  .amdhsa_next_free_sgpr 72
  .amdhsa_accum_offset 224
  .amdhsa_group_segment_fixed_size 0
  .amdhsa_kernarg_size 96
  .amdhsa_user_sgpr_count 2
  .amdhsa_user_sgpr_kernarg_segment_ptr 1
  .amdhsa_system_sgpr_workgroup_id_x 1
.end_amdhsa_kernel

.text
.globl mm_kernel
.p2align 12
.p2align 8
.type mm_kernel,@function
mm_kernel:
  s_cmp_ge_u32 s2, 256
  s_cbranch_scc1 mm_kernel_end
  s_load_dwordx16 s[16:31], s[0:1], 0
  s_load_dwordx8 s[32:39], s[0:1], 64
  s_getpc_b64 s[44:45]
mm_kernel_pc:
  s_lshr_b32 s46, s2, 3
  s_mul_i32 s46, s46, 32768
  v_lshrrev_b32 v15, 6, v0
  v_mul_u32_u24 v15, 64, v15
  v_and_b32 v16, 63, v0
  v_add_u32 v15, v15, v16
  v_lshlrev_b32 v15, 7, v15
  v_sub_u32 v16, 63, v16
  v_and_b32 v16, 0x40000000, v16
  v_add3_u32 v15, v15, v16, s46
  s_and_b32 s45, s45, 0xffff
  s_mov_b32 s46, mm_l1-mm_kernel_pc
  s_mov_b32 s47, 0x20000
  buffer_load_dword v15, v15, s[44:47], 0 offen
  v_and_b32 v1, 63, v0
  v_lshrrev_b32 v2, 6, v0
  s_nop 0
  v_readfirstlane_b32 s3, v2
  s_bfe_u32 s4, s2, 0x20001
  s_lshl_b32 s4, s4, 6
  s_lshr_b32 s5, s2, 6
  s_lshl_b32 s5, s5, 4
  s_add_u32 s4, s4, s5
  s_and_b32 s5, s2, 1
  s_lshl_b32 s5, s5, 3
  s_add_u32 s4, s4, s5
  s_bfe_u32 s5, s2, 0x30003
  s_add_u32 s4, s4, s5
  s_lshr_b32 s5, s4, 2
  s_and_b32 s6, s4, 3
  s_lshl_b32 s6, s6, 3
  v_lshlrev_b32 v4, 4, v1
  v_and_b32 v2, 31, v1
  v_lshrrev_b32 v3, 5, v1
  s_lshl_b32 s8, s3, 16
  s_add_u32 s8, s8, 2097152
  v_lshrrev_b32 v5, 3, v2
  v_lshlrev_b32 v5, 11, v5
  v_and_b32 v6, 7, v1
  v_add_u32 v6, s6, v6
  v_lshl_add_u32 v6, v3, 5, v6
  v_lshl_add_u32 v13, v6, 4, v5
  s_lshl_b32 s7, s5, 15
  s_lshl_b32 s14, s3, 13
  s_add_u32 s49, s7, s14
  s_add_u32 s49, s49, 2621440
  s_add_u32 s7, s7, 0
  s_lshr_b32 s14, s2, 3
  s_and_b32 s14, s14, 0
  s_lshl_b32 s14, s14, 12
  s_add_u32 s9, s8, s14
  s_add_u32 s14, s3, 0
  s_and_b32 s14, s14, 3
  s_lshl_b32 s14, s14, 13
  s_add_u32 s10, s7, s14
  s_add_u32 s14, s3, 1
  s_and_b32 s14, s14, 3
  s_lshl_b32 s14, s14, 13
  s_add_u32 s11, s7, s14
  s_add_u32 s14, s3, 2
  s_and_b32 s14, s14, 3
  s_lshl_b32 s14, s14, 13
  s_add_u32 s12, s7, s14
  s_add_u32 s14, s3, 3
  s_and_b32 s14, s14, 3
  s_lshl_b32 s14, s14, 13
  s_add_u32 s13, s7, s14
  s_waitcnt lgkmcnt(0)
  s_mov_b32 s40, s38
  s_and_b32 s41, s39, 0xffff
  s_mov_b32 s42, 36360192
  s_mov_b32 s43, 0x20000
  buffer_load_dwordx4 a[0:3], v4, s[40:43], s9 offen offset:0
  buffer_load_dwordx4 a[4:7], v4, s[40:43], s9 offen offset:1024
  buffer_load_dwordx4 v[24:27], v13, s[40:43], s11 offen offset:0
  buffer_load_dwordx4 v[28:31], v13, s[40:43], s11 offen offset:1024
  buffer_load_dwordx4 v[32:35], v13, s[40:43], s12 offen offset:0
  buffer_load_dwordx4 v[36:39], v13, s[40:43], s12 offen offset:1024
  buffer_load_dwordx4 a[8:11], v4, s[40:43], s9 offen offset:2048
  buffer_load_dwordx4 a[12:15], v4, s[40:43], s9 offen offset:3072
  buffer_load_dwordx4 v[40:43], v13, s[40:43], s13 offen offset:0
  buffer_load_dwordx4 v[44:47], v13, s[40:43], s13 offen offset:1024
  buffer_load_dwordx4 v[16:19], v13, s[40:43], s10 offen offset:0
  buffer_load_dwordx4 v[20:23], v13, s[40:43], s10 offen offset:1024
  s_add_u32 s9, s9, 4096
  s_pack_lh_b32_b16 s9, s9, s8
  buffer_load_dwordx4 a[16:19], v4, s[40:43], s9 offen offset:0
  buffer_load_dwordx4 a[20:23], v4, s[40:43], s9 offen offset:1024
  buffer_load_dwordx4 a[24:27], v4, s[40:43], s9 offen offset:2048
  buffer_load_dwordx4 a[28:31], v4, s[40:43], s9 offen offset:3072
  s_add_u32 s14, s3, 1
  s_and_b32 s14, s14, 3
  s_mul_i32 s14, s14, 12288
  s_add_u32 s14, s14, 0
  v_add_u32 v6, s14, v4
  s_xor_b32 s14, s3, 1
  s_mul_i32 s14, s14, 12288
  s_add_u32 s14, s14, 0
  v_add_u32 v10, s14, v4
  s_add_u32 s14, s3, 2
  s_and_b32 s14, s14, 3
  s_mul_i32 s14, s14, 12288
  s_add_u32 s14, s14, 4096
  v_add_u32 v7, s14, v4
  s_xor_b32 s14, s3, 2
  s_mul_i32 s14, s14, 12288
  s_add_u32 s14, s14, 4096
  v_add_u32 v11, s14, v4
  s_add_u32 s14, s3, 3
  s_and_b32 s14, s14, 3
  s_mul_i32 s14, s14, 12288
  s_add_u32 s14, s14, 8192
  v_add_u32 v8, s14, v4
  s_xor_b32 s14, s3, 3
  s_mul_i32 s14, s14, 12288
  s_add_u32 s14, s14, 8192
  v_add_u32 v12, s14, v4
  s_mul_i32 s14, s3, 12288
  v_add_u32 v5, s14, v4
  s_mov_b32 s68, s38
  s_and_b32 s69, s39, 0xffff
  s_mov_b32 s70, 36360192
  s_mov_b32 s71, 0x20000
  s_and_b32 s14, s4, 15
  s_lshl_b32 s63, s3, 12
  s_mul_i32 s64, s14, 212992
  s_add_u32 s64, s64, s63
  s_add_u32 s64, s64, 27983872
  s_add_u32 s63, s63, 49152
  s_and_b32 s15, s14, 7
  s_cmp_lt_u32 s15, 7
  s_cselect_b32 s70, s70, 0
  s_lshr_b32 s44, s4, 4
  s_add_u32 s45, s44, s15
  s_and_b32 s44, s44, 0
  s_lshl_b32 s57, s44, 15
  s_lshl_b32 s15, s15, 1
  s_and_b32 s67, s3, 1
  s_add_u32 s67, s67, s15
  s_xor_b32 s65, s67, 1
  s_lshl_b32 s46, s67, 15
  s_lshl_b32 s47, s65, 15
  s_lshl_b32 s15, s3, 13
  s_add_u32 s44, s15, 27525120
  s_add_u32 s46, s46, s44
  s_add_u32 s47, s47, s44
  s_mul_i32 s62, s67, 114688
  s_mul_i32 s65, s65, 114688
  s_mul_i32 s48, s3, 28672
  s_add_u32 s7, s48, 31391744
  s_add_u32 s62, s62, s7
  s_add_u32 s65, s65, s7
  s_lshr_b32 s44, s4, 4
  s_lshl_b32 s44, s44, 2
  s_add_u32 s6, s44, s3
  s_mul_i32 s5, s6, 28672
  s_add_u32 s5, s5, 4718592
  s_lshl_b32 s7, s6, 12
  s_add_u32 s7, s7, 6553600
  s_mul_i32 s6, s6, 112
  s_mul_i32 s13, s14, 7
  s_add_u32 s6, s6, s13
  s_lshl_b32 s6, s6, 10
  s_add_u32 s6, s6, 11010048
  s_lshr_b32 s13, s14, 3
  s_lshl_b32 s13, s13, 1
  s_add_u32 s44, s44, s13
  s_lshr_b32 s13, s3, 1
  s_add_u32 s66, s44, s13
  s_xor_b32 s11, s66, 1
  s_lshl_b32 s50, s66, 15
  s_lshl_b32 s51, s11, 15
  s_add_u32 s15, s15, 2621440
  s_add_u32 s50, s50, s15
  s_add_u32 s51, s51, s15
  s_mul_i32 s10, s66, 114688
  s_mul_i32 s11, s11, 114688
  s_add_u32 s48, s48, 11010048
  s_add_u32 s10, s10, s48
  s_add_u32 s11, s11, s48
  s_mul_i32 s12, s66, 28
  s_lshl_b32 s13, s67, 1
  s_add_u32 s12, s12, s13
  s_lshl_b32 s12, s12, 10
  s_lshl_b32 s56, s66, 12
  s_lshr_b32 s13, s67, 2
  s_lshl_b32 s13, s13, 10
  s_add_u32 s56, s56, s13
  s_bfe_u32 s13, s67, 0x10001
  s_lshl_b32 s13, s13, 9
  s_add_u32 s56, s56, s13
  s_and_b32 s13, s67, 1
  s_lshl_b32 s13, s13, 3
  s_add_u32 s56, s56, s13
  s_add_u32 s56, s56, 6553600
  s_mov_b32 s13, 200000
  s_mov_b32 s61, 0xffff0000
  v_mov_b32 v248, -1
  v_mov_b32 v249, -1
  v_mov_b32 v250, -1
  v_mov_b32 v251, -1
  s_add_u32 s14, s45, 0
  s_and_b32 s14, s14, 3
  s_mul_i32 s52, s14, 0
  s_mov_b32 s52, 0
  s_add_u32 s14, s45, 1
  s_and_b32 s14, s14, 3
  s_mul_i32 s53, s14, 0
  s_mov_b32 s53, 7168
  s_add_u32 s14, s45, 2
  s_and_b32 s14, s14, 3
  s_mul_i32 s54, s14, 0
  s_mov_b32 s54, 14336
  s_add_u32 s14, s45, 3
  s_and_b32 s14, s14, 3
  s_mul_i32 s55, s14, 0
  s_mov_b32 s55, 21504
  s_lshl_b32 s14, s66, 5
  v_add_u32 v14, s14, v2
  v_mul_u32_u24 v14, 896, v14
  v_lshl_add_u32 v14, v3, 3, v14
  s_min_u32 s58, s67, 13
  s_lshl_b32 s58, s58, 6
  s_getpc_b64 s[20:21]
mm_kernel_pc2:
  s_add_u32 s20, s20, mm_l1-mm_kernel_pc2
  s_addc_u32 s21, s21, 0
  s_lshr_b32 s22, s2, 3
  s_mul_i32 s22, s22, 32768
  v_lshrrev_b32 v9, 6, v0
  v_mul_u32_u24 v9, 64, v9
  v_and_b32 v252, 63, v0
  v_add_u32 v9, v9, v252
  v_lshlrev_b32 v9, 7, v9
  v_sub_u32 v252, 63, v252
  v_and_b32 v252, 0x40000000, v252
  v_add3_u32 v9, v9, v252, s22
  s_and_b32 s21, s21, 0xffff
  s_mov_b32 s22, mm_kernel_end-mm_l1
  s_mov_b32 s23, 0x20000
  s_mov_b32 s14, 0x21800000
  s_mov_b32 s15, 0x5d800000
  s_add_u32 m0, s63, s57
  s_add_u32 s48, s64, s57
  s_waitcnt vmcnt(14)
  s_waitcnt vmcnt(12)
  v_mfma_f32_32x32x16_bf16 v[112:127], a[0:3], v[24:27], 0
  s_add_u32 s9, s9, 4096
  s_pack_lh_b32_b16 s9, s9, s8
  buffer_load_dwordx4 a[32:35], v4, s[40:43], s9 offen offset:0
  buffer_load_dwordx4 a[36:39], v4, s[40:43], s9 offen offset:1024
  v_mfma_f32_32x32x16_bf16 v[112:127], a[4:7], v[28:31], v[112:127]
  buffer_load_dwordx4 a[40:43], v4, s[40:43], s9 offen offset:2048
  buffer_load_dwordx4 a[44:47], v4, s[40:43], s9 offen offset:3072
  s_nop 7
  s_waitcnt vmcnt(14)
  v_mfma_f32_32x32x16_bf16 v[128:143], a[0:3], v[32:35], 0
  s_add_u32 s9, s9, 4096
  s_pack_lh_b32_b16 s9, s9, s8
  buffer_load_dwordx4 a[48:51], v4, s[40:43], s9 offen offset:0
  v_exp_f32 v112, v112
  v_exp_f32 v113, v113
  v_exp_f32 v114, v114
  v_exp_f32 v115, v115
  buffer_load_dwordx4 v4, s[40:43], s48 offen offset:0 lds
  v_exp_f32 v116, v116
  v_exp_f32 v117, v117
  v_exp_f32 v118, v118
  v_exp_f32 v119, v119
  v_mfma_f32_32x32x16_bf16 v[128:143], a[4:7], v[36:39], v[128:143]
  v_cvt_pk_bf16_f32 v144, v112, v113
  v_cvt_pk_bf16_f32 v145, v114, v115
  v_cvt_pk_bf16_f32 v146, v116, v117
  v_cvt_pk_bf16_f32 v147, v118, v119
  v_exp_f32 v120, v120
  v_exp_f32 v121, v121
  v_exp_f32 v122, v122
  s_waitcnt vmcnt(14)
  v_mfma_f32_32x32x16_bf16 v[64:79], a[8:11], v[144:147], 0
  buffer_load_dword v9, v9, s[20:23], 0 offen
  v_exp_f32 v123, v123
  v_exp_f32 v124, v124
  v_exp_f32 v125, v125
  v_exp_f32 v126, v126
  v_exp_f32 v127, v127
  v_cvt_pk_bf16_f32 v148, v120, v121
  v_cvt_pk_bf16_f32 v149, v122, v123
  v_cvt_pk_bf16_f32 v150, v124, v125
  v_cvt_pk_bf16_f32 v151, v126, v127
  s_waitcnt vmcnt(13)
  v_mfma_f32_32x32x16_bf16 v[112:127], a[0:3], v[40:43], 0
  buffer_load_dwordx4 a[52:55], v4, s[40:43], s9 offen offset:1024
  v_exp_f32 v128, v128
  v_exp_f32 v129, v129
  v_exp_f32 v130, v130
  v_exp_f32 v131, v131
  v_mfma_f32_32x32x16_bf16 v[64:79], a[12:15], v[148:151], v[64:79]
  buffer_load_dwordx4 v4, s[40:43], s48 offen offset:1024 lds
  v_exp_f32 v132, v132
  v_exp_f32 v133, v133
  v_exp_f32 v134, v134
  v_exp_f32 v135, v135
  v_mfma_f32_32x32x16_bf16 v[112:127], a[4:7], v[44:47], v[112:127]
  v_cvt_pk_bf16_f32 v144, v128, v129
  v_cvt_pk_bf16_f32 v145, v130, v131
  v_cvt_pk_bf16_f32 v146, v132, v133
  v_cvt_pk_bf16_f32 v147, v134, v135
  v_exp_f32 v136, v136
  v_exp_f32 v137, v137
  v_exp_f32 v138, v138
  v_mfma_f32_32x32x16_bf16 v[80:95], a[8:11], v[144:147], 0
  buffer_load_dwordx4 v4, s[40:43], s48 offen offset:2048 lds
  v_exp_f32 v139, v139
  v_exp_f32 v140, v140
  v_exp_f32 v141, v141
  v_exp_f32 v142, v142
  v_exp_f32 v143, v143
  v_cvt_pk_bf16_f32 v148, v136, v137
  v_cvt_pk_bf16_f32 v149, v138, v139
  v_cvt_pk_bf16_f32 v150, v140, v141
  v_cvt_pk_bf16_f32 v151, v142, v143
  s_waitcnt vmcnt(14)
  v_mfma_f32_32x32x16_bf16 v[128:143], a[0:3], v[16:19], 0
  buffer_load_dwordx4 a[56:59], v4, s[40:43], s9 offen offset:2048
  v_exp_f32 v112, v112
  v_exp_f32 v113, v113
  v_exp_f32 v114, v114
  v_exp_f32 v115, v115
  v_mfma_f32_32x32x16_bf16 v[80:95], a[12:15], v[148:151], v[80:95]
  buffer_load_dwordx4 v4, s[40:43], s48 offen offset:3072 lds
  v_exp_f32 v116, v116
  v_exp_f32 v117, v117
  v_exp_f32 v118, v118
  v_exp_f32 v119, v119
  v_mfma_f32_32x32x16_bf16 v[128:143], a[4:7], v[20:23], v[128:143]
  s_add_u32 s57, s57, 16384
  s_cmp_eq_u32 s57, 114688
  s_cselect_b32 s57, 0, s57
  s_add_u32 m0, s63, s57
  s_add_u32 s48, s64, s57
  v_cvt_pk_bf16_f32 v144, v112, v113
  v_cvt_pk_bf16_f32 v145, v114, v115
  v_cvt_pk_bf16_f32 v146, v116, v117
  v_cvt_pk_bf16_f32 v147, v118, v119
  v_exp_f32 v120, v120
  v_exp_f32 v121, v121
  v_exp_f32 v122, v122
  v_mfma_f32_32x32x16_bf16 v[96:111], a[8:11], v[144:147], 0
  v_exp_f32 v123, v123
  v_exp_f32 v124, v124
  v_exp_f32 v125, v125
  v_exp_f32 v126, v126
  v_exp_f32 v127, v127
  v_cvt_pk_bf16_f32 v148, v120, v121
  v_cvt_pk_bf16_f32 v149, v122, v123
  v_cvt_pk_bf16_f32 v150, v124, v125
  v_cvt_pk_bf16_f32 v151, v126, v127
  s_waitcnt vmcnt(12)
  v_mfma_f32_32x32x16_bf16 v[112:127], a[16:19], v[24:27], 0
  buffer_load_dwordx4 a[60:63], v4, s[40:43], s9 offen offset:3072
  v_exp_f32 v128, v128
  v_exp_f32 v129, v129
  v_exp_f32 v130, v130
  v_exp_f32 v131, v131
  v_mfma_f32_32x32x16_bf16 v[96:111], a[12:15], v[148:151], v[96:111]
  buffer_load_dwordx4 v4, s[40:43], s48 offen offset:0 lds
  v_exp_f32 v132, v132
  v_exp_f32 v133, v133
  v_exp_f32 v134, v134
  v_exp_f32 v135, v135
  v_mfma_f32_32x32x16_bf16 v[112:127], a[20:23], v[28:31], v[112:127]
  v_cvt_pk_bf16_f32 v144, v128, v129
  v_cvt_pk_bf16_f32 v145, v130, v131
  v_cvt_pk_bf16_f32 v146, v132, v133
  v_cvt_pk_bf16_f32 v147, v134, v135
  v_exp_f32 v136, v136
  v_exp_f32 v137, v137
  v_exp_f32 v138, v138
  v_mfma_f32_32x32x16_bf16 v[48:63], a[8:11], v[144:147], 0
  s_lshl_b32 s44, s4, 2
  s_add_u32 s44, s44, s3
  s_lshl_b32 s44, s44, 11
  s_add_u32 s44, s44, 2621440
  buffer_store_dwordx4 v[248:251], v4, s[40:43], s44 offen sc1
  v_exp_f32 v139, v139
  v_exp_f32 v140, v140
  v_exp_f32 v141, v141
  v_exp_f32 v142, v142
  v_exp_f32 v143, v143
  v_cvt_pk_bf16_f32 v148, v136, v137
  v_cvt_pk_bf16_f32 v149, v138, v139
  v_cvt_pk_bf16_f32 v150, v140, v141
  v_cvt_pk_bf16_f32 v151, v142, v143
  v_mfma_f32_32x32x16_bf16 v[128:143], a[16:19], v[32:35], 0
  s_add_u32 s9, s9, 4096
  s_pack_lh_b32_b16 s9, s9, s8
  buffer_load_dwordx4 a[0:3], v4, s[40:43], s9 offen offset:0
  v_exp_f32 v112, v112
  v_exp_f32 v113, v113
  v_exp_f32 v114, v114
  v_exp_f32 v115, v115
  v_mfma_f32_32x32x16_bf16 v[48:63], a[12:15], v[148:151], v[48:63]
  buffer_load_dwordx4 v4, s[40:43], s48 offen offset:1024 lds
  v_exp_f32 v116, v116
  v_exp_f32 v117, v117
  v_exp_f32 v118, v118
  v_exp_f32 v119, v119
  v_mfma_f32_32x32x16_bf16 v[128:143], a[20:23], v[36:39], v[128:143]
  v_cvt_pk_bf16_f32 v144, v112, v113
  v_cvt_pk_bf16_f32 v145, v114, v115
  v_cvt_pk_bf16_f32 v146, v116, v117
  v_cvt_pk_bf16_f32 v147, v118, v119
  v_exp_f32 v120, v120
  v_exp_f32 v121, v121
  v_exp_f32 v122, v122
  v_mfma_f32_32x32x16_bf16 v[64:79], a[24:27], v[144:147], v[64:79]
  buffer_load_dwordx4 v4, s[40:43], s48 offen offset:2048 lds
  v_exp_f32 v123, v123
  v_exp_f32 v124, v124
  v_exp_f32 v125, v125
  v_exp_f32 v126, v126
  v_exp_f32 v127, v127
  v_cvt_pk_bf16_f32 v148, v120, v121
  v_cvt_pk_bf16_f32 v149, v122, v123
  v_cvt_pk_bf16_f32 v150, v124, v125
  v_cvt_pk_bf16_f32 v151, v126, v127
  v_mfma_f32_32x32x16_bf16 v[112:127], a[16:19], v[40:43], 0
  buffer_load_dwordx4 a[4:7], v4, s[40:43], s9 offen offset:1024
  v_exp_f32 v128, v128
  v_exp_f32 v129, v129
  v_exp_f32 v130, v130
  v_exp_f32 v131, v131
  v_mfma_f32_32x32x16_bf16 v[64:79], a[28:31], v[148:151], v[64:79]
  buffer_load_dwordx4 v4, s[40:43], s48 offen offset:3072 lds
  v_exp_f32 v132, v132
  v_exp_f32 v133, v133
  v_exp_f32 v134, v134
  v_exp_f32 v135, v135
  v_mfma_f32_32x32x16_bf16 v[112:127], a[20:23], v[44:47], v[112:127]
  s_add_u32 s57, s57, 16384
  s_cmp_eq_u32 s57, 114688
  s_cselect_b32 s57, 0, s57
  s_add_u32 m0, s63, s57
  s_add_u32 s48, s64, s57
  v_cvt_pk_bf16_f32 v144, v128, v129
  v_cvt_pk_bf16_f32 v145, v130, v131
  v_cvt_pk_bf16_f32 v146, v132, v133
  v_cvt_pk_bf16_f32 v147, v134, v135
  v_exp_f32 v136, v136
  v_exp_f32 v137, v137
  v_exp_f32 v138, v138
  v_mfma_f32_32x32x16_bf16 v[80:95], a[24:27], v[144:147], v[80:95]
  v_exp_f32 v139, v139
  v_exp_f32 v140, v140
  v_exp_f32 v141, v141
  v_exp_f32 v142, v142
  v_exp_f32 v143, v143
  v_cvt_pk_bf16_f32 v148, v136, v137
  v_cvt_pk_bf16_f32 v149, v138, v139
  v_cvt_pk_bf16_f32 v150, v140, v141
  v_cvt_pk_bf16_f32 v151, v142, v143
  v_mfma_f32_32x32x16_bf16 v[128:143], a[16:19], v[16:19], 0
  buffer_load_dwordx4 a[8:11], v4, s[40:43], s9 offen offset:2048
  v_exp_f32 v112, v112
  v_exp_f32 v113, v113
  v_exp_f32 v114, v114
  v_exp_f32 v115, v115
  v_mfma_f32_32x32x16_bf16 v[80:95], a[28:31], v[148:151], v[80:95]
  buffer_load_dwordx4 v4, s[40:43], s48 offen offset:0 lds
  v_exp_f32 v116, v116
  v_exp_f32 v117, v117
  v_exp_f32 v118, v118
  v_exp_f32 v119, v119
  v_mfma_f32_32x32x16_bf16 v[128:143], a[20:23], v[20:23], v[128:143]
  v_cvt_pk_bf16_f32 v144, v112, v113
  v_cvt_pk_bf16_f32 v145, v114, v115
  v_cvt_pk_bf16_f32 v146, v116, v117
  v_cvt_pk_bf16_f32 v147, v118, v119
  v_exp_f32 v120, v120
  v_exp_f32 v121, v121
  v_exp_f32 v122, v122
  v_mfma_f32_32x32x16_bf16 v[96:111], a[24:27], v[144:147], v[96:111]
  s_lshl_b32 s44, s4, 2
  s_add_u32 s44, s44, s3
  s_lshl_b32 s44, s44, 11
  s_add_u32 s44, s44, 2621440
  buffer_store_dwordx4 v[248:251], v4, s[40:43], s44 offen offset:1024 sc1
  v_exp_f32 v123, v123
  v_exp_f32 v124, v124
  v_exp_f32 v125, v125
  v_exp_f32 v126, v126
  v_exp_f32 v127, v127
  v_cvt_pk_bf16_f32 v148, v120, v121
  v_cvt_pk_bf16_f32 v149, v122, v123
  v_cvt_pk_bf16_f32 v150, v124, v125
  v_cvt_pk_bf16_f32 v151, v126, v127
  s_waitcnt vmcnt(19)
  v_mfma_f32_32x32x16_bf16 v[112:127], a[32:35], v[24:27], 0
  buffer_load_dwordx4 a[12:15], v4, s[40:43], s9 offen offset:3072
  v_exp_f32 v128, v128
  v_exp_f32 v129, v129
  v_exp_f32 v130, v130
  v_exp_f32 v131, v131
  v_mfma_f32_32x32x16_bf16 v[96:111], a[28:31], v[148:151], v[96:111]
  buffer_load_dwordx4 v4, s[40:43], s48 offen offset:1024 lds
  v_exp_f32 v132, v132
  v_exp_f32 v133, v133
  v_exp_f32 v134, v134
  v_exp_f32 v135, v135
  v_mfma_f32_32x32x16_bf16 v[112:127], a[36:39], v[28:31], v[112:127]
  v_cvt_pk_bf16_f32 v144, v128, v129
  v_cvt_pk_bf16_f32 v145, v130, v131
  v_cvt_pk_bf16_f32 v146, v132, v133
  v_cvt_pk_bf16_f32 v147, v134, v135
  v_exp_f32 v136, v136
  v_exp_f32 v137, v137
  v_exp_f32 v138, v138
  v_mfma_f32_32x32x16_bf16 v[48:63], a[24:27], v[144:147], v[48:63]
  buffer_load_dwordx4 v4, s[40:43], s48 offen offset:2048 lds
  v_exp_f32 v139, v139
  v_exp_f32 v140, v140
  v_exp_f32 v141, v141
  v_exp_f32 v142, v142
  v_exp_f32 v143, v143
  v_cvt_pk_bf16_f32 v148, v136, v137
  v_cvt_pk_bf16_f32 v149, v138, v139
  v_cvt_pk_bf16_f32 v150, v140, v141
  v_cvt_pk_bf16_f32 v151, v142, v143
  v_mfma_f32_32x32x16_bf16 v[128:143], a[32:35], v[32:35], 0
  s_add_u32 s9, s9, 4096
  s_pack_lh_b32_b16 s9, s9, s8
  buffer_load_dwordx4 a[16:19], v4, s[40:43], s9 offen offset:0
  v_exp_f32 v112, v112
  v_exp_f32 v113, v113
  v_exp_f32 v114, v114
  v_exp_f32 v115, v115
  v_mfma_f32_32x32x16_bf16 v[48:63], a[28:31], v[148:151], v[48:63]
  buffer_load_dwordx4 v4, s[40:43], s48 offen offset:3072 lds
  v_exp_f32 v116, v116
  v_exp_f32 v117, v117
  v_exp_f32 v118, v118
  v_exp_f32 v119, v119
  v_mfma_f32_32x32x16_bf16 v[128:143], a[36:39], v[36:39], v[128:143]
  s_add_u32 s57, s57, 16384
  s_cmp_eq_u32 s57, 114688
  s_cselect_b32 s57, 0, s57
  s_add_u32 m0, s63, s57
  s_add_u32 s48, s64, s57
  v_cvt_pk_bf16_f32 v144, v112, v113
  v_cvt_pk_bf16_f32 v145, v114, v115
  v_cvt_pk_bf16_f32 v146, v116, v117
  v_cvt_pk_bf16_f32 v147, v118, v119
  v_exp_f32 v120, v120
  v_exp_f32 v121, v121
  v_exp_f32 v122, v122
  v_mfma_f32_32x32x16_bf16 v[64:79], a[40:43], v[144:147], v[64:79]
  v_exp_f32 v123, v123
  v_exp_f32 v124, v124
  v_exp_f32 v125, v125
  v_exp_f32 v126, v126
  v_exp_f32 v127, v127
  v_cvt_pk_bf16_f32 v148, v120, v121
  v_cvt_pk_bf16_f32 v149, v122, v123
  v_cvt_pk_bf16_f32 v150, v124, v125
  v_cvt_pk_bf16_f32 v151, v126, v127
  v_mfma_f32_32x32x16_bf16 v[112:127], a[32:35], v[40:43], 0
  buffer_load_dwordx4 a[20:23], v4, s[40:43], s9 offen offset:1024
  v_exp_f32 v128, v128
  v_exp_f32 v129, v129
  v_exp_f32 v130, v130
  v_exp_f32 v131, v131
  v_mfma_f32_32x32x16_bf16 v[64:79], a[44:47], v[148:151], v[64:79]
  buffer_load_dwordx4 v4, s[40:43], s48 offen offset:0 lds
  v_exp_f32 v132, v132
  v_exp_f32 v133, v133
  v_exp_f32 v134, v134
  v_exp_f32 v135, v135
  v_mfma_f32_32x32x16_bf16 v[112:127], a[36:39], v[44:47], v[112:127]
  v_cvt_pk_bf16_f32 v144, v128, v129
  v_cvt_pk_bf16_f32 v145, v130, v131
  v_cvt_pk_bf16_f32 v146, v132, v133
  v_cvt_pk_bf16_f32 v147, v134, v135
  v_exp_f32 v136, v136
  v_exp_f32 v137, v137
  v_exp_f32 v138, v138
  v_mfma_f32_32x32x16_bf16 v[80:95], a[40:43], v[144:147], v[80:95]
  s_and_b32 s45, s4, 15
  s_lshl_b32 s45, s45, 2
  s_add_u32 s45, s45, s3
  s_lshr_b32 s29, s4, 4
  s_mul_i32 s29, s29, 112
  s_add_u32 s44, s45, s29
  s_lshl_b32 s44, s44, 10
  s_add_u32 s44, s44, 4718592
  buffer_store_dwordx4 v[248:251], v4, s[40:43], s44 offen sc1
  v_exp_f32 v139, v139
  v_exp_f32 v140, v140
  v_exp_f32 v141, v141
  v_exp_f32 v142, v142
  v_exp_f32 v143, v143
  v_cvt_pk_bf16_f32 v148, v136, v137
  v_cvt_pk_bf16_f32 v149, v138, v139
  v_cvt_pk_bf16_f32 v150, v140, v141
  v_cvt_pk_bf16_f32 v151, v142, v143
  v_mfma_f32_32x32x16_bf16 v[128:143], a[32:35], v[16:19], 0
  buffer_load_dwordx4 a[24:27], v4, s[40:43], s9 offen offset:2048
  v_exp_f32 v112, v112
  v_exp_f32 v113, v113
  v_exp_f32 v114, v114
  v_exp_f32 v115, v115
  v_mfma_f32_32x32x16_bf16 v[80:95], a[44:47], v[148:151], v[80:95]
  buffer_load_dwordx4 v4, s[40:43], s48 offen offset:1024 lds
  v_exp_f32 v116, v116
  v_exp_f32 v117, v117
  v_exp_f32 v118, v118
  v_exp_f32 v119, v119
  v_mfma_f32_32x32x16_bf16 v[128:143], a[36:39], v[20:23], v[128:143]
  v_cvt_pk_bf16_f32 v144, v112, v113
  v_cvt_pk_bf16_f32 v145, v114, v115
  v_cvt_pk_bf16_f32 v146, v116, v117
  v_cvt_pk_bf16_f32 v147, v118, v119
  v_exp_f32 v120, v120
  v_exp_f32 v121, v121
  v_exp_f32 v122, v122
  v_mfma_f32_32x32x16_bf16 v[96:111], a[40:43], v[144:147], v[96:111]
  buffer_load_dwordx4 v4, s[40:43], s48 offen offset:2048 lds
  v_exp_f32 v123, v123
  v_exp_f32 v124, v124
  v_exp_f32 v125, v125
  v_exp_f32 v126, v126
  v_exp_f32 v127, v127
  v_cvt_pk_bf16_f32 v148, v120, v121
  v_cvt_pk_bf16_f32 v149, v122, v123
  v_cvt_pk_bf16_f32 v150, v124, v125
  v_cvt_pk_bf16_f32 v151, v126, v127
  s_waitcnt vmcnt(21)
  v_mfma_f32_32x32x16_bf16 v[112:127], a[48:51], v[24:27], 0
  buffer_load_dwordx4 a[28:31], v4, s[40:43], s9 offen offset:3072
  v_exp_f32 v128, v128
  v_exp_f32 v129, v129
  v_exp_f32 v130, v130
  v_exp_f32 v131, v131
  v_mfma_f32_32x32x16_bf16 v[96:111], a[44:47], v[148:151], v[96:111]
  buffer_load_dwordx4 v4, s[40:43], s48 offen offset:3072 lds
  v_exp_f32 v132, v132
  v_exp_f32 v133, v133
  v_exp_f32 v134, v134
  v_exp_f32 v135, v135
  v_mfma_f32_32x32x16_bf16 v[112:127], a[52:55], v[28:31], v[112:127]
  s_add_u32 s57, s57, 16384
  s_cmp_eq_u32 s57, 114688
  s_cselect_b32 s57, 0, s57
  s_add_u32 m0, s63, s57
  s_add_u32 s48, s64, s57
  v_cvt_pk_bf16_f32 v144, v128, v129
  v_cvt_pk_bf16_f32 v145, v130, v131
  v_cvt_pk_bf16_f32 v146, v132, v133
  v_cvt_pk_bf16_f32 v147, v134, v135
  v_exp_f32 v136, v136
  v_exp_f32 v137, v137
  v_exp_f32 v138, v138
  v_mfma_f32_32x32x16_bf16 v[48:63], a[40:43], v[144:147], v[48:63]
  v_exp_f32 v139, v139
  v_exp_f32 v140, v140
  v_exp_f32 v141, v141
  v_exp_f32 v142, v142
  v_exp_f32 v143, v143
  v_cvt_pk_bf16_f32 v148, v136, v137
  v_cvt_pk_bf16_f32 v149, v138, v139
  v_cvt_pk_bf16_f32 v150, v140, v141
  v_cvt_pk_bf16_f32 v151, v142, v143
  v_mfma_f32_32x32x16_bf16 v[128:143], a[48:51], v[32:35], 0
  s_add_u32 s9, s9, 4096
  s_pack_lh_b32_b16 s9, s9, s8
  buffer_load_dwordx4 a[32:35], v4, s[40:43], s9 offen offset:0
  v_exp_f32 v112, v112
  v_exp_f32 v113, v113
  v_exp_f32 v114, v114
  v_exp_f32 v115, v115
  v_mfma_f32_32x32x16_bf16 v[48:63], a[44:47], v[148:151], v[48:63]
  buffer_load_dwordx4 v4, s[40:43], s48 offen offset:0 lds
  v_exp_f32 v116, v116
  v_exp_f32 v117, v117
  v_exp_f32 v118, v118
  v_exp_f32 v119, v119
  v_mfma_f32_32x32x16_bf16 v[128:143], a[52:55], v[36:39], v[128:143]
  v_cvt_pk_bf16_f32 v144, v112, v113
  v_cvt_pk_bf16_f32 v145, v114, v115
  v_cvt_pk_bf16_f32 v146, v116, v117
  v_cvt_pk_bf16_f32 v147, v118, v119
  v_exp_f32 v120, v120
  v_exp_f32 v121, v121
  v_exp_f32 v122, v122
  v_mfma_f32_32x32x16_bf16 v[64:79], a[56:59], v[144:147], v[64:79]
  s_and_b32 s45, s4, 15
  s_lshl_b32 s45, s45, 2
  s_add_u32 s45, s45, s3
  s_lshr_b32 s29, s4, 4
  s_add_u32 s45, s45, 64
  s_min_u32 s45, s45, 111
  s_mul_i32 s29, s29, 112
  s_add_u32 s44, s45, s29
  s_lshl_b32 s44, s44, 10
  s_add_u32 s44, s44, 4718592
  buffer_store_dwordx4 v[248:251], v4, s[40:43], s44 offen sc1
  v_exp_f32 v123, v123
  v_exp_f32 v124, v124
  v_exp_f32 v125, v125
  v_exp_f32 v126, v126
  v_exp_f32 v127, v127
  v_cvt_pk_bf16_f32 v148, v120, v121
  v_cvt_pk_bf16_f32 v149, v122, v123
  v_cvt_pk_bf16_f32 v150, v124, v125
  v_cvt_pk_bf16_f32 v151, v126, v127
  v_mfma_f32_32x32x16_bf16 v[112:127], a[48:51], v[40:43], 0
  buffer_load_dwordx4 a[36:39], v4, s[40:43], s9 offen offset:1024
  v_exp_f32 v128, v128
  v_exp_f32 v129, v129
  v_exp_f32 v130, v130
  v_exp_f32 v131, v131
  v_mfma_f32_32x32x16_bf16 v[64:79], a[60:63], v[148:151], v[64:79]
  buffer_load_dwordx4 v4, s[40:43], s48 offen offset:1024 lds
  v_exp_f32 v132, v132
  v_exp_f32 v133, v133
  v_exp_f32 v134, v134
  v_exp_f32 v135, v135
  v_mfma_f32_32x32x16_bf16 v[112:127], a[52:55], v[44:47], v[112:127]
  v_cvt_pk_bf16_f32 v144, v128, v129
  v_cvt_pk_bf16_f32 v145, v130, v131
  v_cvt_pk_bf16_f32 v146, v132, v133
  v_cvt_pk_bf16_f32 v147, v134, v135
  v_exp_f32 v136, v136
  v_exp_f32 v137, v137
  v_exp_f32 v138, v138
  v_mfma_f32_32x32x16_bf16 v[80:95], a[56:59], v[144:147], v[80:95]
  buffer_load_dwordx4 v4, s[40:43], s48 offen offset:2048 lds
  v_exp_f32 v139, v139
  v_exp_f32 v140, v140
  v_exp_f32 v141, v141
  v_exp_f32 v142, v142
  v_exp_f32 v143, v143
  v_cvt_pk_bf16_f32 v148, v136, v137
  v_cvt_pk_bf16_f32 v149, v138, v139
  v_cvt_pk_bf16_f32 v150, v140, v141
  v_cvt_pk_bf16_f32 v151, v142, v143
  v_mfma_f32_32x32x16_bf16 v[128:143], a[48:51], v[16:19], 0
  buffer_load_dwordx4 a[40:43], v4, s[40:43], s9 offen offset:2048
  v_exp_f32 v112, v112
  v_exp_f32 v113, v113
  v_exp_f32 v114, v114
  v_exp_f32 v115, v115
  v_mfma_f32_32x32x16_bf16 v[80:95], a[60:63], v[148:151], v[80:95]
  buffer_load_dwordx4 v4, s[40:43], s48 offen offset:3072 lds
  v_exp_f32 v116, v116
  v_exp_f32 v117, v117
  v_exp_f32 v118, v118
  v_exp_f32 v119, v119
  v_mfma_f32_32x32x16_bf16 v[128:143], a[52:55], v[20:23], v[128:143]
  s_add_u32 s57, s57, 16384
  s_cmp_eq_u32 s57, 114688
  s_cselect_b32 s57, 0, s57
  s_add_u32 m0, s63, s57
  s_add_u32 s48, s64, s57
  v_cvt_pk_bf16_f32 v144, v112, v113
  v_cvt_pk_bf16_f32 v145, v114, v115
  v_cvt_pk_bf16_f32 v146, v116, v117
  v_cvt_pk_bf16_f32 v147, v118, v119
  v_exp_f32 v120, v120
  v_exp_f32 v121, v121
  v_exp_f32 v122, v122
  v_mfma_f32_32x32x16_bf16 v[96:111], a[56:59], v[144:147], v[96:111]
  v_exp_f32 v123, v123
  v_exp_f32 v124, v124
  v_exp_f32 v125, v125
  v_exp_f32 v126, v126
  v_exp_f32 v127, v127
  v_cvt_pk_bf16_f32 v148, v120, v121
  v_cvt_pk_bf16_f32 v149, v122, v123
  v_cvt_pk_bf16_f32 v150, v124, v125
  v_cvt_pk_bf16_f32 v151, v126, v127
  s_waitcnt vmcnt(20)
  v_mfma_f32_32x32x16_bf16 v[112:127], a[0:3], v[24:27], 0
  buffer_load_dwordx4 a[44:47], v4, s[40:43], s9 offen offset:3072
  v_exp_f32 v128, v128
  v_exp_f32 v129, v129
  v_exp_f32 v130, v130
  v_exp_f32 v131, v131
  v_mfma_f32_32x32x16_bf16 v[96:111], a[60:63], v[148:151], v[96:111]
  buffer_load_dwordx4 v4, s[40:43], s48 offen offset:0 lds
  v_exp_f32 v132, v132
  v_exp_f32 v133, v133
  v_exp_f32 v134, v134
  v_exp_f32 v135, v135
  v_mfma_f32_32x32x16_bf16 v[112:127], a[4:7], v[28:31], v[112:127]
  v_cvt_pk_bf16_f32 v144, v128, v129
  v_cvt_pk_bf16_f32 v145, v130, v131
  v_cvt_pk_bf16_f32 v146, v132, v133
  v_cvt_pk_bf16_f32 v147, v134, v135
  v_exp_f32 v136, v136
  v_exp_f32 v137, v137
  v_exp_f32 v138, v138
  v_mfma_f32_32x32x16_bf16 v[48:63], a[56:59], v[144:147], v[48:63]
  s_and_b32 s45, s4, 15
  s_lshl_b32 s45, s45, 2
  s_add_u32 s45, s45, s3
  s_lshr_b32 s29, s4, 4
  s_and_b32 s44, s45, 15
  s_lshl_b32 s29, s29, 4
  s_add_u32 s44, s44, s29
  s_lshl_b32 s44, s44, 10
  s_cmp_lt_u32 s45, 32
  s_cselect_b32 s29, 0, 27430912
  s_add_u32 s44, s44, s29
  s_add_u32 s44, s44, 6553600
  buffer_store_dwordx4 v[248:251], v4, s[40:43], s44 offen sc1
  v_exp_f32 v139, v139
  v_exp_f32 v140, v140
  v_exp_f32 v141, v141
  v_exp_f32 v142, v142
  v_exp_f32 v143, v143
  v_cvt_pk_bf16_f32 v148, v136, v137
  v_cvt_pk_bf16_f32 v149, v138, v139
  v_cvt_pk_bf16_f32 v150, v140, v141
  v_cvt_pk_bf16_f32 v151, v142, v143
  v_mfma_f32_32x32x16_bf16 v[128:143], a[0:3], v[32:35], 0
  s_add_u32 s9, s9, 4096
  s_pack_lh_b32_b16 s9, s9, s8
  buffer_load_dwordx4 a[48:51], v4, s[40:43], s9 offen offset:0
  v_exp_f32 v112, v112
  v_exp_f32 v113, v113
  v_exp_f32 v114, v114
  v_exp_f32 v115, v115
  v_mfma_f32_32x32x16_bf16 v[48:63], a[60:63], v[148:151], v[48:63]
  buffer_load_dwordx4 v4, s[40:43], s48 offen offset:1024 lds
  v_exp_f32 v116, v116
  v_exp_f32 v117, v117
  v_exp_f32 v118, v118
  v_exp_f32 v119, v119
  v_mfma_f32_32x32x16_bf16 v[128:143], a[4:7], v[36:39], v[128:143]
  v_cvt_pk_bf16_f32 v144, v112, v113
  v_cvt_pk_bf16_f32 v145, v114, v115
  v_cvt_pk_bf16_f32 v146, v116, v117
  v_cvt_pk_bf16_f32 v147, v118, v119
  v_exp_f32 v120, v120
  v_exp_f32 v121, v121
  v_exp_f32 v122, v122
  v_mfma_f32_32x32x16_bf16 v[64:79], a[8:11], v[144:147], v[64:79]
  buffer_load_dwordx4 v4, s[40:43], s48 offen offset:2048 lds
  v_exp_f32 v123, v123
  v_exp_f32 v124, v124
  v_exp_f32 v125, v125
  v_exp_f32 v126, v126
  v_exp_f32 v127, v127
  v_cvt_pk_bf16_f32 v148, v120, v121
  v_cvt_pk_bf16_f32 v149, v122, v123
  v_cvt_pk_bf16_f32 v150, v124, v125
  v_cvt_pk_bf16_f32 v151, v126, v127
  v_mfma_f32_32x32x16_bf16 v[112:127], a[0:3], v[40:43], 0
  buffer_load_dwordx4 a[52:55], v4, s[40:43], s9 offen offset:1024
  v_exp_f32 v128, v128
  v_exp_f32 v129, v129
  v_exp_f32 v130, v130
  v_exp_f32 v131, v131
  v_mfma_f32_32x32x16_bf16 v[64:79], a[12:15], v[148:151], v[64:79]
  buffer_load_dwordx4 v4, s[40:43], s48 offen offset:3072 lds
  v_exp_f32 v132, v132
  v_exp_f32 v133, v133
  v_exp_f32 v134, v134
  v_exp_f32 v135, v135
  v_mfma_f32_32x32x16_bf16 v[112:127], a[4:7], v[44:47], v[112:127]
  s_add_u32 s57, s57, 16384
  s_cmp_eq_u32 s57, 114688
  s_cselect_b32 s57, 0, s57
  s_add_u32 m0, s63, s57
  s_add_u32 s48, s64, s57
  v_cvt_pk_bf16_f32 v144, v128, v129
  v_cvt_pk_bf16_f32 v145, v130, v131
  v_cvt_pk_bf16_f32 v146, v132, v133
  v_cvt_pk_bf16_f32 v147, v134, v135
  v_exp_f32 v136, v136
  v_exp_f32 v137, v137
  v_exp_f32 v138, v138
  v_mfma_f32_32x32x16_bf16 v[80:95], a[8:11], v[144:147], v[80:95]
  v_exp_f32 v139, v139
  v_exp_f32 v140, v140
  v_exp_f32 v141, v141
  v_exp_f32 v142, v142
  v_exp_f32 v143, v143
  v_cvt_pk_bf16_f32 v148, v136, v137
  v_cvt_pk_bf16_f32 v149, v138, v139
  v_cvt_pk_bf16_f32 v150, v140, v141
  v_cvt_pk_bf16_f32 v151, v142, v143
  v_mfma_f32_32x32x16_bf16 v[128:143], a[0:3], v[16:19], 0
  buffer_load_dwordx4 a[56:59], v4, s[40:43], s9 offen offset:2048
  v_exp_f32 v112, v112
  v_exp_f32 v113, v113
  v_exp_f32 v114, v114
  v_exp_f32 v115, v115
  v_mfma_f32_32x32x16_bf16 v[80:95], a[12:15], v[148:151], v[80:95]
  buffer_load_dwordx4 v4, s[40:43], s48 offen offset:0 lds
  v_exp_f32 v116, v116
  v_exp_f32 v117, v117
  v_exp_f32 v118, v118
  v_exp_f32 v119, v119
  v_mfma_f32_32x32x16_bf16 v[128:143], a[4:7], v[20:23], v[128:143]
  v_cvt_pk_bf16_f32 v144, v112, v113
  v_cvt_pk_bf16_f32 v145, v114, v115
  v_cvt_pk_bf16_f32 v146, v116, v117
  v_cvt_pk_bf16_f32 v147, v118, v119
  v_exp_f32 v120, v120
  v_exp_f32 v121, v121
  v_exp_f32 v122, v122
  v_mfma_f32_32x32x16_bf16 v[96:111], a[8:11], v[144:147], v[96:111]
  s_add_u32 s44, s6, 0
  buffer_store_dwordx4 v[248:251], v4, s[40:43], s44 offen sc1
  v_exp_f32 v123, v123
  v_exp_f32 v124, v124
  v_exp_f32 v125, v125
  v_exp_f32 v126, v126
  v_exp_f32 v127, v127
  v_cvt_pk_bf16_f32 v148, v120, v121
  v_cvt_pk_bf16_f32 v149, v122, v123
  v_cvt_pk_bf16_f32 v150, v124, v125
  v_cvt_pk_bf16_f32 v151, v126, v127
  s_waitcnt vmcnt(20)
  v_mfma_f32_32x32x16_bf16 v[112:127], a[16:19], v[24:27], 0
  buffer_load_dwordx4 a[60:63], v4, s[40:43], s9 offen offset:3072
  v_exp_f32 v128, v128
  v_exp_f32 v129, v129
  v_exp_f32 v130, v130
  v_exp_f32 v131, v131
  v_mfma_f32_32x32x16_bf16 v[96:111], a[12:15], v[148:151], v[96:111]
  buffer_load_dwordx4 v4, s[40:43], s48 offen offset:1024 lds
  v_exp_f32 v132, v132
  v_exp_f32 v133, v133
  v_exp_f32 v134, v134
  v_exp_f32 v135, v135
  v_mfma_f32_32x32x16_bf16 v[112:127], a[20:23], v[28:31], v[112:127]
  v_cvt_pk_bf16_f32 v144, v128, v129
  v_cvt_pk_bf16_f32 v145, v130, v131
  v_cvt_pk_bf16_f32 v146, v132, v133
  v_cvt_pk_bf16_f32 v147, v134, v135
  v_exp_f32 v136, v136
  v_exp_f32 v137, v137
  v_exp_f32 v138, v138
  v_mfma_f32_32x32x16_bf16 v[48:63], a[8:11], v[144:147], v[48:63]
  buffer_load_dwordx4 v4, s[40:43], s48 offen offset:2048 lds
  v_exp_f32 v139, v139
  v_exp_f32 v140, v140
  v_exp_f32 v141, v141
  v_exp_f32 v142, v142
  v_exp_f32 v143, v143
  v_cvt_pk_bf16_f32 v148, v136, v137
  v_cvt_pk_bf16_f32 v149, v138, v139
  v_cvt_pk_bf16_f32 v150, v140, v141
  v_cvt_pk_bf16_f32 v151, v142, v143
  v_mfma_f32_32x32x16_bf16 v[128:143], a[16:19], v[32:35], 0
  s_add_u32 s9, s9, 4096
  s_pack_lh_b32_b16 s9, s9, s8
  buffer_load_dwordx4 a[0:3], v4, s[40:43], s9 offen offset:0
  v_exp_f32 v112, v112
  v_exp_f32 v113, v113
  v_exp_f32 v114, v114
  v_exp_f32 v115, v115
  v_mfma_f32_32x32x16_bf16 v[48:63], a[12:15], v[148:151], v[48:63]
  buffer_load_dwordx4 v4, s[40:43], s48 offen offset:3072 lds
  v_exp_f32 v116, v116
  v_exp_f32 v117, v117
  v_exp_f32 v118, v118
  v_exp_f32 v119, v119
  v_mfma_f32_32x32x16_bf16 v[128:143], a[20:23], v[36:39], v[128:143]
  s_add_u32 s48, s62, s52
  v_cvt_pk_bf16_f32 v144, v112, v113
  v_cvt_pk_bf16_f32 v145, v114, v115
  v_cvt_pk_bf16_f32 v146, v116, v117
  v_cvt_pk_bf16_f32 v147, v118, v119
  v_exp_f32 v120, v120
  v_exp_f32 v121, v121
  v_exp_f32 v122, v122
  v_mfma_f32_32x32x16_bf16 v[64:79], a[24:27], v[144:147], v[64:79]
  v_exp_f32 v123, v123
  v_exp_f32 v124, v124
  v_exp_f32 v125, v125
  v_exp_f32 v126, v126
  v_exp_f32 v127, v127
  v_cvt_pk_bf16_f32 v148, v120, v121
  v_cvt_pk_bf16_f32 v149, v122, v123
  v_cvt_pk_bf16_f32 v150, v124, v125
  v_cvt_pk_bf16_f32 v151, v126, v127
  v_mfma_f32_32x32x16_bf16 v[112:127], a[16:19], v[40:43], 0
  buffer_load_dwordx4 a[4:7], v4, s[40:43], s9 offen offset:1024
  v_exp_f32 v128, v128
  v_exp_f32 v129, v129
  v_exp_f32 v130, v130
  v_exp_f32 v131, v131
  v_mfma_f32_32x32x16_bf16 v[64:79], a[28:31], v[148:151], v[64:79]
  buffer_load_dwordx4 a[64:67], v4, s[68:71], s48 offen offset:0
  v_exp_f32 v132, v132
  v_exp_f32 v133, v133
  v_exp_f32 v134, v134
  v_exp_f32 v135, v135
  v_mfma_f32_32x32x16_bf16 v[112:127], a[20:23], v[44:47], v[112:127]
  v_cvt_pk_bf16_f32 v144, v128, v129
  v_cvt_pk_bf16_f32 v145, v130, v131
  v_cvt_pk_bf16_f32 v146, v132, v133
  v_cvt_pk_bf16_f32 v147, v134, v135
  v_exp_f32 v136, v136
  v_exp_f32 v137, v137
  v_exp_f32 v138, v138
  v_mfma_f32_32x32x16_bf16 v[80:95], a[24:27], v[144:147], v[80:95]
  s_add_u32 s44, s6, 1024
  buffer_store_dwordx4 v[248:251], v4, s[40:43], s44 offen sc1
  v_exp_f32 v139, v139
  v_exp_f32 v140, v140
  v_exp_f32 v141, v141
  v_exp_f32 v142, v142
  v_exp_f32 v143, v143
  v_cvt_pk_bf16_f32 v148, v136, v137
  v_cvt_pk_bf16_f32 v149, v138, v139
  v_cvt_pk_bf16_f32 v150, v140, v141
  v_cvt_pk_bf16_f32 v151, v142, v143
  v_mfma_f32_32x32x16_bf16 v[128:143], a[16:19], v[16:19], 0
  buffer_load_dwordx4 a[8:11], v4, s[40:43], s9 offen offset:2048
  v_exp_f32 v112, v112
  v_exp_f32 v113, v113
  v_exp_f32 v114, v114
  v_exp_f32 v115, v115
  v_mfma_f32_32x32x16_bf16 v[80:95], a[28:31], v[148:151], v[80:95]
  buffer_load_dwordx4 a[68:71], v4, s[68:71], s48 offen offset:1024
  v_exp_f32 v116, v116
  v_exp_f32 v117, v117
  v_exp_f32 v118, v118
  v_exp_f32 v119, v119
  v_mfma_f32_32x32x16_bf16 v[128:143], a[20:23], v[20:23], v[128:143]
  v_cvt_pk_bf16_f32 v144, v112, v113
  v_cvt_pk_bf16_f32 v145, v114, v115
  v_cvt_pk_bf16_f32 v146, v116, v117
  v_cvt_pk_bf16_f32 v147, v118, v119
  v_exp_f32 v120, v120
  v_exp_f32 v121, v121
  v_exp_f32 v122, v122
  v_mfma_f32_32x32x16_bf16 v[96:111], a[24:27], v[144:147], v[96:111]
  buffer_load_dwordx4 a[72:75], v4, s[68:71], s48 offen offset:2048
  v_exp_f32 v123, v123
  v_exp_f32 v124, v124
  v_exp_f32 v125, v125
  v_exp_f32 v126, v126
  v_exp_f32 v127, v127
  v_cvt_pk_bf16_f32 v148, v120, v121
  v_cvt_pk_bf16_f32 v149, v122, v123
  v_cvt_pk_bf16_f32 v150, v124, v125
  v_cvt_pk_bf16_f32 v151, v126, v127
  s_waitcnt vmcnt(21)
  v_mfma_f32_32x32x16_bf16 v[112:127], a[32:35], v[24:27], 0
  buffer_load_dwordx4 a[12:15], v4, s[40:43], s9 offen offset:3072
  v_exp_f32 v128, v128
  v_exp_f32 v129, v129
  v_exp_f32 v130, v130
  v_exp_f32 v131, v131
  v_mfma_f32_32x32x16_bf16 v[96:111], a[28:31], v[148:151], v[96:111]
  buffer_load_dwordx4 a[76:79], v4, s[68:71], s48 offen offset:3072
  v_exp_f32 v132, v132
  v_exp_f32 v133, v133
  v_exp_f32 v134, v134
  v_exp_f32 v135, v135
  v_mfma_f32_32x32x16_bf16 v[112:127], a[36:39], v[28:31], v[112:127]
  s_add_u32 s48, s48, 4096
  v_cvt_pk_bf16_f32 v144, v128, v129
  v_cvt_pk_bf16_f32 v145, v130, v131
  v_cvt_pk_bf16_f32 v146, v132, v133
  v_cvt_pk_bf16_f32 v147, v134, v135
  v_exp_f32 v136, v136
  v_exp_f32 v137, v137
  v_exp_f32 v138, v138
  v_mfma_f32_32x32x16_bf16 v[48:63], a[24:27], v[144:147], v[48:63]
  v_exp_f32 v139, v139
  v_exp_f32 v140, v140
  v_exp_f32 v141, v141
  v_exp_f32 v142, v142
  v_exp_f32 v143, v143
  v_cvt_pk_bf16_f32 v148, v136, v137
  v_cvt_pk_bf16_f32 v149, v138, v139
  v_cvt_pk_bf16_f32 v150, v140, v141
  v_cvt_pk_bf16_f32 v151, v142, v143
  v_mfma_f32_32x32x16_bf16 v[128:143], a[32:35], v[32:35], 0
  s_add_u32 s9, s9, 4096
  s_pack_lh_b32_b16 s9, s9, s8
  buffer_load_dwordx4 a[16:19], v4, s[40:43], s9 offen offset:0
  v_exp_f32 v112, v112
  v_exp_f32 v113, v113
  v_exp_f32 v114, v114
  v_exp_f32 v115, v115
  v_mfma_f32_32x32x16_bf16 v[48:63], a[28:31], v[148:151], v[48:63]
  buffer_load_dwordx4 a[80:83], v4, s[68:71], s48 offen offset:0
  v_exp_f32 v116, v116
  v_exp_f32 v117, v117
  v_exp_f32 v118, v118
  v_exp_f32 v119, v119
  v_mfma_f32_32x32x16_bf16 v[128:143], a[36:39], v[36:39], v[128:143]
  v_cvt_pk_bf16_f32 v144, v112, v113
  v_cvt_pk_bf16_f32 v145, v114, v115
  v_cvt_pk_bf16_f32 v146, v116, v117
  v_cvt_pk_bf16_f32 v147, v118, v119
  v_exp_f32 v120, v120
  v_exp_f32 v121, v121
  v_exp_f32 v122, v122
  v_mfma_f32_32x32x16_bf16 v[64:79], a[40:43], v[144:147], v[64:79]
  s_add_u32 s44, s6, 2048
  buffer_store_dwordx4 v[248:251], v4, s[40:43], s44 offen sc1
  v_exp_f32 v123, v123
  v_exp_f32 v124, v124
  v_exp_f32 v125, v125
  v_exp_f32 v126, v126
  v_exp_f32 v127, v127
  v_cvt_pk_bf16_f32 v148, v120, v121
  v_cvt_pk_bf16_f32 v149, v122, v123
  v_cvt_pk_bf16_f32 v150, v124, v125
  v_cvt_pk_bf16_f32 v151, v126, v127
  v_mfma_f32_32x32x16_bf16 v[112:127], a[32:35], v[40:43], 0
  buffer_load_dwordx4 a[20:23], v4, s[40:43], s9 offen offset:1024
  v_exp_f32 v128, v128
  v_exp_f32 v129, v129
  v_exp_f32 v130, v130
  v_exp_f32 v131, v131
  v_mfma_f32_32x32x16_bf16 v[64:79], a[44:47], v[148:151], v[64:79]
  buffer_load_dwordx4 a[84:87], v4, s[68:71], s48 offen offset:1024
  v_exp_f32 v132, v132
  v_exp_f32 v133, v133
  v_exp_f32 v134, v134
  v_exp_f32 v135, v135
  v_mfma_f32_32x32x16_bf16 v[112:127], a[36:39], v[44:47], v[112:127]
  v_cvt_pk_bf16_f32 v144, v128, v129
  v_cvt_pk_bf16_f32 v145, v130, v131
  v_cvt_pk_bf16_f32 v146, v132, v133
  v_cvt_pk_bf16_f32 v147, v134, v135
  v_exp_f32 v136, v136
  v_exp_f32 v137, v137
  v_exp_f32 v138, v138
  v_mfma_f32_32x32x16_bf16 v[80:95], a[40:43], v[144:147], v[80:95]
  buffer_load_dwordx4 a[88:91], v4, s[68:71], s48 offen offset:2048
  v_exp_f32 v139, v139
  v_exp_f32 v140, v140
  v_exp_f32 v141, v141
  v_exp_f32 v142, v142
  v_exp_f32 v143, v143
  v_cvt_pk_bf16_f32 v148, v136, v137
  v_cvt_pk_bf16_f32 v149, v138, v139
  v_cvt_pk_bf16_f32 v150, v140, v141
  v_cvt_pk_bf16_f32 v151, v142, v143
  v_mfma_f32_32x32x16_bf16 v[128:143], a[32:35], v[16:19], 0
  buffer_load_dwordx4 a[24:27], v4, s[40:43], s9 offen offset:2048
  v_exp_f32 v112, v112
  v_exp_f32 v113, v113
  v_exp_f32 v114, v114
  v_exp_f32 v115, v115
  v_mfma_f32_32x32x16_bf16 v[80:95], a[44:47], v[148:151], v[80:95]
  s_add_u32 s48, s62, s53
  buffer_load_dwordx4 a[92:95], v4, s[68:71], s48 offen offset:0
  v_exp_f32 v116, v116
  v_exp_f32 v117, v117
  v_exp_f32 v118, v118
  v_exp_f32 v119, v119
  v_mfma_f32_32x32x16_bf16 v[128:143], a[36:39], v[20:23], v[128:143]
  v_cvt_pk_bf16_f32 v144, v112, v113
  v_cvt_pk_bf16_f32 v145, v114, v115
  v_cvt_pk_bf16_f32 v146, v116, v117
  v_cvt_pk_bf16_f32 v147, v118, v119
  v_exp_f32 v120, v120
  v_exp_f32 v121, v121
  v_exp_f32 v122, v122
  v_mfma_f32_32x32x16_bf16 v[96:111], a[40:43], v[144:147], v[96:111]
  v_exp_f32 v123, v123
  v_exp_f32 v124, v124
  v_exp_f32 v125, v125
  v_exp_f32 v126, v126
  v_exp_f32 v127, v127
  v_cvt_pk_bf16_f32 v148, v120, v121
  v_cvt_pk_bf16_f32 v149, v122, v123
  v_cvt_pk_bf16_f32 v150, v124, v125
  v_cvt_pk_bf16_f32 v151, v126, v127
  s_waitcnt vmcnt(20)
  v_mfma_f32_32x32x16_bf16 v[112:127], a[48:51], v[24:27], 0
  buffer_load_dwordx4 a[28:31], v4, s[40:43], s9 offen offset:3072
  v_exp_f32 v128, v128
  v_exp_f32 v129, v129
  v_exp_f32 v130, v130
  v_exp_f32 v131, v131
  v_mfma_f32_32x32x16_bf16 v[96:111], a[44:47], v[148:151], v[96:111]
  buffer_load_dwordx4 a[96:99], v4, s[68:71], s48 offen offset:1024
  v_exp_f32 v132, v132
  v_exp_f32 v133, v133
  v_exp_f32 v134, v134
  v_exp_f32 v135, v135
  v_mfma_f32_32x32x16_bf16 v[112:127], a[52:55], v[28:31], v[112:127]
  v_cvt_pk_bf16_f32 v144, v128, v129
  v_cvt_pk_bf16_f32 v145, v130, v131
  v_cvt_pk_bf16_f32 v146, v132, v133
  v_cvt_pk_bf16_f32 v147, v134, v135
  v_exp_f32 v136, v136
  v_exp_f32 v137, v137
  v_exp_f32 v138, v138
  v_mfma_f32_32x32x16_bf16 v[48:63], a[40:43], v[144:147], v[48:63]
  s_add_u32 s44, s6, 3072
  buffer_store_dwordx4 v[248:251], v4, s[40:43], s44 offen sc1
  v_exp_f32 v139, v139
  v_exp_f32 v140, v140
  v_exp_f32 v141, v141
  v_exp_f32 v142, v142
  v_exp_f32 v143, v143
  v_cvt_pk_bf16_f32 v148, v136, v137
  v_cvt_pk_bf16_f32 v149, v138, v139
  v_cvt_pk_bf16_f32 v150, v140, v141
  v_cvt_pk_bf16_f32 v151, v142, v143
  v_mfma_f32_32x32x16_bf16 v[128:143], a[48:51], v[32:35], 0
  s_add_u32 s9, s9, 4096
  s_pack_lh_b32_b16 s9, s9, s8
  buffer_load_dwordx4 a[32:35], v4, s[40:43], s9 offen offset:0
  v_exp_f32 v112, v112
  v_exp_f32 v113, v113
  v_exp_f32 v114, v114
  v_exp_f32 v115, v115
  v_mfma_f32_32x32x16_bf16 v[48:63], a[44:47], v[148:151], v[48:63]
  buffer_load_dwordx4 a[100:103], v4, s[68:71], s48 offen offset:2048
  v_exp_f32 v116, v116
  v_exp_f32 v117, v117
  v_exp_f32 v118, v118
  v_exp_f32 v119, v119
  v_mfma_f32_32x32x16_bf16 v[128:143], a[52:55], v[36:39], v[128:143]
  v_cvt_pk_bf16_f32 v144, v112, v113
  v_cvt_pk_bf16_f32 v145, v114, v115
  v_cvt_pk_bf16_f32 v146, v116, v117
  v_cvt_pk_bf16_f32 v147, v118, v119
  v_exp_f32 v120, v120
  v_exp_f32 v121, v121
  v_exp_f32 v122, v122
  v_mfma_f32_32x32x16_bf16 v[64:79], a[56:59], v[144:147], v[64:79]
  s_lshr_b32 s29, s4, 4
  s_lshl_b32 s29, s29, 9
  s_add_u32 s29, s29, 36352000
  s_lshl_b32 s45, s3, 7
  s_add_u32 s29, s29, s45
  v_mov_b32 v254, 1
  v_mov_b32 v255, 0
  s_mov_b64 exec, 1
  buffer_atomic_add v254, v255, s[40:43], s29 offen sc1
  s_mov_b64 exec, -1
  buffer_load_dwordx4 a[104:107], v4, s[68:71], s48 offen offset:3072
  v_exp_f32 v123, v123
  v_exp_f32 v124, v124
  v_exp_f32 v125, v125
  v_exp_f32 v126, v126
  v_exp_f32 v127, v127
  v_cvt_pk_bf16_f32 v148, v120, v121
  v_cvt_pk_bf16_f32 v149, v122, v123
  v_cvt_pk_bf16_f32 v150, v124, v125
  v_cvt_pk_bf16_f32 v151, v126, v127
  v_mfma_f32_32x32x16_bf16 v[112:127], a[48:51], v[40:43], 0
  buffer_load_dwordx4 a[36:39], v4, s[40:43], s9 offen offset:1024
  v_exp_f32 v128, v128
  v_exp_f32 v129, v129
  v_exp_f32 v130, v130
  v_exp_f32 v131, v131
  v_mfma_f32_32x32x16_bf16 v[64:79], a[60:63], v[148:151], v[64:79]
  s_add_u32 s48, s48, 4096
  buffer_load_dwordx4 a[108:111], v4, s[68:71], s48 offen offset:0
  v_exp_f32 v132, v132
  v_exp_f32 v133, v133
  v_exp_f32 v134, v134
  v_exp_f32 v135, v135
  v_mfma_f32_32x32x16_bf16 v[112:127], a[52:55], v[44:47], v[112:127]
  v_cvt_pk_bf16_f32 v144, v128, v129
  v_cvt_pk_bf16_f32 v145, v130, v131
  v_cvt_pk_bf16_f32 v146, v132, v133
  v_cvt_pk_bf16_f32 v147, v134, v135
  v_exp_f32 v136, v136
  v_exp_f32 v137, v137
  v_exp_f32 v138, v138
  v_mfma_f32_32x32x16_bf16 v[80:95], a[56:59], v[144:147], v[80:95]
  v_exp_f32 v139, v139
  v_exp_f32 v140, v140
  v_exp_f32 v141, v141
  v_exp_f32 v142, v142
  v_exp_f32 v143, v143
  v_cvt_pk_bf16_f32 v148, v136, v137
  v_cvt_pk_bf16_f32 v149, v138, v139
  v_cvt_pk_bf16_f32 v150, v140, v141
  v_cvt_pk_bf16_f32 v151, v142, v143
  v_mfma_f32_32x32x16_bf16 v[128:143], a[48:51], v[16:19], 0
  buffer_load_dwordx4 a[40:43], v4, s[40:43], s9 offen offset:2048
  v_exp_f32 v112, v112
  v_exp_f32 v113, v113
  v_exp_f32 v114, v114
  v_exp_f32 v115, v115
  v_mfma_f32_32x32x16_bf16 v[80:95], a[60:63], v[148:151], v[80:95]
  buffer_load_dwordx4 a[112:115], v4, s[68:71], s48 offen offset:1024
  v_exp_f32 v116, v116
  v_exp_f32 v117, v117
  v_exp_f32 v118, v118
  v_exp_f32 v119, v119
  v_mfma_f32_32x32x16_bf16 v[128:143], a[52:55], v[20:23], v[128:143]
  v_cvt_pk_bf16_f32 v144, v112, v113
  v_cvt_pk_bf16_f32 v145, v114, v115
  v_cvt_pk_bf16_f32 v146, v116, v117
  v_cvt_pk_bf16_f32 v147, v118, v119
  v_exp_f32 v120, v120
  v_exp_f32 v121, v121
  v_exp_f32 v122, v122
  v_mfma_f32_32x32x16_bf16 v[96:111], a[56:59], v[144:147], v[96:111]
  s_add_u32 s44, s6, 4096
  buffer_store_dwordx4 v[248:251], v4, s[40:43], s44 offen sc1
  v_exp_f32 v123, v123
  v_exp_f32 v124, v124
  v_exp_f32 v125, v125
  v_exp_f32 v126, v126
  v_exp_f32 v127, v127
  v_cvt_pk_bf16_f32 v148, v120, v121
  v_cvt_pk_bf16_f32 v149, v122, v123
  v_cvt_pk_bf16_f32 v150, v124, v125
  v_cvt_pk_bf16_f32 v151, v126, v127
  s_waitcnt vmcnt(21)
  v_mfma_f32_32x32x16_bf16 v[112:127], a[0:3], v[24:27], 0
  buffer_load_dwordx4 a[44:47], v4, s[40:43], s9 offen offset:3072
  v_exp_f32 v128, v128
  v_exp_f32 v129, v129
  v_exp_f32 v130, v130
  v_exp_f32 v131, v131
  v_mfma_f32_32x32x16_bf16 v[96:111], a[60:63], v[148:151], v[96:111]
  buffer_load_dwordx4 a[116:119], v4, s[68:71], s48 offen offset:2048
  v_exp_f32 v132, v132
  v_exp_f32 v133, v133
  v_exp_f32 v134, v134
  v_exp_f32 v135, v135
  v_mfma_f32_32x32x16_bf16 v[112:127], a[4:7], v[28:31], v[112:127]
  s_add_u32 s48, s62, s54
  v_cvt_pk_bf16_f32 v144, v128, v129
  v_cvt_pk_bf16_f32 v145, v130, v131
  v_cvt_pk_bf16_f32 v146, v132, v133
  v_cvt_pk_bf16_f32 v147, v134, v135
  v_exp_f32 v136, v136
  v_exp_f32 v137, v137
  v_exp_f32 v138, v138
  v_mfma_f32_32x32x16_bf16 v[48:63], a[56:59], v[144:147], v[48:63]
  buffer_load_dwordx4 a[120:123], v4, s[68:71], s48 offen offset:0
  v_exp_f32 v139, v139
  v_exp_f32 v140, v140
  v_exp_f32 v141, v141
  v_exp_f32 v142, v142
  v_exp_f32 v143, v143
  v_cvt_pk_bf16_f32 v148, v136, v137
  v_cvt_pk_bf16_f32 v149, v138, v139
  v_cvt_pk_bf16_f32 v150, v140, v141
  v_cvt_pk_bf16_f32 v151, v142, v143
  v_mfma_f32_32x32x16_bf16 v[128:143], a[0:3], v[32:35], 0
  s_add_u32 s9, s9, 4096
  s_pack_lh_b32_b16 s9, s9, s8
  buffer_load_dwordx4 a[48:51], v4, s[40:43], s9 offen offset:0
  v_exp_f32 v112, v112
  v_exp_f32 v113, v113
  v_exp_f32 v114, v114
  v_exp_f32 v115, v115
  v_mfma_f32_32x32x16_bf16 v[48:63], a[60:63], v[148:151], v[48:63]
  buffer_load_dwordx4 a[124:127], v4, s[68:71], s48 offen offset:1024
  v_exp_f32 v116, v116
  v_exp_f32 v117, v117
  v_exp_f32 v118, v118
  v_exp_f32 v119, v119
  v_mfma_f32_32x32x16_bf16 v[128:143], a[4:7], v[36:39], v[128:143]
  v_cvt_pk_bf16_f32 v144, v112, v113
  v_cvt_pk_bf16_f32 v145, v114, v115
  v_cvt_pk_bf16_f32 v146, v116, v117
  v_cvt_pk_bf16_f32 v147, v118, v119
  v_exp_f32 v120, v120
  v_exp_f32 v121, v121
  v_exp_f32 v122, v122
  v_mfma_f32_32x32x16_bf16 v[64:79], a[8:11], v[144:147], v[64:79]
  v_exp_f32 v123, v123
  v_exp_f32 v124, v124
  v_exp_f32 v125, v125
  v_exp_f32 v126, v126
  v_exp_f32 v127, v127
  v_cvt_pk_bf16_f32 v148, v120, v121
  v_cvt_pk_bf16_f32 v149, v122, v123
  v_cvt_pk_bf16_f32 v150, v124, v125
  v_cvt_pk_bf16_f32 v151, v126, v127
  v_mfma_f32_32x32x16_bf16 v[112:127], a[0:3], v[40:43], 0
  buffer_load_dwordx4 a[52:55], v4, s[40:43], s9 offen offset:1024
  v_exp_f32 v128, v128
  v_exp_f32 v129, v129
  v_exp_f32 v130, v130
  v_exp_f32 v131, v131
  v_mfma_f32_32x32x16_bf16 v[64:79], a[12:15], v[148:151], v[64:79]
  buffer_load_dwordx4 a[128:131], v4, s[68:71], s48 offen offset:2048
  v_exp_f32 v132, v132
  v_exp_f32 v133, v133
  v_exp_f32 v134, v134
  v_exp_f32 v135, v135
  v_mfma_f32_32x32x16_bf16 v[112:127], a[4:7], v[44:47], v[112:127]
  v_cvt_pk_bf16_f32 v144, v128, v129
  v_cvt_pk_bf16_f32 v145, v130, v131
  v_cvt_pk_bf16_f32 v146, v132, v133
  v_cvt_pk_bf16_f32 v147, v134, v135
  v_exp_f32 v136, v136
  v_exp_f32 v137, v137
  v_exp_f32 v138, v138
  v_mfma_f32_32x32x16_bf16 v[80:95], a[8:11], v[144:147], v[80:95]
  s_add_u32 s44, s6, 5120
  buffer_store_dwordx4 v[248:251], v4, s[40:43], s44 offen sc1
  v_exp_f32 v139, v139
  v_exp_f32 v140, v140
  v_exp_f32 v141, v141
  v_exp_f32 v142, v142
  v_exp_f32 v143, v143
  v_cvt_pk_bf16_f32 v148, v136, v137
  v_cvt_pk_bf16_f32 v149, v138, v139
  v_cvt_pk_bf16_f32 v150, v140, v141
  v_cvt_pk_bf16_f32 v151, v142, v143
  v_mfma_f32_32x32x16_bf16 v[128:143], a[0:3], v[16:19], 0
  buffer_load_dwordx4 a[56:59], v4, s[40:43], s9 offen offset:2048
  v_exp_f32 v112, v112
  v_exp_f32 v113, v113
  v_exp_f32 v114, v114
  v_exp_f32 v115, v115
  v_mfma_f32_32x32x16_bf16 v[80:95], a[12:15], v[148:151], v[80:95]
  buffer_load_dwordx4 a[132:135], v4, s[68:71], s48 offen offset:3072
  v_exp_f32 v116, v116
  v_exp_f32 v117, v117
  v_exp_f32 v118, v118
  v_exp_f32 v119, v119
  v_mfma_f32_32x32x16_bf16 v[128:143], a[4:7], v[20:23], v[128:143]
  s_add_u32 s48, s48, 4096
  v_cvt_pk_bf16_f32 v144, v112, v113
  v_cvt_pk_bf16_f32 v145, v114, v115
  v_cvt_pk_bf16_f32 v146, v116, v117
  v_cvt_pk_bf16_f32 v147, v118, v119
  v_exp_f32 v120, v120
  v_exp_f32 v121, v121
  v_exp_f32 v122, v122
  v_mfma_f32_32x32x16_bf16 v[96:111], a[8:11], v[144:147], v[96:111]
  buffer_load_dwordx4 a[136:139], v4, s[68:71], s48 offen offset:0
  v_exp_f32 v123, v123
  v_exp_f32 v124, v124
  v_exp_f32 v125, v125
  v_exp_f32 v126, v126
  v_exp_f32 v127, v127
  v_cvt_pk_bf16_f32 v148, v120, v121
  v_cvt_pk_bf16_f32 v149, v122, v123
  v_cvt_pk_bf16_f32 v150, v124, v125
  v_cvt_pk_bf16_f32 v151, v126, v127
  s_waitcnt vmcnt(22)
  v_mfma_f32_32x32x16_bf16 v[112:127], a[16:19], v[24:27], 0
  buffer_load_dwordx4 a[60:63], v4, s[40:43], s9 offen offset:3072
  v_exp_f32 v128, v128
  v_exp_f32 v129, v129
  v_exp_f32 v130, v130
  v_exp_f32 v131, v131
  v_mfma_f32_32x32x16_bf16 v[96:111], a[12:15], v[148:151], v[96:111]
  buffer_load_dwordx4 a[140:143], v4, s[68:71], s48 offen offset:1024
  v_exp_f32 v132, v132
  v_exp_f32 v133, v133
  v_exp_f32 v134, v134
  v_exp_f32 v135, v135
  v_mfma_f32_32x32x16_bf16 v[112:127], a[20:23], v[28:31], v[112:127]
  v_cvt_pk_bf16_f32 v144, v128, v129
  v_cvt_pk_bf16_f32 v145, v130, v131
  v_cvt_pk_bf16_f32 v146, v132, v133
  v_cvt_pk_bf16_f32 v147, v134, v135
  v_exp_f32 v136, v136
  v_exp_f32 v137, v137
  v_exp_f32 v138, v138
  v_mfma_f32_32x32x16_bf16 v[48:63], a[8:11], v[144:147], v[48:63]
  v_exp_f32 v139, v139
  v_exp_f32 v140, v140
  v_exp_f32 v141, v141
  v_exp_f32 v142, v142
  v_exp_f32 v143, v143
  v_cvt_pk_bf16_f32 v148, v136, v137
  v_cvt_pk_bf16_f32 v149, v138, v139
  v_cvt_pk_bf16_f32 v150, v140, v141
  v_cvt_pk_bf16_f32 v151, v142, v143
  v_mfma_f32_32x32x16_bf16 v[128:143], a[16:19], v[32:35], 0
  s_add_u32 s9, s9, 4096
  s_pack_lh_b32_b16 s9, s9, s8
  buffer_load_dwordx4 a[0:3], v4, s[40:43], s9 offen offset:0
  v_exp_f32 v112, v112
  v_exp_f32 v113, v113
  v_exp_f32 v114, v114
  v_exp_f32 v115, v115
  v_mfma_f32_32x32x16_bf16 v[48:63], a[12:15], v[148:151], v[48:63]
  buffer_load_dwordx4 a[144:147], v4, s[68:71], s48 offen offset:2048
  v_exp_f32 v116, v116
  v_exp_f32 v117, v117
  v_exp_f32 v118, v118
  v_exp_f32 v119, v119
  v_mfma_f32_32x32x16_bf16 v[128:143], a[20:23], v[36:39], v[128:143]
  s_add_u32 s48, s62, s55
  v_cvt_pk_bf16_f32 v144, v112, v113
  v_cvt_pk_bf16_f32 v145, v114, v115
  v_cvt_pk_bf16_f32 v146, v116, v117
  v_cvt_pk_bf16_f32 v147, v118, v119
  v_exp_f32 v120, v120
  v_exp_f32 v121, v121
  v_exp_f32 v122, v122
  v_mfma_f32_32x32x16_bf16 v[64:79], a[24:27], v[144:147], v[64:79]
  s_add_u32 s44, s6, 6144
  buffer_store_dwordx4 v[248:251], v4, s[40:43], s44 offen sc1
  v_exp_f32 v123, v123
  v_exp_f32 v124, v124
  v_exp_f32 v125, v125
  v_exp_f32 v126, v126
  v_exp_f32 v127, v127
  v_cvt_pk_bf16_f32 v148, v120, v121
  v_cvt_pk_bf16_f32 v149, v122, v123
  v_cvt_pk_bf16_f32 v150, v124, v125
  v_cvt_pk_bf16_f32 v151, v126, v127
  v_mfma_f32_32x32x16_bf16 v[112:127], a[16:19], v[40:43], 0
  buffer_load_dwordx4 a[4:7], v4, s[40:43], s9 offen offset:1024
  v_exp_f32 v128, v128
  v_exp_f32 v129, v129
  v_exp_f32 v130, v130
  v_exp_f32 v131, v131
  v_mfma_f32_32x32x16_bf16 v[64:79], a[28:31], v[148:151], v[64:79]
  buffer_load_dwordx4 a[148:151], v4, s[68:71], s48 offen offset:0
  v_exp_f32 v132, v132
  v_exp_f32 v133, v133
  v_exp_f32 v134, v134
  v_exp_f32 v135, v135
  v_mfma_f32_32x32x16_bf16 v[112:127], a[20:23], v[44:47], v[112:127]
  v_cvt_pk_bf16_f32 v144, v128, v129
  v_cvt_pk_bf16_f32 v145, v130, v131
  v_cvt_pk_bf16_f32 v146, v132, v133
  v_cvt_pk_bf16_f32 v147, v134, v135
  v_exp_f32 v136, v136
  v_exp_f32 v137, v137
  v_exp_f32 v138, v138
  v_mfma_f32_32x32x16_bf16 v[80:95], a[24:27], v[144:147], v[80:95]
  v_exp_f32 v139, v139
  v_exp_f32 v140, v140
  v_exp_f32 v141, v141
  v_exp_f32 v142, v142
  v_exp_f32 v143, v143
  v_cvt_pk_bf16_f32 v148, v136, v137
  v_cvt_pk_bf16_f32 v149, v138, v139
  v_cvt_pk_bf16_f32 v150, v140, v141
  v_cvt_pk_bf16_f32 v151, v142, v143
  v_mfma_f32_32x32x16_bf16 v[128:143], a[16:19], v[16:19], 0
  buffer_load_dwordx4 a[8:11], v4, s[40:43], s9 offen offset:2048
  v_exp_f32 v112, v112
  v_exp_f32 v113, v113
  v_exp_f32 v114, v114
  v_exp_f32 v115, v115
  v_mfma_f32_32x32x16_bf16 v[80:95], a[28:31], v[148:151], v[80:95]
  buffer_load_dwordx4 a[152:155], v4, s[68:71], s48 offen offset:1024
  v_exp_f32 v116, v116
  v_exp_f32 v117, v117
  v_exp_f32 v118, v118
  v_exp_f32 v119, v119
  v_mfma_f32_32x32x16_bf16 v[128:143], a[20:23], v[20:23], v[128:143]
  v_cvt_pk_bf16_f32 v144, v112, v113
  v_cvt_pk_bf16_f32 v145, v114, v115
  v_cvt_pk_bf16_f32 v146, v116, v117
  v_cvt_pk_bf16_f32 v147, v118, v119
  v_exp_f32 v120, v120
  v_exp_f32 v121, v121
  v_exp_f32 v122, v122
  v_mfma_f32_32x32x16_bf16 v[96:111], a[24:27], v[144:147], v[96:111]
  v_exp_f32 v123, v123
  v_exp_f32 v124, v124
  v_exp_f32 v125, v125
  v_exp_f32 v126, v126
  v_exp_f32 v127, v127
  v_cvt_pk_bf16_f32 v148, v120, v121
  v_cvt_pk_bf16_f32 v149, v122, v123
  v_cvt_pk_bf16_f32 v150, v124, v125
  v_cvt_pk_bf16_f32 v151, v126, v127
  s_waitcnt vmcnt(19)
  v_mfma_f32_32x32x16_bf16 v[112:127], a[32:35], v[24:27], 0
  buffer_load_dwordx4 a[12:15], v4, s[40:43], s9 offen offset:3072
  v_exp_f32 v128, v128
  v_exp_f32 v129, v129
  v_exp_f32 v130, v130
  v_exp_f32 v131, v131
  v_mfma_f32_32x32x16_bf16 v[96:111], a[28:31], v[148:151], v[96:111]
  buffer_load_dwordx4 a[156:159], v4, s[68:71], s48 offen offset:2048
  v_exp_f32 v132, v132
  v_exp_f32 v133, v133
  v_exp_f32 v134, v134
  v_exp_f32 v135, v135
  v_mfma_f32_32x32x16_bf16 v[112:127], a[36:39], v[28:31], v[112:127]
  v_cvt_pk_bf16_f32 v144, v128, v129
  v_cvt_pk_bf16_f32 v145, v130, v131
  v_cvt_pk_bf16_f32 v146, v132, v133
  v_cvt_pk_bf16_f32 v147, v134, v135
  v_exp_f32 v136, v136
  v_exp_f32 v137, v137
  v_exp_f32 v138, v138
  v_mfma_f32_32x32x16_bf16 v[48:63], a[24:27], v[144:147], v[48:63]
  s_add_u32 s44, s12, 25690112
  buffer_store_dwordx4 v[248:251], v4, s[68:71], s44 offen sc1
  v_exp_f32 v139, v139
  v_exp_f32 v140, v140
  v_exp_f32 v141, v141
  v_exp_f32 v142, v142
  v_exp_f32 v143, v143
  v_cvt_pk_bf16_f32 v148, v136, v137
  v_cvt_pk_bf16_f32 v149, v138, v139
  v_cvt_pk_bf16_f32 v150, v140, v141
  v_cvt_pk_bf16_f32 v151, v142, v143
  v_mfma_f32_32x32x16_bf16 v[128:143], a[32:35], v[32:35], 0
  s_add_u32 s9, s9, 4096
  s_pack_lh_b32_b16 s9, s9, s8
  buffer_load_dwordx4 a[16:19], v4, s[40:43], s9 offen offset:0
  v_exp_f32 v112, v112
  v_exp_f32 v113, v113
  v_exp_f32 v114, v114
  v_exp_f32 v115, v115
  v_mfma_f32_32x32x16_bf16 v[48:63], a[28:31], v[148:151], v[48:63]
  buffer_load_dwordx4 a[160:163], v4, s[68:71], s48 offen offset:3072
  v_exp_f32 v116, v116
  v_exp_f32 v117, v117
  v_exp_f32 v118, v118
  v_exp_f32 v119, v119
  v_mfma_f32_32x32x16_bf16 v[128:143], a[36:39], v[36:39], v[128:143]
  s_add_u32 s48, s48, 4096
  v_cvt_pk_bf16_f32 v144, v112, v113
  v_cvt_pk_bf16_f32 v145, v114, v115
  v_cvt_pk_bf16_f32 v146, v116, v117
  v_cvt_pk_bf16_f32 v147, v118, v119
  v_exp_f32 v120, v120
  v_exp_f32 v121, v121
  v_exp_f32 v122, v122
  v_mfma_f32_32x32x16_bf16 v[64:79], a[40:43], v[144:147], v[64:79]
  v_exp_f32 v123, v123
  v_exp_f32 v124, v124
  v_exp_f32 v125, v125
  v_exp_f32 v126, v126
  v_exp_f32 v127, v127
  v_cvt_pk_bf16_f32 v148, v120, v121
  v_cvt_pk_bf16_f32 v149, v122, v123
  v_cvt_pk_bf16_f32 v150, v124, v125
  v_cvt_pk_bf16_f32 v151, v126, v127
  v_mfma_f32_32x32x16_bf16 v[112:127], a[32:35], v[40:43], 0
  buffer_load_dwordx4 a[20:23], v4, s[40:43], s9 offen offset:1024
  v_exp_f32 v128, v128
  v_exp_f32 v129, v129
  v_exp_f32 v130, v130
  v_exp_f32 v131, v131
  v_mfma_f32_32x32x16_bf16 v[64:79], a[44:47], v[148:151], v[64:79]
  buffer_load_dwordx4 a[164:167], v4, s[68:71], s48 offen offset:0
  v_exp_f32 v132, v132
  v_exp_f32 v133, v133
  v_exp_f32 v134, v134
  v_exp_f32 v135, v135
  v_mfma_f32_32x32x16_bf16 v[112:127], a[36:39], v[44:47], v[112:127]
  v_cvt_pk_bf16_f32 v144, v128, v129
  v_cvt_pk_bf16_f32 v145, v130, v131
  v_cvt_pk_bf16_f32 v146, v132, v133
  v_cvt_pk_bf16_f32 v147, v134, v135
  v_exp_f32 v136, v136
  v_exp_f32 v137, v137
  v_exp_f32 v138, v138
  v_mfma_f32_32x32x16_bf16 v[80:95], a[40:43], v[144:147], v[80:95]
  v_exp_f32 v139, v139
  v_exp_f32 v140, v140
  v_exp_f32 v141, v141
  v_exp_f32 v142, v142
  v_exp_f32 v143, v143
  v_cvt_pk_bf16_f32 v148, v136, v137
  v_cvt_pk_bf16_f32 v149, v138, v139
  v_cvt_pk_bf16_f32 v150, v140, v141
  v_cvt_pk_bf16_f32 v151, v142, v143
  v_mfma_f32_32x32x16_bf16 v[128:143], a[32:35], v[16:19], 0
  buffer_load_dwordx4 a[24:27], v4, s[40:43], s9 offen offset:2048
  v_exp_f32 v112, v112
  v_exp_f32 v113, v113
  v_exp_f32 v114, v114
  v_exp_f32 v115, v115
  v_mfma_f32_32x32x16_bf16 v[80:95], a[44:47], v[148:151], v[80:95]
  buffer_load_dwordx4 a[168:171], v4, s[68:71], s48 offen offset:1024
  v_exp_f32 v116, v116
  v_exp_f32 v117, v117
  v_exp_f32 v118, v118
  v_exp_f32 v119, v119
  v_mfma_f32_32x32x16_bf16 v[128:143], a[36:39], v[20:23], v[128:143]
  v_cvt_pk_bf16_f32 v144, v112, v113
  v_cvt_pk_bf16_f32 v145, v114, v115
  v_cvt_pk_bf16_f32 v146, v116, v117
  v_cvt_pk_bf16_f32 v147, v118, v119
  v_exp_f32 v120, v120
  v_exp_f32 v121, v121
  v_exp_f32 v122, v122
  v_mfma_f32_32x32x16_bf16 v[96:111], a[40:43], v[144:147], v[96:111]
  s_add_u32 s44, s12, 25691136
  buffer_store_dwordx4 v[248:251], v4, s[68:71], s44 offen sc1
  v_exp_f32 v123, v123
  v_exp_f32 v124, v124
  v_exp_f32 v125, v125
  v_exp_f32 v126, v126
  v_exp_f32 v127, v127
  v_cvt_pk_bf16_f32 v148, v120, v121
  v_cvt_pk_bf16_f32 v149, v122, v123
  v_cvt_pk_bf16_f32 v150, v124, v125
  v_cvt_pk_bf16_f32 v151, v126, v127
  s_waitcnt vmcnt(18)
  v_mfma_f32_32x32x16_bf16 v[112:127], a[48:51], v[24:27], 0
  buffer_load_dwordx4 a[28:31], v4, s[40:43], s9 offen offset:3072
  v_exp_f32 v128, v128
  v_exp_f32 v129, v129
  v_exp_f32 v130, v130
  v_exp_f32 v131, v131
  v_mfma_f32_32x32x16_bf16 v[96:111], a[44:47], v[148:151], v[96:111]
  buffer_load_dwordx4 a[172:175], v4, s[68:71], s48 offen offset:2048
  v_exp_f32 v132, v132
  v_exp_f32 v133, v133
  v_exp_f32 v134, v134
  v_exp_f32 v135, v135
  v_mfma_f32_32x32x16_bf16 v[112:127], a[52:55], v[28:31], v[112:127]
  s_add_u32 s48, s65, s52
  v_cvt_pk_bf16_f32 v144, v128, v129
  v_cvt_pk_bf16_f32 v145, v130, v131
  v_cvt_pk_bf16_f32 v146, v132, v133
  v_cvt_pk_bf16_f32 v147, v134, v135
  v_exp_f32 v136, v136
  v_exp_f32 v137, v137
  v_exp_f32 v138, v138
  v_mfma_f32_32x32x16_bf16 v[48:63], a[40:43], v[144:147], v[48:63]
  v_exp_f32 v139, v139
  v_exp_f32 v140, v140
  v_exp_f32 v141, v141
  v_exp_f32 v142, v142
  v_exp_f32 v143, v143
  v_cvt_pk_bf16_f32 v148, v136, v137
  v_cvt_pk_bf16_f32 v149, v138, v139
  v_cvt_pk_bf16_f32 v150, v140, v141
  v_cvt_pk_bf16_f32 v151, v142, v143
  v_mfma_f32_32x32x16_bf16 v[128:143], a[48:51], v[32:35], 0
  s_add_u32 s9, s9, 4096
  s_pack_lh_b32_b16 s9, s9, s8
  buffer_load_dwordx4 a[32:35], v4, s[40:43], s9 offen offset:0
  v_exp_f32 v112, v112
  v_exp_f32 v113, v113
  v_exp_f32 v114, v114
  v_exp_f32 v115, v115
  v_mfma_f32_32x32x16_bf16 v[48:63], a[44:47], v[148:151], v[48:63]
  buffer_load_dwordx4 a[176:179], v4, s[68:71], s48 offen offset:0
  v_exp_f32 v116, v116
  v_exp_f32 v117, v117
  v_exp_f32 v118, v118
  v_exp_f32 v119, v119
  v_mfma_f32_32x32x16_bf16 v[128:143], a[52:55], v[36:39], v[128:143]
  v_cvt_pk_bf16_f32 v144, v112, v113
  v_cvt_pk_bf16_f32 v145, v114, v115
  v_cvt_pk_bf16_f32 v146, v116, v117
  v_cvt_pk_bf16_f32 v147, v118, v119
  v_exp_f32 v120, v120
  v_exp_f32 v121, v121
  v_exp_f32 v122, v122
  v_mfma_f32_32x32x16_bf16 v[64:79], a[56:59], v[144:147], v[64:79]
  v_exp_f32 v123, v123
  v_exp_f32 v124, v124
  v_exp_f32 v125, v125
  v_exp_f32 v126, v126
  v_exp_f32 v127, v127
  v_cvt_pk_bf16_f32 v148, v120, v121
  v_cvt_pk_bf16_f32 v149, v122, v123
  v_cvt_pk_bf16_f32 v150, v124, v125
  v_cvt_pk_bf16_f32 v151, v126, v127
  v_mfma_f32_32x32x16_bf16 v[112:127], a[48:51], v[40:43], 0
  buffer_load_dwordx4 a[36:39], v4, s[40:43], s9 offen offset:1024
  v_exp_f32 v128, v128
  v_exp_f32 v129, v129
  v_exp_f32 v130, v130
  v_exp_f32 v131, v131
  v_mfma_f32_32x32x16_bf16 v[64:79], a[60:63], v[148:151], v[64:79]
  buffer_load_dwordx4 a[180:183], v4, s[68:71], s48 offen offset:1024
  v_exp_f32 v132, v132
  v_exp_f32 v133, v133
  v_exp_f32 v134, v134
  v_exp_f32 v135, v135
  v_mfma_f32_32x32x16_bf16 v[112:127], a[52:55], v[44:47], v[112:127]
  v_cvt_pk_bf16_f32 v144, v128, v129
  v_cvt_pk_bf16_f32 v145, v130, v131
  v_cvt_pk_bf16_f32 v146, v132, v133
  v_cvt_pk_bf16_f32 v147, v134, v135
  v_exp_f32 v136, v136
  v_exp_f32 v137, v137
  v_exp_f32 v138, v138
  v_mfma_f32_32x32x16_bf16 v[80:95], a[56:59], v[144:147], v[80:95]
  s_lshl_b32 s44, s66, 4
  s_add_u32 s44, s44, s67
  s_lshl_b32 s44, s44, 11
  s_add_u32 s44, s44, 34246656
  buffer_store_dwordx4 v[248:251], v4, s[40:43], s44 offen sc1
  v_exp_f32 v139, v139
  v_exp_f32 v140, v140
  v_exp_f32 v141, v141
  v_exp_f32 v142, v142
  v_exp_f32 v143, v143
  v_cvt_pk_bf16_f32 v148, v136, v137
  v_cvt_pk_bf16_f32 v149, v138, v139
  v_cvt_pk_bf16_f32 v150, v140, v141
  v_cvt_pk_bf16_f32 v151, v142, v143
  v_mfma_f32_32x32x16_bf16 v[128:143], a[48:51], v[16:19], 0
  buffer_load_dwordx4 a[40:43], v4, s[40:43], s9 offen offset:2048
  v_exp_f32 v112, v112
  v_exp_f32 v113, v113
  v_exp_f32 v114, v114
  v_exp_f32 v115, v115
  v_mfma_f32_32x32x16_bf16 v[80:95], a[60:63], v[148:151], v[80:95]
  buffer_load_dwordx4 a[184:187], v4, s[68:71], s48 offen offset:2048
  v_exp_f32 v116, v116
  v_exp_f32 v117, v117
  v_exp_f32 v118, v118
  v_exp_f32 v119, v119
  v_mfma_f32_32x32x16_bf16 v[128:143], a[52:55], v[20:23], v[128:143]
  v_cvt_pk_bf16_f32 v144, v112, v113
  v_cvt_pk_bf16_f32 v145, v114, v115
  v_cvt_pk_bf16_f32 v146, v116, v117
  v_cvt_pk_bf16_f32 v147, v118, v119
  v_exp_f32 v120, v120
  v_exp_f32 v121, v121
  v_exp_f32 v122, v122
  v_mfma_f32_32x32x16_bf16 v[96:111], a[56:59], v[144:147], v[96:111]
  v_exp_f32 v123, v123
  v_exp_f32 v124, v124
  v_exp_f32 v125, v125
  v_exp_f32 v126, v126
  v_exp_f32 v127, v127
  v_cvt_pk_bf16_f32 v148, v120, v121
  v_cvt_pk_bf16_f32 v149, v122, v123
  v_cvt_pk_bf16_f32 v150, v124, v125
  v_cvt_pk_bf16_f32 v151, v126, v127
  s_waitcnt vmcnt(18)
  v_mfma_f32_32x32x16_bf16 v[112:127], a[0:3], v[24:27], 0
  buffer_load_dwordx4 a[44:47], v4, s[40:43], s9 offen offset:3072
  v_exp_f32 v128, v128
  v_exp_f32 v129, v129
  v_exp_f32 v130, v130
  v_exp_f32 v131, v131
  v_mfma_f32_32x32x16_bf16 v[96:111], a[60:63], v[148:151], v[96:111]
  buffer_load_dwordx4 a[188:191], v4, s[68:71], s48 offen offset:3072
  v_exp_f32 v132, v132
  v_exp_f32 v133, v133
  v_exp_f32 v134, v134
  v_exp_f32 v135, v135
  v_mfma_f32_32x32x16_bf16 v[112:127], a[4:7], v[28:31], v[112:127]
  s_add_u32 s48, s48, 4096
  v_cvt_pk_bf16_f32 v144, v128, v129
  v_cvt_pk_bf16_f32 v145, v130, v131
  v_cvt_pk_bf16_f32 v146, v132, v133
  v_cvt_pk_bf16_f32 v147, v134, v135
  v_exp_f32 v136, v136
  v_exp_f32 v137, v137
  v_exp_f32 v138, v138
  v_mfma_f32_32x32x16_bf16 v[48:63], a[56:59], v[144:147], v[48:63]
  v_exp_f32 v139, v139
  v_exp_f32 v140, v140
  v_exp_f32 v141, v141
  v_exp_f32 v142, v142
  v_exp_f32 v143, v143
  v_cvt_pk_bf16_f32 v148, v136, v137
  v_cvt_pk_bf16_f32 v149, v138, v139
  v_cvt_pk_bf16_f32 v150, v140, v141
  v_cvt_pk_bf16_f32 v151, v142, v143
  v_mfma_f32_32x32x16_bf16 v[128:143], a[0:3], v[32:35], 0
  s_add_u32 s9, s9, 4096
  s_pack_lh_b32_b16 s9, s9, s8
  buffer_load_dwordx4 a[48:51], v4, s[40:43], s9 offen offset:0
  v_exp_f32 v112, v112
  v_exp_f32 v113, v113
  v_exp_f32 v114, v114
  v_exp_f32 v115, v115
  v_mfma_f32_32x32x16_bf16 v[48:63], a[60:63], v[148:151], v[48:63]
  buffer_load_dwordx4 a[192:195], v4, s[68:71], s48 offen offset:0
  v_exp_f32 v116, v116
  v_exp_f32 v117, v117
  v_exp_f32 v118, v118
  v_exp_f32 v119, v119
  v_mfma_f32_32x32x16_bf16 v[128:143], a[4:7], v[36:39], v[128:143]
  v_cvt_pk_bf16_f32 v144, v112, v113
  v_cvt_pk_bf16_f32 v145, v114, v115
  v_cvt_pk_bf16_f32 v146, v116, v117
  v_cvt_pk_bf16_f32 v147, v118, v119
  v_exp_f32 v120, v120
  v_exp_f32 v121, v121
  v_exp_f32 v122, v122
  v_mfma_f32_32x32x16_bf16 v[64:79], a[8:11], v[144:147], v[64:79]
  s_lshl_b32 s44, s66, 4
  s_add_u32 s44, s44, s67
  s_lshl_b32 s44, s44, 11
  s_add_u32 s44, s44, 34247680
  buffer_store_dwordx4 v[248:251], v4, s[40:43], s44 offen sc1
  v_exp_f32 v123, v123
  v_exp_f32 v124, v124
  v_exp_f32 v125, v125
  v_exp_f32 v126, v126
  v_exp_f32 v127, v127
  v_cvt_pk_bf16_f32 v148, v120, v121
  v_cvt_pk_bf16_f32 v149, v122, v123
  v_cvt_pk_bf16_f32 v150, v124, v125
  v_cvt_pk_bf16_f32 v151, v126, v127
  v_mfma_f32_32x32x16_bf16 v[112:127], a[0:3], v[40:43], 0
  buffer_load_dwordx4 a[52:55], v4, s[40:43], s9 offen offset:1024
  v_exp_f32 v128, v128
  v_exp_f32 v129, v129
  v_exp_f32 v130, v130
  v_exp_f32 v131, v131
  v_mfma_f32_32x32x16_bf16 v[64:79], a[12:15], v[148:151], v[64:79]
  buffer_load_dwordx4 a[196:199], v4, s[68:71], s48 offen offset:1024
  v_exp_f32 v132, v132
  v_exp_f32 v133, v133
  v_exp_f32 v134, v134
  v_exp_f32 v135, v135
  v_mfma_f32_32x32x16_bf16 v[112:127], a[4:7], v[44:47], v[112:127]
  v_cvt_pk_bf16_f32 v144, v128, v129
  v_cvt_pk_bf16_f32 v145, v130, v131
  v_cvt_pk_bf16_f32 v146, v132, v133
  v_cvt_pk_bf16_f32 v147, v134, v135
  v_exp_f32 v136, v136
  v_exp_f32 v137, v137
  v_exp_f32 v138, v138
  v_mfma_f32_32x32x16_bf16 v[80:95], a[8:11], v[144:147], v[80:95]
  v_exp_f32 v139, v139
  v_exp_f32 v140, v140
  v_exp_f32 v141, v141
  v_exp_f32 v142, v142
  v_exp_f32 v143, v143
  v_cvt_pk_bf16_f32 v148, v136, v137
  v_cvt_pk_bf16_f32 v149, v138, v139
  v_cvt_pk_bf16_f32 v150, v140, v141
  v_cvt_pk_bf16_f32 v151, v142, v143
  v_mfma_f32_32x32x16_bf16 v[128:143], a[0:3], v[16:19], 0
  buffer_load_dwordx4 a[56:59], v4, s[40:43], s9 offen offset:2048
  v_exp_f32 v112, v112
  v_exp_f32 v113, v113
  v_exp_f32 v114, v114
  v_exp_f32 v115, v115
  v_mfma_f32_32x32x16_bf16 v[80:95], a[12:15], v[148:151], v[80:95]
  buffer_load_dwordx4 a[200:203], v4, s[68:71], s48 offen offset:2048
  v_exp_f32 v116, v116
  v_exp_f32 v117, v117
  v_exp_f32 v118, v118
  v_exp_f32 v119, v119
  v_mfma_f32_32x32x16_bf16 v[128:143], a[4:7], v[20:23], v[128:143]
  s_add_u32 s48, s65, s53
  v_cvt_pk_bf16_f32 v144, v112, v113
  v_cvt_pk_bf16_f32 v145, v114, v115
  v_cvt_pk_bf16_f32 v146, v116, v117
  v_cvt_pk_bf16_f32 v147, v118, v119
  v_exp_f32 v120, v120
  v_exp_f32 v121, v121
  v_exp_f32 v122, v122
  v_mfma_f32_32x32x16_bf16 v[96:111], a[8:11], v[144:147], v[96:111]
  v_exp_f32 v123, v123
  v_exp_f32 v124, v124
  v_exp_f32 v125, v125
  v_exp_f32 v126, v126
  v_exp_f32 v127, v127
  v_cvt_pk_bf16_f32 v148, v120, v121
  v_cvt_pk_bf16_f32 v149, v122, v123
  v_cvt_pk_bf16_f32 v150, v124, v125
  v_cvt_pk_bf16_f32 v151, v126, v127
  s_waitcnt vmcnt(17)
  v_mfma_f32_32x32x16_bf16 v[112:127], a[16:19], v[24:27], 0
  buffer_load_dwordx4 a[60:63], v4, s[40:43], s9 offen offset:3072
  v_exp_f32 v128, v128
  v_exp_f32 v129, v129
  v_exp_f32 v130, v130
  v_exp_f32 v131, v131
  v_mfma_f32_32x32x16_bf16 v[96:111], a[12:15], v[148:151], v[96:111]
  buffer_load_dwordx4 a[204:207], v4, s[68:71], s48 offen offset:0
  v_exp_f32 v132, v132
  v_exp_f32 v133, v133
  v_exp_f32 v134, v134
  v_exp_f32 v135, v135
  v_mfma_f32_32x32x16_bf16 v[112:127], a[20:23], v[28:31], v[112:127]
  v_cvt_pk_bf16_f32 v144, v128, v129
  v_cvt_pk_bf16_f32 v145, v130, v131
  v_cvt_pk_bf16_f32 v146, v132, v133
  v_cvt_pk_bf16_f32 v147, v134, v135
  v_exp_f32 v136, v136
  v_exp_f32 v137, v137
  v_exp_f32 v138, v138
  v_mfma_f32_32x32x16_bf16 v[48:63], a[8:11], v[144:147], v[48:63]
  v_exp_f32 v139, v139
  v_exp_f32 v140, v140
  v_exp_f32 v141, v141
  v_exp_f32 v142, v142
  v_exp_f32 v143, v143
  v_cvt_pk_bf16_f32 v148, v136, v137
  v_cvt_pk_bf16_f32 v149, v138, v139
  v_cvt_pk_bf16_f32 v150, v140, v141
  v_cvt_pk_bf16_f32 v151, v142, v143
  v_mfma_f32_32x32x16_bf16 v[128:143], a[16:19], v[32:35], 0
  buffer_load_dwordx4 a[208:211], v4, s[68:71], s48 offen offset:1024
  v_exp_f32 v112, v112
  v_exp_f32 v113, v113
  v_exp_f32 v114, v114
  v_exp_f32 v115, v115
  v_mfma_f32_32x32x16_bf16 v[48:63], a[12:15], v[148:151], v[48:63]
  buffer_load_dwordx4 a[212:215], v4, s[68:71], s48 offen offset:2048
  v_exp_f32 v116, v116
  v_exp_f32 v117, v117
  v_exp_f32 v118, v118
  v_exp_f32 v119, v119
  v_mfma_f32_32x32x16_bf16 v[128:143], a[20:23], v[36:39], v[128:143]
  v_cvt_pk_bf16_f32 v144, v112, v113
  v_cvt_pk_bf16_f32 v145, v114, v115
  v_cvt_pk_bf16_f32 v146, v116, v117
  v_cvt_pk_bf16_f32 v147, v118, v119
  v_exp_f32 v120, v120
  v_exp_f32 v121, v121
  v_exp_f32 v122, v122
  v_mfma_f32_32x32x16_bf16 v[64:79], a[24:27], v[144:147], v[64:79]
  v_exp_f32 v123, v123
  v_exp_f32 v124, v124
  v_exp_f32 v125, v125
  v_exp_f32 v126, v126
  v_exp_f32 v127, v127
  v_cvt_pk_bf16_f32 v148, v120, v121
  v_cvt_pk_bf16_f32 v149, v122, v123
  v_cvt_pk_bf16_f32 v150, v124, v125
  v_cvt_pk_bf16_f32 v151, v126, v127
  v_mfma_f32_32x32x16_bf16 v[112:127], a[16:19], v[40:43], 0
  buffer_load_dwordx4 a[216:219], v4, s[68:71], s48 offen offset:3072
  v_exp_f32 v128, v128
  v_exp_f32 v129, v129
  v_exp_f32 v130, v130
  v_exp_f32 v131, v131
  v_mfma_f32_32x32x16_bf16 v[64:79], a[28:31], v[148:151], v[64:79]
  s_add_u32 s48, s48, 4096
  buffer_load_dwordx4 a[220:223], v4, s[68:71], s48 offen offset:0
  v_exp_f32 v132, v132
  v_exp_f32 v133, v133
  v_exp_f32 v134, v134
  v_exp_f32 v135, v135
  v_mfma_f32_32x32x16_bf16 v[112:127], a[20:23], v[44:47], v[112:127]
  v_cvt_pk_bf16_f32 v144, v128, v129
  v_cvt_pk_bf16_f32 v145, v130, v131
  v_cvt_pk_bf16_f32 v146, v132, v133
  v_cvt_pk_bf16_f32 v147, v134, v135
  v_exp_f32 v136, v136
  v_exp_f32 v137, v137
  v_exp_f32 v138, v138
  v_mfma_f32_32x32x16_bf16 v[80:95], a[24:27], v[144:147], v[80:95]
  v_exp_f32 v139, v139
  v_exp_f32 v140, v140
  v_exp_f32 v141, v141
  v_exp_f32 v142, v142
  v_exp_f32 v143, v143
  v_cvt_pk_bf16_f32 v148, v136, v137
  v_cvt_pk_bf16_f32 v149, v138, v139
  v_cvt_pk_bf16_f32 v150, v140, v141
  v_cvt_pk_bf16_f32 v151, v142, v143
  v_mfma_f32_32x32x16_bf16 v[128:143], a[16:19], v[16:19], 0
  buffer_load_dwordx4 a[224:227], v4, s[68:71], s48 offen offset:1024
  v_exp_f32 v112, v112
  v_exp_f32 v113, v113
  v_exp_f32 v114, v114
  v_exp_f32 v115, v115
  v_mfma_f32_32x32x16_bf16 v[80:95], a[28:31], v[148:151], v[80:95]
  buffer_load_dwordx4 a[228:231], v4, s[68:71], s48 offen offset:2048
  v_exp_f32 v116, v116
  v_exp_f32 v117, v117
  v_exp_f32 v118, v118
  v_exp_f32 v119, v119
  v_mfma_f32_32x32x16_bf16 v[128:143], a[20:23], v[20:23], v[128:143]
  s_add_u32 s48, s65, s54
  v_cvt_pk_bf16_f32 v144, v112, v113
  v_cvt_pk_bf16_f32 v145, v114, v115
  v_cvt_pk_bf16_f32 v146, v116, v117
  v_cvt_pk_bf16_f32 v147, v118, v119
  v_exp_f32 v120, v120
  v_exp_f32 v121, v121
  v_exp_f32 v122, v122
  v_mfma_f32_32x32x16_bf16 v[96:111], a[24:27], v[144:147], v[96:111]
  v_lshlrev_b32 v15, 7, v1
  s_lshr_b32 s29, s4, 4
  s_lshl_b32 s29, s29, 9
  s_add_u32 s29, s29, 36352000
  s_mov_b64 exec, 15
  buffer_load_dword v252, v15, s[40:43], s29 offen sc1
  s_mov_b64 exec, -1
  v_exp_f32 v123, v123
  v_exp_f32 v124, v124
  v_exp_f32 v125, v125
  v_exp_f32 v126, v126
  v_exp_f32 v127, v127
  v_cvt_pk_bf16_f32 v148, v120, v121
  v_cvt_pk_bf16_f32 v149, v122, v123
  v_cvt_pk_bf16_f32 v150, v124, v125
  v_cvt_pk_bf16_f32 v151, v126, v127
  s_waitcnt vmcnt(17)
  v_mfma_f32_32x32x16_bf16 v[112:127], a[32:35], v[24:27], 0
  buffer_load_dwordx4 a[232:235], v4, s[68:71], s48 offen offset:0
  v_exp_f32 v128, v128
  v_exp_f32 v129, v129
  v_exp_f32 v130, v130
  v_exp_f32 v131, v131
  v_mfma_f32_32x32x16_bf16 v[96:111], a[28:31], v[148:151], v[96:111]
  buffer_load_dwordx4 a[236:239], v4, s[68:71], s48 offen offset:1024
  v_exp_f32 v132, v132
  v_exp_f32 v133, v133
  v_exp_f32 v134, v134
  v_exp_f32 v135, v135
  v_mfma_f32_32x32x16_bf16 v[112:127], a[36:39], v[28:31], v[112:127]
  v_cvt_pk_bf16_f32 v144, v128, v129
  v_cvt_pk_bf16_f32 v145, v130, v131
  v_cvt_pk_bf16_f32 v146, v132, v133
  v_cvt_pk_bf16_f32 v147, v134, v135
  v_exp_f32 v136, v136
  v_exp_f32 v137, v137
  v_exp_f32 v138, v138
  v_mfma_f32_32x32x16_bf16 v[48:63], a[24:27], v[144:147], v[48:63]
  v_exp_f32 v139, v139
  v_exp_f32 v140, v140
  v_exp_f32 v141, v141
  v_exp_f32 v142, v142
  v_exp_f32 v143, v143
  v_cvt_pk_bf16_f32 v148, v136, v137
  v_cvt_pk_bf16_f32 v149, v138, v139
  v_cvt_pk_bf16_f32 v150, v140, v141
  v_cvt_pk_bf16_f32 v151, v142, v143
  v_mfma_f32_32x32x16_bf16 v[128:143], a[32:35], v[32:35], 0
  buffer_load_dwordx4 v[152:155], v4, s[68:71], s46 offen offset:0
  v_exp_f32 v112, v112
  v_exp_f32 v113, v113
  v_exp_f32 v114, v114
  v_exp_f32 v115, v115
  v_mfma_f32_32x32x16_bf16 v[48:63], a[28:31], v[148:151], v[48:63]
  buffer_load_dwordx4 v[156:159], v4, s[68:71], s46 offen offset:1024
  v_exp_f32 v116, v116
  v_exp_f32 v117, v117
  v_exp_f32 v118, v118
  v_exp_f32 v119, v119
  v_mfma_f32_32x32x16_bf16 v[128:143], a[36:39], v[36:39], v[128:143]
  v_cvt_pk_bf16_f32 v144, v112, v113
  v_cvt_pk_bf16_f32 v145, v114, v115
  v_cvt_pk_bf16_f32 v146, v116, v117
  v_cvt_pk_bf16_f32 v147, v118, v119
  v_exp_f32 v120, v120
  v_exp_f32 v121, v121
  v_exp_f32 v122, v122
  v_mfma_f32_32x32x16_bf16 v[64:79], a[40:43], v[144:147], v[64:79]
  v_exp_f32 v123, v123
  v_exp_f32 v124, v124
  v_exp_f32 v125, v125
  v_exp_f32 v126, v126
  v_exp_f32 v127, v127
  v_cvt_pk_bf16_f32 v148, v120, v121
  v_cvt_pk_bf16_f32 v149, v122, v123
  v_cvt_pk_bf16_f32 v150, v124, v125
  v_cvt_pk_bf16_f32 v151, v126, v127
  v_mfma_f32_32x32x16_bf16 v[112:127], a[32:35], v[40:43], 0
  buffer_load_dwordx4 v[160:163], v4, s[68:71], s46 offen offset:2048
  v_exp_f32 v128, v128
  v_exp_f32 v129, v129
  v_exp_f32 v130, v130
  v_exp_f32 v131, v131
  v_mfma_f32_32x32x16_bf16 v[64:79], a[44:47], v[148:151], v[64:79]
  buffer_load_dwordx4 v[164:167], v4, s[68:71], s46 offen offset:3072
  v_exp_f32 v132, v132
  v_exp_f32 v133, v133
  v_exp_f32 v134, v134
  v_exp_f32 v135, v135
  v_mfma_f32_32x32x16_bf16 v[112:127], a[36:39], v[44:47], v[112:127]
  s_add_u32 s48, s46, 4096
  v_cvt_pk_bf16_f32 v144, v128, v129
  v_cvt_pk_bf16_f32 v145, v130, v131
  v_cvt_pk_bf16_f32 v146, v132, v133
  v_cvt_pk_bf16_f32 v147, v134, v135
  v_exp_f32 v136, v136
  v_exp_f32 v137, v137
  v_exp_f32 v138, v138
  v_mfma_f32_32x32x16_bf16 v[80:95], a[40:43], v[144:147], v[80:95]
  v_exp_f32 v139, v139
  v_exp_f32 v140, v140
  v_exp_f32 v141, v141
  v_exp_f32 v142, v142
  v_exp_f32 v143, v143
  v_cvt_pk_bf16_f32 v148, v136, v137
  v_cvt_pk_bf16_f32 v149, v138, v139
  v_cvt_pk_bf16_f32 v150, v140, v141
  v_cvt_pk_bf16_f32 v151, v142, v143
  v_mfma_f32_32x32x16_bf16 v[128:143], a[32:35], v[16:19], 0
  buffer_load_dwordx4 v[168:171], v4, s[68:71], s48 offen offset:0
  v_exp_f32 v112, v112
  v_exp_f32 v113, v113
  v_exp_f32 v114, v114
  v_exp_f32 v115, v115
  v_mfma_f32_32x32x16_bf16 v[80:95], a[44:47], v[148:151], v[80:95]
  buffer_load_dwordx4 v[172:175], v4, s[68:71], s48 offen offset:1024
  v_exp_f32 v116, v116
  v_exp_f32 v117, v117
  v_exp_f32 v118, v118
  v_exp_f32 v119, v119
  v_mfma_f32_32x32x16_bf16 v[128:143], a[36:39], v[20:23], v[128:143]
  v_cvt_pk_bf16_f32 v144, v112, v113
  v_cvt_pk_bf16_f32 v145, v114, v115
  v_cvt_pk_bf16_f32 v146, v116, v117
  v_cvt_pk_bf16_f32 v147, v118, v119
  v_exp_f32 v120, v120
  v_exp_f32 v121, v121
  v_exp_f32 v122, v122
  v_mfma_f32_32x32x16_bf16 v[96:111], a[40:43], v[144:147], v[96:111]
  v_exp_f32 v123, v123
  v_exp_f32 v124, v124
  v_exp_f32 v125, v125
  v_exp_f32 v126, v126
  v_exp_f32 v127, v127
  v_cvt_pk_bf16_f32 v148, v120, v121
  v_cvt_pk_bf16_f32 v149, v122, v123
  v_cvt_pk_bf16_f32 v150, v124, v125
  v_cvt_pk_bf16_f32 v151, v126, v127
  s_waitcnt vmcnt(16)
  v_mfma_f32_32x32x16_bf16 v[112:127], a[48:51], v[24:27], 0
  buffer_load_dwordx4 v[176:179], v4, s[68:71], s48 offen offset:2048
  v_exp_f32 v128, v128
  v_exp_f32 v129, v129
  v_exp_f32 v130, v130
  v_exp_f32 v131, v131
  v_mfma_f32_32x32x16_bf16 v[96:111], a[44:47], v[148:151], v[96:111]
  buffer_load_dwordx4 v[180:183], v4, s[68:71], s48 offen offset:3072
  v_exp_f32 v132, v132
  v_exp_f32 v133, v133
  v_exp_f32 v134, v134
  v_exp_f32 v135, v135
  v_mfma_f32_32x32x16_bf16 v[112:127], a[52:55], v[28:31], v[112:127]
  v_cvt_pk_bf16_f32 v144, v128, v129
  v_cvt_pk_bf16_f32 v145, v130, v131
  v_cvt_pk_bf16_f32 v146, v132, v133
  v_cvt_pk_bf16_f32 v147, v134, v135
  v_exp_f32 v136, v136
  v_exp_f32 v137, v137
  v_exp_f32 v138, v138
  v_mfma_f32_32x32x16_bf16 v[48:63], a[40:43], v[144:147], v[48:63]
  v_exp_f32 v139, v139
  v_exp_f32 v140, v140
  v_exp_f32 v141, v141
  v_exp_f32 v142, v142
  v_exp_f32 v143, v143
  v_cvt_pk_bf16_f32 v148, v136, v137
  v_cvt_pk_bf16_f32 v149, v138, v139
  v_cvt_pk_bf16_f32 v150, v140, v141
  v_cvt_pk_bf16_f32 v151, v142, v143
  v_mfma_f32_32x32x16_bf16 v[128:143], a[48:51], v[32:35], 0
  buffer_load_dwordx4 v[184:187], v4, s[68:71], s47 offen offset:0
  v_exp_f32 v112, v112
  v_exp_f32 v113, v113
  v_exp_f32 v114, v114
  v_exp_f32 v115, v115
  v_mfma_f32_32x32x16_bf16 v[48:63], a[44:47], v[148:151], v[48:63]
  buffer_load_dwordx4 v[188:191], v4, s[68:71], s47 offen offset:1024
  v_exp_f32 v116, v116
  v_exp_f32 v117, v117
  v_exp_f32 v118, v118
  v_exp_f32 v119, v119
  v_mfma_f32_32x32x16_bf16 v[128:143], a[52:55], v[36:39], v[128:143]
  v_cvt_pk_bf16_f32 v144, v112, v113
  v_cvt_pk_bf16_f32 v145, v114, v115
  v_cvt_pk_bf16_f32 v146, v116, v117
  v_cvt_pk_bf16_f32 v147, v118, v119
  v_exp_f32 v120, v120
  v_exp_f32 v121, v121
  v_exp_f32 v122, v122
  v_mfma_f32_32x32x16_bf16 v[64:79], a[56:59], v[144:147], v[64:79]
  v_exp_f32 v123, v123
  v_exp_f32 v124, v124
  v_exp_f32 v125, v125
  v_exp_f32 v126, v126
  v_exp_f32 v127, v127
  v_cvt_pk_bf16_f32 v148, v120, v121
  v_cvt_pk_bf16_f32 v149, v122, v123
  v_cvt_pk_bf16_f32 v150, v124, v125
  v_cvt_pk_bf16_f32 v151, v126, v127
  v_mfma_f32_32x32x16_bf16 v[112:127], a[48:51], v[40:43], 0
  buffer_load_dwordx4 v[192:195], v4, s[68:71], s47 offen offset:2048
  v_exp_f32 v128, v128
  v_exp_f32 v129, v129
  v_exp_f32 v130, v130
  v_exp_f32 v131, v131
  v_mfma_f32_32x32x16_bf16 v[64:79], a[60:63], v[148:151], v[64:79]
  buffer_load_dwordx4 v[196:199], v4, s[68:71], s47 offen offset:3072
  v_exp_f32 v132, v132
  v_exp_f32 v133, v133
  v_exp_f32 v134, v134
  v_exp_f32 v135, v135
  v_mfma_f32_32x32x16_bf16 v[112:127], a[52:55], v[44:47], v[112:127]
  s_add_u32 s48, s47, 4096
  v_cvt_pk_bf16_f32 v144, v128, v129
  v_cvt_pk_bf16_f32 v145, v130, v131
  v_cvt_pk_bf16_f32 v146, v132, v133
  v_cvt_pk_bf16_f32 v147, v134, v135
  v_exp_f32 v136, v136
  v_exp_f32 v137, v137
  v_exp_f32 v138, v138
  v_mfma_f32_32x32x16_bf16 v[80:95], a[56:59], v[144:147], v[80:95]
  v_exp_f32 v139, v139
  v_exp_f32 v140, v140
  v_exp_f32 v141, v141
  v_exp_f32 v142, v142
  v_exp_f32 v143, v143
  v_cvt_pk_bf16_f32 v148, v136, v137
  v_cvt_pk_bf16_f32 v149, v138, v139
  v_cvt_pk_bf16_f32 v150, v140, v141
  v_cvt_pk_bf16_f32 v151, v142, v143
  v_mfma_f32_32x32x16_bf16 v[128:143], a[48:51], v[16:19], 0
  buffer_load_dwordx4 v[200:203], v4, s[68:71], s48 offen offset:0
  v_exp_f32 v112, v112
  v_exp_f32 v113, v113
  v_exp_f32 v114, v114
  v_exp_f32 v115, v115
  v_mfma_f32_32x32x16_bf16 v[80:95], a[60:63], v[148:151], v[80:95]
  buffer_load_dwordx4 v[204:207], v4, s[68:71], s48 offen offset:1024
  v_exp_f32 v116, v116
  v_exp_f32 v117, v117
  v_exp_f32 v118, v118
  v_exp_f32 v119, v119
  v_mfma_f32_32x32x16_bf16 v[128:143], a[52:55], v[20:23], v[128:143]
  v_cvt_pk_bf16_f32 v144, v112, v113
  v_cvt_pk_bf16_f32 v145, v114, v115
  v_cvt_pk_bf16_f32 v146, v116, v117
  v_cvt_pk_bf16_f32 v147, v118, v119
  v_exp_f32 v120, v120
  v_exp_f32 v121, v121
  v_exp_f32 v122, v122
  v_mfma_f32_32x32x16_bf16 v[96:111], a[56:59], v[144:147], v[96:111]
  v_exp_f32 v123, v123
  ds_write_b128 v6, v[64:67] offset:0
  v_exp_f32 v124, v124
  ds_write_b128 v6, v[68:71] offset:1024
  v_exp_f32 v125, v125
  ds_write_b128 v6, v[72:75] offset:2048
  v_exp_f32 v126, v126
  ds_write_b128 v6, v[76:79] offset:3072
  v_exp_f32 v127, v127
  v_cvt_pk_bf16_f32 v148, v120, v121
  v_cvt_pk_bf16_f32 v149, v122, v123
  v_cvt_pk_bf16_f32 v150, v124, v125
  v_cvt_pk_bf16_f32 v151, v126, v127
  buffer_load_dwordx4 v[208:211], v4, s[68:71], s48 offen offset:2048
  v_exp_f32 v128, v128
  v_exp_f32 v129, v129
  v_exp_f32 v130, v130
  v_exp_f32 v131, v131
  v_mfma_f32_32x32x16_bf16 v[96:111], a[60:63], v[148:151], v[96:111]
  buffer_load_dwordx4 v[212:215], v4, s[68:71], s48 offen offset:3072
  v_exp_f32 v132, v132
  v_exp_f32 v133, v133
  v_exp_f32 v134, v134
  v_exp_f32 v135, v135
  v_cvt_pk_bf16_f32 v144, v128, v129
  v_cvt_pk_bf16_f32 v145, v130, v131
  v_cvt_pk_bf16_f32 v146, v132, v133
  v_cvt_pk_bf16_f32 v147, v134, v135
  v_exp_f32 v136, v136
  v_exp_f32 v137, v137
  v_exp_f32 v138, v138
  v_mfma_f32_32x32x16_bf16 v[48:63], a[56:59], v[144:147], v[48:63]
  v_exp_f32 v139, v139
  ds_write_b128 v7, v[80:83] offset:0
  v_exp_f32 v140, v140
  ds_write_b128 v7, v[84:87] offset:1024
  v_exp_f32 v141, v141
  ds_write_b128 v7, v[88:91] offset:2048
  v_exp_f32 v142, v142
  ds_write_b128 v7, v[92:95] offset:3072
  v_exp_f32 v143, v143
  ds_write_b128 v8, v[96:99] offset:0
  v_cvt_pk_bf16_f32 v148, v136, v137
  ds_write_b128 v8, v[100:103] offset:1024
  v_cvt_pk_bf16_f32 v149, v138, v139
  ds_write_b128 v8, v[104:107] offset:2048
  v_cvt_pk_bf16_f32 v150, v140, v141
  ds_write_b128 v8, v[108:111] offset:3072
  v_cvt_pk_bf16_f32 v151, v142, v143
  s_nop 1
  v_mfma_f32_32x32x16_bf16 v[48:63], a[60:63], v[148:151], v[48:63]
  s_mov_b32 s44, s16
  s_and_b32 s45, s17, 0xffff
  s_mov_b32 s46, 1835008
  s_mov_b32 s47, 0x20000
  s_waitcnt vmcnt(18)
  v_cmp_le_u32 vcc, 16, v252
  s_nop 0
  s_and_b32 s28, vcc_lo, 15
  s_cmp_lg_u32 s28, 15
  s_cbranch_scc1 mm_kernel_g2
mm_kernel_g2_b:
  buffer_load_dwordx2 v[248:249], v14, s[44:47], s58 offen offset:0
  buffer_load_dwordx2 v[250:251], v14, s[44:47], s58 offen offset:16
  buffer_load_dwordx2 v[252:253], v14, s[44:47], s58 offen offset:32
  buffer_load_dwordx2 v[254:255], v14, s[44:47], s58 offen offset:48
  s_waitcnt lgkmcnt(0)
  s_barrier
  ds_read_b128 v[64:67], v5 offset:0
  ds_read_b128 v[68:71], v5 offset:1024
  ds_read_b128 v[72:75], v5 offset:2048
  ds_read_b128 v[76:79], v5 offset:3072
  ds_read_b128 v[80:83], v5 offset:4096
  ds_read_b128 v[84:87], v5 offset:5120
  ds_read_b128 v[88:91], v5 offset:6144
  ds_read_b128 v[92:95], v5 offset:7168
  ds_read_b128 v[96:99], v5 offset:8192
  ds_read_b128 v[100:103], v5 offset:9216
  ds_read_b128 v[104:107], v5 offset:10240
  ds_read_b128 v[108:111], v5 offset:11264
  s_waitcnt lgkmcnt(8)
  v_pk_add_f32 v[48:49], v[48:49], v[64:65]
  v_pk_add_f32 v[50:51], v[50:51], v[66:67]
  v_pk_add_f32 v[52:53], v[52:53], v[68:69]
  v_pk_add_f32 v[54:55], v[54:55], v[70:71]
  v_pk_add_f32 v[56:57], v[56:57], v[72:73]
  v_pk_add_f32 v[58:59], v[58:59], v[74:75]
  v_pk_add_f32 v[60:61], v[60:61], v[76:77]
  v_pk_add_f32 v[62:63], v[62:63], v[78:79]
  s_waitcnt lgkmcnt(4)
  v_pk_add_f32 v[48:49], v[48:49], v[80:81]
  v_pk_add_f32 v[50:51], v[50:51], v[82:83]
  v_pk_add_f32 v[52:53], v[52:53], v[84:85]
  v_pk_add_f32 v[54:55], v[54:55], v[86:87]
  v_pk_add_f32 v[56:57], v[56:57], v[88:89]
  v_pk_add_f32 v[58:59], v[58:59], v[90:91]
  v_pk_add_f32 v[60:61], v[60:61], v[92:93]
  v_pk_add_f32 v[62:63], v[62:63], v[94:95]
  s_waitcnt lgkmcnt(0)
  v_pk_add_f32 v[60:61], v[60:61], v[108:109]
  v_mov_b32 v9, v60
  v_mov_b32 v8, v60
  v_pk_add_f32 v[48:49], v[48:49], v[96:97]
  v_pk_add_f32 v[50:51], v[50:51], v[98:99]
  v_permlane32_swap_b32 v9, v8
  v_pk_add_f32 v[52:53], v[52:53], v[100:101]
  v_rcp_f32 v9, v8
  v_cmp_nle_f32 vcc, s14, v8
  v_cmp_nge_f32 s[46:47], s15, v8
  v_pk_add_f32 v[54:55], v[54:55], v[102:103]
  v_pk_add_f32 v[56:57], v[56:57], v[104:105]
  v_pk_add_f32 v[58:59], v[58:59], v[106:107]
  s_or_b64 vcc, vcc, s[46:47]
  v_pk_add_f32 v[62:63], v[62:63], v[110:111]
  s_cbranch_vccnz mm_kernel_fb
mm_kernel_norm:
  v_pk_mul_f32 v[48:49], v[48:49], v[8:9] op_sel:[0,1] op_sel_hi:[1,1]
  v_pk_mul_f32 v[50:51], v[50:51], v[8:9] op_sel:[0,1] op_sel_hi:[1,1]
  v_pk_mul_f32 v[52:53], v[52:53], v[8:9] op_sel:[0,1] op_sel_hi:[1,1]
  v_pk_mul_f32 v[54:55], v[54:55], v[8:9] op_sel:[0,1] op_sel_hi:[1,1]
  v_cvt_pk_bf16_f32 v144, v48, v49
  v_cvt_pk_bf16_f32 v145, v50, v51
  v_cvt_pk_bf16_f32 v146, v52, v53
  v_cvt_pk_bf16_f32 v147, v54, v55
  buffer_store_dwordx4 v[144:147], v13, s[40:43], s49 offen offset:0 sc1
  v_pk_mul_f32 v[56:57], v[56:57], v[8:9] op_sel:[0,1] op_sel_hi:[1,1]
  v_pk_mul_f32 v[58:59], v[58:59], v[8:9] op_sel:[0,1] op_sel_hi:[1,1]
  v_pk_mul_f32 v[60:61], v[60:61], v[8:9] op_sel:[0,1] op_sel_hi:[1,1]
  v_pk_mul_f32 v[62:63], v[62:63], v[8:9] op_sel:[0,1] op_sel_hi:[1,1]
  v_cvt_pk_bf16_f32 v148, v56, v57
  v_cvt_pk_bf16_f32 v149, v58, v59
  v_cvt_pk_bf16_f32 v150, v60, v61
  v_cvt_pk_bf16_f32 v151, v62, v63
  buffer_store_dwordx4 v[148:151], v13, s[40:43], s49 offen offset:1024 sc1
  s_barrier
  s_waitcnt vmcnt(2)
  v_lshlrev_b32 v80, 16, v248
  v_and_b32 v81, s61, v248
  v_lshlrev_b32 v82, 16, v249
  v_and_b32 v83, s61, v249
  v_lshlrev_b32 v84, 16, v250
  v_and_b32 v85, s61, v250
  v_lshlrev_b32 v86, 16, v251
  v_and_b32 v87, s61, v251
  v_lshlrev_b32 v88, 16, v252
  v_and_b32 v89, s61, v252
  v_lshlrev_b32 v90, 16, v253
  v_and_b32 v91, s61, v253
  v_lshlrev_b32 v92, 16, v254
  v_and_b32 v93, s61, v254
  v_lshlrev_b32 v94, 16, v255
  v_and_b32 v95, s61, v255
  s_waitcnt vmcnt(0)
mm_kernel_pr1:
  s_add_u32 s15, s51, 0
  buffer_load_dwordx4 v[20:23], v4, s[40:43], s15 offen offset:0 sc1
  buffer_load_dwordx4 v[28:31], v4, s[40:43], s15 offen offset:1024 sc1
  buffer_load_dwordx4 v[36:39], v4, s[40:43], s15 offen offset:2048 sc1
  buffer_load_dwordx4 v[44:47], v4, s[40:43], s15 offen offset:3072 sc1
  s_add_u32 s15, s51, 4096
  buffer_load_dwordx4 v[52:55], v4, s[40:43], s15 offen offset:0 sc1
  buffer_load_dwordx4 v[60:63], v4, s[40:43], s15 offen offset:1024 sc1
  buffer_load_dwordx4 v[68:71], v4, s[40:43], s15 offen offset:2048 sc1
  buffer_load_dwordx4 v[76:79], v4, s[40:43], s15 offen offset:3072 sc1
  s_add_u32 s15, s50, 0
  buffer_load_dwordx4 v[16:19], v4, s[40:43], s15 offen offset:0 sc1
  buffer_load_dwordx4 v[24:27], v4, s[40:43], s15 offen offset:1024 sc1
  buffer_load_dwordx4 v[32:35], v4, s[40:43], s15 offen offset:2048 sc1
  buffer_load_dwordx4 v[40:43], v4, s[40:43], s15 offen offset:3072 sc1
  s_add_u32 s15, s50, 4096
  buffer_load_dwordx4 v[48:51], v4, s[40:43], s15 offen offset:0 sc1
  buffer_load_dwordx4 v[56:59], v4, s[40:43], s15 offen offset:1024 sc1
  buffer_load_dwordx4 v[64:67], v4, s[40:43], s15 offen offset:2048 sc1
  buffer_load_dwordx4 v[72:75], v4, s[40:43], s15 offen offset:3072 sc1
  s_sub_i32 s13, s13, 1
  s_cmp_lt_i32 s13, 0
  s_waitcnt vmcnt(8)
  v_max_u32 v3, v20, v22
  v_max3_u32 v3, v28, v30, v3
  v_max3_u32 v3, v36, v38, v3
  v_max3_u32 v3, v44, v46, v3
  v_max3_u32 v3, v52, v54, v3
  v_max3_u32 v3, v60, v62, v3
  v_max3_u32 v3, v68, v70, v3
  v_max3_u32 v3, v76, v78, v3
  v_cmp_eq_u32 vcc, -1, v3
  s_cbranch_scc1 mm_kernel_pr1_b
  s_nop 3
  s_cbranch_vccnz mm_kernel_pr1
mm_kernel_pr1_b:
  v_mfma_f32_32x32x16_bf16 v[128:143], v[184:187], v[20:23], 0
  v_mfma_f32_32x32x16_bf16 v[128:143], v[188:191], v[28:31], v[128:143]
  v_mfma_f32_32x32x16_bf16 v[128:143], v[192:195], v[36:39], v[128:143]
  v_mfma_f32_32x32x16_bf16 v[128:143], v[196:199], v[44:47], v[128:143]
  v_mfma_f32_32x32x16_bf16 v[128:143], v[200:203], v[52:55], v[128:143]
  v_mfma_f32_32x32x16_bf16 v[128:143], v[204:207], v[60:63], v[128:143]
  v_mfma_f32_32x32x16_bf16 v[128:143], v[208:211], v[68:71], v[128:143]
  v_mfma_f32_32x32x16_bf16 v[128:143], v[212:215], v[76:79], v[128:143]
  v_mfma_f32_32x32x16_bf16 v[112:127], v[152:155], v[20:23], 0
  v_mfma_f32_32x32x16_bf16 v[112:127], v[156:159], v[28:31], v[112:127]
  s_nop 9
  ds_write_b128 v12, v[128:131] offset:0
  v_mfma_f32_32x32x16_bf16 v[112:127], v[160:163], v[36:39], v[112:127]
  s_waitcnt vmcnt(0)
  v_max_u32 v3, v16, v18
  v_max3_u32 v3, v24, v26, v3
  v_max3_u32 v3, v32, v34, v3
  v_mfma_f32_32x32x16_bf16 v[112:127], v[164:167], v[44:47], v[112:127]
  ds_write_b128 v12, v[132:135] offset:1024
  v_max3_u32 v3, v40, v42, v3
  v_max3_u32 v3, v48, v50, v3
  v_max3_u32 v3, v56, v58, v3
  v_mfma_f32_32x32x16_bf16 v[112:127], v[168:171], v[52:55], v[112:127]
  v_max3_u32 v3, v64, v66, v3
  v_max3_u32 v3, v72, v74, v3
  v_cmp_eq_u32 vcc, -1, v3
  v_mfma_f32_32x32x16_bf16 v[112:127], v[172:175], v[60:63], v[112:127]
  ds_write_b128 v12, v[136:139] offset:2048
  v_mfma_f32_32x32x16_bf16 v[112:127], v[176:179], v[68:71], v[112:127]
  v_mfma_f32_32x32x16_bf16 v[112:127], v[180:183], v[76:79], v[112:127]
  ds_write_b128 v12, v[140:143] offset:3072
  s_cbranch_vccnz mm_kernel_st2
mm_kernel_st2_b:
  v_mfma_f32_32x32x16_bf16 v[96:111], v[184:187], v[16:19], 0
  s_add_u32 s48, s65, s54
  buffer_load_dwordx4 a[240:243], v4, s[68:71], s48 offen offset:2048
  v_mfma_f32_32x32x16_bf16 v[96:111], v[188:191], v[24:27], v[96:111]
  buffer_load_dwordx4 a[244:247], v4, s[68:71], s48 offen offset:3072
  s_nop 4
  ds_write_b128 v11, v[112:115] offset:0
  v_mfma_f32_32x32x16_bf16 v[96:111], v[192:195], v[32:35], v[96:111]
  s_add_u32 s48, s65, s54
  s_add_u32 s48, s48, 4096
  buffer_load_dwordx4 a[248:251], v4, s[68:71], s48 offen offset:0
  v_mfma_f32_32x32x16_bf16 v[96:111], v[196:199], v[40:43], v[96:111]
  buffer_load_dwordx4 a[252:255], v4, s[68:71], s48 offen offset:1024
  ds_write_b128 v11, v[116:119] offset:1024
  v_mfma_f32_32x32x16_bf16 v[96:111], v[200:203], v[48:51], v[96:111]
  buffer_load_dwordx4 v[216:219], v4, s[68:71], s48 offen offset:2048
  v_mfma_f32_32x32x16_bf16 v[96:111], v[204:207], v[56:59], v[96:111]
  s_add_u32 s48, s65, s55
  buffer_load_dwordx4 v[220:223], v4, s[68:71], s48 offen offset:0
  ds_write_b128 v11, v[120:123] offset:2048
  v_mfma_f32_32x32x16_bf16 v[96:111], v[208:211], v[64:67], v[96:111]
  buffer_load_dwordx4 v[224:227], v4, s[68:71], s48 offen offset:1024
  v_mfma_f32_32x32x16_bf16 v[96:111], v[212:215], v[72:75], v[96:111]
  buffer_load_dwordx4 v[228:231], v4, s[68:71], s48 offen offset:2048
  ds_write_b128 v11, v[124:127] offset:3072
  v_mfma_f32_32x32x16_bf16 v[80:95], v[152:155], v[16:19], v[80:95]
  buffer_load_dwordx4 v[232:235], v4, s[68:71], s48 offen offset:3072
  v_mfma_f32_32x32x16_bf16 v[80:95], v[156:159], v[24:27], v[80:95]
  s_add_u32 s48, s65, s55
  s_add_u32 s48, s48, 4096
  buffer_load_dwordx4 v[236:239], v4, s[68:71], s48 offen offset:0
  s_nop 3
  ds_write_b128 v10, v[96:99] offset:0
  v_mfma_f32_32x32x16_bf16 v[80:95], v[160:163], v[32:35], v[80:95]
  buffer_load_dwordx4 v[240:243], v4, s[68:71], s48 offen offset:1024
  v_mfma_f32_32x32x16_bf16 v[80:95], v[164:167], v[40:43], v[80:95]
  buffer_load_dwordx4 v[244:247], v4, s[68:71], s48 offen offset:2048
  ds_write_b128 v10, v[100:103] offset:1024
  v_mfma_f32_32x32x16_bf16 v[80:95], v[168:171], v[48:51], v[80:95]
  v_mfma_f32_32x32x16_bf16 v[80:95], v[172:175], v[56:59], v[80:95]
  ds_write_b128 v10, v[104:107] offset:2048
  v_mfma_f32_32x32x16_bf16 v[80:95], v[176:179], v[64:67], v[80:95]
  v_mfma_f32_32x32x16_bf16 v[80:95], v[180:183], v[72:75], v[80:95]
  ds_write_b128 v10, v[108:111] offset:3072
  s_add_u32 s9, s12, 4718592
  s_lshr_b32 s15, s4, 3
  s_lshl_b32 s15, s15, 2
  s_add_u32 s15, s15, s3
  s_lshl_b32 s15, s15, 12
  s_add_u32 s15, s15, 33460224
  s_cmp_eq_u32 s70, 0
  s_cselect_b32 s9, s15, s9
  s_add_u32 s15, s15, 2048
  s_cmp_eq_u32 s70, 0
  s_cselect_b32 s56, s15, s56
  s_waitcnt lgkmcnt(0)
  s_barrier
  ds_read_b128 v[16:19], v5 offset:0
  ds_read_b128 v[20:23], v5 offset:1024
  ds_read_b128 v[24:27], v5 offset:2048
  ds_read_b128 v[28:31], v5 offset:3072
  ds_read_b128 v[32:35], v5 offset:4096
  ds_read_b128 v[36:39], v5 offset:5120
  ds_read_b128 v[40:43], v5 offset:6144
  ds_read_b128 v[44:47], v5 offset:7168
  ds_read_b128 v[48:51], v5 offset:8192
  ds_read_b128 v[52:55], v5 offset:9216
  ds_read_b128 v[56:59], v5 offset:10240
  ds_read_b128 v[60:63], v5 offset:11264
  s_waitcnt lgkmcnt(8)
  v_pk_add_f32 v[80:81], v[80:81], v[16:17]
  v_pk_add_f32 v[82:83], v[82:83], v[18:19]
  v_pk_add_f32 v[84:85], v[84:85], v[20:21]
  v_pk_add_f32 v[86:87], v[86:87], v[22:23]
  v_pk_add_f32 v[88:89], v[88:89], v[24:25]
  v_pk_add_f32 v[90:91], v[90:91], v[26:27]
  v_pk_add_f32 v[92:93], v[92:93], v[28:29]
  v_pk_add_f32 v[94:95], v[94:95], v[30:31]
  s_waitcnt lgkmcnt(4)
  v_pk_add_f32 v[80:81], v[80:81], v[32:33]
  v_pk_add_f32 v[82:83], v[82:83], v[34:35]
  v_pk_add_f32 v[84:85], v[84:85], v[36:37]
  v_pk_add_f32 v[86:87], v[86:87], v[38:39]
  v_pk_add_f32 v[88:89], v[88:89], v[40:41]
  v_pk_add_f32 v[90:91], v[90:91], v[42:43]
  v_pk_add_f32 v[92:93], v[92:93], v[44:45]
  v_pk_add_f32 v[94:95], v[94:95], v[46:47]
  s_waitcnt lgkmcnt(0)
  v_pk_add_f32 v[80:81], v[80:81], v[48:49]
  v_pk_add_f32 v[82:83], v[82:83], v[50:51]
  v_pk_add_f32 v[84:85], v[84:85], v[52:53]
  v_pk_add_f32 v[86:87], v[86:87], v[54:55]
  v_pk_add_f32 v[88:89], v[88:89], v[56:57]
  v_pk_add_f32 v[90:91], v[90:91], v[58:59]
  v_pk_add_f32 v[92:93], v[92:93], v[60:61]
  v_pk_add_f32 v[94:95], v[94:95], v[62:63]
  v_cvt_pk_bf16_f32 v248, v80, v81
  v_cvt_pk_bf16_f32 v249, v82, v83
  v_cvt_pk_bf16_f32 v250, v84, v85
  v_cvt_pk_bf16_f32 v251, v86, v87
  buffer_store_dwordx4 v[248:251], v4, s[40:43], s9 offen offset:0 sc1
  v_cvt_pk_bf16_f32 v252, v88, v89
  v_cvt_pk_bf16_f32 v253, v90, v91
  v_cvt_pk_bf16_f32 v254, v92, v93
  v_cvt_pk_bf16_f32 v255, v94, v95
  buffer_store_dwordx4 v[252:255], v4, s[40:43], s9 offen offset:1024 sc1
  v_pk_add_f32 v[6:7], v[80:81], v[82:83]
  v_pk_mul_f32 v[8:9], v[80:81], v[80:81]
  v_pk_fma_f32 v[8:9], v[82:83], v[82:83], v[8:9]
  v_pk_add_f32 v[6:7], v[6:7], v[84:85]
  v_pk_fma_f32 v[8:9], v[84:85], v[84:85], v[8:9]
  v_pk_add_f32 v[6:7], v[6:7], v[86:87]
  v_pk_fma_f32 v[8:9], v[86:87], v[86:87], v[8:9]
  v_pk_add_f32 v[6:7], v[6:7], v[88:89]
  v_pk_fma_f32 v[8:9], v[88:89], v[88:89], v[8:9]
  v_pk_add_f32 v[6:7], v[6:7], v[90:91]
  v_pk_fma_f32 v[8:9], v[90:91], v[90:91], v[8:9]
  v_pk_add_f32 v[6:7], v[6:7], v[92:93]
  v_pk_fma_f32 v[8:9], v[92:93], v[92:93], v[8:9]
  v_pk_add_f32 v[6:7], v[6:7], v[94:95]
  v_pk_fma_f32 v[8:9], v[94:95], v[94:95], v[8:9]
  v_add_f32 v6, v6, v7
  v_add_f32 v7, v8, v9
  v_mov_b32 v8, v6
  v_mov_b32 v9, v7
  s_nop 0
  v_permlane32_swap_b32 v6, v8
  v_permlane32_swap_b32 v7, v9
  s_mov_b32 exec_hi, 0
  v_pk_add_f32 v[6:7], v[6:7], v[8:9]
  buffer_store_dwordx2 v[6:7], v4, s[40:43], s56 offen sc1
  s_mov_b32 exec_hi, -1
mm_kernel_xjoin:
  s_barrier
  v_add_u32 v5, 0x10000, v4
  v_add_u32 v6, 0x20000, v4
  v_mov_b32 v172, 0
  v_mov_b32 v173, 0
  v_mov_b32 v174, 0
  v_mov_b32 v175, 0
  s_mul_i32 s50, s67, 28672
  s_xor_b32 s51, s67, 1
  s_mul_i32 s51, s51, 28672
  s_mul_i32 s15, s3, 7168
  s_add_u32 s15, s15, 32997376
  s_add_u32 s50, s50, s15
  s_add_u32 s51, s51, s15
  s_lshl_b32 s60, s67, 7
  s_add_u32 s60, s60, 33456128
  s_mul_i32 s59, s3, 14336
  s_cmp_eq_u32 s3, 3
  s_cselect_b32 s59, 147456, s59
  s_waitcnt vmcnt(1)
  ds_read_b128 v[128:131], v4 offset:49152
  ds_read_b128 v[132:135], v4 offset:50176
  ds_read_b128 v[136:139], v4 offset:51200
  ds_read_b128 v[140:143], v4 offset:52224
  ds_read_b128 v[144:147], v4 offset:53248
  ds_read_b128 v[148:151], v4 offset:54272
mm_kernel_pr3:
  s_add_u32 s15, s5, 6144
  buffer_load_dwordx4 v[176:179], v4, s[40:43], s15 offen offset:0 sc1
  s_add_u32 s15, s5, 13312
  buffer_load_dwordx4 v[180:183], v4, s[40:43], s15 offen offset:0 sc1
  s_add_u32 s15, s5, 20480
  buffer_load_dwordx4 v[184:187], v4, s[40:43], s15 offen offset:0 sc1
  s_add_u32 s15, s5, 27648
  buffer_load_dwordx4 v[188:191], v4, s[40:43], s15 offen offset:0 sc1
  s_add_u32 s15, s5, 0
  buffer_load_dwordx4 v[192:195], v4, s[40:43], s15 offen offset:0 sc1
  buffer_load_dwordx4 v[196:199], v4, s[40:43], s15 offen offset:1024 sc1
  buffer_load_dwordx4 v[200:203], v4, s[40:43], s15 offen offset:2048 sc1
  buffer_load_dwordx4 v[204:207], v4, s[40:43], s15 offen offset:3072 sc1
  s_add_u32 s15, s5, 4096
  buffer_load_dwordx4 v[208:211], v4, s[40:43], s15 offen offset:0 sc1
  buffer_load_dwordx4 v[212:215], v4, s[40:43], s15 offen offset:1024 sc1
  s_sub_i32 s13, s13, 1
  s_cmp_lt_i32 s13, 0
  s_waitcnt vmcnt(6)
  v_max_u32 v3, v176, v178
  v_max3_u32 v3, v180, v182, v3
  v_max3_u32 v3, v184, v186, v3
  v_max3_u32 v3, v188, v190, v3
  v_cmp_eq_u32 vcc, -1, v3
  s_cbranch_scc1 mm_kernel_pr3_b
  s_nop 3
  s_cbranch_vccnz mm_kernel_pr3
mm_kernel_pr3_b:
  ds_read_b128 v[152:155], v4 offset:55296
  s_waitcnt lgkmcnt(5)
  v_mfma_f32_32x32x16_bf16 v[16:31], v[128:131], v[176:179], 0
  s_add_u32 s44, s5, 7168
  buffer_load_dwordx4 v[8:11], v4, s[40:43], s44 offen offset:0 sc1
  ds_read_b128 v[156:159], v4 offset:56320
  v_mfma_f32_32x32x16_bf16 v[32:47], v[132:135], v[176:179], 0
  ds_read_b128 v[128:131], v4 offset:57344
  s_waitcnt lgkmcnt(5)
  v_mfma_f32_32x32x16_bf16 v[48:63], v[136:139], v[176:179], 0
  buffer_load_dwordx4 v[12:15], v4, s[40:43], s44 offen offset:1024 sc1
  ds_read_b128 v[132:135], v4 offset:58368
  v_mfma_f32_32x32x16_bf16 v[16:31], v[140:143], v[180:183], v[16:31]
  ds_read_b128 v[136:139], v4 offset:59392
  s_waitcnt lgkmcnt(5)
  v_mfma_f32_32x32x16_bf16 v[32:47], v[144:147], v[180:183], v[32:47]
  ds_read_b128 v[140:143], v4 offset:60416
  v_mfma_f32_32x32x16_bf16 v[48:63], v[148:151], v[180:183], v[48:63]
  buffer_load_dwordx4 a[0:3], v4, s[40:43], s44 offen offset:2048 sc1
  ds_read_b128 v[144:147], v4 offset:61440
  s_waitcnt lgkmcnt(5)
  v_mfma_f32_32x32x16_bf16 v[16:31], v[152:155], v[184:187], v[16:31]
  ds_read_b128 v[148:151], v4 offset:62464
  v_mfma_f32_32x32x16_bf16 v[32:47], v[156:159], v[184:187], v[32:47]
  buffer_load_dwordx4 a[4:7], v4, s[40:43], s44 offen offset:3072 sc1
  ds_read_b128 v[152:155], v4 offset:63488
  s_waitcnt vmcnt(8)
  v_max_u32 v3, v192, v194
  v_max3_u32 v3, v196, v198, v3
  s_waitcnt lgkmcnt(5)
  v_mfma_f32_32x32x16_bf16 v[48:63], v[128:131], v[184:187], v[48:63]
  ds_read_b128 v[156:159], v4 offset:64512
  v_cmp_eq_u32 vcc, -1, v3
  v_mfma_f32_32x32x16_bf16 v[16:31], v[132:135], v[188:191], v[16:31]
  ds_read_b128 v[128:131], v5 offset:0
  s_nop 2
  s_cbranch_vccnz mm_kernel_st4
mm_kernel_st4_b:
  s_waitcnt lgkmcnt(5)
  v_mfma_f32_32x32x16_bf16 v[32:47], v[136:139], v[188:191], v[32:47]
  s_add_u32 s44, s5, 11264
  buffer_load_dwordx4 a[8:11], v4, s[40:43], s44 offen offset:0 sc1
  ds_read_b128 v[132:135], v5 offset:1024
  v_mfma_f32_32x32x16_bf16 v[48:63], v[140:143], v[188:191], v[48:63]
  ds_read_b128 v[136:139], v5 offset:2048
  s_waitcnt lgkmcnt(5)
  v_mfma_f32_32x32x16_bf16 v[16:31], v[144:147], v[192:195], v[16:31]
  buffer_load_dwordx4 a[12:15], v4, s[40:43], s44 offen offset:1024 sc1
  ds_read_b128 v[140:143], v5 offset:3072
  v_mfma_f32_32x32x16_bf16 v[32:47], v[148:151], v[192:195], v[32:47]
  ds_read_b128 v[144:147], v5 offset:4096
  s_waitcnt vmcnt(8)
  v_max_u32 v3, v200, v202
  v_max3_u32 v3, v204, v206, v3
  s_waitcnt lgkmcnt(5)
  v_mfma_f32_32x32x16_bf16 v[48:63], v[152:155], v[192:195], v[48:63]
  ds_read_b128 v[148:151], v5 offset:5120
  v_cmp_eq_u32 vcc, -1, v3
  v_mfma_f32_32x32x16_bf16 v[16:31], v[156:159], v[196:199], v[16:31]
  buffer_load_dwordx4 a[16:19], v4, s[40:43], s44 offen offset:3072 sc1
  ds_read_b128 v[152:155], v5 offset:6144
  s_nop 1
  s_cbranch_vccnz mm_kernel_st5
mm_kernel_st5_b:
  s_waitcnt lgkmcnt(5)
  v_mfma_f32_32x32x16_bf16 v[32:47], v[128:131], v[196:199], v[32:47]
  ds_read_b128 v[156:159], v5 offset:7168
  v_mfma_f32_32x32x16_bf16 v[48:63], v[132:135], v[196:199], v[48:63]
  s_add_u32 s44, s5, 15360
  buffer_load_dwordx4 a[20:23], v4, s[40:43], s44 offen offset:0 sc1
  ds_read_b128 v[128:131], v5 offset:8192
  s_waitcnt lgkmcnt(5)
  v_mfma_f32_32x32x16_bf16 v[16:31], v[136:139], v[200:203], v[16:31]
  ds_read_b128 v[132:135], v5 offset:9216
  v_mfma_f32_32x32x16_bf16 v[32:47], v[140:143], v[200:203], v[32:47]
  ds_read_b128 v[136:139], v5 offset:10240
  s_waitcnt vmcnt(8)
  v_max_u32 v3, v208, v210
  v_max3_u32 v3, v212, v214, v3
  s_waitcnt lgkmcnt(5)
  v_mfma_f32_32x32x16_bf16 v[48:63], v[144:147], v[200:203], v[48:63]
  ds_read_b128 v[140:143], v5 offset:11264
  v_cmp_eq_u32 vcc, -1, v3
  v_mfma_f32_32x32x16_bf16 v[16:31], v[148:151], v[204:207], v[16:31]
  buffer_load_dwordx4 a[24:27], v4, s[40:43], s44 offen offset:1024 sc1
  ds_read_b128 v[144:147], v5 offset:12288
  s_nop 1
  s_cbranch_vccnz mm_kernel_st6
mm_kernel_st6_b:
  s_waitcnt lgkmcnt(5)
  v_mfma_f32_32x32x16_bf16 v[32:47], v[152:155], v[204:207], v[32:47]
  ds_read_b128 v[148:151], v5 offset:13312
  v_mfma_f32_32x32x16_bf16 v[48:63], v[156:159], v[204:207], v[48:63]
  buffer_load_dwordx4 a[28:31], v4, s[40:43], s44 offen offset:2048 sc1
  ds_read_b128 v[152:155], v5 offset:14336
  s_waitcnt lgkmcnt(5)
  v_mfma_f32_32x32x16_bf16 v[16:31], v[128:131], v[208:211], v[16:31]
  ds_read_b128 v[156:159], v5 offset:15360
  v_mfma_f32_32x32x16_bf16 v[32:47], v[132:135], v[208:211], v[32:47]
  ds_read_b128 v[128:131], v5 offset:16384
  s_waitcnt vmcnt(8)
  v_max_u32 v3, v8, v10
  v_max3_u32 v3, v12, v14, v3
  s_waitcnt lgkmcnt(5)
  v_mfma_f32_32x32x16_bf16 v[48:63], v[136:139], v[208:211], v[48:63]
  ds_read_b128 v[132:135], v5 offset:17408
  v_cmp_eq_u32 vcc, -1, v3
  v_mfma_f32_32x32x16_bf16 v[16:31], v[140:143], v[212:215], v[16:31]
  buffer_load_dwordx4 a[32:35], v4, s[40:43], s44 offen offset:3072 sc1
  ds_read_b128 v[136:139], v5 offset:18432
  s_nop 1
  s_cbranch_vccnz mm_kernel_st7
mm_kernel_st7_b:
  s_waitcnt lgkmcnt(5)
  v_mfma_f32_32x32x16_bf16 v[32:47], v[144:147], v[212:215], v[32:47]
  ds_read_b128 v[140:143], v5 offset:19456
  v_mfma_f32_32x32x16_bf16 v[48:63], v[148:151], v[212:215], v[48:63]
  s_add_u32 s14, s7, 0
  buffer_load_dwordx4 v[160:163], v4, s[40:43], s14 offen offset:0 sc1
  ds_read_b128 v[144:147], v5 offset:20480
  s_waitcnt lgkmcnt(5)
  v_mfma_f32_32x32x16_bf16 v[16:31], v[152:155], v[8:11], v[16:31]
  ds_read_b128 v[148:151], v5 offset:21504
  s_waitcnt vmcnt(8)
  v_accvgpr_read_b32 v2, a0
  v_accvgpr_read_b32 v7, a2
  v_mfma_f32_32x32x16_bf16 v[32:47], v[156:159], v[8:11], v[32:47]
  ds_read_b128 v[152:155], v5 offset:22528
  v_max_u32 v3, v2, v7
  v_accvgpr_read_b32 v2, a4
  v_accvgpr_read_b32 v7, a6
  s_waitcnt lgkmcnt(5)
  v_mfma_f32_32x32x16_bf16 v[48:63], v[128:131], v[8:11], v[48:63]
  ds_read_b128 v[156:159], v5 offset:23552
  v_max3_u32 v3, v2, v7, v3
  v_cmp_eq_u32 vcc, -1, v3
  v_mfma_f32_32x32x16_bf16 v[16:31], v[132:135], v[12:15], v[16:31]
  buffer_load_dwordx4 v[164:167], v4, s[40:43], s14 offen offset:1024 sc1
  ds_read_b128 v[128:131], v5 offset:24576
  s_nop 1
  s_cbranch_vccnz mm_kernel_st8
mm_kernel_st8_b:
  s_waitcnt lgkmcnt(5)
  v_mfma_f32_32x32x16_bf16 v[32:47], v[136:139], v[12:15], v[32:47]
  ds_read_b128 v[132:135], v5 offset:25600
  v_mfma_f32_32x32x16_bf16 v[48:63], v[140:143], v[12:15], v[48:63]
  buffer_load_dwordx4 v[168:171], v4, s[40:43], s14 offen offset:2048 sc1
  ds_read_b128 v[136:139], v5 offset:26624
  s_waitcnt lgkmcnt(5)
  v_mfma_f32_32x32x16_bf16 v[16:31], v[144:147], a[0:3], v[16:31]
  ds_read_b128 v[140:143], v5 offset:27648
  s_waitcnt vmcnt(8)
  v_accvgpr_read_b32 v2, a8
  v_accvgpr_read_b32 v7, a10
  v_mfma_f32_32x32x16_bf16 v[32:47], v[148:151], a[0:3], v[32:47]
  ds_read_b128 v[144:147], v5 offset:28672
  v_max_u32 v3, v2, v7
  v_accvgpr_read_b32 v2, a12
  v_accvgpr_read_b32 v7, a14
  s_waitcnt lgkmcnt(5)
  v_mfma_f32_32x32x16_bf16 v[48:63], v[152:155], a[0:3], v[48:63]
  ds_read_b128 v[148:151], v5 offset:29696
  v_max3_u32 v3, v2, v7, v3
  v_cmp_eq_u32 vcc, -1, v3
  v_mfma_f32_32x32x16_bf16 v[16:31], v[156:159], a[4:7], v[16:31]
  s_mov_b32 exec_hi, 0
  buffer_load_dwordx4 v[172:175], v4, s[40:43], s14 offen offset:3072 sc1
  s_mov_b32 exec_hi, -1
  ds_read_b128 v[152:155], v5 offset:30720
  s_cbranch_vccnz mm_kernel_st9
mm_kernel_st9_b:
  s_waitcnt lgkmcnt(5)
  v_mfma_f32_32x32x16_bf16 v[32:47], v[128:131], a[4:7], v[32:47]
  ds_read_b128 v[156:159], v5 offset:31744
  v_mfma_f32_32x32x16_bf16 v[48:63], v[132:135], a[4:7], v[48:63]
  s_add_u32 s44, s5, 19456
  buffer_load_dwordx4 a[36:39], v4, s[40:43], s44 offen offset:0 sc1
  ds_read_b128 v[128:131], v5 offset:32768
  s_waitcnt lgkmcnt(5)
  v_mfma_f32_32x32x16_bf16 v[16:31], v[136:139], a[8:11], v[16:31]
  ds_read_b128 v[132:135], v5 offset:33792
  s_waitcnt vmcnt(8)
  v_accvgpr_read_b32 v2, a16
  v_accvgpr_read_b32 v7, a18
  v_mfma_f32_32x32x16_bf16 v[32:47], v[140:143], a[8:11], v[32:47]
  ds_read_b128 v[136:139], v5 offset:34816
  v_max_u32 v3, v2, v7
  v_accvgpr_read_b32 v2, a20
  v_accvgpr_read_b32 v7, a22
  s_waitcnt lgkmcnt(5)
  v_mfma_f32_32x32x16_bf16 v[48:63], v[144:147], a[8:11], v[48:63]
  ds_read_b128 v[140:143], v5 offset:35840
  v_max3_u32 v3, v2, v7, v3
  v_cmp_eq_u32 vcc, -1, v3
  v_mfma_f32_32x32x16_bf16 v[16:31], v[148:151], a[12:15], v[16:31]
  buffer_load_dwordx4 a[40:43], v4, s[40:43], s44 offen offset:2048 sc1
  ds_read_b128 v[144:147], v5 offset:36864
  s_nop 1
  s_cbranch_vccnz mm_kernel_st10
mm_kernel_st10_b:
  s_waitcnt lgkmcnt(5)
  v_mfma_f32_32x32x16_bf16 v[32:47], v[152:155], a[12:15], v[32:47]
  ds_read_b128 v[148:151], v5 offset:37888
  v_mfma_f32_32x32x16_bf16 v[48:63], v[156:159], a[12:15], v[48:63]
  buffer_load_dwordx4 a[44:47], v4, s[40:43], s44 offen offset:3072 sc1
  ds_read_b128 v[152:155], v5 offset:38912
  s_waitcnt lgkmcnt(5)
  v_mfma_f32_32x32x16_bf16 v[16:31], v[128:131], a[16:19], v[16:31]
  ds_read_b128 v[156:159], v5 offset:39936
  s_waitcnt vmcnt(8)
  v_accvgpr_read_b32 v2, a24
  v_accvgpr_read_b32 v7, a26
  v_mfma_f32_32x32x16_bf16 v[32:47], v[132:135], a[16:19], v[32:47]
  ds_read_b128 v[128:131], v5 offset:40960
  v_max_u32 v3, v2, v7
  v_accvgpr_read_b32 v2, a28
  v_accvgpr_read_b32 v7, a30
  s_waitcnt lgkmcnt(5)
  v_mfma_f32_32x32x16_bf16 v[48:63], v[136:139], a[16:19], v[48:63]
  ds_read_b128 v[132:135], v5 offset:41984
  v_max3_u32 v3, v2, v7, v3
  v_cmp_eq_u32 vcc, -1, v3
  v_mfma_f32_32x32x16_bf16 v[16:31], v[140:143], a[20:23], v[16:31]
  s_add_u32 s44, s5, 23552
  buffer_load_dwordx4 a[48:51], v4, s[40:43], s44 offen offset:0 sc1
  ds_read_b128 v[136:139], v5 offset:43008
  s_nop 0
  s_cbranch_vccnz mm_kernel_st11
mm_kernel_st11_b:
  s_waitcnt lgkmcnt(5)
  v_mfma_f32_32x32x16_bf16 v[32:47], v[144:147], a[20:23], v[32:47]
  ds_read_b128 v[140:143], v5 offset:44032
  v_mfma_f32_32x32x16_bf16 v[48:63], v[148:151], a[20:23], v[48:63]
  buffer_load_dwordx4 a[52:55], v4, s[40:43], s44 offen offset:1024 sc1
  ds_read_b128 v[144:147], v5 offset:45056
  s_waitcnt lgkmcnt(5)
  v_mfma_f32_32x32x16_bf16 v[16:31], v[152:155], a[24:27], v[16:31]
  ds_read_b128 v[148:151], v5 offset:46080
  s_waitcnt vmcnt(4)
  v_accvgpr_read_b32 v2, a32
  v_accvgpr_read_b32 v7, a34
  v_mfma_f32_32x32x16_bf16 v[32:47], v[156:159], a[24:27], v[32:47]
  ds_read_b128 v[152:155], v5 offset:47104
  v_max_u32 v3, v2, v7
  v_accvgpr_read_b32 v2, a36
  v_accvgpr_read_b32 v7, a38
  s_waitcnt lgkmcnt(5)
  v_mfma_f32_32x32x16_bf16 v[48:63], v[128:131], a[24:27], v[48:63]
  ds_read_b128 v[156:159], v5 offset:48128
  v_max3_u32 v3, v2, v7, v3
  v_cmp_eq_u32 vcc, -1, v3
  v_mfma_f32_32x32x16_bf16 v[16:31], v[132:135], a[28:31], v[16:31]
  buffer_load_dwordx4 a[56:59], v4, s[40:43], s44 offen offset:2048 sc1
  ds_read_b128 v[128:131], v5 offset:49152
  s_nop 1
  s_cbranch_vccnz mm_kernel_st12
mm_kernel_st12_b:
  v_max_u32 v3, v160, v162
  v_max3_u32 v3, v164, v166, v3
  s_waitcnt lgkmcnt(5)
  v_mfma_f32_32x32x16_bf16 v[32:47], v[136:139], a[28:31], v[32:47]
  ds_read_b128 v[132:135], v5 offset:50176
  v_max3_u32 v3, v168, v170, v3
  v_max3_u32 v3, v172, v174, v3
  v_cmp_eq_u32 vcc, -1, v3
  v_mfma_f32_32x32x16_bf16 v[48:63], v[140:143], a[28:31], v[48:63]
  buffer_load_dwordx4 a[60:63], v4, s[40:43], s44 offen offset:3072 sc1
  ds_read_b128 v[136:139], v5 offset:51200
  s_waitcnt lgkmcnt(5)
  v_mfma_f32_32x32x16_bf16 v[16:31], v[144:147], a[32:35], v[16:31]
  ds_read_b128 v[140:143], v5 offset:52224
  s_cbranch_vccnz mm_kernel_st13
mm_kernel_st13_b:
  s_waitcnt vmcnt(4)
  v_accvgpr_read_b32 v2, a40
  v_mfma_f32_32x32x16_bf16 v[32:47], v[148:151], a[32:35], v[32:47]
  v_add_f32 v160, v160, v162
  v_add_f32 v161, v161, v163
  ds_read_b128 v[144:147], v5 offset:53248
  v_accvgpr_read_b32 v7, a42
  v_max_u32 v3, v2, v7
  v_accvgpr_read_b32 v2, a44
  s_waitcnt lgkmcnt(5)
  v_mfma_f32_32x32x16_bf16 v[48:63], v[152:155], a[32:35], v[48:63]
  v_add_f32 v164, v164, v166
  ds_read_b128 v[148:151], v5 offset:54272
  v_accvgpr_read_b32 v7, a46
  v_max3_u32 v3, v2, v7, v3
  v_cmp_eq_u32 vcc, -1, v3
  v_mfma_f32_32x32x16_bf16 v[16:31], v[156:159], a[36:39], v[16:31]
  s_sub_u32 m0, s63, 49152
  s_add_u32 s48, s64, 114688
  buffer_load_dwordx4 v4, s[40:43], s48 offen offset:0 lds
  ds_read_b128 v[152:155], v5 offset:55296
  s_waitcnt lgkmcnt(5)
  v_mfma_f32_32x32x16_bf16 v[32:47], v[128:131], a[36:39], v[32:47]
  v_add_f32 v165, v165, v167
  v_add_f32 v168, v168, v170
  v_add_f32 v169, v169, v171
  v_add_f32 v172, v172, v174
  ds_read_b128 v[156:159], v5 offset:56320
  s_cbranch_vccnz mm_kernel_st14
mm_kernel_st14_b:
  v_mfma_f32_32x32x16_bf16 v[48:63], v[132:135], a[36:39], v[48:63]
  buffer_load_dwordx4 v4, s[40:43], s48 offen offset:1024 lds
  v_add_f32 v173, v173, v175
  v_add_f32 v160, v160, v164
  ds_read_b128 v[128:131], v5 offset:57344
  s_waitcnt lgkmcnt(5)
  v_mfma_f32_32x32x16_bf16 v[16:31], v[136:139], a[40:43], v[16:31]
  v_add_f32 v161, v161, v165
  v_add_f32 v168, v168, v172
  v_add_f32 v169, v169, v173
  v_add_f32 v160, v160, v168
  ds_read_b128 v[132:135], v5 offset:58368
  s_waitcnt vmcnt(4)
  v_accvgpr_read_b32 v2, a48
  v_accvgpr_read_b32 v7, a50
  v_mfma_f32_32x32x16_bf16 v[32:47], v[140:143], a[40:43], v[32:47]
  v_add_f32 v161, v161, v169
  v_mov_b32 v164, v160
  ds_read_b128 v[136:139], v5 offset:59392
  v_max_u32 v3, v2, v7
  v_accvgpr_read_b32 v2, a52
  v_accvgpr_read_b32 v7, a54
  s_waitcnt lgkmcnt(5)
  v_mfma_f32_32x32x16_bf16 v[48:63], v[144:147], a[40:43], v[48:63]
  v_mov_b32 v165, v161
  ds_read_b128 v[140:143], v5 offset:60416
  v_max3_u32 v3, v2, v7, v3
  v_cmp_eq_u32 vcc, -1, v3
  v_mfma_f32_32x32x16_bf16 v[16:31], v[148:151], a[44:47], v[16:31]
  buffer_load_dwordx4 v4, s[40:43], s48 offen offset:2048 lds
  ds_read_b128 v[144:147], v5 offset:61440
  s_nop 1
  s_cbranch_vccnz mm_kernel_st15
mm_kernel_st15_b:
  s_waitcnt lgkmcnt(5)
  v_mfma_f32_32x32x16_bf16 v[32:47], v[152:155], a[44:47], v[32:47]
  v_permlane32_swap_b32 v160, v164
  v_permlane32_swap_b32 v161, v165
  v_add_f32 v160, v160, v164
  ds_read_b128 v[148:151], v5 offset:62464
  v_mfma_f32_32x32x16_bf16 v[48:63], v[156:159], a[44:47], v[48:63]
  buffer_load_dwordx4 v4, s[40:43], s48 offen offset:3072 lds
  v_add_f32 v161, v161, v165
  v_mul_f32 v160, 0xbb124925, v160
  v_mul_f32 v161, 0x3b124925, v161
  ds_read_b128 v[152:155], v5 offset:63488
  s_waitcnt lgkmcnt(5)
  v_mfma_f32_32x32x16_bf16 v[16:31], v[128:131], a[48:51], v[16:31]
  v_fma_f32 v161, -v160, v160, v161
  v_max_f32 v161, 0, v161
  v_add_f32 v161, 0x3727c5ac, v161
  v_rcp_f32 v172, v161
  ds_read_b128 v[156:159], v5 offset:64512
  s_waitcnt vmcnt(4)
  v_accvgpr_read_b32 v2, a56
  v_accvgpr_read_b32 v7, a58
  v_mfma_f32_32x32x16_bf16 v[32:47], v[132:135], a[48:51], v[32:47]
  v_cvt_pk_bf16_f32 v168, v160, v160
  v_lshlrev_b32 v164, 16, v168
  ds_read_b128 v[128:131], v6 offset:0
  v_max_u32 v3, v2, v7
  v_accvgpr_read_b32 v2, a60
  v_accvgpr_read_b32 v7, a62
  s_waitcnt lgkmcnt(5)
  v_mfma_f32_32x32x16_bf16 v[48:63], v[136:139], a[48:51], v[48:63]
  v_sub_f32 v164, v160, v164
  ds_read_b128 v[132:135], v6 offset:1024
  v_max3_u32 v3, v2, v7, v3
  v_cmp_eq_u32 vcc, -1, v3
  v_mfma_f32_32x32x16_bf16 v[16:31], v[140:143], a[52:55], v[16:31]
  s_sub_u32 m0, s63, 32768
  s_add_u32 s48, s64, 131072
  buffer_load_dwordx4 v4, s[40:43], s48 offen offset:0 lds
  ds_read_b128 v[136:139], v6 offset:2048
  s_cbranch_vccnz mm_kernel_st16
mm_kernel_st16_b:
  s_waitcnt lgkmcnt(5)
  v_mfma_f32_32x32x16_bf16 v[32:47], v[144:147], a[52:55], v[32:47]
  v_mov_b32 v173, v172
  s_mov_b32 exec_lo, 0
  v_cvt_pk_bf16_f32 v168, v164, v164
  s_mov_b32 exec_lo, -1
  ds_read_b128 v[140:143], v6 offset:3072
  v_mfma_f32_32x32x16_bf16 v[48:63], v[148:151], a[52:55], v[48:63]
  buffer_load_dwordx4 v4, s[40:43], s48 offen offset:1024 lds
  v_mov_b32 v169, v168
  v_mov_b32 v170, v168
  v_mov_b32 v171, v168
  v_lshlrev_b32 v147, 2, v1
  v_add_u32 v147, 131072, v147
  ds_read2st64_b32 v[144:145], v147 offset0:16 offset1:17
  ds_read2st64_b32 v[146:147], v147 offset0:18 offset1:19
  s_waitcnt lgkmcnt(6)
  v_mfma_f32_32x32x16_bf16 v[16:31], v[152:155], a[56:59], v[16:31]
  v_lshlrev_b32 v151, 2, v1
  v_add_u32 v151, 131072, v151
  ds_read2st64_b32 v[148:149], v151 offset0:20 offset1:21
  ds_read2st64_b32 v[150:151], v151 offset0:22 offset1:23
  v_mfma_f32_32x32x16_bf16 v[32:47], v[156:159], a[56:59], v[32:47]
  v_lshlrev_b32 v155, 2, v1
  v_add_u32 v155, 131072, v155
  ds_read2st64_b32 v[152:153], v155 offset0:24 offset1:25
  ds_read2st64_b32 v[154:155], v155 offset0:26 offset1:27
  s_waitcnt lgkmcnt(8)
  v_mfma_f32_32x32x16_bf16 v[48:63], v[128:131], a[56:59], v[48:63]
  buffer_load_dwordx4 v4, s[40:43], s48 offen offset:2048 lds
  ds_read_b128 v[156:159], v6 offset:7168
  v_mfma_f32_32x32x16_bf16 v[16:31], v[132:135], a[60:63], v[16:31]
  ds_read_b128 v[128:131], v6 offset:8192
  s_waitcnt lgkmcnt(8)
  v_mfma_f32_32x32x16_bf16 v[32:47], v[136:139], a[60:63], v[32:47]
  buffer_load_dwordx4 v4, s[40:43], s48 offen offset:3072 lds
  ds_read_b128 v[132:135], v6 offset:9216
  v_mfma_f32_32x32x16_bf16 v[48:63], v[140:143], a[60:63], v[48:63]
  ds_read_b128 v[136:139], v6 offset:10240
  s_waitcnt lgkmcnt(6)
  v_mfma_f32_32x32x16_bf16 v[16:31], v[144:147], v[168:171], v[16:31]
  ds_read_b128 v[140:143], v6 offset:11264
  v_mfma_f32_32x32x16_bf16 v[32:47], v[148:151], v[168:171], v[32:47]
  s_sub_u32 m0, s63, 16384
  s_add_u32 s48, s64, 147456
  buffer_load_dwordx4 v4, s[40:43], s48 offen offset:0 lds
  ds_read_b128 v[144:147], v6 offset:12288
  s_waitcnt lgkmcnt(5)
  v_mfma_f32_32x32x16_bf16 v[48:63], v[152:155], v[168:171], v[48:63]
  ds_read_b128 v[148:151], v6 offset:13312
  v_mfma_f32_32x32x16_bf16 v[64:79], v[156:159], v[192:195], 0
  buffer_load_dwordx4 v4, s[40:43], s48 offen offset:1024 lds
  s_nop 0
  v_mul_f32 v16, v16, v24
  v_mul_f32 v17, v17, v25
  v_mul_f32 v16, v172, v16
  ds_read_b128 v[152:155], v6 offset:14336
  s_waitcnt lgkmcnt(5)
  v_mfma_f32_32x32x16_bf16 v[80:95], v[128:131], v[192:195], 0
  v_mul_f32 v17, v172, v17
  v_cvt_pk_bf16_f32 v160, v16, v17
  v_mul_f32 v18, v18, v26
  v_mul_f32 v19, v19, v27
  ds_read_b128 v[156:159], v6 offset:15360
  v_mfma_f32_32x32x16_bf16 v[64:79], v[132:135], v[196:199], v[64:79]
  v_mul_f32 v18, v172, v18
  v_mul_f32 v19, v172, v19
  v_cvt_pk_bf16_f32 v161, v18, v19
  v_mul_f32 v20, v20, v28
  v_mul_f32 v21, v21, v29
  ds_read_b128 v[128:131], v6 offset:16384
  s_waitcnt lgkmcnt(5)
  v_mfma_f32_32x32x16_bf16 v[80:95], v[136:139], v[196:199], v[80:95]
  buffer_load_dwordx4 v4, s[40:43], s48 offen offset:2048 lds
  v_mul_f32 v20, v172, v20
  v_mul_f32 v21, v172, v21
  ds_read_b128 v[132:135], v6 offset:17408
  v_mfma_f32_32x32x16_bf16 v[64:79], v[140:143], v[200:203], v[64:79]
  v_cvt_pk_bf16_f32 v162, v20, v21
  v_mul_f32 v22, v22, v30
  v_mul_f32 v23, v23, v31
  v_mul_f32 v22, v172, v22
  v_mul_f32 v23, v172, v23
  ds_read_b128 v[136:139], v6 offset:18432
  s_waitcnt lgkmcnt(5)
  v_mfma_f32_32x32x16_bf16 v[80:95], v[144:147], v[200:203], v[80:95]
  buffer_load_dwordx4 v4, s[40:43], s48 offen offset:3072 lds
  v_cvt_pk_bf16_f32 v163, v22, v23
  s_add_u32 s14, s6, 0
  buffer_store_dwordx4 v[160:163], v4, s[40:43], s14 offen sc1
  ds_read_b128 v[140:143], v6 offset:19456
  v_mfma_f32_32x32x16_bf16 v[64:79], v[148:151], v[204:207], v[64:79]
  v_mul_f32 v32, v32, v40
  v_mul_f32 v33, v33, v41
  v_mul_f32 v32, v172, v32
  v_mul_f32 v33, v172, v33
  v_cvt_pk_bf16_f32 v164, v32, v33
  ds_read_b128 v[144:147], v6 offset:20480
  s_waitcnt lgkmcnt(5)
  v_mfma_f32_32x32x16_bf16 v[80:95], v[152:155], v[204:207], v[80:95]
  v_mul_f32 v34, v34, v42
  v_mul_f32 v35, v35, v43
  v_mul_f32 v34, v172, v34
  v_mul_f32 v35, v172, v35
  ds_read_b128 v[148:151], v6 offset:21504
  v_mfma_f32_32x32x16_bf16 v[64:79], v[156:159], v[208:211], v[64:79]
  v_cvt_pk_bf16_f32 v165, v34, v35
  v_mul_f32 v36, v36, v44
  v_mul_f32 v37, v37, v45
  v_mul_f32 v36, v172, v36
  v_mul_f32 v37, v172, v37
  ds_read_b128 v[152:155], v6 offset:22528
  s_waitcnt lgkmcnt(5)
  v_mfma_f32_32x32x16_bf16 v[80:95], v[128:131], v[208:211], v[80:95]
  v_cvt_pk_bf16_f32 v166, v36, v37
  v_mul_f32 v38, v38, v46
  v_mul_f32 v39, v39, v47
  v_mul_f32 v38, v172, v38
  ds_read_b128 v[156:159], v6 offset:23552
  v_mfma_f32_32x32x16_bf16 v[64:79], v[132:135], v[212:215], v[64:79]
  v_mul_f32 v39, v172, v39
  v_cvt_pk_bf16_f32 v167, v38, v39
  s_add_u32 s14, s6, 1024
  buffer_store_dwordx4 v[164:167], v4, s[40:43], s14 offen sc1
  ds_read_b128 v[128:131], v6 offset:24576
  s_waitcnt lgkmcnt(5)
  v_mfma_f32_32x32x16_bf16 v[80:95], v[136:139], v[212:215], v[80:95]
  v_mul_f32 v48, v48, v56
  v_mul_f32 v49, v49, v57
  v_mul_f32 v48, v172, v48
  v_mul_f32 v49, v172, v49
  ds_read_b128 v[132:135], v6 offset:25600
  v_mfma_f32_32x32x16_bf16 v[64:79], v[140:143], v[176:179], v[64:79]
  v_cvt_pk_bf16_f32 v160, v48, v49
  v_mul_f32 v50, v50, v58
  v_mul_f32 v51, v51, v59
  v_mul_f32 v50, v172, v50
  v_mul_f32 v51, v172, v51
  ds_read_b128 v[136:139], v6 offset:26624
  s_waitcnt lgkmcnt(5)
  v_mfma_f32_32x32x16_bf16 v[80:95], v[144:147], v[176:179], v[80:95]
  v_cvt_pk_bf16_f32 v161, v50, v51
  v_mul_f32 v52, v52, v60
  v_mul_f32 v53, v53, v61
  v_mul_f32 v52, v172, v52
  ds_read_b128 v[140:143], v6 offset:27648
  v_mfma_f32_32x32x16_bf16 v[64:79], v[148:151], v[8:11], v[64:79]
  v_mul_f32 v53, v172, v53
  v_cvt_pk_bf16_f32 v162, v52, v53
  v_mul_f32 v54, v54, v62
  v_mul_f32 v55, v55, v63
  v_mul_f32 v54, v172, v54
  ds_read_b128 v[144:147], v6 offset:28672
  s_waitcnt lgkmcnt(5)
  v_mfma_f32_32x32x16_bf16 v[80:95], v[152:155], v[8:11], v[80:95]
  v_mul_f32 v55, v172, v55
  v_cvt_pk_bf16_f32 v163, v54, v55
  s_add_u32 s14, s6, 2048
  buffer_store_dwordx4 v[160:163], v4, s[40:43], s14 offen sc1
  ds_read_b128 v[148:151], v6 offset:29696
  v_mfma_f32_32x32x16_bf16 v[64:79], v[156:159], v[12:15], v[64:79]
  ds_read_b128 v[152:155], v6 offset:30720
  s_waitcnt lgkmcnt(5)
  v_mfma_f32_32x32x16_bf16 v[80:95], v[128:131], v[12:15], v[80:95]
  ds_read_b128 v[156:159], v6 offset:31744
  v_mfma_f32_32x32x16_bf16 v[64:79], v[132:135], a[0:3], v[64:79]
  s_waitcnt vmcnt(3)
  s_barrier
  ds_read_b128 v[128:131], v4 offset:0
  s_waitcnt lgkmcnt(5)
  v_mfma_f32_32x32x16_bf16 v[80:95], v[136:139], a[0:3], v[80:95]
  s_add_u32 m0, s63, 0
  s_add_u32 s48, s64, 163840
  buffer_load_dwordx4 v4, s[40:43], s48 offen offset:0 lds
  ds_read_b128 v[132:135], v4 offset:1024
  v_mfma_f32_32x32x16_bf16 v[64:79], v[140:143], a[4:7], v[64:79]
  ds_read_b128 v[136:139], v4 offset:2048
  s_waitcnt lgkmcnt(5)
  v_mfma_f32_32x32x16_bf16 v[80:95], v[144:147], a[4:7], v[80:95]
  buffer_load_dwordx4 v4, s[40:43], s48 offen offset:1024 lds
  ds_read_b128 v[140:143], v4 offset:3072
  v_mfma_f32_32x32x16_bf16 v[64:79], v[148:151], a[8:11], v[64:79]
  ds_read_b128 v[144:147], v4 offset:4096
  s_waitcnt lgkmcnt(5)
  v_mfma_f32_32x32x16_bf16 v[80:95], v[152:155], a[8:11], v[80:95]
  ds_read_b128 v[148:151], v4 offset:5120
  v_mfma_f32_32x32x16_bf16 v[64:79], v[156:159], a[12:15], v[64:79]
  buffer_load_dwordx4 v4, s[40:43], s48 offen offset:2048 lds
  ds_read_b128 v[152:155], v4 offset:6144
  s_waitcnt lgkmcnt(5)
  v_mfma_f32_32x32x16_bf16 v[80:95], v[128:131], a[12:15], v[80:95]
  ds_read_b128 v[156:159], v4 offset:7168
  v_mfma_f32_32x32x16_bf16 v[64:79], v[132:135], v[180:183], v[64:79]
  buffer_load_dwordx4 v4, s[40:43], s48 offen offset:3072 lds
  ds_read_b128 v[128:131], v4 offset:8192
  s_waitcnt lgkmcnt(5)
  v_mfma_f32_32x32x16_bf16 v[80:95], v[136:139], v[180:183], v[80:95]
  ds_read_b128 v[132:135], v4 offset:9216
  v_mfma_f32_32x32x16_bf16 v[64:79], v[140:143], a[16:19], v[64:79]
  ds_read_b128 v[136:139], v4 offset:10240
  s_waitcnt lgkmcnt(5)
  v_mfma_f32_32x32x16_bf16 v[80:95], v[144:147], a[16:19], v[80:95]
  s_add_u32 m0, s63, 16384
  s_add_u32 s48, s64, 180224
  buffer_load_dwordx4 v4, s[40:43], s48 offen offset:0 lds
  ds_read_b128 v[140:143], v4 offset:11264
  v_mfma_f32_32x32x16_bf16 v[64:79], v[148:151], a[20:23], v[64:79]
  ds_read_b128 v[144:147], v4 offset:12288
  s_waitcnt lgkmcnt(5)
  v_mfma_f32_32x32x16_bf16 v[80:95], v[152:155], a[20:23], v[80:95]
  buffer_load_dwordx4 v4, s[40:43], s48 offen offset:1024 lds
  ds_read_b128 v[148:151], v4 offset:13312
  v_mfma_f32_32x32x16_bf16 v[64:79], v[156:159], a[24:27], v[64:79]
  ds_read_b128 v[152:155], v4 offset:14336
  s_waitcnt lgkmcnt(5)
  v_mfma_f32_32x32x16_bf16 v[80:95], v[128:131], a[24:27], v[80:95]
  ds_read_b128 v[156:159], v4 offset:15360
  v_mfma_f32_32x32x16_bf16 v[64:79], v[132:135], a[28:31], v[64:79]
  buffer_load_dwordx4 v4, s[40:43], s48 offen offset:2048 lds
  ds_read_b128 v[128:131], v4 offset:16384
  s_waitcnt lgkmcnt(5)
  v_mfma_f32_32x32x16_bf16 v[80:95], v[136:139], a[28:31], v[80:95]
  ds_read_b128 v[132:135], v4 offset:17408
  v_mfma_f32_32x32x16_bf16 v[64:79], v[140:143], a[32:35], v[64:79]
  buffer_load_dwordx4 v4, s[40:43], s48 offen offset:3072 lds
  ds_read_b128 v[136:139], v4 offset:18432
  s_waitcnt lgkmcnt(5)
  v_mfma_f32_32x32x16_bf16 v[80:95], v[144:147], a[32:35], v[80:95]
  ds_read_b128 v[140:143], v4 offset:19456
  v_mfma_f32_32x32x16_bf16 v[64:79], v[148:151], a[36:39], v[64:79]
  ds_read_b128 v[144:147], v4 offset:20480
  s_waitcnt lgkmcnt(5)
  v_mfma_f32_32x32x16_bf16 v[80:95], v[152:155], a[36:39], v[80:95]
  s_add_u32 m0, s63, 32768
  s_add_u32 s48, s64, 196608
  buffer_load_dwordx4 v4, s[40:43], s48 offen offset:0 lds
  ds_read_b128 v[148:151], v4 offset:21504
  v_mfma_f32_32x32x16_bf16 v[64:79], v[156:159], v[184:187], v[64:79]
  ds_read_b128 v[152:155], v4 offset:22528
  s_waitcnt lgkmcnt(5)
  v_mfma_f32_32x32x16_bf16 v[80:95], v[128:131], v[184:187], v[80:95]
  buffer_load_dwordx4 v4, s[40:43], s48 offen offset:1024 lds
  ds_read_b128 v[156:159], v4 offset:23552
  v_mfma_f32_32x32x16_bf16 v[64:79], v[132:135], a[40:43], v[64:79]
  ds_read_b128 v[128:131], v4 offset:24576
  s_waitcnt lgkmcnt(5)
  v_mfma_f32_32x32x16_bf16 v[80:95], v[136:139], a[40:43], v[80:95]
  ds_read_b128 v[132:135], v4 offset:25600
  v_mfma_f32_32x32x16_bf16 v[64:79], v[140:143], a[44:47], v[64:79]
  buffer_load_dwordx4 v4, s[40:43], s48 offen offset:2048 lds
  ds_read_b128 v[136:139], v4 offset:26624
  s_waitcnt lgkmcnt(5)
  v_mfma_f32_32x32x16_bf16 v[80:95], v[144:147], a[44:47], v[80:95]
  ds_read_b128 v[140:143], v4 offset:27648
  v_mfma_f32_32x32x16_bf16 v[64:79], v[148:151], a[48:51], v[64:79]
  buffer_load_dwordx4 v4, s[40:43], s48 offen offset:3072 lds
  ds_read_b128 v[144:147], v4 offset:28672
  s_waitcnt lgkmcnt(5)
  v_mfma_f32_32x32x16_bf16 v[80:95], v[152:155], a[48:51], v[80:95]
  ds_read_b128 v[148:151], v4 offset:29696
  v_mfma_f32_32x32x16_bf16 v[64:79], v[156:159], a[52:55], v[64:79]
  ds_read_b128 v[152:155], v4 offset:30720
  s_waitcnt lgkmcnt(5)
  v_mfma_f32_32x32x16_bf16 v[80:95], v[128:131], a[52:55], v[80:95]
  v_lshlrev_b32 v159, 2, v1
  ds_read2st64_b32 v[156:157], v159 offset0:124 offset1:125
  ds_read2st64_b32 v[158:159], v159 offset0:126 offset1:127
  v_mfma_f32_32x32x16_bf16 v[64:79], v[132:135], a[56:59], v[64:79]
  v_lshlrev_b32 v131, 2, v1
  ds_read2st64_b32 v[128:129], v131 offset0:128 offset1:129
  ds_read2st64_b32 v[130:131], v131 offset0:130 offset1:131
  s_waitcnt lgkmcnt(7)
  v_mfma_f32_32x32x16_bf16 v[80:95], v[136:139], a[56:59], v[80:95]
  ds_read_b128 v[132:135], v4 offset:33792
  v_mfma_f32_32x32x16_bf16 v[64:79], v[140:143], a[60:63], v[64:79]
  ds_read_b128 v[136:139], v4 offset:34816
  s_waitcnt lgkmcnt(7)
  v_mfma_f32_32x32x16_bf16 v[80:95], v[144:147], a[60:63], v[80:95]
  ds_read_b128 v[140:143], v4 offset:35840
  v_mfma_f32_32x32x16_bf16 v[64:79], v[148:151], v[188:191], v[64:79]
  ds_read_b128 v[144:147], v4 offset:36864
  s_waitcnt lgkmcnt(6)
  v_mfma_f32_32x32x16_bf16 v[80:95], v[152:155], v[188:191], v[80:95]
  ds_read_b128 v[148:151], v4 offset:37888
  v_mfma_f32_32x32x16_bf16 v[64:79], v[156:159], v[168:171], v[64:79]
  ds_read_b128 v[152:155], v4 offset:38912
  s_waitcnt lgkmcnt(5)
  v_mfma_f32_32x32x16_bf16 v[80:95], v[128:131], v[168:171], v[80:95]
  ds_read_b128 v[156:159], v4 offset:39936
  v_mfma_f32_32x32x16_bf16 v[96:111], v[132:135], v[192:195], 0
  ds_read_b128 v[128:131], v4 offset:40960
  s_waitcnt lgkmcnt(5)
  v_mfma_f32_32x32x16_bf16 v[112:127], v[136:139], v[192:195], 0
  s_nop 3
  v_mul_f32 v64, v64, v72
  v_mul_f32 v65, v65, v73
  v_mul_f32 v64, v172, v64
  v_mul_f32 v65, v172, v65
  ds_read_b128 v[132:135], v4 offset:41984
  v_mfma_f32_32x32x16_bf16 v[96:111], v[140:143], v[196:199], v[96:111]
  v_cvt_pk_bf16_f32 v164, v64, v65
  v_mul_f32 v66, v66, v74
  v_mul_f32 v67, v67, v75
  v_mul_f32 v66, v172, v66
  v_mul_f32 v67, v172, v67
  ds_read_b128 v[136:139], v4 offset:43008
  s_waitcnt lgkmcnt(5)
  v_mfma_f32_32x32x16_bf16 v[112:127], v[144:147], v[196:199], v[112:127]
  v_cvt_pk_bf16_f32 v165, v66, v67
  v_mul_f32 v68, v68, v76
  v_mul_f32 v69, v69, v77
  v_mul_f32 v68, v172, v68
  ds_read_b128 v[140:143], v4 offset:44032
  v_mfma_f32_32x32x16_bf16 v[96:111], v[148:151], v[200:203], v[96:111]
  v_mul_f32 v69, v172, v69
  v_cvt_pk_bf16_f32 v166, v68, v69
  v_mul_f32 v70, v70, v78
  v_mul_f32 v71, v71, v79
  v_mul_f32 v70, v172, v70
  ds_read_b128 v[144:147], v4 offset:45056
  s_waitcnt lgkmcnt(5)
  v_mfma_f32_32x32x16_bf16 v[112:127], v[152:155], v[200:203], v[112:127]
  s_add_u32 s44, s10, s52
  buffer_load_dwordx4 v[16:19], v4, s[68:71], s44 offen offset:0 sc1
  v_mul_f32 v71, v172, v71
  ds_read_b128 v[148:151], v4 offset:46080
  v_mfma_f32_32x32x16_bf16 v[96:111], v[156:159], v[204:207], v[96:111]
  v_cvt_pk_bf16_f32 v167, v70, v71
  s_add_u32 s14, s6, 3072
  buffer_store_dwordx4 v[164:167], v4, s[40:43], s14 offen sc1
  v_mul_f32 v80, v80, v88
  ds_read_b128 v[152:155], v4 offset:47104
  s_waitcnt lgkmcnt(5)
  v_mfma_f32_32x32x16_bf16 v[112:127], v[128:131], v[204:207], v[112:127]
  s_add_u32 s45, s11, s52
  buffer_load_dwordx4 v[20:23], v4, s[68:71], s45 offen offset:0 sc1
  v_mul_f32 v81, v81, v89
  ds_read_b128 v[156:159], v4 offset:48128
  v_mfma_f32_32x32x16_bf16 v[96:111], v[132:135], v[208:211], v[96:111]
  v_mul_f32 v80, v172, v80
  v_mul_f32 v81, v172, v81
  v_cvt_pk_bf16_f32 v160, v80, v81
  v_mul_f32 v82, v82, v90
  v_mul_f32 v83, v83, v91
  s_waitcnt vmcnt(3)
  s_barrier
  ds_read_b128 v[128:131], v4 offset:49152
  s_waitcnt lgkmcnt(5)
  v_mfma_f32_32x32x16_bf16 v[112:127], v[136:139], v[208:211], v[112:127]
  v_mul_f32 v82, v172, v82
  v_mul_f32 v83, v172, v83
  ds_read_b128 v[132:135], v4 offset:50176
  v_mfma_f32_32x32x16_bf16 v[96:111], v[140:143], v[212:215], v[96:111]
  buffer_load_dwordx4 v[24:27], v4, s[68:71], s44 offen offset:1024 sc1
  v_cvt_pk_bf16_f32 v161, v82, v83
  v_mul_f32 v84, v84, v92
  v_mul_f32 v85, v85, v93
  ds_read_b128 v[136:139], v4 offset:51200
  s_waitcnt lgkmcnt(5)
  v_mfma_f32_32x32x16_bf16 v[112:127], v[144:147], v[212:215], v[112:127]
  v_mul_f32 v84, v172, v84
  v_mul_f32 v85, v172, v85
  v_cvt_pk_bf16_f32 v162, v84, v85
  v_mul_f32 v86, v86, v94
  ds_read_b128 v[140:143], v4 offset:52224
  v_mfma_f32_32x32x16_bf16 v[96:111], v[148:151], v[176:179], v[96:111]
  buffer_load_dwordx4 v[28:31], v4, s[68:71], s45 offen offset:1024 sc1
  v_mul_f32 v87, v87, v95
  v_mul_f32 v86, v172, v86
  v_mul_f32 v87, v172, v87
  ds_read_b128 v[144:147], v4 offset:53248
  s_waitcnt lgkmcnt(5)
  v_mfma_f32_32x32x16_bf16 v[112:127], v[152:155], v[176:179], v[112:127]
  v_cvt_pk_bf16_f32 v163, v86, v87
  s_add_u32 s14, s6, 4096
  buffer_store_dwordx4 v[160:163], v4, s[40:43], s14 offen sc1
  ds_read_b128 v[148:151], v4 offset:54272
  v_mfma_f32_32x32x16_bf16 v[96:111], v[156:159], v[8:11], v[96:111]
  v_lshlrev_b32 v64, 16, v248
  v_and_b32 v65, s61, v248
  v_lshlrev_b32 v66, 16, v249
  v_and_b32 v67, s61, v249
  v_lshlrev_b32 v68, 16, v250
  ds_read_b128 v[152:155], v4 offset:55296
  s_waitcnt lgkmcnt(5)
  v_mfma_f32_32x32x16_bf16 v[112:127], v[128:131], v[8:11], v[112:127]
  buffer_load_dwordx4 v[32:35], v4, s[68:71], s44 offen offset:2048 sc1
  v_and_b32 v69, s61, v250
  v_lshlrev_b32 v70, 16, v251
  ds_read_b128 v[156:159], v4 offset:56320
  v_mfma_f32_32x32x16_bf16 v[96:111], v[132:135], v[12:15], v[96:111]
  v_and_b32 v71, s61, v251
  v_lshlrev_b32 v72, 16, v252
  v_and_b32 v73, s61, v252
  v_lshlrev_b32 v74, 16, v253
  v_and_b32 v75, s61, v253
  ds_read_b128 v[128:131], v4 offset:57344
  s_waitcnt lgkmcnt(5)
  v_mfma_f32_32x32x16_bf16 v[112:127], v[136:139], v[12:15], v[112:127]
  buffer_load_dwordx4 v[36:39], v4, s[68:71], s45 offen offset:2048 sc1
  v_lshlrev_b32 v76, 16, v254
  v_and_b32 v77, s61, v254
  ds_read_b128 v[132:135], v4 offset:58368
  v_mfma_f32_32x32x16_bf16 v[96:111], v[140:143], a[0:3], v[96:111]
  v_lshlrev_b32 v78, 16, v255
  v_and_b32 v79, s61, v255
  ds_read_b128 v[136:139], v4 offset:59392
  s_waitcnt lgkmcnt(5)
  v_mfma_f32_32x32x16_bf16 v[112:127], v[144:147], a[0:3], v[112:127]
  ds_read_b128 v[140:143], v4 offset:60416
  v_mfma_f32_32x32x16_bf16 v[96:111], v[148:151], a[4:7], v[96:111]
  s_add_u32 s44, s10, s53
  buffer_load_dwordx4 v[40:43], v4, s[68:71], s44 offen offset:0 sc1
  ds_read_b128 v[144:147], v4 offset:61440
  s_waitcnt lgkmcnt(5)
  v_mfma_f32_32x32x16_bf16 v[112:127], v[152:155], a[4:7], v[112:127]
  ds_read_b128 v[148:151], v4 offset:62464
  v_mfma_f32_32x32x16_bf16 v[96:111], v[156:159], a[8:11], v[96:111]
  s_add_u32 s45, s11, s53
  buffer_load_dwordx4 v[44:47], v4, s[68:71], s45 offen offset:0 sc1
  ds_read_b128 v[152:155], v4 offset:63488
  s_waitcnt lgkmcnt(5)
  v_mfma_f32_32x32x16_bf16 v[112:127], v[128:131], a[8:11], v[112:127]
  ds_read_b128 v[156:159], v4 offset:64512
  v_mfma_f32_32x32x16_bf16 v[96:111], v[132:135], a[12:15], v[96:111]
  ds_read_b128 v[128:131], v5 offset:0
  s_waitcnt lgkmcnt(5)
  v_mfma_f32_32x32x16_bf16 v[112:127], v[136:139], a[12:15], v[112:127]
  buffer_load_dwordx4 v[48:51], v4, s[68:71], s44 offen offset:1024 sc1
  ds_read_b128 v[132:135], v5 offset:1024
  v_mfma_f32_32x32x16_bf16 v[96:111], v[140:143], v[180:183], v[96:111]
  ds_read_b128 v[136:139], v5 offset:2048
  s_waitcnt lgkmcnt(5)
  v_mfma_f32_32x32x16_bf16 v[112:127], v[144:147], v[180:183], v[112:127]
  buffer_load_dwordx4 v[52:55], v4, s[68:71], s45 offen offset:1024 sc1
  ds_read_b128 v[140:143], v5 offset:3072
  v_mfma_f32_32x32x16_bf16 v[96:111], v[148:151], a[16:19], v[96:111]
  ds_read_b128 v[144:147], v5 offset:4096
  s_waitcnt lgkmcnt(5)
  v_mfma_f32_32x32x16_bf16 v[112:127], v[152:155], a[16:19], v[112:127]
  ds_read_b128 v[148:151], v5 offset:5120
  v_mfma_f32_32x32x16_bf16 v[96:111], v[156:159], a[20:23], v[96:111]
  buffer_load_dwordx4 v[56:59], v4, s[68:71], s44 offen offset:2048 sc1
  ds_read_b128 v[152:155], v5 offset:6144
  s_waitcnt lgkmcnt(5)
  v_mfma_f32_32x32x16_bf16 v[112:127], v[128:131], a[20:23], v[112:127]
  ds_read_b128 v[156:159], v5 offset:7168
  v_mfma_f32_32x32x16_bf16 v[96:111], v[132:135], a[24:27], v[96:111]
  buffer_load_dwordx4 v[60:63], v4, s[68:71], s45 offen offset:2048 sc1
  ds_read_b128 v[128:131], v5 offset:8192
  s_waitcnt lgkmcnt(5)
  v_mfma_f32_32x32x16_bf16 v[112:127], v[136:139], a[24:27], v[112:127]
  ds_read_b128 v[132:135], v5 offset:9216
  v_mfma_f32_32x32x16_bf16 v[96:111], v[140:143], a[28:31], v[96:111]
  ds_read_b128 v[136:139], v5 offset:10240
  s_waitcnt lgkmcnt(5)
  v_mfma_f32_32x32x16_bf16 v[112:127], v[144:147], a[28:31], v[112:127]
  s_add_u32 s44, s10, s54
  buffer_load_dwordx4 v[192:195], v4, s[68:71], s44 offen offset:0 sc1
  ds_read_b128 v[140:143], v5 offset:11264
  v_mfma_f32_32x32x16_bf16 v[96:111], v[148:151], a[32:35], v[96:111]
  ds_read_b128 v[144:147], v5 offset:12288
  s_waitcnt lgkmcnt(5)
  v_mfma_f32_32x32x16_bf16 v[112:127], v[152:155], a[32:35], v[112:127]
  s_add_u32 s45, s11, s54
  buffer_load_dwordx4 v[196:199], v4, s[68:71], s45 offen offset:0 sc1
  ds_read_b128 v[148:151], v5 offset:13312
  v_mfma_f32_32x32x16_bf16 v[96:111], v[156:159], a[36:39], v[96:111]
  ds_read_b128 v[152:155], v5 offset:14336
  s_waitcnt lgkmcnt(5)
  v_mfma_f32_32x32x16_bf16 v[112:127], v[128:131], a[36:39], v[112:127]
  ds_read_b128 v[156:159], v5 offset:15360
  v_mfma_f32_32x32x16_bf16 v[96:111], v[132:135], v[184:187], v[96:111]
  buffer_load_dwordx4 v[200:203], v4, s[68:71], s44 offen offset:1024 sc1
  ds_read_b128 v[128:131], v5 offset:16384
  s_waitcnt lgkmcnt(5)
  v_mfma_f32_32x32x16_bf16 v[112:127], v[136:139], v[184:187], v[112:127]
  ds_read_b128 v[132:135], v5 offset:17408
  v_mfma_f32_32x32x16_bf16 v[96:111], v[140:143], a[40:43], v[96:111]
  buffer_load_dwordx4 v[204:207], v4, s[68:71], s45 offen offset:1024 sc1
  ds_read_b128 v[136:139], v5 offset:18432
  s_waitcnt lgkmcnt(5)
  v_mfma_f32_32x32x16_bf16 v[112:127], v[144:147], a[40:43], v[112:127]
  ds_read_b128 v[140:143], v5 offset:19456
  v_mfma_f32_32x32x16_bf16 v[96:111], v[148:151], a[44:47], v[96:111]
  ds_read_b128 v[144:147], v5 offset:20480
  s_waitcnt lgkmcnt(5)
  v_mfma_f32_32x32x16_bf16 v[112:127], v[152:155], a[44:47], v[112:127]
  buffer_load_dwordx4 v[208:211], v4, s[68:71], s44 offen offset:2048 sc1
  ds_read_b128 v[148:151], v5 offset:21504
  v_mfma_f32_32x32x16_bf16 v[96:111], v[156:159], a[48:51], v[96:111]
  ds_read_b128 v[152:155], v5 offset:22528
  s_waitcnt lgkmcnt(5)
  v_mfma_f32_32x32x16_bf16 v[112:127], v[128:131], a[48:51], v[112:127]
  buffer_load_dwordx4 v[212:215], v4, s[68:71], s45 offen offset:2048 sc1
  ds_read_b128 v[156:159], v5 offset:23552
  v_mfma_f32_32x32x16_bf16 v[96:111], v[132:135], a[52:55], v[96:111]
  ds_read_b128 v[128:131], v5 offset:24576
  s_waitcnt lgkmcnt(5)
  v_mfma_f32_32x32x16_bf16 v[112:127], v[136:139], a[52:55], v[112:127]
  v_lshlrev_b32 v135, 2, v1
  v_add_u32 v135, 65536, v135
  ds_read2st64_b32 v[132:133], v135 offset0:100 offset1:101
  ds_read2st64_b32 v[134:135], v135 offset0:102 offset1:103
  v_mfma_f32_32x32x16_bf16 v[96:111], v[140:143], a[56:59], v[96:111]
  s_add_u32 s44, s10, s55
  buffer_load_dwordx4 v[176:179], v4, s[68:71], s44 offen offset:0 sc1
  v_lshlrev_b32 v139, 2, v1
  v_add_u32 v139, 65536, v139
  ds_read2st64_b32 v[136:137], v139 offset0:104 offset1:105
  ds_read2st64_b32 v[138:139], v139 offset0:106 offset1:107
  s_waitcnt lgkmcnt(7)
  v_mfma_f32_32x32x16_bf16 v[112:127], v[144:147], a[56:59], v[112:127]
  v_mfma_f32_32x32x16_bf16 v[96:111], v[148:151], a[60:63], v[96:111]
  s_add_u32 s45, s11, s55
  buffer_load_dwordx4 v[8:11], v4, s[68:71], s45 offen offset:0 sc1
  s_waitcnt lgkmcnt(5)
  v_mfma_f32_32x32x16_bf16 v[112:127], v[152:155], a[60:63], v[112:127]
  s_waitcnt vmcnt(19)
  v_max_u32 v3, v16, v18
  v_max3_u32 v3, v20, v22, v3
  v_mfma_f32_32x32x16_bf16 v[96:111], v[156:159], v[188:191], v[96:111]
  v_cmp_eq_u32 vcc, -1, v3
  s_waitcnt lgkmcnt(2)
  v_mfma_f32_32x32x16_bf16 v[112:127], v[128:131], v[188:191], v[112:127]
  buffer_load_dwordx4 v[12:15], v4, s[68:71], s44 offen offset:1024 sc1
  s_nop 1
  s_cbranch_vccnz mm_kernel_st17
mm_kernel_st17_b:
  s_waitcnt vmcnt(18)
  v_max_u32 v3, v24, v26
  v_mfma_f32_32x32x16_bf16 v[96:111], v[132:135], v[168:171], v[96:111]
  v_max3_u32 v3, v28, v30, v3
  v_cmp_eq_u32 vcc, -1, v3
  s_waitcnt lgkmcnt(0)
  v_mfma_f32_32x32x16_bf16 v[112:127], v[136:139], v[168:171], v[112:127]
  s_cmp_eq_u32 s70, 0
  s_cbranch_scc1 mm_kernel_norole
  buffer_load_dwordx4 a[0:3], v4, s[68:71], s45 offen offset:1024 sc1
  s_cbranch_vccnz mm_kernel_st18
mm_kernel_st18_b:
  s_waitcnt vmcnt(16)
  v_max_u32 v3, v32, v34
  v_mfma_f32_32x32x16_bf16 v[64:79], a[64:67], v[16:19], v[64:79]
  s_nop 0
  v_mul_f32 v96, v96, v104
  v_mul_f32 v97, v97, v105
  v_mul_f32 v96, v172, v96
  v_mul_f32 v97, v172, v97
  v_cvt_pk_bf16_f32 v164, v96, v97
  v_mul_f32 v98, v98, v106
  v_max3_u32 v3, v36, v38, v3
  v_cmp_eq_u32 vcc, -1, v3
  v_mfma_f32_32x32x16_bf16 v[80:95], a[64:67], v[20:23], 0
  v_mul_f32 v99, v99, v107
  v_mul_f32 v98, v172, v98
  v_mul_f32 v99, v172, v99
  v_cvt_pk_bf16_f32 v165, v98, v99
  v_mul_f32 v100, v100, v108
  v_mul_f32 v101, v101, v109
  s_cbranch_vccnz mm_kernel_st19
mm_kernel_st19_b:
  s_waitcnt vmcnt(14)
  v_max_u32 v3, v40, v42
  v_mfma_f32_32x32x16_bf16 v[64:79], a[68:71], v[24:27], v[64:79]
  buffer_load_dwordx4 a[4:7], v4, s[68:71], s44 offen offset:2048 sc1
  v_mul_f32 v100, v172, v100
  v_mul_f32 v101, v172, v101
  v_cvt_pk_bf16_f32 v166, v100, v101
  v_mul_f32 v102, v102, v110
  v_mul_f32 v103, v103, v111
  v_mul_f32 v102, v172, v102
  v_max3_u32 v3, v44, v46, v3
  v_cmp_eq_u32 vcc, -1, v3
  v_mfma_f32_32x32x16_bf16 v[80:95], a[68:71], v[28:31], v[80:95]
  v_mul_f32 v103, v172, v103
  v_cvt_pk_bf16_f32 v167, v102, v103
  s_add_u32 s14, s6, 5120
  buffer_store_dwordx4 v[164:167], v4, s[40:43], s14 offen sc1
  v_mul_f32 v112, v112, v120
  s_cbranch_vccnz mm_kernel_st20
mm_kernel_st20_b:
  v_mfma_f32_32x32x16_bf16 v[64:79], a[72:75], v[32:35], v[64:79]
  buffer_load_dwordx4 a[8:11], v4, s[68:71], s45 offen offset:2048 sc1
  v_mul_f32 v113, v113, v121
  v_mul_f32 v112, v172, v112
  v_mul_f32 v113, v172, v113
  v_cvt_pk_bf16_f32 v160, v112, v113
  v_mul_f32 v114, v114, v122
  v_mul_f32 v115, v115, v123
  v_mfma_f32_32x32x16_bf16 v[80:95], a[72:75], v[36:39], v[80:95]
  v_mul_f32 v114, v172, v114
  v_mul_f32 v115, v172, v115
  v_cvt_pk_bf16_f32 v161, v114, v115
  v_mul_f32 v116, v116, v124
  v_mul_f32 v117, v117, v125
  v_mul_f32 v116, v172, v116
  v_mfma_f32_32x32x16_bf16 v[64:79], a[92:95], v[40:43], v[64:79]
  s_add_u32 s44, s10, s52
  s_add_u32 s44, s44, 3072
  buffer_load_dwordx4 a[12:15], v4, s[68:71], s44 offen offset:0 sc1
  v_mul_f32 v117, v172, v117
  v_cvt_pk_bf16_f32 v162, v116, v117
  v_mul_f32 v118, v118, v126
  v_mul_f32 v119, v119, v127
  v_mul_f32 v118, v172, v118
  v_mul_f32 v119, v172, v119
  v_mfma_f32_32x32x16_bf16 v[80:95], a[92:95], v[44:47], v[80:95]
  v_cvt_pk_bf16_f32 v163, v118, v119
  s_add_u32 s14, s6, 6144
  buffer_store_dwordx4 v[160:163], v4, s[40:43], s14 offen sc1
  v_mfma_f32_32x32x16_bf16 v[96:111], a[176:179], v[16:19], 0
  s_add_u32 s45, s11, s52
  s_add_u32 s45, s45, 3072
  buffer_load_dwordx4 v[180:183], v4, s[68:71], s45 offen offset:0 sc1
  v_mfma_f32_32x32x16_bf16 v[112:127], a[176:179], v[20:23], 0
  v_mfma_f32_32x32x16_bf16 v[96:111], a[180:183], v[24:27], v[96:111]
  buffer_load_dwordx4 a[16:19], v4, s[68:71], s44 offen offset:1024 sc1
  v_mfma_f32_32x32x16_bf16 v[112:127], a[180:183], v[28:31], v[112:127]
  s_waitcnt vmcnt(19)
  v_max_u32 v3, v48, v50
  v_max3_u32 v3, v52, v54, v3
  v_mfma_f32_32x32x16_bf16 v[96:111], a[184:187], v[32:35], v[96:111]
  buffer_load_dwordx4 a[20:23], v4, s[68:71], s45 offen offset:1024 sc1
  v_cmp_eq_u32 vcc, -1, v3
  v_mfma_f32_32x32x16_bf16 v[112:127], a[184:187], v[36:39], v[112:127]
  s_nop 3
  s_cbranch_vccnz mm_kernel_st21
mm_kernel_st21_b:
  v_mfma_f32_32x32x16_bf16 v[96:111], a[204:207], v[40:43], v[96:111]
  s_add_u32 s44, s10, s53
  s_add_u32 s44, s44, 3072
  buffer_load_dwordx4 a[24:27], v4, s[68:71], s44 offen offset:0 sc1
  v_mfma_f32_32x32x16_bf16 v[112:127], a[204:207], v[44:47], v[112:127]
  s_waitcnt vmcnt(19)
  v_max_u32 v3, v56, v58
  v_max3_u32 v3, v60, v62, v3
  v_mfma_f32_32x32x16_bf16 v[64:79], a[96:99], v[48:51], v[64:79]
  s_add_u32 s45, s11, s53
  s_add_u32 s45, s45, 3072
  buffer_load_dwordx4 a[28:31], v4, s[68:71], s45 offen offset:0 sc1
  v_cmp_eq_u32 vcc, -1, v3
  v_mfma_f32_32x32x16_bf16 v[80:95], a[96:99], v[52:55], v[80:95]
  s_nop 3
  s_cbranch_vccnz mm_kernel_st22
mm_kernel_st22_b:
  v_mfma_f32_32x32x16_bf16 v[96:111], a[208:211], v[48:51], v[96:111]
  buffer_load_dwordx4 a[32:35], v4, s[68:71], s44 offen offset:1024 sc1
  v_mfma_f32_32x32x16_bf16 v[112:127], a[208:211], v[52:55], v[112:127]
  s_waitcnt vmcnt(19)
  v_max_u32 v3, v192, v194
  v_max3_u32 v3, v196, v198, v3
  v_mfma_f32_32x32x16_bf16 v[64:79], a[100:103], v[56:59], v[64:79]
  buffer_load_dwordx4 a[36:39], v4, s[68:71], s45 offen offset:1024 sc1
  v_cmp_eq_u32 vcc, -1, v3
  v_mfma_f32_32x32x16_bf16 v[80:95], a[100:103], v[60:63], v[80:95]
  s_nop 3
  s_cbranch_vccnz mm_kernel_st23
mm_kernel_st23_b:
  v_mfma_f32_32x32x16_bf16 v[96:111], a[212:215], v[56:59], v[96:111]
  s_add_u32 s44, s10, s54
  s_add_u32 s44, s44, 3072
  buffer_load_dwordx4 v[184:187], v4, s[68:71], s44 offen offset:0 sc1
  v_mfma_f32_32x32x16_bf16 v[112:127], a[212:215], v[60:63], v[112:127]
  s_waitcnt vmcnt(19)
  v_max_u32 v3, v200, v202
  v_max3_u32 v3, v204, v206, v3
  v_mfma_f32_32x32x16_bf16 v[64:79], a[120:123], v[192:195], v[64:79]
  s_add_u32 s45, s11, s54
  s_add_u32 s45, s45, 3072
  buffer_load_dwordx4 a[40:43], v4, s[68:71], s45 offen offset:0 sc1
  v_cmp_eq_u32 vcc, -1, v3
  v_mfma_f32_32x32x16_bf16 v[80:95], a[120:123], v[196:199], v[80:95]
  s_nop 3
  s_cbranch_vccnz mm_kernel_st24
mm_kernel_st24_b:
  v_mfma_f32_32x32x16_bf16 v[96:111], a[232:235], v[192:195], v[96:111]
  buffer_load_dwordx4 a[44:47], v4, s[68:71], s44 offen offset:1024 sc1
  v_mfma_f32_32x32x16_bf16 v[112:127], a[232:235], v[196:199], v[112:127]
  s_waitcnt vmcnt(19)
  v_max_u32 v3, v208, v210
  v_max3_u32 v3, v212, v214, v3
  v_mfma_f32_32x32x16_bf16 v[64:79], a[124:127], v[200:203], v[64:79]
  buffer_load_dwordx4 a[48:51], v4, s[68:71], s45 offen offset:1024 sc1
  v_cmp_eq_u32 vcc, -1, v3
  v_mfma_f32_32x32x16_bf16 v[80:95], a[124:127], v[204:207], v[80:95]
  s_nop 3
  s_cbranch_vccnz mm_kernel_st25
mm_kernel_st25_b:
  v_mfma_f32_32x32x16_bf16 v[96:111], a[236:239], v[200:203], v[96:111]
  s_add_u32 s44, s10, s55
  s_add_u32 s44, s44, 3072
  buffer_load_dwordx4 a[52:55], v4, s[68:71], s44 offen offset:0 sc1
  v_mfma_f32_32x32x16_bf16 v[112:127], a[236:239], v[204:207], v[112:127]
  s_waitcnt vmcnt(19)
  v_max_u32 v3, v176, v178
  v_max3_u32 v3, v8, v10, v3
  v_mfma_f32_32x32x16_bf16 v[64:79], a[128:131], v[208:211], v[64:79]
  s_add_u32 s45, s11, s55
  s_add_u32 s45, s45, 3072
  buffer_load_dwordx4 a[56:59], v4, s[68:71], s45 offen offset:0 sc1
  v_cmp_eq_u32 vcc, -1, v3
  v_mfma_f32_32x32x16_bf16 v[80:95], a[128:131], v[212:215], v[80:95]
  s_nop 3
  s_cbranch_vccnz mm_kernel_st26
mm_kernel_st26_b:
  v_mfma_f32_32x32x16_bf16 v[96:111], a[240:243], v[208:211], v[96:111]
  buffer_load_dwordx4 a[60:63], v4, s[68:71], s44 offen offset:1024 sc1
  s_waitcnt vmcnt(19)
  v_max_u32 v3, v12, v14
  v_accvgpr_read_b32 v2, a0
  v_mfma_f32_32x32x16_bf16 v[112:127], a[240:243], v[212:215], v[112:127]
  v_accvgpr_read_b32 v7, a2
  v_max3_u32 v3, v2, v7, v3
  v_cmp_eq_u32 vcc, -1, v3
  v_mfma_f32_32x32x16_bf16 v[64:79], a[148:151], v[176:179], v[64:79]
  buffer_load_dwordx4 v[188:191], v4, s[68:71], s45 offen offset:1024 sc1
  v_mfma_f32_32x32x16_bf16 v[80:95], a[148:151], v[8:11], v[80:95]
  s_nop 1
  s_cbranch_vccnz mm_kernel_st27
mm_kernel_st27_b:
  v_mfma_f32_32x32x16_bf16 v[96:111], v[220:223], v[176:179], v[96:111]
  s_add_u32 m0, s59, 0
  s_add_u32 s48, s50, 0
  buffer_load_dwordx4 v4, s[40:43], s48 offen offset:0 lds
  s_waitcnt vmcnt(18)
  v_accvgpr_read_b32 v2, a4
  v_accvgpr_read_b32 v7, a6
  v_mfma_f32_32x32x16_bf16 v[112:127], v[220:223], v[8:11], v[112:127]
  v_max_u32 v3, v2, v7
  v_accvgpr_read_b32 v2, a8
  v_accvgpr_read_b32 v7, a10
  v_mfma_f32_32x32x16_bf16 v[64:79], a[152:155], v[12:15], v[64:79]
  buffer_load_dwordx4 v4, s[40:43], s48 offen offset:1024 lds
  v_max3_u32 v3, v2, v7, v3
  v_cmp_eq_u32 vcc, -1, v3
  v_mfma_f32_32x32x16_bf16 v[80:95], a[152:155], a[0:3], v[80:95]
  s_nop 3
  s_cbranch_vccnz mm_kernel_st28
mm_kernel_st28_b:
  v_mfma_f32_32x32x16_bf16 v[96:111], v[224:227], v[12:15], v[96:111]
  buffer_load_dwordx4 v4, s[40:43], s48 offen offset:2048 lds
  s_waitcnt vmcnt(17)
  v_accvgpr_read_b32 v2, a12
  v_accvgpr_read_b32 v7, a14
  v_mfma_f32_32x32x16_bf16 v[112:127], v[224:227], a[0:3], v[112:127]
  v_max_u32 v3, v2, v7
  v_max3_u32 v3, v180, v182, v3
  v_cmp_eq_u32 vcc, -1, v3
  v_mfma_f32_32x32x16_bf16 v[64:79], a[156:159], a[4:7], v[64:79]
  buffer_load_dwordx4 v4, s[40:43], s48 offen offset:3072 lds
  v_mfma_f32_32x32x16_bf16 v[80:95], a[156:159], a[8:11], v[80:95]
  s_nop 1
  s_cbranch_vccnz mm_kernel_st29
mm_kernel_st29_b:
  v_mfma_f32_32x32x16_bf16 v[96:111], v[228:231], a[4:7], v[96:111]
  s_add_u32 m0, s59, 4096
  s_add_u32 s48, s50, 4096
  buffer_load_dwordx4 v4, s[40:43], s48 offen offset:0 lds
  s_waitcnt vmcnt(17)
  v_accvgpr_read_b32 v2, a16
  v_accvgpr_read_b32 v7, a18
  v_mfma_f32_32x32x16_bf16 v[112:127], v[228:231], a[8:11], v[112:127]
  v_max_u32 v3, v2, v7
  v_accvgpr_read_b32 v2, a20
  v_accvgpr_read_b32 v7, a22
  v_mfma_f32_32x32x16_bf16 v[64:79], a[76:79], a[12:15], v[64:79]
  buffer_load_dwordx4 v4, s[40:43], s48 offen offset:1024 lds
  v_max3_u32 v3, v2, v7, v3
  v_cmp_eq_u32 vcc, -1, v3
  v_mfma_f32_32x32x16_bf16 v[80:95], a[76:79], v[180:183], v[80:95]
  s_nop 3
  s_cbranch_vccnz mm_kernel_st30
mm_kernel_st30_b:
  v_mfma_f32_32x32x16_bf16 v[96:111], a[188:191], a[12:15], v[96:111]
  s_add_u32 s45, s11, s52
  s_add_u32 s45, s45, 5120
  buffer_load_dwordx4 v[128:131], v4, s[68:71], s45 offen offset:0 sc1
  s_waitcnt vmcnt(17)
  v_accvgpr_read_b32 v2, a24
  v_accvgpr_read_b32 v7, a26
  v_mfma_f32_32x32x16_bf16 v[112:127], a[188:191], v[180:183], v[112:127]
  v_max_u32 v3, v2, v7
  v_accvgpr_read_b32 v2, a28
  v_accvgpr_read_b32 v7, a30
  v_mfma_f32_32x32x16_bf16 v[64:79], a[80:83], a[16:19], v[64:79]
  buffer_load_dwordx4 v[132:135], v4, s[68:71], s45 offen offset:1024 sc1
  v_max3_u32 v3, v2, v7, v3
  v_cmp_eq_u32 vcc, -1, v3
  v_mfma_f32_32x32x16_bf16 v[80:95], a[80:83], a[20:23], v[80:95]
  s_nop 3
  s_cbranch_vccnz mm_kernel_st31
mm_kernel_st31_b:
  v_mfma_f32_32x32x16_bf16 v[96:111], a[192:195], a[16:19], v[96:111]
  s_add_u32 s45, s11, s53
  s_add_u32 s45, s45, 5120
  buffer_load_dwordx4 v[136:139], v4, s[68:71], s45 offen offset:0 sc1
  s_waitcnt vmcnt(17)
  v_accvgpr_read_b32 v2, a32
  v_accvgpr_read_b32 v7, a34
  v_mfma_f32_32x32x16_bf16 v[112:127], a[192:195], a[20:23], v[112:127]
  v_max_u32 v3, v2, v7
  v_accvgpr_read_b32 v2, a36
  v_accvgpr_read_b32 v7, a38
  v_mfma_f32_32x32x16_bf16 v[64:79], a[104:107], a[24:27], v[64:79]
  buffer_load_dwordx4 v[140:143], v4, s[68:71], s45 offen offset:1024 sc1
  v_max3_u32 v3, v2, v7, v3
  v_cmp_eq_u32 vcc, -1, v3
  v_mfma_f32_32x32x16_bf16 v[80:95], a[104:107], a[28:31], v[80:95]
  s_nop 3
  s_cbranch_vccnz mm_kernel_st32
mm_kernel_st32_b:
  v_mfma_f32_32x32x16_bf16 v[96:111], a[216:219], a[24:27], v[96:111]
  s_add_u32 s45, s11, s54
  s_add_u32 s45, s45, 5120
  buffer_load_dwordx4 v[144:147], v4, s[68:71], s45 offen offset:0 sc1
  s_waitcnt vmcnt(17)
  v_max_u32 v3, v184, v186
  v_accvgpr_read_b32 v2, a40
  v_mfma_f32_32x32x16_bf16 v[112:127], a[216:219], a[28:31], v[112:127]
  v_accvgpr_read_b32 v7, a42
  v_max3_u32 v3, v2, v7, v3
  v_cmp_eq_u32 vcc, -1, v3
  v_mfma_f32_32x32x16_bf16 v[64:79], a[108:111], a[32:35], v[64:79]
  buffer_load_dwordx4 v[148:151], v4, s[68:71], s45 offen offset:1024 sc1
  v_mfma_f32_32x32x16_bf16 v[80:95], a[108:111], a[36:39], v[80:95]
  s_nop 1
  s_cbranch_vccnz mm_kernel_st33
mm_kernel_st33_b:
  v_mfma_f32_32x32x16_bf16 v[96:111], a[220:223], a[32:35], v[96:111]
  s_add_u32 s45, s11, s55
  s_add_u32 s45, s45, 5120
  buffer_load_dwordx4 v[152:155], v4, s[68:71], s45 offen offset:0 sc1
  s_waitcnt vmcnt(17)
  v_accvgpr_read_b32 v2, a44
  v_accvgpr_read_b32 v7, a46
  v_mfma_f32_32x32x16_bf16 v[112:127], a[220:223], a[36:39], v[112:127]
  v_max_u32 v3, v2, v7
  v_accvgpr_read_b32 v2, a48
  v_accvgpr_read_b32 v7, a50
  v_mfma_f32_32x32x16_bf16 v[64:79], a[132:135], v[184:187], v[64:79]
  buffer_load_dwordx4 v[156:159], v4, s[68:71], s45 offen offset:1024 sc1
  v_max3_u32 v3, v2, v7, v3
  v_cmp_eq_u32 vcc, -1, v3
  v_mfma_f32_32x32x16_bf16 v[80:95], a[132:135], a[40:43], v[80:95]
  s_nop 3
  s_cbranch_vccnz mm_kernel_st34
mm_kernel_st34_b:
  v_mfma_f32_32x32x16_bf16 v[96:111], a[244:247], v[184:187], v[96:111]
  s_add_u32 s44, s10, s52
  s_add_u32 s44, s44, 5120
  buffer_load_dwordx4 v[16:19], v4, s[68:71], s44 offen offset:0 sc1
  s_waitcnt vmcnt(17)
  v_accvgpr_read_b32 v2, a52
  v_accvgpr_read_b32 v7, a54
  v_mfma_f32_32x32x16_bf16 v[112:127], a[244:247], a[40:43], v[112:127]
  v_max_u32 v3, v2, v7
  v_accvgpr_read_b32 v2, a56
  v_accvgpr_read_b32 v7, a58
  v_mfma_f32_32x32x16_bf16 v[64:79], a[136:139], a[44:47], v[64:79]
  buffer_load_dwordx4 v[20:23], v4, s[68:71], s44 offen offset:1024 sc1
  v_max3_u32 v3, v2, v7, v3
  v_cmp_eq_u32 vcc, -1, v3
  v_mfma_f32_32x32x16_bf16 v[80:95], a[136:139], a[48:51], v[80:95]
  s_nop 3
  s_cbranch_vccnz mm_kernel_st35
mm_kernel_st35_b:
  v_mfma_f32_32x32x16_bf16 v[96:111], a[248:251], a[44:47], v[96:111]
  s_add_u32 s44, s10, s53
  s_add_u32 s44, s44, 5120
  buffer_load_dwordx4 v[24:27], v4, s[68:71], s44 offen offset:0 sc1
  s_waitcnt vmcnt(17)
  v_accvgpr_read_b32 v2, a60
  v_accvgpr_read_b32 v7, a62
  v_mfma_f32_32x32x16_bf16 v[112:127], a[248:251], a[48:51], v[112:127]
  v_max_u32 v3, v2, v7
  v_max3_u32 v3, v188, v190, v3
  v_cmp_eq_u32 vcc, -1, v3
  v_mfma_f32_32x32x16_bf16 v[64:79], a[160:163], a[52:55], v[64:79]
  buffer_load_dwordx4 v[28:31], v4, s[68:71], s44 offen offset:1024 sc1
  v_mfma_f32_32x32x16_bf16 v[80:95], a[160:163], a[56:59], v[80:95]
  s_nop 1
  s_cbranch_vccnz mm_kernel_st36
mm_kernel_st36_b:
  v_mfma_f32_32x32x16_bf16 v[96:111], v[232:235], a[52:55], v[96:111]
  s_add_u32 s44, s10, s54
  s_add_u32 s44, s44, 5120
  buffer_load_dwordx4 v[32:35], v4, s[68:71], s44 offen offset:0 sc1
  v_mfma_f32_32x32x16_bf16 v[112:127], v[232:235], a[56:59], v[112:127]
  s_waitcnt vmcnt(11)
  v_max_u32 v3, v128, v130
  v_max3_u32 v3, v132, v134, v3
  v_mfma_f32_32x32x16_bf16 v[64:79], a[164:167], a[60:63], v[64:79]
  buffer_load_dwordx4 v[36:39], v4, s[68:71], s44 offen offset:1024 sc1
  v_cmp_eq_u32 vcc, -1, v3
  v_mfma_f32_32x32x16_bf16 v[80:95], a[164:167], v[188:191], v[80:95]
  s_nop 3
  s_cbranch_vccnz mm_kernel_st37
mm_kernel_st37_b:
  s_waitcnt vmcnt(10)
  v_max_u32 v3, v136, v138
  v_mfma_f32_32x32x16_bf16 v[96:111], v[236:239], a[60:63], v[96:111]
  s_add_u32 s44, s10, s55
  s_add_u32 s44, s44, 5120
  buffer_load_dwordx4 v[40:43], v4, s[68:71], s44 offen offset:0 sc1
  v_max3_u32 v3, v140, v142, v3
  v_cmp_eq_u32 vcc, -1, v3
  v_mfma_f32_32x32x16_bf16 v[112:127], v[236:239], v[188:191], v[112:127]
  s_nop 3
  s_cbranch_vccnz mm_kernel_st38
mm_kernel_st38_b:
  s_waitcnt vmcnt(9)
  v_max_u32 v3, v144, v146
  v_mfma_f32_32x32x16_bf16 v[112:127], a[196:199], v[128:131], v[112:127]
  buffer_load_dwordx4 v[44:47], v4, s[68:71], s44 offen offset:1024 sc1
  v_max3_u32 v3, v148, v150, v3
  v_cmp_eq_u32 vcc, -1, v3
  v_mfma_f32_32x32x16_bf16 v[112:127], a[200:203], v[132:135], v[112:127]
  s_nop 3
  s_cbranch_vccnz mm_kernel_st39
mm_kernel_st39_b:
  s_waitcnt vmcnt(8)
  v_max_u32 v3, v152, v154
  v_mfma_f32_32x32x16_bf16 v[112:127], a[224:227], v[136:139], v[112:127]
  buffer_load_dwordx4 v4, s[40:43], s48 offen offset:2048 lds
  v_max3_u32 v3, v156, v158, v3
  v_cmp_eq_u32 vcc, -1, v3
  v_mfma_f32_32x32x16_bf16 v[112:127], a[228:231], v[140:143], v[112:127]
  s_nop 3
  s_cbranch_vccnz mm_kernel_st40
mm_kernel_st40_b:
  v_mfma_f32_32x32x16_bf16 v[112:127], a[252:255], v[144:147], v[112:127]
  s_add_u32 m0, s59, 7168
  s_add_u32 s48, s51, 0
  buffer_load_dwordx4 v4, s[40:43], s48 offen offset:0 lds
  v_mfma_f32_32x32x16_bf16 v[112:127], v[216:219], v[148:151], v[112:127]
  v_mfma_f32_32x32x16_bf16 v[112:127], v[240:243], v[152:155], v[112:127]
  s_xor_b32 s9, s3, 1
  s_mul_i32 s9, s9, 12288
  s_add_u32 s9, s9, 98304
  v_add_u32 v5, s9, v4
  s_xor_b32 s9, s3, 2
  s_mul_i32 s9, s9, 12288
  s_add_u32 s9, s9, 102400
  v_add_u32 v6, s9, v4
  s_xor_b32 s9, s3, 3
  s_mul_i32 s9, s9, 12288
  s_add_u32 s9, s9, 106496
  v_add_u32 v7, s9, v4
  s_mul_i32 s9, s3, 12288
  s_add_u32 s9, s9, 98304
  v_add_u32 v2, s9, v4
  buffer_load_dwordx4 v4, s[40:43], s48 offen offset:1024 lds
  v_mfma_f32_32x32x16_bf16 v[112:127], v[244:247], v[156:159], v[112:127]
  v_mfma_f32_32x32x16_bf16 v[80:95], a[84:87], v[128:131], v[80:95]
  buffer_load_dwordx4 v4, s[40:43], s48 offen offset:2048 lds
  v_mfma_f32_32x32x16_bf16 v[80:95], a[88:91], v[132:135], v[80:95]
  s_nop 8
  ds_write_b128 v7, v[112:115] offset:0
  v_mfma_f32_32x32x16_bf16 v[80:95], a[112:115], v[136:139], v[80:95]
  buffer_load_dwordx4 v4, s[40:43], s48 offen offset:3072 lds
  v_mfma_f32_32x32x16_bf16 v[80:95], a[116:119], v[140:143], v[80:95]
  ds_write_b128 v7, v[116:119] offset:1024
  s_waitcnt vmcnt(11)
  v_max_u32 v3, v16, v18
  v_max3_u32 v3, v20, v22, v3
  v_mfma_f32_32x32x16_bf16 v[80:95], a[140:143], v[144:147], v[80:95]
  s_add_u32 m0, s59, 11264
  s_add_u32 s48, s51, 4096
  buffer_load_dwordx4 v4, s[40:43], s48 offen offset:0 lds
  v_cmp_eq_u32 vcc, -1, v3
  v_mfma_f32_32x32x16_bf16 v[80:95], a[144:147], v[148:151], v[80:95]
  ds_write_b128 v7, v[120:123] offset:2048
  s_nop 2
  s_cbranch_vccnz mm_kernel_st41
mm_kernel_st41_b:
  s_waitcnt vmcnt(10)
  v_max_u32 v3, v24, v26
  v_mfma_f32_32x32x16_bf16 v[80:95], a[168:171], v[152:155], v[80:95]
  buffer_load_dwordx4 v4, s[40:43], s48 offen offset:1024 lds
  v_max3_u32 v3, v28, v30, v3
  v_cmp_eq_u32 vcc, -1, v3
  v_mfma_f32_32x32x16_bf16 v[80:95], a[172:175], v[156:159], v[80:95]
  ds_write_b128 v7, v[124:127] offset:3072
  s_nop 2
  s_cbranch_vccnz mm_kernel_st42
mm_kernel_st42_b:
  s_waitcnt vmcnt(9)
  v_max_u32 v3, v32, v34
  v_mfma_f32_32x32x16_bf16 v[96:111], a[196:199], v[16:19], v[96:111]
  buffer_load_dwordx4 v4, s[40:43], s48 offen offset:2048 lds
  v_max3_u32 v3, v36, v38, v3
  v_cmp_eq_u32 vcc, -1, v3
  v_mfma_f32_32x32x16_bf16 v[96:111], a[200:203], v[20:23], v[96:111]
  ds_write_b128 v6, v[80:83] offset:0
  s_nop 2
  s_cbranch_vccnz mm_kernel_st43
mm_kernel_st43_b:
  s_waitcnt vmcnt(8)
  v_max_u32 v3, v40, v42
  v_mfma_f32_32x32x16_bf16 v[96:111], a[224:227], v[24:27], v[96:111]
  v_lshrrev_b32 v0, 5, v1
  v_lshlrev_b32 v0, 4, v0
  buffer_load_dwordx4 v[160:163], v0, s[40:43], s60 offen offset:0
  buffer_load_dwordx4 v[164:167], v0, s[40:43], s60 offen offset:32
  buffer_load_dwordx4 v[168:171], v0, s[40:43], s60 offen offset:64
  buffer_load_dwordx4 v[172:175], v0, s[40:43], s60 offen offset:96
  v_max3_u32 v3, v44, v46, v3
  v_cmp_eq_u32 vcc, -1, v3
  v_mfma_f32_32x32x16_bf16 v[96:111], a[228:231], v[28:31], v[96:111]
  ds_write_b128 v6, v[84:87] offset:1024
  s_nop 2
  s_cbranch_vccnz mm_kernel_st44
mm_kernel_st44_b:
  v_mfma_f32_32x32x16_bf16 v[96:111], a[252:255], v[32:35], v[96:111]
  v_mfma_f32_32x32x16_bf16 v[96:111], v[216:219], v[36:39], v[96:111]
  ds_write_b128 v6, v[88:91] offset:2048
  v_mfma_f32_32x32x16_bf16 v[96:111], v[240:243], v[40:43], v[96:111]
  v_mfma_f32_32x32x16_bf16 v[96:111], v[244:247], v[44:47], v[96:111]
  ds_write_b128 v6, v[92:95] offset:3072
  v_mfma_f32_32x32x16_bf16 v[64:79], a[84:87], v[16:19], v[64:79]
  v_mfma_f32_32x32x16_bf16 v[64:79], a[88:91], v[20:23], v[64:79]
  s_nop 8
  ds_write_b128 v5, v[96:99] offset:0
  v_mfma_f32_32x32x16_bf16 v[64:79], a[112:115], v[24:27], v[64:79]
  v_mfma_f32_32x32x16_bf16 v[64:79], a[116:119], v[28:31], v[64:79]
  ds_write_b128 v5, v[100:103] offset:1024
  v_mfma_f32_32x32x16_bf16 v[64:79], a[140:143], v[32:35], v[64:79]
  v_mfma_f32_32x32x16_bf16 v[64:79], a[144:147], v[36:39], v[64:79]
  ds_write_b128 v5, v[104:107] offset:2048
  v_mfma_f32_32x32x16_bf16 v[64:79], a[168:171], v[40:43], v[64:79]
  v_mfma_f32_32x32x16_bf16 v[64:79], a[172:175], v[44:47], v[64:79]
  ds_write_b128 v5, v[108:111] offset:3072
  s_waitcnt lgkmcnt(0)
  s_barrier
  ds_read_b128 v[16:19], v2 offset:0
  ds_read_b128 v[20:23], v2 offset:1024
  ds_read_b128 v[24:27], v2 offset:2048
  ds_read_b128 v[28:31], v2 offset:3072
  ds_read_b128 v[32:35], v2 offset:4096
  ds_read_b128 v[36:39], v2 offset:5120
  ds_read_b128 v[40:43], v2 offset:6144
  ds_read_b128 v[44:47], v2 offset:7168
  ds_read_b128 v[48:51], v2 offset:8192
  ds_read_b128 v[52:55], v2 offset:9216
  ds_read_b128 v[56:59], v2 offset:10240
  ds_read_b128 v[60:63], v2 offset:11264
  s_waitcnt lgkmcnt(8)
  v_pk_add_f32 v[64:65], v[64:65], v[16:17]
  v_pk_add_f32 v[66:67], v[66:67], v[18:19]
  v_pk_add_f32 v[68:69], v[68:69], v[20:21]
  v_pk_add_f32 v[70:71], v[70:71], v[22:23]
  v_pk_add_f32 v[72:73], v[72:73], v[24:25]
  v_pk_add_f32 v[74:75], v[74:75], v[26:27]
  v_pk_add_f32 v[76:77], v[76:77], v[28:29]
  v_pk_add_f32 v[78:79], v[78:79], v[30:31]
  s_waitcnt lgkmcnt(4)
  v_pk_add_f32 v[64:65], v[64:65], v[32:33]
  v_pk_add_f32 v[66:67], v[66:67], v[34:35]
  v_pk_add_f32 v[68:69], v[68:69], v[36:37]
  v_pk_add_f32 v[70:71], v[70:71], v[38:39]
  v_pk_add_f32 v[72:73], v[72:73], v[40:41]
  v_pk_add_f32 v[74:75], v[74:75], v[42:43]
  v_pk_add_f32 v[76:77], v[76:77], v[44:45]
  v_pk_add_f32 v[78:79], v[78:79], v[46:47]
  s_waitcnt lgkmcnt(0)
  v_pk_add_f32 v[64:65], v[64:65], v[48:49]
  v_pk_add_f32 v[66:67], v[66:67], v[50:51]
  v_pk_add_f32 v[68:69], v[68:69], v[52:53]
  v_pk_add_f32 v[70:71], v[70:71], v[54:55]
  v_pk_add_f32 v[72:73], v[72:73], v[56:57]
  v_pk_add_f32 v[74:75], v[74:75], v[58:59]
  v_pk_add_f32 v[76:77], v[76:77], v[60:61]
  v_pk_add_f32 v[78:79], v[78:79], v[62:63]
  v_cvt_pk_bf16_f32 v8, v64, v65
  v_cvt_pk_bf16_f32 v9, v66, v67
  v_cvt_pk_bf16_f32 v10, v68, v69
  v_cvt_pk_bf16_f32 v11, v70, v71
  v_cvt_pk_bf16_f32 v12, v72, v73
  v_cvt_pk_bf16_f32 v13, v74, v75
  v_cvt_pk_bf16_f32 v14, v76, v77
  v_cvt_pk_bf16_f32 v15, v78, v79
  s_add_u32 s9, s12, 25690112
  buffer_store_dwordx4 v[8:11], v4, s[40:43], s9 offen offset:0 sc1
  buffer_store_dwordx4 v[12:15], v4, s[40:43], s9 offen offset:1024 sc1
  s_add_u32 s56, s56, 27430912
  v_pk_add_f32 v[16:17], v[64:65], v[66:67]
  v_pk_mul_f32 v[18:19], v[64:65], v[64:65]
  v_pk_fma_f32 v[18:19], v[66:67], v[66:67], v[18:19]
  v_pk_add_f32 v[16:17], v[16:17], v[68:69]
  v_pk_fma_f32 v[18:19], v[68:69], v[68:69], v[18:19]
  v_pk_add_f32 v[16:17], v[16:17], v[70:71]
  v_pk_fma_f32 v[18:19], v[70:71], v[70:71], v[18:19]
  v_pk_add_f32 v[16:17], v[16:17], v[72:73]
  v_pk_fma_f32 v[18:19], v[72:73], v[72:73], v[18:19]
  v_pk_add_f32 v[16:17], v[16:17], v[74:75]
  v_pk_fma_f32 v[18:19], v[74:75], v[74:75], v[18:19]
  v_pk_add_f32 v[16:17], v[16:17], v[76:77]
  v_pk_fma_f32 v[18:19], v[76:77], v[76:77], v[18:19]
  v_pk_add_f32 v[16:17], v[16:17], v[78:79]
  v_pk_fma_f32 v[18:19], v[78:79], v[78:79], v[18:19]
  v_add_f32 v16, v16, v17
  v_add_f32 v17, v18, v19
  v_mov_b32 v18, v16
  v_mov_b32 v19, v17
  s_nop 0
  v_permlane32_swap_b32 v16, v18
  v_permlane32_swap_b32 v17, v19
  s_mov_b32 exec_hi, 0
  v_pk_add_f32 v[16:17], v[16:17], v[18:19]
  buffer_store_dwordx2 v[16:17], v4, s[40:43], s56 offen sc1
  s_mov_b32 exec_hi, -1
mm_kernel_p1b:
  v_add_u32 v13, s59, v4
  s_waitcnt vmcnt(3)
  ds_read_b128 a[0:3], v13 offset:0
  ds_read_b128 a[4:7], v13 offset:1024
  ds_read_b128 a[8:11], v13 offset:2048
  ds_read_b128 a[12:15], v13 offset:3072
  ds_read_b128 a[16:19], v13 offset:4096
  ds_read_b128 a[20:23], v13 offset:5120
  ds_read_b128 a[24:27], v13 offset:6144
  ds_read_b128 a[28:31], v13 offset:7168
  ds_read_b128 a[32:35], v13 offset:8192
  ds_read_b128 a[36:39], v13 offset:9216
  ds_read_b128 a[40:43], v13 offset:10240
  ds_read_b128 a[44:47], v13 offset:11264
  ds_read_b128 a[48:51], v13 offset:12288
  ds_read_b128 a[52:55], v13 offset:13312
  s_mul_i32 s10, s66, 28672
  s_xor_b32 s11, s66, 1
  s_mul_i32 s11, s11, 28672
  s_mul_i32 s9, s3, 7168
  s_add_u32 s9, s9, 25690112
  s_add_u32 s10, s10, s9
  s_add_u32 s11, s11, s9
  s_lshl_b32 s56, s66, 12
  s_add_u32 s56, s56, 33984512
  s_lshr_b32 s4, s66, 1
  s_and_b32 s12, s66, 1
  s_lshr_b32 s5, s67, 1
  s_mov_b32 s48, s13
  s_and_b32 s13, s67, 1
  v_and_b32 v2, 31, v1
  v_mov_b32 v44, 0
  v_mov_b32 v45, 0
  v_mov_b32 v46, 0
  v_mov_b32 v47, 0
  s_lshl_b32 s6, s4, 1
  s_add_u32 s6, s6, s12
  s_lshl_b32 s7, s5, 1
  s_add_u32 s62, s7, s13
  s_lshl_b32 s8, s6, 4
  s_add_u32 s8, s8, s62
  s_lshl_b32 s8, s8, 11
  s_add_u32 s60, s8, 34246656
  v_lshlrev_b32 v50, 4, v1
  s_lshl_b32 s9, s6, 12
  s_add_u32 s9, s9, 2359296
  s_and_b32 s6, s62, 7
  s_lshr_b32 s7, s6, 2
  s_lshl_b32 s7, s7, 10
  s_and_b32 s8, s6, 1
  s_lshl_b32 s8, s8, 9
  s_add_u32 s7, s7, s8
  s_and_b32 s8, s6, 2
  s_lshl_b32 s8, s8, 2
  s_add_u32 s7, s7, s8
  s_lshl_b32 s8, s6, 6
  s_add_u32 s8, s8, 2048
  s_cmp_ge_u32 s62, 8
  s_cselect_b32 s7, s8, s7
  s_cselect_b64 vcc, -1, 0
  s_add_u32 s61, s9, s7
  v_bfe_u32 v51, v1, 3, 1
  v_lshlrev_b32 v51, 10, v51
  v_bfe_u32 v52, v1, 2, 1
  v_lshl_add_u32 v51, v52, 9, v51
  v_and_b32 v52, 3, v1
  v_lshl_add_u32 v51, v52, 4, v51
  v_lshlrev_b32 v52, 4, v2
  v_cndmask_b32 v51, v52, v51, vcc
  v_bfe_u32 v53, v1, 2, 2
  v_and_b32 v52, 1, v1
  v_lshl_add_u32 v53, v52, 2, v53
  v_bfe_u32 v52, v1, 1, 1
  v_lshl_add_u32 v53, v52, 4, v53
  v_lshl_add_u32 v53, v53, 3, s59
  v_lshl_add_u32 v52, v2, 3, s59
  s_mov_b32 s13, s48
  s_xor_b32 s9, s3, 1
  s_mul_i32 s9, s9, 12288
  s_add_u32 s9, s9, 49152
  v_add_u32 v5, s9, v4
  s_xor_b32 s9, s3, 2
  s_mul_i32 s9, s9, 12288
  s_add_u32 s9, s9, 53248
  v_add_u32 v6, s9, v4
  s_xor_b32 s9, s3, 3
  s_mul_i32 s9, s9, 12288
  s_add_u32 s9, s9, 57344
  v_add_u32 v7, s9, v4
  s_mul_i32 s9, s3, 12288
  s_add_u32 s9, s9, 49152
  v_add_u32 v12, s9, v4
  s_waitcnt vmcnt(0)
mm_kernel_pr45:
  s_add_u32 s15, s11, 0
  buffer_load_dwordx4 v[180:183], v4, s[40:43], s15 offen offset:0 sc1
  buffer_load_dwordx4 v[188:191], v4, s[40:43], s15 offen offset:1024 sc1
  buffer_load_dwordx4 v[196:199], v4, s[40:43], s15 offen offset:2048 sc1
  buffer_load_dwordx4 v[204:207], v4, s[40:43], s15 offen offset:3072 sc1
  s_add_u32 s15, s11, 4096
  buffer_load_dwordx4 v[212:215], v4, s[40:43], s15 offen offset:0 sc1
  buffer_load_dwordx4 v[132:135], v4, s[40:43], s15 offen offset:1024 sc1
  buffer_load_dwordx4 v[140:143], v4, s[40:43], s15 offen offset:2048 sc1
  s_add_u32 s15, s10, 0
  buffer_load_dwordx4 v[176:179], v4, s[40:43], s15 offen offset:0 sc1
  buffer_load_dwordx4 v[184:187], v4, s[40:43], s15 offen offset:1024 sc1
  buffer_load_dwordx4 v[192:195], v4, s[40:43], s15 offen offset:2048 sc1
  buffer_load_dwordx4 v[200:203], v4, s[40:43], s15 offen offset:3072 sc1
  s_add_u32 s15, s10, 4096
  buffer_load_dwordx4 v[208:211], v4, s[40:43], s15 offen offset:0 sc1
  buffer_load_dwordx4 v[128:131], v4, s[40:43], s15 offen offset:1024 sc1
  buffer_load_dwordx4 v[136:139], v4, s[40:43], s15 offen offset:2048 sc1
  s_add_u32 s15, s56, 0
  buffer_load_dwordx4 v[32:35], v4, s[40:43], s15 offen offset:0 sc1
  buffer_load_dwordx4 v[36:39], v4, s[40:43], s15 offen offset:1024 sc1
  buffer_load_dwordx4 v[40:43], v4, s[40:43], s15 offen offset:2048 sc1
  s_mov_b32 exec_hi, 0
  buffer_load_dwordx4 v[44:47], v4, s[40:43], s15 offen offset:3072 sc1
  s_mov_b32 exec_hi, -1
  s_sub_i32 s13, s13, 1
  s_cmp_lt_i32 s13, 0
  s_waitcnt vmcnt(11)
  v_max_u32 v3, v180, v182
  v_max3_u32 v3, v188, v190, v3
  v_max3_u32 v3, v196, v198, v3
  v_max3_u32 v3, v204, v206, v3
  v_max3_u32 v3, v212, v214, v3
  v_max3_u32 v3, v132, v134, v3
  v_max3_u32 v3, v140, v142, v3
  v_cmp_eq_u32 vcc, -1, v3
  s_cbranch_scc1 mm_kernel_pr45_b
  s_nop 3
  s_cbranch_vccnz mm_kernel_pr45
mm_kernel_pr45_b:
  s_waitcnt lgkmcnt(0)
  v_mfma_f32_32x32x16_bf16 v[112:127], a[28:31], v[180:183], 0
  v_mfma_f32_32x32x16_bf16 v[112:127], a[32:35], v[188:191], v[112:127]
  v_mfma_f32_32x32x16_bf16 v[112:127], a[36:39], v[196:199], v[112:127]
  v_mfma_f32_32x32x16_bf16 v[112:127], a[40:43], v[204:207], v[112:127]
  v_mfma_f32_32x32x16_bf16 v[112:127], a[44:47], v[212:215], v[112:127]
  v_mfma_f32_32x32x16_bf16 v[112:127], a[48:51], v[132:135], v[112:127]
  v_mfma_f32_32x32x16_bf16 v[112:127], a[52:55], v[140:143], v[112:127]
  v_mfma_f32_32x32x16_bf16 v[80:95], a[0:3], v[180:183], 0
  v_mfma_f32_32x32x16_bf16 v[80:95], a[4:7], v[188:191], v[80:95]
  s_nop 9
  ds_write_b128 v7, v[112:115] offset:0
  v_mfma_f32_32x32x16_bf16 v[80:95], a[8:11], v[196:199], v[80:95]
  s_waitcnt vmcnt(4)
  v_max_u32 v3, v176, v178
  v_max3_u32 v3, v184, v186, v3
  v_max3_u32 v3, v192, v194, v3
  v_max3_u32 v3, v200, v202, v3
  v_mfma_f32_32x32x16_bf16 v[80:95], a[12:15], v[204:207], v[80:95]
  ds_write_b128 v7, v[116:119] offset:1024
  v_max3_u32 v3, v208, v210, v3
  v_max3_u32 v3, v128, v130, v3
  v_max3_u32 v3, v136, v138, v3
  v_cmp_eq_u32 vcc, -1, v3
  v_mfma_f32_32x32x16_bf16 v[80:95], a[16:19], v[212:215], v[80:95]
  v_mfma_f32_32x32x16_bf16 v[80:95], a[20:23], v[132:135], v[80:95]
  ds_write_b128 v7, v[120:123] offset:2048
  v_mfma_f32_32x32x16_bf16 v[80:95], a[24:27], v[140:143], v[80:95]
  ds_write_b128 v7, v[124:127] offset:3072
  s_cbranch_vccnz mm_kernel_st46
mm_kernel_st46_b:
  v_mfma_f32_32x32x16_bf16 v[96:111], a[28:31], v[176:179], 0
  s_waitcnt vmcnt(0)
  v_max_u32 v3, v32, v34
  v_max3_u32 v3, v36, v38, v3
  v_max3_u32 v3, v40, v42, v3
  v_max3_u32 v3, v44, v46, v3
  v_cmp_eq_u32 vcc, -1, v3
  v_mfma_f32_32x32x16_bf16 v[96:111], a[32:35], v[184:187], v[96:111]
  s_nop 1
  ds_write_b128 v6, v[80:83] offset:0
  v_mfma_f32_32x32x16_bf16 v[96:111], a[36:39], v[192:195], v[96:111]
  s_cbranch_vccnz mm_kernel_st47
mm_kernel_st47_b:
  v_mfma_f32_32x32x16_bf16 v[96:111], a[40:43], v[200:203], v[96:111]
  v_add_f32 v32, v32, v34
  v_add_f32 v33, v33, v35
  v_add_f32 v36, v36, v38
  v_add_f32 v37, v37, v39
  ds_write_b128 v6, v[84:87] offset:1024
  v_mfma_f32_32x32x16_bf16 v[96:111], a[44:47], v[208:211], v[96:111]
  v_add_f32 v40, v40, v42
  v_add_f32 v41, v41, v43
  v_add_f32 v44, v44, v46
  v_add_f32 v45, v45, v47
  v_mfma_f32_32x32x16_bf16 v[96:111], a[48:51], v[128:131], v[96:111]
  v_add_f32 v32, v32, v36
  v_add_f32 v33, v33, v37
  v_add_f32 v40, v40, v44
  v_add_f32 v41, v41, v45
  ds_write_b128 v6, v[88:91] offset:2048
  v_mfma_f32_32x32x16_bf16 v[96:111], a[52:55], v[136:139], v[96:111]
  v_add_f32 v30, v32, v40
  v_add_f32 v31, v33, v41
  v_mov_b32 v32, v30
  v_mov_b32 v33, v31
  ds_write_b128 v6, v[92:95] offset:3072
  v_mfma_f32_32x32x16_bf16 v[64:79], a[0:3], v[176:179], 0
  v_lshrrev_b32 v3, 5, v1
  s_waitcnt lgkmcnt(0)
  s_barrier
  ds_read_b128 v[112:115], v12 offset:8192
  ds_read_b128 v[116:119], v12 offset:9216
  v_mfma_f32_32x32x16_bf16 v[64:79], a[4:7], v[184:187], v[64:79]
  v_permlane32_swap_b32 v30, v32
  v_permlane32_swap_b32 v31, v33
  v_add_f32 v30, v30, v32
  v_add_f32 v31, v31, v33
  ds_write_b128 v5, v[96:99] offset:0
  ds_read_b128 v[120:123], v12 offset:10240
  v_mfma_f32_32x32x16_bf16 v[64:79], a[8:11], v[192:195], v[64:79]
  v_mul_f32 v30, 0x3b124925, v30
  v_mul_f32 v31, 0x3b124925, v31
  v_fma_f32 v31, -v30, v30, v31
  v_max_f32 v31, 0, v31
  ds_read_b128 v[124:127], v12 offset:11264
  ds_read_b128 v[80:83], v12 offset:4096
  v_mfma_f32_32x32x16_bf16 v[64:79], a[12:15], v[200:203], v[64:79]
  v_add_f32 v31, 0x3727c5ac, v31
  v_rsq_f32 v31, v31
  ds_write_b128 v5, v[100:103] offset:1024
  ds_read_b128 v[84:87], v12 offset:5120
  v_mfma_f32_32x32x16_bf16 v[64:79], a[16:19], v[208:211], v[64:79]
  ds_read_b128 v[88:91], v12 offset:6144
  ds_read_b128 v[92:95], v12 offset:7168
  v_mfma_f32_32x32x16_bf16 v[64:79], a[20:23], v[128:131], v[64:79]
  ds_write_b128 v5, v[104:107] offset:2048
  v_mfma_f32_32x32x16_bf16 v[64:79], a[24:27], v[136:139], v[64:79]
  ds_write_b128 v5, v[108:111] offset:3072
  s_waitcnt lgkmcnt(0)
  s_barrier
  ds_read_b128 v[96:99], v12 offset:0
  ds_read_b128 v[100:103], v12 offset:1024
  ds_read_b128 v[104:107], v12 offset:2048
  ds_read_b128 v[108:111], v12 offset:3072
  v_pk_add_f32 v[112:113], v[112:113], v[80:81]
  v_pk_add_f32 v[114:115], v[114:115], v[82:83]
  v_pk_add_f32 v[116:117], v[116:117], v[84:85]
  v_pk_add_f32 v[118:119], v[118:119], v[86:87]
  v_pk_add_f32 v[120:121], v[120:121], v[88:89]
  v_pk_add_f32 v[122:123], v[122:123], v[90:91]
  v_pk_add_f32 v[124:125], v[124:125], v[92:93]
  v_pk_add_f32 v[126:127], v[126:127], v[94:95]
  v_pk_add_f32 v[64:65], v[64:65], v[112:113]
  v_pk_add_f32 v[66:67], v[66:67], v[114:115]
  v_pk_add_f32 v[68:69], v[68:69], v[116:117]
  v_pk_add_f32 v[70:71], v[70:71], v[118:119]
  v_pk_add_f32 v[72:73], v[72:73], v[120:121]
  v_pk_add_f32 v[74:75], v[74:75], v[122:123]
  v_pk_add_f32 v[76:77], v[76:77], v[124:125]
  v_pk_add_f32 v[78:79], v[78:79], v[126:127]
  s_waitcnt lgkmcnt(2)
  v_pk_add_f32 v[64:65], v[64:65], v[96:97]
  v_pk_add_f32 v[66:67], v[66:67], v[98:99]
  v_pk_add_f32 v[68:69], v[68:69], v[100:101]
  v_pk_add_f32 v[70:71], v[70:71], v[102:103]
  s_waitcnt lgkmcnt(0)
  v_pk_add_f32 v[72:73], v[72:73], v[104:105]
  v_pk_add_f32 v[74:75], v[74:75], v[106:107]
  v_pk_add_f32 v[76:77], v[76:77], v[108:109]
  v_pk_add_f32 v[78:79], v[78:79], v[110:111]
  v_mul_f32 v36, 0x3e8b97f6, v31
  v_cmp_eq_u32 vcc, 1, v3
  v_sub_f32 v30, 0, v30
  s_nop 0
  v_cndmask_b32 v37, v36, v31, vcc
  v_fmac_f32 v64, v30, v160
  v_fmac_f32 v65, v30, v161
  v_fmac_f32 v66, v30, v162
  v_fmac_f32 v67, v30, v163
  v_fmac_f32 v68, v30, v164
  v_fmac_f32 v69, v30, v165
  v_fmac_f32 v70, v30, v166
  v_fmac_f32 v71, v30, v167
  v_fmac_f32 v72, v30, v168
  v_fmac_f32 v73, v30, v169
  v_fmac_f32 v74, v30, v170
  v_fmac_f32 v75, v30, v171
  v_fmac_f32 v76, v30, v172
  v_fmac_f32 v77, v30, v173
  v_fmac_f32 v78, v30, v174
  v_fmac_f32 v79, v30, v175
  v_mul_f32 v64, v36, v64
  v_mul_f32 v65, v36, v65
  v_mul_f32 v66, v36, v66
  v_mul_f32 v67, v36, v67
  v_mul_f32 v68, v36, v68
  v_mul_f32 v69, v36, v69
  v_mul_f32 v70, v36, v70
  v_mul_f32 v71, v36, v71
  v_mul_f32 v72, v36, v72
  v_mul_f32 v73, v36, v73
  v_mul_f32 v74, v36, v74
  v_mul_f32 v75, v36, v75
  v_mul_f32 v76, v37, v76
  v_mul_f32 v77, v37, v77
  v_mul_f32 v78, v37, v78
  v_mul_f32 v79, v37, v79
  v_cvt_pk_bf16_f32 v40, v64, v65
  v_cvt_pk_bf16_f32 v41, v66, v67
  v_cvt_pk_bf16_f32 v42, v68, v69
  v_cvt_pk_bf16_f32 v43, v70, v71
  v_cvt_pk_bf16_f32 v44, v72, v73
  v_cvt_pk_bf16_f32 v45, v74, v75
  v_cvt_pk_bf16_f32 v46, v76, v77
  v_cvt_pk_bf16_f32 v47, v78, v79
  buffer_store_dwordx4 v[40:43], v50, s[40:43], s60 offen sc1
  buffer_store_dwordx4 v[44:47], v50, s[40:43], s60 offen offset:1024 sc1
  s_and_b32 s10, s62, 7
  v_mov_b32 v48, v46
  v_mov_b32 v49, v47
  s_mov_b32 exec_lo, 0
  s_cmp_lg_u32 s10, 7
  s_cbranch_scc1 mm_kernel_kv1
  s_cmp_ge_u32 s62, 8
  s_cselect_b32 s10, 0x3f80, 0
  v_mov_b32 v48, s10
  v_mov_b32 v49, 0
mm_kernel_kv1:
  s_cmp_ge_u32 s62, 8
  s_cbranch_scc1 mm_kernel_v
  buffer_store_dwordx2 v[48:49], v51, s[40:43], s61 offen sc1
  s_branch mm_kernel_kvd
mm_kernel_v:
  ds_write_b64 v52, v[48:49]
  s_mov_b64 exec, -1
  s_waitcnt lgkmcnt(0)
  ds_read_b64_tr_b16 v[36:37], v53
  ds_read_b64_tr_b16 v[38:39], v53 offset:64
  s_mov_b64 exec, 0xffff
  s_waitcnt lgkmcnt(0)
  buffer_store_dwordx4 v[36:39], v51, s[40:43], s61 offen sc1
mm_kernel_kvd:
  s_mov_b64 exec, -1
  s_branch mm_l1
mm_kernel_norole:
  s_nop 15
  v_pk_mul_f32 v[96:97], v[96:97], v[104:105]
  v_pk_mul_f32 v[98:99], v[98:99], v[106:107]
  v_pk_mul_f32 v[100:101], v[100:101], v[108:109]
  v_pk_mul_f32 v[102:103], v[102:103], v[110:111]
  v_pk_mul_f32 v[96:97], v[96:97], v[172:173]
  v_pk_mul_f32 v[98:99], v[98:99], v[172:173]
  v_pk_mul_f32 v[100:101], v[100:101], v[172:173]
  v_pk_mul_f32 v[102:103], v[102:103], v[172:173]
  v_cvt_pk_bf16_f32 v164, v96, v97
  v_cvt_pk_bf16_f32 v165, v98, v99
  v_cvt_pk_bf16_f32 v166, v100, v101
  v_cvt_pk_bf16_f32 v167, v102, v103
  s_add_u32 s14, s6, 5120
  buffer_store_dwordx4 v[164:167], v4, s[40:43], s14 offen sc1
  v_pk_mul_f32 v[112:113], v[112:113], v[120:121]
  v_pk_mul_f32 v[114:115], v[114:115], v[122:123]
  v_pk_mul_f32 v[116:117], v[116:117], v[124:125]
  v_pk_mul_f32 v[118:119], v[118:119], v[126:127]
  v_pk_mul_f32 v[112:113], v[112:113], v[172:173]
  v_pk_mul_f32 v[114:115], v[114:115], v[172:173]
  v_pk_mul_f32 v[116:117], v[116:117], v[172:173]
  v_pk_mul_f32 v[118:119], v[118:119], v[172:173]
  v_cvt_pk_bf16_f32 v160, v112, v113
  v_cvt_pk_bf16_f32 v161, v114, v115
  v_cvt_pk_bf16_f32 v162, v116, v117
  v_cvt_pk_bf16_f32 v163, v118, v119
  s_add_u32 s14, s6, 6144
  buffer_store_dwordx4 v[160:163], v4, s[40:43], s14 offen sc1
  s_waitcnt vmcnt(0)
  s_add_u32 m0, s59, 0
  s_add_u32 s48, s50, 0
  buffer_load_dwordx4 v4, s[40:43], s48 offen offset:0 lds
  buffer_load_dwordx4 v4, s[40:43], s48 offen offset:1024 lds
  buffer_load_dwordx4 v4, s[40:43], s48 offen offset:2048 lds
  buffer_load_dwordx4 v4, s[40:43], s48 offen offset:3072 lds
  s_add_u32 m0, s59, 4096
  s_add_u32 s48, s50, 4096
  buffer_load_dwordx4 v4, s[40:43], s48 offen offset:0 lds
  buffer_load_dwordx4 v4, s[40:43], s48 offen offset:1024 lds
  buffer_load_dwordx4 v4, s[40:43], s48 offen offset:2048 lds
  s_add_u32 m0, s59, 7168
  s_add_u32 s48, s51, 0
  buffer_load_dwordx4 v4, s[40:43], s48 offen offset:0 lds
  buffer_load_dwordx4 v4, s[40:43], s48 offen offset:1024 lds
  buffer_load_dwordx4 v4, s[40:43], s48 offen offset:2048 lds
  buffer_load_dwordx4 v4, s[40:43], s48 offen offset:3072 lds
  s_add_u32 m0, s59, 11264
  s_add_u32 s48, s51, 4096
  buffer_load_dwordx4 v4, s[40:43], s48 offen offset:0 lds
  buffer_load_dwordx4 v4, s[40:43], s48 offen offset:1024 lds
  buffer_load_dwordx4 v4, s[40:43], s48 offen offset:2048 lds
  v_lshrrev_b32 v0, 5, v1
  v_lshlrev_b32 v0, 4, v0
  buffer_load_dwordx4 v[160:163], v0, s[40:43], s60 offen offset:0
  buffer_load_dwordx4 v[164:167], v0, s[40:43], s60 offen offset:32
  buffer_load_dwordx4 v[168:171], v0, s[40:43], s60 offen offset:64
  buffer_load_dwordx4 v[172:175], v0, s[40:43], s60 offen offset:96
  s_lshr_b32 s9, s4, 3
  s_lshl_b32 s9, s9, 2
  s_add_u32 s9, s9, s3
  s_lshl_b32 s9, s9, 15
  s_add_u32 s9, s9, 6815744
  v_mov_b32 v16, -1
  v_mov_b32 v17, -1
  v_mov_b32 v18, -1
  v_mov_b32 v19, -1
  buffer_store_dwordx4 v[16:19], v4, s[40:43], s9 offen offset:0 sc1
  buffer_store_dwordx4 v[16:19], v4, s[40:43], s9 offen offset:1024 sc1
  buffer_store_dwordx4 v[16:19], v4, s[40:43], s9 offen offset:2048 sc1
  buffer_store_dwordx4 v[16:19], v4, s[40:43], s9 offen offset:3072 sc1
  s_add_u32 s9, s9, 4096
  buffer_store_dwordx4 v[16:19], v4, s[40:43], s9 offen offset:0 sc1
  buffer_store_dwordx4 v[16:19], v4, s[40:43], s9 offen offset:1024 sc1
  buffer_store_dwordx4 v[16:19], v4, s[40:43], s9 offen offset:2048 sc1
  buffer_store_dwordx4 v[16:19], v4, s[40:43], s9 offen offset:3072 sc1
  s_add_u32 s9, s9, 4096
  buffer_store_dwordx4 v[16:19], v4, s[40:43], s9 offen offset:0 sc1
  buffer_store_dwordx4 v[16:19], v4, s[40:43], s9 offen offset:1024 sc1
  buffer_store_dwordx4 v[16:19], v4, s[40:43], s9 offen offset:2048 sc1
  s_waitcnt vmcnt(0)
  buffer_store_dwordx4 v[16:19], v4, s[40:43], s9 offen offset:3072 sc1
  s_add_u32 s9, s9, 4096
  buffer_store_dwordx4 v[16:19], v4, s[40:43], s9 offen offset:0 sc1
  buffer_store_dwordx4 v[16:19], v4, s[40:43], s9 offen offset:1024 sc1
  buffer_store_dwordx4 v[16:19], v4, s[40:43], s9 offen offset:2048 sc1
  buffer_store_dwordx4 v[16:19], v4, s[40:43], s9 offen offset:3072 sc1
  s_add_u32 s9, s9, 4096
  buffer_store_dwordx4 v[16:19], v4, s[40:43], s9 offen offset:0 sc1
  buffer_store_dwordx4 v[16:19], v4, s[40:43], s9 offen offset:1024 sc1
  buffer_store_dwordx4 v[16:19], v4, s[40:43], s9 offen offset:2048 sc1
  buffer_store_dwordx4 v[16:19], v4, s[40:43], s9 offen offset:3072 sc1
  s_add_u32 s9, s9, 4096
  buffer_store_dwordx4 v[16:19], v4, s[40:43], s9 offen offset:0 sc1
  buffer_store_dwordx4 v[16:19], v4, s[40:43], s9 offen offset:1024 sc1
  s_waitcnt vmcnt(0)
  buffer_store_dwordx4 v[16:19], v4, s[40:43], s9 offen offset:2048 sc1
  buffer_store_dwordx4 v[16:19], v4, s[40:43], s9 offen offset:3072 sc1
  s_add_u32 s9, s9, 4096
  buffer_store_dwordx4 v[16:19], v4, s[40:43], s9 offen offset:0 sc1
  buffer_store_dwordx4 v[16:19], v4, s[40:43], s9 offen offset:1024 sc1
  buffer_store_dwordx4 v[16:19], v4, s[40:43], s9 offen offset:2048 sc1
  buffer_store_dwordx4 v[16:19], v4, s[40:43], s9 offen offset:3072 sc1
  s_add_u32 s9, s9, 4096
  buffer_store_dwordx4 v[16:19], v4, s[40:43], s9 offen offset:0 sc1
  buffer_store_dwordx4 v[16:19], v4, s[40:43], s9 offen offset:1024 sc1
  buffer_store_dwordx4 v[16:19], v4, s[40:43], s9 offen offset:2048 sc1
  buffer_store_dwordx4 v[16:19], v4, s[40:43], s9 offen offset:3072 sc1
  s_waitcnt vmcnt(0)
  s_barrier
  s_branch mm_kernel_p1b
mm_kernel_g2:
  s_lshr_b32 s29, s4, 4
  s_lshl_b32 s29, s29, 9
  s_add_u32 s29, s29, 36352000
  s_mov_b64 exec, 15
  buffer_load_dword v252, v15, s[40:43], s29 offen sc1
  s_mov_b64 exec, -1
  s_sub_i32 s13, s13, 1
  s_waitcnt vmcnt(0)
  v_cmp_le_u32 vcc, 16, v252
  s_cmp_lt_i32 s13, 0
  s_cbranch_scc1 mm_kernel_g2_b
  s_and_b32 s28, vcc_lo, 15
  s_cmp_lg_u32 s28, 15
  s_cbranch_scc1 mm_kernel_g2
  s_branch mm_kernel_g2_b
mm_kernel_st2:
  s_add_u32 s15, s50, 0
  buffer_load_dwordx4 v[16:19], v4, s[40:43], s15 offen offset:0 sc1
  buffer_load_dwordx4 v[24:27], v4, s[40:43], s15 offen offset:1024 sc1
  buffer_load_dwordx4 v[32:35], v4, s[40:43], s15 offen offset:2048 sc1
  buffer_load_dwordx4 v[40:43], v4, s[40:43], s15 offen offset:3072 sc1
  s_add_u32 s15, s50, 4096
  buffer_load_dwordx4 v[48:51], v4, s[40:43], s15 offen offset:0 sc1
  buffer_load_dwordx4 v[56:59], v4, s[40:43], s15 offen offset:1024 sc1
  buffer_load_dwordx4 v[64:67], v4, s[40:43], s15 offen offset:2048 sc1
  buffer_load_dwordx4 v[72:75], v4, s[40:43], s15 offen offset:3072 sc1
  s_sub_i32 s13, s13, 1
  s_cmp_lt_i32 s13, 0
  s_waitcnt vmcnt(0)
  v_max_u32 v3, v16, v18
  v_max3_u32 v3, v24, v26, v3
  v_max3_u32 v3, v32, v34, v3
  v_max3_u32 v3, v40, v42, v3
  v_max3_u32 v3, v48, v50, v3
  v_max3_u32 v3, v56, v58, v3
  v_max3_u32 v3, v64, v66, v3
  v_max3_u32 v3, v72, v74, v3
  v_cmp_eq_u32 vcc, -1, v3
  s_cbranch_scc1 mm_kernel_st2_b
  s_nop 3
  s_cbranch_vccnz mm_kernel_st2
  s_branch mm_kernel_st2_b
mm_kernel_st4:
  s_add_u32 s15, s5, 0
  buffer_load_dwordx4 v[192:195], v4, s[40:43], s15 offen offset:0 sc1
  buffer_load_dwordx4 v[196:199], v4, s[40:43], s15 offen offset:1024 sc1
  s_sub_i32 s13, s13, 1
  s_cmp_lt_i32 s13, 0
  s_waitcnt vmcnt(0)
  v_max_u32 v3, v192, v194
  v_max3_u32 v3, v196, v198, v3
  v_cmp_eq_u32 vcc, -1, v3
  s_cbranch_scc1 mm_kernel_st4_b
  s_nop 3
  s_cbranch_vccnz mm_kernel_st4
  s_branch mm_kernel_st4_b
mm_kernel_st5:
  s_add_u32 s15, s5, 2048
  buffer_load_dwordx4 v[200:203], v4, s[40:43], s15 offen offset:0 sc1
  buffer_load_dwordx4 v[204:207], v4, s[40:43], s15 offen offset:1024 sc1
  s_sub_i32 s13, s13, 1
  s_cmp_lt_i32 s13, 0
  s_waitcnt vmcnt(0)
  v_max_u32 v3, v200, v202
  v_max3_u32 v3, v204, v206, v3
  v_cmp_eq_u32 vcc, -1, v3
  s_cbranch_scc1 mm_kernel_st5_b
  s_nop 3
  s_cbranch_vccnz mm_kernel_st5
  s_branch mm_kernel_st5_b
mm_kernel_st6:
  s_add_u32 s15, s5, 4096
  buffer_load_dwordx4 v[208:211], v4, s[40:43], s15 offen offset:0 sc1
  buffer_load_dwordx4 v[212:215], v4, s[40:43], s15 offen offset:1024 sc1
  s_sub_i32 s13, s13, 1
  s_cmp_lt_i32 s13, 0
  s_waitcnt vmcnt(0)
  v_max_u32 v3, v208, v210
  v_max3_u32 v3, v212, v214, v3
  v_cmp_eq_u32 vcc, -1, v3
  s_cbranch_scc1 mm_kernel_st6_b
  s_nop 3
  s_cbranch_vccnz mm_kernel_st6
  s_branch mm_kernel_st6_b
mm_kernel_st7:
  s_add_u32 s15, s5, 7168
  buffer_load_dwordx4 v[8:11], v4, s[40:43], s15 offen offset:0 sc1
  buffer_load_dwordx4 v[12:15], v4, s[40:43], s15 offen offset:1024 sc1
  s_sub_i32 s13, s13, 1
  s_cmp_lt_i32 s13, 0
  s_waitcnt vmcnt(0)
  v_max_u32 v3, v8, v10
  v_max3_u32 v3, v12, v14, v3
  v_cmp_eq_u32 vcc, -1, v3
  s_cbranch_scc1 mm_kernel_st7_b
  s_nop 3
  s_cbranch_vccnz mm_kernel_st7
  s_branch mm_kernel_st7_b
mm_kernel_st8:
  s_add_u32 s15, s5, 9216
  buffer_load_dwordx4 a[0:3], v4, s[40:43], s15 offen offset:0 sc1
  buffer_load_dwordx4 a[4:7], v4, s[40:43], s15 offen offset:1024 sc1
  s_sub_i32 s13, s13, 1
  s_cmp_lt_i32 s13, 0
  s_waitcnt vmcnt(0)
  v_accvgpr_read_b32 v2, a0
  v_accvgpr_read_b32 v7, a2
  v_max_u32 v3, v2, v7
  v_accvgpr_read_b32 v2, a4
  v_accvgpr_read_b32 v7, a6
  v_max3_u32 v3, v2, v7, v3
  v_cmp_eq_u32 vcc, -1, v3
  s_cbranch_scc1 mm_kernel_st8_b
  s_nop 3
  s_cbranch_vccnz mm_kernel_st8
  s_branch mm_kernel_st8_b
mm_kernel_st9:
  s_add_u32 s15, s5, 11264
  buffer_load_dwordx4 a[8:11], v4, s[40:43], s15 offen offset:0 sc1
  buffer_load_dwordx4 a[12:15], v4, s[40:43], s15 offen offset:1024 sc1
  s_sub_i32 s13, s13, 1
  s_cmp_lt_i32 s13, 0
  s_waitcnt vmcnt(0)
  v_accvgpr_read_b32 v2, a8
  v_accvgpr_read_b32 v7, a10
  v_max_u32 v3, v2, v7
  v_accvgpr_read_b32 v2, a12
  v_accvgpr_read_b32 v7, a14
  v_max3_u32 v3, v2, v7, v3
  v_cmp_eq_u32 vcc, -1, v3
  s_cbranch_scc1 mm_kernel_st9_b
  s_nop 3
  s_cbranch_vccnz mm_kernel_st9
  s_branch mm_kernel_st9_b
mm_kernel_st10:
  s_add_u32 s15, s5, 14336
  buffer_load_dwordx4 a[16:19], v4, s[40:43], s15 offen offset:0 sc1
  buffer_load_dwordx4 a[20:23], v4, s[40:43], s15 offen offset:1024 sc1
  s_sub_i32 s13, s13, 1
  s_cmp_lt_i32 s13, 0
  s_waitcnt vmcnt(0)
  v_accvgpr_read_b32 v2, a16
  v_accvgpr_read_b32 v7, a18
  v_max_u32 v3, v2, v7
  v_accvgpr_read_b32 v2, a20
  v_accvgpr_read_b32 v7, a22
  v_max3_u32 v3, v2, v7, v3
  v_cmp_eq_u32 vcc, -1, v3
  s_cbranch_scc1 mm_kernel_st10_b
  s_nop 3
  s_cbranch_vccnz mm_kernel_st10
  s_branch mm_kernel_st10_b
mm_kernel_st11:
  s_add_u32 s15, s5, 16384
  buffer_load_dwordx4 a[24:27], v4, s[40:43], s15 offen offset:0 sc1
  buffer_load_dwordx4 a[28:31], v4, s[40:43], s15 offen offset:1024 sc1
  s_sub_i32 s13, s13, 1
  s_cmp_lt_i32 s13, 0
  s_waitcnt vmcnt(0)
  v_accvgpr_read_b32 v2, a24
  v_accvgpr_read_b32 v7, a26
  v_max_u32 v3, v2, v7
  v_accvgpr_read_b32 v2, a28
  v_accvgpr_read_b32 v7, a30
  v_max3_u32 v3, v2, v7, v3
  v_cmp_eq_u32 vcc, -1, v3
  s_cbranch_scc1 mm_kernel_st11_b
  s_nop 3
  s_cbranch_vccnz mm_kernel_st11
  s_branch mm_kernel_st11_b
mm_kernel_st12:
  s_add_u32 s15, s5, 18432
  buffer_load_dwordx4 a[32:35], v4, s[40:43], s15 offen offset:0 sc1
  buffer_load_dwordx4 a[36:39], v4, s[40:43], s15 offen offset:1024 sc1
  s_sub_i32 s13, s13, 1
  s_cmp_lt_i32 s13, 0
  s_waitcnt vmcnt(0)
  v_accvgpr_read_b32 v2, a32
  v_accvgpr_read_b32 v7, a34
  v_max_u32 v3, v2, v7
  v_accvgpr_read_b32 v2, a36
  v_accvgpr_read_b32 v7, a38
  v_max3_u32 v3, v2, v7, v3
  v_cmp_eq_u32 vcc, -1, v3
  s_cbranch_scc1 mm_kernel_st12_b
  s_nop 3
  s_cbranch_vccnz mm_kernel_st12
  s_branch mm_kernel_st12_b
mm_kernel_st13:
  s_add_u32 s15, s7, 0
  buffer_load_dwordx4 v[160:163], v4, s[40:43], s15 offen offset:0 sc1
  buffer_load_dwordx4 v[164:167], v4, s[40:43], s15 offen offset:1024 sc1
  buffer_load_dwordx4 v[168:171], v4, s[40:43], s15 offen offset:2048 sc1
  s_mov_b32 exec_hi, 0
  buffer_load_dwordx4 v[172:175], v4, s[40:43], s15 offen offset:3072 sc1
  s_mov_b32 exec_hi, -1
  s_sub_i32 s13, s13, 1
  s_cmp_lt_i32 s13, 0
  s_waitcnt vmcnt(0)
  v_max_u32 v3, v160, v162
  v_max3_u32 v3, v164, v166, v3
  v_max3_u32 v3, v168, v170, v3
  v_max3_u32 v3, v172, v174, v3
  v_cmp_eq_u32 vcc, -1, v3
  s_cbranch_scc1 mm_kernel_st13_b
  s_nop 3
  s_cbranch_vccnz mm_kernel_st13
  s_branch mm_kernel_st13_b
mm_kernel_st14:
  s_add_u32 s15, s5, 21504
  buffer_load_dwordx4 a[40:43], v4, s[40:43], s15 offen offset:0 sc1
  buffer_load_dwordx4 a[44:47], v4, s[40:43], s15 offen offset:1024 sc1
  s_sub_i32 s13, s13, 1
  s_cmp_lt_i32 s13, 0
  s_waitcnt vmcnt(0)
  v_accvgpr_read_b32 v2, a40
  v_accvgpr_read_b32 v7, a42
  v_max_u32 v3, v2, v7
  v_accvgpr_read_b32 v2, a44
  v_accvgpr_read_b32 v7, a46
  v_max3_u32 v3, v2, v7, v3
  v_cmp_eq_u32 vcc, -1, v3
  s_cbranch_scc1 mm_kernel_st14_b
  s_nop 3
  s_cbranch_vccnz mm_kernel_st14
  s_branch mm_kernel_st14_b
mm_kernel_st15:
  s_add_u32 s15, s5, 23552
  buffer_load_dwordx4 a[48:51], v4, s[40:43], s15 offen offset:0 sc1
  buffer_load_dwordx4 a[52:55], v4, s[40:43], s15 offen offset:1024 sc1
  s_sub_i32 s13, s13, 1
  s_cmp_lt_i32 s13, 0
  s_waitcnt vmcnt(0)
  v_accvgpr_read_b32 v2, a48
  v_accvgpr_read_b32 v7, a50
  v_max_u32 v3, v2, v7
  v_accvgpr_read_b32 v2, a52
  v_accvgpr_read_b32 v7, a54
  v_max3_u32 v3, v2, v7, v3
  v_cmp_eq_u32 vcc, -1, v3
  s_cbranch_scc1 mm_kernel_st15_b
  s_nop 3
  s_cbranch_vccnz mm_kernel_st15
  s_branch mm_kernel_st15_b
mm_kernel_st16:
  s_add_u32 s15, s5, 25600
  buffer_load_dwordx4 a[56:59], v4, s[40:43], s15 offen offset:0 sc1
  buffer_load_dwordx4 a[60:63], v4, s[40:43], s15 offen offset:1024 sc1
  s_sub_i32 s13, s13, 1
  s_cmp_lt_i32 s13, 0
  s_waitcnt vmcnt(0)
  v_accvgpr_read_b32 v2, a56
  v_accvgpr_read_b32 v7, a58
  v_max_u32 v3, v2, v7
  v_accvgpr_read_b32 v2, a60
  v_accvgpr_read_b32 v7, a62
  v_max3_u32 v3, v2, v7, v3
  v_cmp_eq_u32 vcc, -1, v3
  s_cbranch_scc1 mm_kernel_st16_b
  s_nop 3
  s_cbranch_vccnz mm_kernel_st16
  s_branch mm_kernel_st16_b
mm_kernel_st17:
  s_add_u32 s15, s10, s52
  buffer_load_dwordx4 v[16:19], v4, s[68:71], s15 offen offset:0 sc1
  s_add_u32 s15, s11, s52
  buffer_load_dwordx4 v[20:23], v4, s[68:71], s15 offen offset:0 sc1
  s_sub_i32 s13, s13, 1
  s_cmp_lt_i32 s13, 0
  s_waitcnt vmcnt(0)
  v_max_u32 v3, v16, v18
  v_max3_u32 v3, v20, v22, v3
  v_cmp_eq_u32 vcc, -1, v3
  s_cbranch_scc1 mm_kernel_st17_b
  s_nop 3
  s_cbranch_vccnz mm_kernel_st17
  s_branch mm_kernel_st17_b
mm_kernel_st18:
  s_add_u32 s15, s10, s52
  s_add_u32 s15, s15, 1024
  buffer_load_dwordx4 v[24:27], v4, s[68:71], s15 offen offset:0 sc1
  s_add_u32 s15, s11, s52
  s_add_u32 s15, s15, 1024
  buffer_load_dwordx4 v[28:31], v4, s[68:71], s15 offen offset:0 sc1
  s_sub_i32 s13, s13, 1
  s_cmp_lt_i32 s13, 0
  s_waitcnt vmcnt(0)
  v_max_u32 v3, v24, v26
  v_max3_u32 v3, v28, v30, v3
  v_cmp_eq_u32 vcc, -1, v3
  s_cbranch_scc1 mm_kernel_st18_b
  s_nop 3
  s_cbranch_vccnz mm_kernel_st18
  s_branch mm_kernel_st18_b
mm_kernel_st19:
  s_add_u32 s15, s10, s52
  s_add_u32 s15, s15, 2048
  buffer_load_dwordx4 v[32:35], v4, s[68:71], s15 offen offset:0 sc1
  s_add_u32 s15, s11, s52
  s_add_u32 s15, s15, 2048
  buffer_load_dwordx4 v[36:39], v4, s[68:71], s15 offen offset:0 sc1
  s_sub_i32 s13, s13, 1
  s_cmp_lt_i32 s13, 0
  s_waitcnt vmcnt(0)
  v_max_u32 v3, v32, v34
  v_max3_u32 v3, v36, v38, v3
  v_cmp_eq_u32 vcc, -1, v3
  s_cbranch_scc1 mm_kernel_st19_b
  s_nop 3
  s_cbranch_vccnz mm_kernel_st19
  s_branch mm_kernel_st19_b
mm_kernel_st20:
  s_add_u32 s15, s10, s53
  buffer_load_dwordx4 v[40:43], v4, s[68:71], s15 offen offset:0 sc1
  s_add_u32 s15, s11, s53
  buffer_load_dwordx4 v[44:47], v4, s[68:71], s15 offen offset:0 sc1
  s_sub_i32 s13, s13, 1
  s_cmp_lt_i32 s13, 0
  s_waitcnt vmcnt(0)
  v_max_u32 v3, v40, v42
  v_max3_u32 v3, v44, v46, v3
  v_cmp_eq_u32 vcc, -1, v3
  s_cbranch_scc1 mm_kernel_st20_b
  s_nop 3
  s_cbranch_vccnz mm_kernel_st20
  s_branch mm_kernel_st20_b
mm_kernel_st21:
  s_add_u32 s15, s10, s53
  s_add_u32 s15, s15, 1024
  buffer_load_dwordx4 v[48:51], v4, s[68:71], s15 offen offset:0 sc1
  s_add_u32 s15, s11, s53
  s_add_u32 s15, s15, 1024
  buffer_load_dwordx4 v[52:55], v4, s[68:71], s15 offen offset:0 sc1
  s_sub_i32 s13, s13, 1
  s_cmp_lt_i32 s13, 0
  s_waitcnt vmcnt(0)
  v_max_u32 v3, v48, v50
  v_max3_u32 v3, v52, v54, v3
  v_cmp_eq_u32 vcc, -1, v3
  s_cbranch_scc1 mm_kernel_st21_b
  s_nop 3
  s_cbranch_vccnz mm_kernel_st21
  s_branch mm_kernel_st21_b
mm_kernel_st22:
  s_add_u32 s15, s10, s53
  s_add_u32 s15, s15, 2048
  buffer_load_dwordx4 v[56:59], v4, s[68:71], s15 offen offset:0 sc1
  s_add_u32 s15, s11, s53
  s_add_u32 s15, s15, 2048
  buffer_load_dwordx4 v[60:63], v4, s[68:71], s15 offen offset:0 sc1
  s_sub_i32 s13, s13, 1
  s_cmp_lt_i32 s13, 0
  s_waitcnt vmcnt(0)
  v_max_u32 v3, v56, v58
  v_max3_u32 v3, v60, v62, v3
  v_cmp_eq_u32 vcc, -1, v3
  s_cbranch_scc1 mm_kernel_st22_b
  s_nop 3
  s_cbranch_vccnz mm_kernel_st22
  s_branch mm_kernel_st22_b
mm_kernel_st23:
  s_add_u32 s15, s10, s54
  buffer_load_dwordx4 v[192:195], v4, s[68:71], s15 offen offset:0 sc1
  s_add_u32 s15, s11, s54
  buffer_load_dwordx4 v[196:199], v4, s[68:71], s15 offen offset:0 sc1
  s_sub_i32 s13, s13, 1
  s_cmp_lt_i32 s13, 0
  s_waitcnt vmcnt(0)
  v_max_u32 v3, v192, v194
  v_max3_u32 v3, v196, v198, v3
  v_cmp_eq_u32 vcc, -1, v3
  s_cbranch_scc1 mm_kernel_st23_b
  s_nop 3
  s_cbranch_vccnz mm_kernel_st23
  s_branch mm_kernel_st23_b
mm_kernel_st24:
  s_add_u32 s15, s10, s54
  s_add_u32 s15, s15, 1024
  buffer_load_dwordx4 v[200:203], v4, s[68:71], s15 offen offset:0 sc1
  s_add_u32 s15, s11, s54
  s_add_u32 s15, s15, 1024
  buffer_load_dwordx4 v[204:207], v4, s[68:71], s15 offen offset:0 sc1
  s_sub_i32 s13, s13, 1
  s_cmp_lt_i32 s13, 0
  s_waitcnt vmcnt(0)
  v_max_u32 v3, v200, v202
  v_max3_u32 v3, v204, v206, v3
  v_cmp_eq_u32 vcc, -1, v3
  s_cbranch_scc1 mm_kernel_st24_b
  s_nop 3
  s_cbranch_vccnz mm_kernel_st24
  s_branch mm_kernel_st24_b
mm_kernel_st25:
  s_add_u32 s15, s10, s54
  s_add_u32 s15, s15, 2048
  buffer_load_dwordx4 v[208:211], v4, s[68:71], s15 offen offset:0 sc1
  s_add_u32 s15, s11, s54
  s_add_u32 s15, s15, 2048
  buffer_load_dwordx4 v[212:215], v4, s[68:71], s15 offen offset:0 sc1
  s_sub_i32 s13, s13, 1
  s_cmp_lt_i32 s13, 0
  s_waitcnt vmcnt(0)
  v_max_u32 v3, v208, v210
  v_max3_u32 v3, v212, v214, v3
  v_cmp_eq_u32 vcc, -1, v3
  s_cbranch_scc1 mm_kernel_st25_b
  s_nop 3
  s_cbranch_vccnz mm_kernel_st25
  s_branch mm_kernel_st25_b
mm_kernel_st26:
  s_add_u32 s15, s10, s55
  buffer_load_dwordx4 v[176:179], v4, s[68:71], s15 offen offset:0 sc1
  s_add_u32 s15, s11, s55
  buffer_load_dwordx4 v[8:11], v4, s[68:71], s15 offen offset:0 sc1
  s_sub_i32 s13, s13, 1
  s_cmp_lt_i32 s13, 0
  s_waitcnt vmcnt(0)
  v_max_u32 v3, v176, v178
  v_max3_u32 v3, v8, v10, v3
  v_cmp_eq_u32 vcc, -1, v3
  s_cbranch_scc1 mm_kernel_st26_b
  s_nop 3
  s_cbranch_vccnz mm_kernel_st26
  s_branch mm_kernel_st26_b
mm_kernel_st27:
  s_add_u32 s15, s10, s55
  s_add_u32 s15, s15, 1024
  buffer_load_dwordx4 v[12:15], v4, s[68:71], s15 offen offset:0 sc1
  s_add_u32 s15, s11, s55
  s_add_u32 s15, s15, 1024
  buffer_load_dwordx4 a[0:3], v4, s[68:71], s15 offen offset:0 sc1
  s_sub_i32 s13, s13, 1
  s_cmp_lt_i32 s13, 0
  s_waitcnt vmcnt(0)
  v_max_u32 v3, v12, v14
  v_accvgpr_read_b32 v2, a0
  v_accvgpr_read_b32 v7, a2
  v_max3_u32 v3, v2, v7, v3
  v_cmp_eq_u32 vcc, -1, v3
  s_cbranch_scc1 mm_kernel_st27_b
  s_nop 3
  s_cbranch_vccnz mm_kernel_st27
  s_branch mm_kernel_st27_b
mm_kernel_st28:
  s_add_u32 s15, s10, s55
  s_add_u32 s15, s15, 2048
  buffer_load_dwordx4 a[4:7], v4, s[68:71], s15 offen offset:0 sc1
  s_add_u32 s15, s11, s55
  s_add_u32 s15, s15, 2048
  buffer_load_dwordx4 a[8:11], v4, s[68:71], s15 offen offset:0 sc1
  s_sub_i32 s13, s13, 1
  s_cmp_lt_i32 s13, 0
  s_waitcnt vmcnt(0)
  v_accvgpr_read_b32 v2, a4
  v_accvgpr_read_b32 v7, a6
  v_max_u32 v3, v2, v7
  v_accvgpr_read_b32 v2, a8
  v_accvgpr_read_b32 v7, a10
  v_max3_u32 v3, v2, v7, v3
  v_cmp_eq_u32 vcc, -1, v3
  s_cbranch_scc1 mm_kernel_st28_b
  s_nop 3
  s_cbranch_vccnz mm_kernel_st28
  s_branch mm_kernel_st28_b
mm_kernel_st29:
  s_add_u32 s15, s10, s52
  s_add_u32 s15, s15, 3072
  buffer_load_dwordx4 a[12:15], v4, s[68:71], s15 offen offset:0 sc1
  s_add_u32 s15, s11, s52
  s_add_u32 s15, s15, 3072
  buffer_load_dwordx4 v[180:183], v4, s[68:71], s15 offen offset:0 sc1
  s_sub_i32 s13, s13, 1
  s_cmp_lt_i32 s13, 0
  s_waitcnt vmcnt(0)
  v_accvgpr_read_b32 v2, a12
  v_accvgpr_read_b32 v7, a14
  v_max_u32 v3, v2, v7
  v_max3_u32 v3, v180, v182, v3
  v_cmp_eq_u32 vcc, -1, v3
  s_cbranch_scc1 mm_kernel_st29_b
  s_nop 3
  s_cbranch_vccnz mm_kernel_st29
  s_branch mm_kernel_st29_b
mm_kernel_st30:
  s_add_u32 s15, s10, s52
  s_add_u32 s15, s15, 4096
  buffer_load_dwordx4 a[16:19], v4, s[68:71], s15 offen offset:0 sc1
  s_add_u32 s15, s11, s52
  s_add_u32 s15, s15, 4096
  buffer_load_dwordx4 a[20:23], v4, s[68:71], s15 offen offset:0 sc1
  s_sub_i32 s13, s13, 1
  s_cmp_lt_i32 s13, 0
  s_waitcnt vmcnt(0)
  v_accvgpr_read_b32 v2, a16
  v_accvgpr_read_b32 v7, a18
  v_max_u32 v3, v2, v7
  v_accvgpr_read_b32 v2, a20
  v_accvgpr_read_b32 v7, a22
  v_max3_u32 v3, v2, v7, v3
  v_cmp_eq_u32 vcc, -1, v3
  s_cbranch_scc1 mm_kernel_st30_b
  s_nop 3
  s_cbranch_vccnz mm_kernel_st30
  s_branch mm_kernel_st30_b
mm_kernel_st31:
  s_add_u32 s15, s10, s53
  s_add_u32 s15, s15, 3072
  buffer_load_dwordx4 a[24:27], v4, s[68:71], s15 offen offset:0 sc1
  s_add_u32 s15, s11, s53
  s_add_u32 s15, s15, 3072
  buffer_load_dwordx4 a[28:31], v4, s[68:71], s15 offen offset:0 sc1
  s_sub_i32 s13, s13, 1
  s_cmp_lt_i32 s13, 0
  s_waitcnt vmcnt(0)
  v_accvgpr_read_b32 v2, a24
  v_accvgpr_read_b32 v7, a26
  v_max_u32 v3, v2, v7
  v_accvgpr_read_b32 v2, a28
  v_accvgpr_read_b32 v7, a30
  v_max3_u32 v3, v2, v7, v3
  v_cmp_eq_u32 vcc, -1, v3
  s_cbranch_scc1 mm_kernel_st31_b
  s_nop 3
  s_cbranch_vccnz mm_kernel_st31
  s_branch mm_kernel_st31_b
mm_kernel_st32:
  s_add_u32 s15, s10, s53
  s_add_u32 s15, s15, 4096
  buffer_load_dwordx4 a[32:35], v4, s[68:71], s15 offen offset:0 sc1
  s_add_u32 s15, s11, s53
  s_add_u32 s15, s15, 4096
  buffer_load_dwordx4 a[36:39], v4, s[68:71], s15 offen offset:0 sc1
  s_sub_i32 s13, s13, 1
  s_cmp_lt_i32 s13, 0
  s_waitcnt vmcnt(0)
  v_accvgpr_read_b32 v2, a32
  v_accvgpr_read_b32 v7, a34
  v_max_u32 v3, v2, v7
  v_accvgpr_read_b32 v2, a36
  v_accvgpr_read_b32 v7, a38
  v_max3_u32 v3, v2, v7, v3
  v_cmp_eq_u32 vcc, -1, v3
  s_cbranch_scc1 mm_kernel_st32_b
  s_nop 3
  s_cbranch_vccnz mm_kernel_st32
  s_branch mm_kernel_st32_b
mm_kernel_st33:
  s_add_u32 s15, s10, s54
  s_add_u32 s15, s15, 3072
  buffer_load_dwordx4 v[184:187], v4, s[68:71], s15 offen offset:0 sc1
  s_add_u32 s15, s11, s54
  s_add_u32 s15, s15, 3072
  buffer_load_dwordx4 a[40:43], v4, s[68:71], s15 offen offset:0 sc1
  s_sub_i32 s13, s13, 1
  s_cmp_lt_i32 s13, 0
  s_waitcnt vmcnt(0)
  v_max_u32 v3, v184, v186
  v_accvgpr_read_b32 v2, a40
  v_accvgpr_read_b32 v7, a42
  v_max3_u32 v3, v2, v7, v3
  v_cmp_eq_u32 vcc, -1, v3
  s_cbranch_scc1 mm_kernel_st33_b
  s_nop 3
  s_cbranch_vccnz mm_kernel_st33
  s_branch mm_kernel_st33_b
mm_kernel_st34:
  s_add_u32 s15, s10, s54
  s_add_u32 s15, s15, 4096
  buffer_load_dwordx4 a[44:47], v4, s[68:71], s15 offen offset:0 sc1
  s_add_u32 s15, s11, s54
  s_add_u32 s15, s15, 4096
  buffer_load_dwordx4 a[48:51], v4, s[68:71], s15 offen offset:0 sc1
  s_sub_i32 s13, s13, 1
  s_cmp_lt_i32 s13, 0
  s_waitcnt vmcnt(0)
  v_accvgpr_read_b32 v2, a44
  v_accvgpr_read_b32 v7, a46
  v_max_u32 v3, v2, v7
  v_accvgpr_read_b32 v2, a48
  v_accvgpr_read_b32 v7, a50
  v_max3_u32 v3, v2, v7, v3
  v_cmp_eq_u32 vcc, -1, v3
  s_cbranch_scc1 mm_kernel_st34_b
  s_nop 3
  s_cbranch_vccnz mm_kernel_st34
  s_branch mm_kernel_st34_b
mm_kernel_st35:
  s_add_u32 s15, s10, s55
  s_add_u32 s15, s15, 3072
  buffer_load_dwordx4 a[52:55], v4, s[68:71], s15 offen offset:0 sc1
  s_add_u32 s15, s11, s55
  s_add_u32 s15, s15, 3072
  buffer_load_dwordx4 a[56:59], v4, s[68:71], s15 offen offset:0 sc1
  s_sub_i32 s13, s13, 1
  s_cmp_lt_i32 s13, 0
  s_waitcnt vmcnt(0)
  v_accvgpr_read_b32 v2, a52
  v_accvgpr_read_b32 v7, a54
  v_max_u32 v3, v2, v7
  v_accvgpr_read_b32 v2, a56
  v_accvgpr_read_b32 v7, a58
  v_max3_u32 v3, v2, v7, v3
  v_cmp_eq_u32 vcc, -1, v3
  s_cbranch_scc1 mm_kernel_st35_b
  s_nop 3
  s_cbranch_vccnz mm_kernel_st35
  s_branch mm_kernel_st35_b
mm_kernel_st36:
  s_add_u32 s15, s10, s55
  s_add_u32 s15, s15, 4096
  buffer_load_dwordx4 a[60:63], v4, s[68:71], s15 offen offset:0 sc1
  s_add_u32 s15, s11, s55
  s_add_u32 s15, s15, 4096
  buffer_load_dwordx4 v[188:191], v4, s[68:71], s15 offen offset:0 sc1
  s_sub_i32 s13, s13, 1
  s_cmp_lt_i32 s13, 0
  s_waitcnt vmcnt(0)
  v_accvgpr_read_b32 v2, a60
  v_accvgpr_read_b32 v7, a62
  v_max_u32 v3, v2, v7
  v_max3_u32 v3, v188, v190, v3
  v_cmp_eq_u32 vcc, -1, v3
  s_cbranch_scc1 mm_kernel_st36_b
  s_nop 3
  s_cbranch_vccnz mm_kernel_st36
  s_branch mm_kernel_st36_b
mm_kernel_st37:
  s_add_u32 s15, s11, s52
  s_add_u32 s15, s15, 5120
  buffer_load_dwordx4 v[128:131], v4, s[68:71], s15 offen offset:0 sc1
  buffer_load_dwordx4 v[132:135], v4, s[68:71], s15 offen offset:1024 sc1
  s_sub_i32 s13, s13, 1
  s_cmp_lt_i32 s13, 0
  s_waitcnt vmcnt(0)
  v_max_u32 v3, v128, v130
  v_max3_u32 v3, v132, v134, v3
  v_cmp_eq_u32 vcc, -1, v3
  s_cbranch_scc1 mm_kernel_st37_b
  s_nop 3
  s_cbranch_vccnz mm_kernel_st37
  s_branch mm_kernel_st37_b
mm_kernel_st38:
  s_add_u32 s15, s11, s53
  s_add_u32 s15, s15, 5120
  buffer_load_dwordx4 v[136:139], v4, s[68:71], s15 offen offset:0 sc1
  buffer_load_dwordx4 v[140:143], v4, s[68:71], s15 offen offset:1024 sc1
  s_sub_i32 s13, s13, 1
  s_cmp_lt_i32 s13, 0
  s_waitcnt vmcnt(0)
  v_max_u32 v3, v136, v138
  v_max3_u32 v3, v140, v142, v3
  v_cmp_eq_u32 vcc, -1, v3
  s_cbranch_scc1 mm_kernel_st38_b
  s_nop 3
  s_cbranch_vccnz mm_kernel_st38
  s_branch mm_kernel_st38_b
mm_kernel_st39:
  s_add_u32 s15, s11, s54
  s_add_u32 s15, s15, 5120
  buffer_load_dwordx4 v[144:147], v4, s[68:71], s15 offen offset:0 sc1
  buffer_load_dwordx4 v[148:151], v4, s[68:71], s15 offen offset:1024 sc1
  s_sub_i32 s13, s13, 1
  s_cmp_lt_i32 s13, 0
  s_waitcnt vmcnt(0)
  v_max_u32 v3, v144, v146
  v_max3_u32 v3, v148, v150, v3
  v_cmp_eq_u32 vcc, -1, v3
  s_cbranch_scc1 mm_kernel_st39_b
  s_nop 3
  s_cbranch_vccnz mm_kernel_st39
  s_branch mm_kernel_st39_b
mm_kernel_st40:
  s_add_u32 s15, s11, s55
  s_add_u32 s15, s15, 5120
  buffer_load_dwordx4 v[152:155], v4, s[68:71], s15 offen offset:0 sc1
  buffer_load_dwordx4 v[156:159], v4, s[68:71], s15 offen offset:1024 sc1
  s_sub_i32 s13, s13, 1
  s_cmp_lt_i32 s13, 0
  s_waitcnt vmcnt(0)
  v_max_u32 v3, v152, v154
  v_max3_u32 v3, v156, v158, v3
  v_cmp_eq_u32 vcc, -1, v3
  s_cbranch_scc1 mm_kernel_st40_b
  s_nop 3
  s_cbranch_vccnz mm_kernel_st40
  s_branch mm_kernel_st40_b
mm_kernel_st41:
  s_add_u32 s15, s10, s52
  s_add_u32 s15, s15, 5120
  buffer_load_dwordx4 v[16:19], v4, s[68:71], s15 offen offset:0 sc1
  buffer_load_dwordx4 v[20:23], v4, s[68:71], s15 offen offset:1024 sc1
  s_sub_i32 s13, s13, 1
  s_cmp_lt_i32 s13, 0
  s_waitcnt vmcnt(0)
  v_max_u32 v3, v16, v18
  v_max3_u32 v3, v20, v22, v3
  v_cmp_eq_u32 vcc, -1, v3
  s_cbranch_scc1 mm_kernel_st41_b
  s_nop 3
  s_cbranch_vccnz mm_kernel_st41
  s_branch mm_kernel_st41_b
mm_kernel_st42:
  s_add_u32 s15, s10, s53
  s_add_u32 s15, s15, 5120
  buffer_load_dwordx4 v[24:27], v4, s[68:71], s15 offen offset:0 sc1
  buffer_load_dwordx4 v[28:31], v4, s[68:71], s15 offen offset:1024 sc1
  s_sub_i32 s13, s13, 1
  s_cmp_lt_i32 s13, 0
  s_waitcnt vmcnt(0)
  v_max_u32 v3, v24, v26
  v_max3_u32 v3, v28, v30, v3
  v_cmp_eq_u32 vcc, -1, v3
  s_cbranch_scc1 mm_kernel_st42_b
  s_nop 3
  s_cbranch_vccnz mm_kernel_st42
  s_branch mm_kernel_st42_b
mm_kernel_st43:
  s_add_u32 s15, s10, s54
  s_add_u32 s15, s15, 5120
  buffer_load_dwordx4 v[32:35], v4, s[68:71], s15 offen offset:0 sc1
  buffer_load_dwordx4 v[36:39], v4, s[68:71], s15 offen offset:1024 sc1
  s_sub_i32 s13, s13, 1
  s_cmp_lt_i32 s13, 0
  s_waitcnt vmcnt(0)
  v_max_u32 v3, v32, v34
  v_max3_u32 v3, v36, v38, v3
  v_cmp_eq_u32 vcc, -1, v3
  s_cbranch_scc1 mm_kernel_st43_b
  s_nop 3
  s_cbranch_vccnz mm_kernel_st43
  s_branch mm_kernel_st43_b
mm_kernel_st44:
  s_add_u32 s15, s10, s55
  s_add_u32 s15, s15, 5120
  buffer_load_dwordx4 v[40:43], v4, s[68:71], s15 offen offset:0 sc1
  buffer_load_dwordx4 v[44:47], v4, s[68:71], s15 offen offset:1024 sc1
  s_sub_i32 s13, s13, 1
  s_cmp_lt_i32 s13, 0
  s_waitcnt vmcnt(0)
  v_max_u32 v3, v40, v42
  v_max3_u32 v3, v44, v46, v3
  v_cmp_eq_u32 vcc, -1, v3
  s_cbranch_scc1 mm_kernel_st44_b
  s_nop 3
  s_cbranch_vccnz mm_kernel_st44
  s_branch mm_kernel_st44_b
mm_kernel_st46:
  s_add_u32 s15, s10, 0
  buffer_load_dwordx4 v[176:179], v4, s[40:43], s15 offen offset:0 sc1
  buffer_load_dwordx4 v[184:187], v4, s[40:43], s15 offen offset:1024 sc1
  buffer_load_dwordx4 v[192:195], v4, s[40:43], s15 offen offset:2048 sc1
  buffer_load_dwordx4 v[200:203], v4, s[40:43], s15 offen offset:3072 sc1
  s_add_u32 s15, s10, 4096
  buffer_load_dwordx4 v[208:211], v4, s[40:43], s15 offen offset:0 sc1
  buffer_load_dwordx4 v[128:131], v4, s[40:43], s15 offen offset:1024 sc1
  buffer_load_dwordx4 v[136:139], v4, s[40:43], s15 offen offset:2048 sc1
  s_sub_i32 s13, s13, 1
  s_cmp_lt_i32 s13, 0
  s_waitcnt vmcnt(0)
  v_max_u32 v3, v176, v178
  v_max3_u32 v3, v184, v186, v3
  v_max3_u32 v3, v192, v194, v3
  v_max3_u32 v3, v200, v202, v3
  v_max3_u32 v3, v208, v210, v3
  v_max3_u32 v3, v128, v130, v3
  v_max3_u32 v3, v136, v138, v3
  v_cmp_eq_u32 vcc, -1, v3
  s_cbranch_scc1 mm_kernel_st46_b
  s_nop 3
  s_cbranch_vccnz mm_kernel_st46
  s_branch mm_kernel_st46_b
mm_kernel_st47:
  s_add_u32 s15, s56, 0
  buffer_load_dwordx4 v[32:35], v4, s[40:43], s15 offen offset:0 sc1
  buffer_load_dwordx4 v[36:39], v4, s[40:43], s15 offen offset:1024 sc1
  buffer_load_dwordx4 v[40:43], v4, s[40:43], s15 offen offset:2048 sc1
  s_mov_b32 exec_hi, 0
  buffer_load_dwordx4 v[44:47], v4, s[40:43], s15 offen offset:3072 sc1
  s_mov_b32 exec_hi, -1
  s_sub_i32 s13, s13, 1
  s_cmp_lt_i32 s13, 0
  s_waitcnt vmcnt(0)
  v_max_u32 v3, v32, v34
  v_max3_u32 v3, v36, v38, v3
  v_max3_u32 v3, v40, v42, v3
  v_max3_u32 v3, v44, v46, v3
  v_cmp_eq_u32 vcc, -1, v3
  s_cbranch_scc1 mm_kernel_st47_b
  s_nop 3
  s_cbranch_vccnz mm_kernel_st47
  s_branch mm_kernel_st47_b
mm_kernel_fb:
  v_mov_b32 v14, 0xff800000
  s_mov_b32 s9, 2097152
mm_kernel_fb_l1:
  buffer_load_dwordx4 v[64:67], v4, s[40:43], s9 offen
  buffer_load_dwordx4 v[68:71], v4, s[40:43], s9 offen offset:1024
  s_waitcnt vmcnt(0)
  v_mfma_f32_32x32x16_bf16 v[80:95], v[64:67], v[16:19], 0
  v_mfma_f32_32x32x16_bf16 v[80:95], v[68:71], v[20:23], v[80:95]
  s_nop 11
  v_max3_f32 v14, v80, v81, v14
  v_max3_f32 v14, v82, v83, v14
  v_max3_f32 v14, v84, v85, v14
  v_max3_f32 v14, v86, v87, v14
  v_max3_f32 v14, v88, v89, v14
  v_max3_f32 v14, v90, v91, v14
  v_max3_f32 v14, v92, v93, v14
  v_max3_f32 v14, v94, v95, v14
  s_add_u32 s9, s9, 4096
  s_cmp_lt_u32 s9, 2359296
  s_cbranch_scc1 mm_kernel_fb_l1
  v_mov_b32 v8, v14
  s_nop 1
  v_permlane32_swap_b32 v14, v8
  v_max_f32 v14, v14, v8
  v_mov_b32 v48, 0
  v_mov_b32 v49, 0
  v_mov_b32 v50, 0
  v_mov_b32 v51, 0
  v_mov_b32 v52, 0
  v_mov_b32 v53, 0
  v_mov_b32 v54, 0
  v_mov_b32 v55, 0
  v_mov_b32 v56, 0
  v_mov_b32 v57, 0
  v_mov_b32 v58, 0
  v_mov_b32 v59, 0
  v_mov_b32 v60, 0
  v_mov_b32 v61, 0
  v_mov_b32 v62, 0
  v_mov_b32 v63, 0
  s_mov_b32 s9, 2097152
mm_kernel_fb_l2:
  buffer_load_dwordx4 v[64:67], v4, s[40:43], s9 offen
  buffer_load_dwordx4 v[68:71], v4, s[40:43], s9 offen offset:1024
  buffer_load_dwordx4 v[72:75], v4, s[40:43], s9 offen offset:2048
  buffer_load_dwordx4 v[76:79], v4, s[40:43], s9 offen offset:3072
  s_waitcnt vmcnt(0)
  v_mfma_f32_32x32x16_bf16 v[80:95], v[64:67], v[16:19], 0
  v_mfma_f32_32x32x16_bf16 v[80:95], v[68:71], v[20:23], v[80:95]
  s_nop 11
  v_sub_f32 v80, v80, v14
  v_sub_f32 v81, v81, v14
  v_sub_f32 v82, v82, v14
  v_sub_f32 v83, v83, v14
  v_sub_f32 v84, v84, v14
  v_sub_f32 v85, v85, v14
  v_sub_f32 v86, v86, v14
  v_sub_f32 v87, v87, v14
  v_sub_f32 v88, v88, v14
  v_sub_f32 v89, v89, v14
  v_sub_f32 v90, v90, v14
  v_sub_f32 v91, v91, v14
  v_sub_f32 v92, v92, v14
  v_sub_f32 v93, v93, v14
  v_sub_f32 v94, v94, v14
  v_sub_f32 v95, v95, v14
  v_exp_f32 v80, v80
  v_exp_f32 v81, v81
  v_exp_f32 v82, v82
  v_exp_f32 v83, v83
  v_exp_f32 v84, v84
  v_exp_f32 v85, v85
  v_exp_f32 v86, v86
  v_exp_f32 v87, v87
  v_exp_f32 v88, v88
  v_exp_f32 v89, v89
  v_exp_f32 v90, v90
  v_exp_f32 v91, v91
  v_exp_f32 v92, v92
  v_exp_f32 v93, v93
  v_exp_f32 v94, v94
  v_exp_f32 v95, v95
  v_cvt_pk_bf16_f32 v144, v80, v81
  v_cvt_pk_bf16_f32 v145, v82, v83
  v_cvt_pk_bf16_f32 v146, v84, v85
  v_cvt_pk_bf16_f32 v147, v86, v87
  v_cvt_pk_bf16_f32 v148, v88, v89
  v_cvt_pk_bf16_f32 v149, v90, v91
  v_cvt_pk_bf16_f32 v150, v92, v93
  v_cvt_pk_bf16_f32 v151, v94, v95
  v_mfma_f32_32x32x16_bf16 v[48:63], v[72:75], v[144:147], v[48:63]
  s_nop 0
  v_mfma_f32_32x32x16_bf16 v[48:63], v[76:79], v[148:151], v[48:63]
  s_add_u32 s9, s9, 4096
  s_cmp_lt_u32 s9, 2359296
  s_nop 7
  s_cbranch_scc1 mm_kernel_fb_l2
  s_nop 7
  v_mov_b32 v9, v60
  v_mov_b32 v8, v60
  s_nop 1
  v_permlane32_swap_b32 v9, v8
  v_rcp_f32 v9, v8
  s_nop 1
  s_branch mm_kernel_norm
mm_l1:
  s_bfe_u32 s4, s2, 0x20001
  s_lshl_b32 s4, s4, 6
  s_lshr_b32 s5, s2, 6
  s_lshl_b32 s5, s5, 4
  s_add_u32 s4, s4, s5
  s_and_b32 s5, s2, 1
  s_lshl_b32 s5, s5, 3
  s_add_u32 s4, s4, s5
  s_bfe_u32 s5, s2, 0x30003
  s_add_u32 s4, s4, s5
  s_lshr_b32 s5, s4, 2
  s_and_b32 s6, s4, 3
  s_lshl_b32 s6, s6, 3
  v_lshlrev_b32 v4, 4, v1
  v_and_b32 v2, 31, v1
  v_lshrrev_b32 v3, 5, v1
  s_lshl_b32 s8, s3, 16
  s_add_u32 s8, s8, 2359296
  v_lshrrev_b32 v5, 3, v2
  v_lshlrev_b32 v5, 11, v5
  v_and_b32 v6, 7, v1
  v_add_u32 v6, s6, v6
  v_lshl_add_u32 v6, v3, 5, v6
  v_lshl_add_u32 v13, v6, 4, v5
  s_lshl_b32 s7, s5, 15
  s_lshl_b32 s14, s3, 13
  s_add_u32 s49, s7, s14
  s_add_u32 s49, s49, 6815744
  s_add_u32 s7, s7, 34246656
  s_lshr_b32 s14, s2, 3
  s_and_b32 s14, s14, 0
  s_lshl_b32 s14, s14, 12
  s_add_u32 s9, s8, s14
  s_add_u32 s14, s3, 0
  s_and_b32 s14, s14, 3
  s_lshl_b32 s14, s14, 13
  s_add_u32 s20, s7, s14
  s_add_u32 s14, s3, 1
  s_and_b32 s14, s14, 3
  s_lshl_b32 s14, s14, 13
  s_add_u32 s21, s7, s14
  s_add_u32 s14, s3, 2
  s_and_b32 s14, s14, 3
  s_lshl_b32 s14, s14, 13
  s_add_u32 s22, s7, s14
  s_add_u32 s14, s3, 3
  s_and_b32 s14, s14, 3
  s_lshl_b32 s14, s14, 13
  s_add_u32 s23, s7, s14
  s_mov_b32 s36, 36343808
  s_lshr_b32 s14, s4, 4
  s_add_u32 s14, s14, 0
  s_and_b32 s32, s14, 15
  s_lshl_b32 s9, s32, 14
  s_lshl_b32 s14, s3, 12
  s_add_u32 s9, s9, s14
  s_mov_b32 s33, s9
  s_lshr_b32 s37, s4, 4
  s_lshl_b32 s37, s37, 7
  s_add_u32 s37, s37, 36343808
  s_add_u32 s24, s38, 2359296
  s_addc_u32 s25, s39, 0
  s_and_b32 s25, s25, 0xffff
  s_mov_b32 s26, 262144
  s_mov_b32 s27, 0x20000
  s_add_u32 s14, s3, 1
  s_and_b32 s14, s14, 3
  s_mul_i32 s14, s14, 12288
  s_add_u32 s14, s14, 0
  v_add_u32 v6, s14, v4
  s_xor_b32 s14, s3, 1
  s_mul_i32 s14, s14, 12288
  s_add_u32 s14, s14, 0
  v_add_u32 v10, s14, v4
  s_add_u32 s14, s3, 2
  s_and_b32 s14, s14, 3
  s_mul_i32 s14, s14, 12288
  s_add_u32 s14, s14, 4096
  v_add_u32 v7, s14, v4
  s_xor_b32 s14, s3, 2
  s_mul_i32 s14, s14, 12288
  s_add_u32 s14, s14, 4096
  v_add_u32 v11, s14, v4
  s_add_u32 s14, s3, 3
  s_and_b32 s14, s14, 3
  s_mul_i32 s14, s14, 12288
  s_add_u32 s14, s14, 8192
  v_add_u32 v8, s14, v4
  s_xor_b32 s14, s3, 3
  s_mul_i32 s14, s14, 12288
  s_add_u32 s14, s14, 8192
  v_add_u32 v12, s14, v4
  s_mul_i32 s14, s3, 12288
  v_add_u32 v5, s14, v4
  s_mov_b32 s68, s38
  s_and_b32 s69, s39, 0xffff
  s_mov_b32 s70, 36360192
  s_mov_b32 s71, 0x20000
  s_and_b32 s14, s4, 15
  s_lshl_b32 s63, s3, 12
  s_mul_i32 s64, s14, 212992
  s_add_u32 s64, s64, s63
  s_add_u32 s64, s64, 27983872
  s_add_u32 s63, s63, 49152
  s_and_b32 s15, s14, 7
  s_cmp_lt_u32 s15, 7
  s_cselect_b32 s70, s70, 0
  s_lshr_b32 s44, s4, 4
  s_add_u32 s45, s44, s15
  s_and_b32 s44, s44, 0
  s_lshl_b32 s57, s44, 15
  s_lshl_b32 s15, s15, 1
  s_and_b32 s67, s3, 1
  s_add_u32 s67, s67, s15
  s_xor_b32 s65, s67, 1
  s_lshl_b32 s46, s67, 15
  s_lshl_b32 s47, s65, 15
  s_lshl_b32 s15, s3, 13
  s_add_u32 s44, s15, 27525120
  s_add_u32 s46, s46, s44
  s_add_u32 s47, s47, s44
  s_mul_i32 s62, s67, 114688
  s_mul_i32 s65, s65, 114688
  s_mul_i32 s48, s3, 28672
  s_add_u32 s7, s48, 31391744
  s_add_u32 s62, s62, s7
  s_add_u32 s65, s65, s7
  s_lshr_b32 s44, s4, 4
  s_lshl_b32 s44, s44, 2
  s_add_u32 s6, s44, s3
  s_mul_i32 s5, s6, 28672
  s_add_u32 s5, s5, 8912896
  s_lshl_b32 s7, s6, 12
  s_add_u32 s7, s7, 10747904
  s_mul_i32 s6, s6, 112
  s_mul_i32 s13, s14, 7
  s_add_u32 s6, s6, s13
  s_lshl_b32 s6, s6, 10
  s_add_u32 s6, s6, 18350080
  s_lshr_b32 s13, s14, 3
  s_lshl_b32 s13, s13, 1
  s_add_u32 s44, s44, s13
  s_lshr_b32 s13, s3, 1
  s_add_u32 s66, s44, s13
  s_xor_b32 s11, s66, 1
  s_lshl_b32 s50, s66, 15
  s_lshl_b32 s51, s11, 15
  s_add_u32 s15, s15, 6815744
  s_add_u32 s50, s50, s15
  s_add_u32 s51, s51, s15
  s_mul_i32 s10, s66, 114688
  s_mul_i32 s11, s11, 114688
  s_add_u32 s48, s48, 18350080
  s_add_u32 s10, s10, s48
  s_add_u32 s11, s11, s48
  s_mul_i32 s12, s66, 28
  s_lshl_b32 s13, s67, 1
  s_add_u32 s12, s12, s13
  s_lshl_b32 s12, s12, 10
  s_lshl_b32 s56, s66, 12
  s_lshr_b32 s13, s67, 2
  s_lshl_b32 s13, s13, 10
  s_add_u32 s56, s56, s13
  s_bfe_u32 s13, s67, 0x10001
  s_lshl_b32 s13, s13, 9
  s_add_u32 s56, s56, s13
  s_and_b32 s13, s67, 1
  s_lshl_b32 s13, s13, 3
  s_add_u32 s56, s56, s13
  s_add_u32 s56, s56, 10747904
  s_mov_b32 s13, 200000
  s_mov_b32 s61, 0xffff0000
  v_mov_b32 v248, -1
  v_mov_b32 v249, -1
  v_mov_b32 v250, -1
  v_mov_b32 v251, -1
  s_add_u32 s14, s45, 0
  s_and_b32 s14, s14, 3
  s_mul_i32 s52, s14, 0
  s_mov_b32 s52, 0
  s_add_u32 s14, s45, 1
  s_and_b32 s14, s14, 3
  s_mul_i32 s53, s14, 0
  s_mov_b32 s53, 7168
  s_add_u32 s14, s45, 2
  s_and_b32 s14, s14, 3
  s_mul_i32 s54, s14, 0
  s_mov_b32 s54, 14336
  s_add_u32 s14, s45, 3
  s_and_b32 s14, s14, 3
  s_mul_i32 s55, s14, 0
  s_mov_b32 s55, 21504
  s_mov_b32 s14, 0x21800000
  s_mov_b32 s15, 0x5d800000
  s_mov_b32 s13, 200000
  s_waitcnt vmcnt(0) lgkmcnt(0)
  v_sub_u32 v15, 15, v1
  v_and_b32 v15, 0x40000000, v15
  v_lshl_add_u32 v15, v1, 7, v15
  s_mov_b32 s28, 0
  v_mov_b32 v255, 0
  v_mov_b32 v253, 1
  s_barrier
  s_cmp_lg_u32 s3, 0
  s_cbranch_scc1 mm_l1_nf
  s_mov_b64 exec, 1
  buffer_atomic_add v253, v255, s[40:43], s37 offen offset:2048 sc0 sc1
  s_mov_b64 exec, -1
mm_l1_nf:
  buffer_load_dwordx4 a[0:3], v4, s[24:27], s9 offen offset:0 sc1
  buffer_load_dwordx4 a[4:7], v4, s[24:27], s9 offen offset:1024 sc1
  buffer_load_dwordx4 v[24:27], v13, s[40:43], s21 offen offset:0 sc1
  buffer_load_dwordx4 v[28:31], v13, s[40:43], s21 offen offset:1024 sc1
  buffer_load_dwordx4 v[32:35], v13, s[40:43], s22 offen offset:0 sc1
  buffer_load_dwordx4 v[36:39], v13, s[40:43], s22 offen offset:1024 sc1
  buffer_load_dwordx4 a[8:11], v4, s[24:27], s9 offen offset:2048 sc1
  buffer_load_dwordx4 a[12:15], v4, s[24:27], s9 offen offset:3072 sc1
  buffer_load_dwordx4 v[40:43], v13, s[40:43], s23 offen offset:0 sc1
  buffer_load_dwordx4 v[44:47], v13, s[40:43], s23 offen offset:1024 sc1
  buffer_load_dwordx4 v[16:19], v13, s[40:43], s20 offen offset:0 sc1
  buffer_load_dwordx4 v[20:23], v13, s[40:43], s20 offen offset:1024 sc1
  s_add_u32 m0, s63, s57
  s_add_u32 s48, s64, s57
  s_waitcnt vmcnt(10)
  s_waitcnt vmcnt(8)
  v_max_u32 v3, v24, v26
  v_max3_u32 v3, v28, v30, v3
  v_accvgpr_read_b32 v2, a0
  v_accvgpr_read_b32 v254, a2
  v_max3_u32 v3, v2, v254, v3
  v_accvgpr_read_b32 v2, a4
  v_accvgpr_read_b32 v254, a6
  v_max3_u32 v3, v2, v254, v3
  v_cmp_eq_u32 vcc, -1, v3
  s_nop 4
  s_cbranch_vccnz mm_l1_st48
mm_l1_st48_b:
  s_cmp_lg_u32 s3, 0
  s_cbranch_scc1 mm_l1_nf49
  v_readfirstlane_b32 s29, v253
  s_nop 0
  s_cmp_lg_u32 s29, 15
  s_cbranch_scc1 mm_l1_nf49
  s_mov_b64 exec, 1
  buffer_store_dword v255, v255, s[40:43], s37 offen sc1
  v_mov_b32 v253, 0
  s_mov_b64 exec, -1
mm_l1_nf49:
  v_mfma_f32_32x32x16_bf16 v[112:127], a[0:3], v[24:27], 0
  s_add_u32 s9, s9, 16384
  s_and_b32 s9, s9, 0x3ffff
  buffer_load_dwordx4 a[16:19], v4, s[24:27], s9 offen offset:0 sc1
  buffer_load_dwordx4 a[20:23], v4, s[24:27], s9 offen offset:1024 sc1
  v_mfma_f32_32x32x16_bf16 v[112:127], a[4:7], v[28:31], v[112:127]
  buffer_load_dwordx4 a[24:27], v4, s[24:27], s9 offen offset:2048 sc1
  buffer_load_dwordx4 a[28:31], v4, s[24:27], s9 offen offset:3072 sc1
  s_nop 7
  s_waitcnt vmcnt(10)
  v_max_u32 v3, v32, v34
  v_max3_u32 v3, v36, v38, v3
  v_cmp_eq_u32 vcc, -1, v3
  s_nop 4
  s_cbranch_vccnz mm_l1_st50
mm_l1_st50_b:
  v_mfma_f32_32x32x16_bf16 v[128:143], a[0:3], v[32:35], 0
  s_add_u32 s9, s9, 16384
  s_and_b32 s9, s9, 0x3ffff
  buffer_load_dwordx4 a[32:35], v4, s[24:27], s9 offen offset:0 sc1
  v_exp_f32 v112, v112
  v_exp_f32 v113, v113
  v_exp_f32 v114, v114
  v_exp_f32 v115, v115
  buffer_load_dwordx4 v4, s[40:43], s48 offen offset:0 lds
  v_exp_f32 v116, v116
  v_exp_f32 v117, v117
  v_exp_f32 v118, v118
  v_exp_f32 v119, v119
  v_mfma_f32_32x32x16_bf16 v[128:143], a[4:7], v[36:39], v[128:143]
  v_cvt_pk_bf16_f32 v144, v112, v113
  v_cvt_pk_bf16_f32 v145, v114, v115
  v_cvt_pk_bf16_f32 v146, v116, v117
  v_cvt_pk_bf16_f32 v147, v118, v119
  v_exp_f32 v120, v120
  v_exp_f32 v121, v121
  v_exp_f32 v122, v122
  s_waitcnt vmcnt(10)
  v_accvgpr_read_b32 v2, a8
  v_accvgpr_read_b32 v254, a10
  v_max_u32 v3, v2, v254
  v_accvgpr_read_b32 v2, a12
  v_accvgpr_read_b32 v254, a14
  v_max3_u32 v3, v2, v254, v3
  v_cmp_eq_u32 vcc, -1, v3
  s_nop 4
  s_cbranch_vccnz mm_l1_st51
mm_l1_st51_b:
  v_mfma_f32_32x32x16_bf16 v[64:79], a[8:11], v[144:147], 0
  s_add_u32 s44, s6, 0
  buffer_store_dwordx4 v[248:251], v4, s[40:43], s44 offen sc1
  v_exp_f32 v123, v123
  v_exp_f32 v124, v124
  v_exp_f32 v125, v125
  v_exp_f32 v126, v126
  v_exp_f32 v127, v127
  v_cvt_pk_bf16_f32 v148, v120, v121
  v_cvt_pk_bf16_f32 v149, v122, v123
  v_cvt_pk_bf16_f32 v150, v124, v125
  v_cvt_pk_bf16_f32 v151, v126, v127
  s_waitcnt vmcnt(9)
  v_max_u32 v3, v40, v42
  v_max3_u32 v3, v44, v46, v3
  v_cmp_eq_u32 vcc, -1, v3
  s_nop 4
  s_cbranch_vccnz mm_l1_st52
mm_l1_st52_b:
  v_mfma_f32_32x32x16_bf16 v[112:127], a[0:3], v[40:43], 0
  buffer_load_dwordx4 a[36:39], v4, s[24:27], s9 offen offset:1024 sc1
  v_exp_f32 v128, v128
  v_exp_f32 v129, v129
  v_exp_f32 v130, v130
  v_exp_f32 v131, v131
  v_mfma_f32_32x32x16_bf16 v[64:79], a[12:15], v[148:151], v[64:79]
  buffer_load_dwordx4 v4, s[40:43], s48 offen offset:1024 lds
  v_exp_f32 v132, v132
  v_exp_f32 v133, v133
  v_exp_f32 v134, v134
  v_exp_f32 v135, v135
  v_mfma_f32_32x32x16_bf16 v[112:127], a[4:7], v[44:47], v[112:127]
  v_cvt_pk_bf16_f32 v144, v128, v129
  v_cvt_pk_bf16_f32 v145, v130, v131
  v_cvt_pk_bf16_f32 v146, v132, v133
  v_cvt_pk_bf16_f32 v147, v134, v135
  v_exp_f32 v136, v136
  v_exp_f32 v137, v137
  v_exp_f32 v138, v138
  v_mfma_f32_32x32x16_bf16 v[80:95], a[8:11], v[144:147], 0
  v_exp_f32 v139, v139
  v_exp_f32 v140, v140
  v_exp_f32 v141, v141
  v_exp_f32 v142, v142
  v_exp_f32 v143, v143
  v_cvt_pk_bf16_f32 v148, v136, v137
  v_cvt_pk_bf16_f32 v149, v138, v139
  v_cvt_pk_bf16_f32 v150, v140, v141
  v_cvt_pk_bf16_f32 v151, v142, v143
  s_waitcnt vmcnt(9)
  v_max_u32 v3, v16, v18
  v_max3_u32 v3, v20, v22, v3
  v_cmp_eq_u32 vcc, -1, v3
  s_nop 4
  s_cbranch_vccnz mm_l1_st53
mm_l1_st53_b:
  v_mfma_f32_32x32x16_bf16 v[128:143], a[0:3], v[16:19], 0
  buffer_load_dwordx4 a[40:43], v4, s[24:27], s9 offen offset:2048 sc1
  v_exp_f32 v112, v112
  v_exp_f32 v113, v113
  v_exp_f32 v114, v114
  v_exp_f32 v115, v115
  v_mfma_f32_32x32x16_bf16 v[80:95], a[12:15], v[148:151], v[80:95]
  buffer_load_dwordx4 v4, s[40:43], s48 offen offset:2048 lds
  v_exp_f32 v116, v116
  v_exp_f32 v117, v117
  v_exp_f32 v118, v118
  v_exp_f32 v119, v119
  v_mfma_f32_32x32x16_bf16 v[128:143], a[4:7], v[20:23], v[128:143]
  v_cvt_pk_bf16_f32 v144, v112, v113
  v_cvt_pk_bf16_f32 v145, v114, v115
  v_cvt_pk_bf16_f32 v146, v116, v117
  v_cvt_pk_bf16_f32 v147, v118, v119
  v_exp_f32 v120, v120
  v_exp_f32 v121, v121
  v_exp_f32 v122, v122
  v_mfma_f32_32x32x16_bf16 v[96:111], a[8:11], v[144:147], 0
  v_exp_f32 v123, v123
  v_exp_f32 v124, v124
  v_exp_f32 v125, v125
  v_exp_f32 v126, v126
  v_exp_f32 v127, v127
  v_cvt_pk_bf16_f32 v148, v120, v121
  v_cvt_pk_bf16_f32 v149, v122, v123
  v_cvt_pk_bf16_f32 v150, v124, v125
  v_cvt_pk_bf16_f32 v151, v126, v127
  s_waitcnt vmcnt(7)
  v_accvgpr_read_b32 v2, a16
  v_accvgpr_read_b32 v254, a18
  v_max_u32 v3, v2, v254
  v_accvgpr_read_b32 v2, a20
  v_accvgpr_read_b32 v254, a22
  v_max3_u32 v3, v2, v254, v3
  v_accvgpr_read_b32 v2, a24
  v_accvgpr_read_b32 v254, a26
  v_max3_u32 v3, v2, v254, v3
  v_accvgpr_read_b32 v2, a28
  v_accvgpr_read_b32 v254, a30
  v_max3_u32 v3, v2, v254, v3
  v_cmp_eq_u32 vcc, -1, v3
  s_nop 4
  s_cbranch_vccnz mm_l1_st54
mm_l1_st54_b:
  v_mfma_f32_32x32x16_bf16 v[112:127], a[16:19], v[24:27], 0
  buffer_load_dwordx4 a[44:47], v4, s[24:27], s9 offen offset:3072 sc1
  v_exp_f32 v128, v128
  v_exp_f32 v129, v129
  v_exp_f32 v130, v130
  v_exp_f32 v131, v131
  v_mfma_f32_32x32x16_bf16 v[96:111], a[12:15], v[148:151], v[96:111]
  buffer_load_dwordx4 v4, s[40:43], s48 offen offset:3072 lds
  v_exp_f32 v132, v132
  v_exp_f32 v133, v133
  v_exp_f32 v134, v134
  v_exp_f32 v135, v135
  v_mfma_f32_32x32x16_bf16 v[112:127], a[20:23], v[28:31], v[112:127]
  s_add_u32 s57, s57, 16384
  s_cmp_eq_u32 s57, 114688
  s_cselect_b32 s57, 0, s57
  s_add_u32 m0, s63, s57
  s_add_u32 s48, s64, s57
  v_cvt_pk_bf16_f32 v144, v128, v129
  v_cvt_pk_bf16_f32 v145, v130, v131
  v_cvt_pk_bf16_f32 v146, v132, v133
  v_cvt_pk_bf16_f32 v147, v134, v135
  v_exp_f32 v136, v136
  v_exp_f32 v137, v137
  v_exp_f32 v138, v138
  v_mfma_f32_32x32x16_bf16 v[48:63], a[8:11], v[144:147], 0
  v_exp_f32 v139, v139
  v_exp_f32 v140, v140
  v_exp_f32 v141, v141
  v_exp_f32 v142, v142
  v_exp_f32 v143, v143
  v_cvt_pk_bf16_f32 v148, v136, v137
  v_cvt_pk_bf16_f32 v149, v138, v139
  v_cvt_pk_bf16_f32 v150, v140, v141
  v_cvt_pk_bf16_f32 v151, v142, v143
  v_mfma_f32_32x32x16_bf16 v[128:143], a[16:19], v[32:35], 0
  s_add_u32 s9, s9, 16384
  s_and_b32 s9, s9, 0x3ffff
  buffer_load_dwordx4 a[48:51], v4, s[24:27], s9 offen offset:0 sc1
  buffer_load_dwordx4 a[52:55], v4, s[24:27], s9 offen offset:1024 sc1
  v_exp_f32 v112, v112
  v_exp_f32 v113, v113
  v_exp_f32 v114, v114
  v_exp_f32 v115, v115
  v_mfma_f32_32x32x16_bf16 v[48:63], a[12:15], v[148:151], v[48:63]
  buffer_load_dwordx4 v4, s[40:43], s48 offen offset:0 lds
  v_exp_f32 v116, v116
  v_exp_f32 v117, v117
  v_exp_f32 v118, v118
  v_exp_f32 v119, v119
  v_mfma_f32_32x32x16_bf16 v[128:143], a[20:23], v[36:39], v[128:143]
  v_cvt_pk_bf16_f32 v144, v112, v113
  v_cvt_pk_bf16_f32 v145, v114, v115
  v_cvt_pk_bf16_f32 v146, v116, v117
  v_cvt_pk_bf16_f32 v147, v118, v119
  v_exp_f32 v120, v120
  v_exp_f32 v121, v121
  v_exp_f32 v122, v122
  v_mfma_f32_32x32x16_bf16 v[64:79], a[24:27], v[144:147], v[64:79]
  s_add_u32 s44, s6, 1024
  buffer_store_dwordx4 v[248:251], v4, s[40:43], s44 offen sc1
  v_exp_f32 v123, v123
  v_exp_f32 v124, v124
  v_exp_f32 v125, v125
  v_exp_f32 v126, v126
  v_exp_f32 v127, v127
  v_cvt_pk_bf16_f32 v148, v120, v121
  v_cvt_pk_bf16_f32 v149, v122, v123
  v_cvt_pk_bf16_f32 v150, v124, v125
  v_cvt_pk_bf16_f32 v151, v126, v127
  v_mfma_f32_32x32x16_bf16 v[112:127], a[16:19], v[40:43], 0
  buffer_load_dwordx4 a[56:59], v4, s[24:27], s9 offen offset:2048 sc1
  buffer_load_dwordx4 a[60:63], v4, s[24:27], s9 offen offset:3072 sc1
  v_exp_f32 v128, v128
  v_exp_f32 v129, v129
  v_exp_f32 v130, v130
  v_exp_f32 v131, v131
  v_mfma_f32_32x32x16_bf16 v[64:79], a[28:31], v[148:151], v[64:79]
  buffer_load_dwordx4 v4, s[40:43], s48 offen offset:1024 lds
  v_exp_f32 v132, v132
  v_exp_f32 v133, v133
  v_exp_f32 v134, v134
  v_exp_f32 v135, v135
  v_mfma_f32_32x32x16_bf16 v[112:127], a[20:23], v[44:47], v[112:127]
  v_cvt_pk_bf16_f32 v144, v128, v129
  v_cvt_pk_bf16_f32 v145, v130, v131
  v_cvt_pk_bf16_f32 v146, v132, v133
  v_cvt_pk_bf16_f32 v147, v134, v135
  v_exp_f32 v136, v136
  v_exp_f32 v137, v137
  v_exp_f32 v138, v138
  v_mfma_f32_32x32x16_bf16 v[80:95], a[24:27], v[144:147], v[80:95]
  v_exp_f32 v139, v139
  v_exp_f32 v140, v140
  v_exp_f32 v141, v141
  v_exp_f32 v142, v142
  v_exp_f32 v143, v143
  v_cvt_pk_bf16_f32 v148, v136, v137
  v_cvt_pk_bf16_f32 v149, v138, v139
  v_cvt_pk_bf16_f32 v150, v140, v141
  v_cvt_pk_bf16_f32 v151, v142, v143
  v_mfma_f32_32x32x16_bf16 v[128:143], a[16:19], v[16:19], 0
  s_add_u32 s9, s9, 16384
  s_and_b32 s9, s9, 0x3ffff
  buffer_load_dwordx4 a[0:3], v4, s[24:27], s9 offen offset:0 sc1
  buffer_load_dwordx4 a[4:7], v4, s[24:27], s9 offen offset:1024 sc1
  v_exp_f32 v112, v112
  v_exp_f32 v113, v113
  v_exp_f32 v114, v114
  v_exp_f32 v115, v115
  v_mfma_f32_32x32x16_bf16 v[80:95], a[28:31], v[148:151], v[80:95]
  buffer_load_dwordx4 v4, s[40:43], s48 offen offset:2048 lds
  v_exp_f32 v116, v116
  v_exp_f32 v117, v117
  v_exp_f32 v118, v118
  v_exp_f32 v119, v119
  v_mfma_f32_32x32x16_bf16 v[128:143], a[20:23], v[20:23], v[128:143]
  v_cvt_pk_bf16_f32 v144, v112, v113
  v_cvt_pk_bf16_f32 v145, v114, v115
  v_cvt_pk_bf16_f32 v146, v116, v117
  v_cvt_pk_bf16_f32 v147, v118, v119
  v_exp_f32 v120, v120
  v_exp_f32 v121, v121
  v_exp_f32 v122, v122
  v_mfma_f32_32x32x16_bf16 v[96:111], a[24:27], v[144:147], v[96:111]
  v_exp_f32 v123, v123
  v_exp_f32 v124, v124
  v_exp_f32 v125, v125
  v_exp_f32 v126, v126
  v_exp_f32 v127, v127
  v_cvt_pk_bf16_f32 v148, v120, v121
  v_cvt_pk_bf16_f32 v149, v122, v123
  v_cvt_pk_bf16_f32 v150, v124, v125
  v_cvt_pk_bf16_f32 v151, v126, v127
  s_waitcnt vmcnt(11)
  v_accvgpr_read_b32 v2, a32
  v_accvgpr_read_b32 v254, a34
  v_max_u32 v3, v2, v254
  v_accvgpr_read_b32 v2, a36
  v_accvgpr_read_b32 v254, a38
  v_max3_u32 v3, v2, v254, v3
  v_accvgpr_read_b32 v2, a40
  v_accvgpr_read_b32 v254, a42
  v_max3_u32 v3, v2, v254, v3
  v_accvgpr_read_b32 v2, a44
  v_accvgpr_read_b32 v254, a46
  v_max3_u32 v3, v2, v254, v3
  v_cmp_eq_u32 vcc, -1, v3
  s_nop 4
  s_cbranch_vccnz mm_l1_st55
mm_l1_st55_b:
  v_mfma_f32_32x32x16_bf16 v[112:127], a[32:35], v[24:27], 0
  buffer_load_dwordx4 a[8:11], v4, s[24:27], s9 offen offset:2048 sc1
  buffer_load_dwordx4 a[12:15], v4, s[24:27], s9 offen offset:3072 sc1
  v_exp_f32 v128, v128
  v_exp_f32 v129, v129
  v_exp_f32 v130, v130
  v_exp_f32 v131, v131
  v_mfma_f32_32x32x16_bf16 v[96:111], a[28:31], v[148:151], v[96:111]
  buffer_load_dwordx4 v4, s[40:43], s48 offen offset:3072 lds
  v_exp_f32 v132, v132
  v_exp_f32 v133, v133
  v_exp_f32 v134, v134
  v_exp_f32 v135, v135
  v_mfma_f32_32x32x16_bf16 v[112:127], a[36:39], v[28:31], v[112:127]
  s_add_u32 s57, s57, 16384
  s_cmp_eq_u32 s57, 114688
  s_cselect_b32 s57, 0, s57
  s_add_u32 m0, s63, s57
  s_add_u32 s48, s64, s57
  v_cvt_pk_bf16_f32 v144, v128, v129
  v_cvt_pk_bf16_f32 v145, v130, v131
  v_cvt_pk_bf16_f32 v146, v132, v133
  v_cvt_pk_bf16_f32 v147, v134, v135
  v_exp_f32 v136, v136
  v_exp_f32 v137, v137
  v_exp_f32 v138, v138
  v_mfma_f32_32x32x16_bf16 v[48:63], a[24:27], v[144:147], v[48:63]
  v_exp_f32 v139, v139
  v_exp_f32 v140, v140
  v_exp_f32 v141, v141
  v_exp_f32 v142, v142
  v_exp_f32 v143, v143
  v_cvt_pk_bf16_f32 v148, v136, v137
  v_cvt_pk_bf16_f32 v149, v138, v139
  v_cvt_pk_bf16_f32 v150, v140, v141
  v_cvt_pk_bf16_f32 v151, v142, v143
  v_mfma_f32_32x32x16_bf16 v[128:143], a[32:35], v[32:35], 0
  s_add_u32 s9, s9, 16384
  s_and_b32 s9, s9, 0x3ffff
  buffer_load_dwordx4 a[16:19], v4, s[24:27], s9 offen offset:0 sc1
  v_exp_f32 v112, v112
  v_exp_f32 v113, v113
  v_exp_f32 v114, v114
  v_exp_f32 v115, v115
  v_mfma_f32_32x32x16_bf16 v[48:63], a[28:31], v[148:151], v[48:63]
  buffer_load_dwordx4 v4, s[40:43], s48 offen offset:0 lds
  v_exp_f32 v116, v116
  v_exp_f32 v117, v117
  v_exp_f32 v118, v118
  v_exp_f32 v119, v119
  v_mfma_f32_32x32x16_bf16 v[128:143], a[36:39], v[36:39], v[128:143]
  v_cvt_pk_bf16_f32 v144, v112, v113
  v_cvt_pk_bf16_f32 v145, v114, v115
  v_cvt_pk_bf16_f32 v146, v116, v117
  v_cvt_pk_bf16_f32 v147, v118, v119
  v_exp_f32 v120, v120
  v_exp_f32 v121, v121
  v_exp_f32 v122, v122
  v_mfma_f32_32x32x16_bf16 v[64:79], a[40:43], v[144:147], v[64:79]
  buffer_load_dword v252, v15, s[40:43], s36 offen sc1
  s_add_u32 s44, s6, 2048
  buffer_store_dwordx4 v[248:251], v4, s[40:43], s44 offen sc1
  v_exp_f32 v123, v123
  v_exp_f32 v124, v124
  v_exp_f32 v125, v125
  v_exp_f32 v126, v126
  v_exp_f32 v127, v127
  v_cvt_pk_bf16_f32 v148, v120, v121
  v_cvt_pk_bf16_f32 v149, v122, v123
  v_cvt_pk_bf16_f32 v150, v124, v125
  v_cvt_pk_bf16_f32 v151, v126, v127
  v_mfma_f32_32x32x16_bf16 v[112:127], a[32:35], v[40:43], 0
  buffer_load_dwordx4 a[20:23], v4, s[24:27], s9 offen offset:1024 sc1
  v_exp_f32 v128, v128
  v_exp_f32 v129, v129
  v_exp_f32 v130, v130
  v_exp_f32 v131, v131
  v_mfma_f32_32x32x16_bf16 v[64:79], a[44:47], v[148:151], v[64:79]
  buffer_load_dwordx4 v4, s[40:43], s48 offen offset:1024 lds
  v_exp_f32 v132, v132
  v_exp_f32 v133, v133
  v_exp_f32 v134, v134
  v_exp_f32 v135, v135
  v_mfma_f32_32x32x16_bf16 v[112:127], a[36:39], v[44:47], v[112:127]
  v_cvt_pk_bf16_f32 v144, v128, v129
  v_cvt_pk_bf16_f32 v145, v130, v131
  v_cvt_pk_bf16_f32 v146, v132, v133
  v_cvt_pk_bf16_f32 v147, v134, v135
  v_exp_f32 v136, v136
  v_exp_f32 v137, v137
  v_exp_f32 v138, v138
  v_mfma_f32_32x32x16_bf16 v[80:95], a[40:43], v[144:147], v[80:95]
  v_exp_f32 v139, v139
  v_exp_f32 v140, v140
  v_exp_f32 v141, v141
  v_exp_f32 v142, v142
  v_exp_f32 v143, v143
  v_cvt_pk_bf16_f32 v148, v136, v137
  v_cvt_pk_bf16_f32 v149, v138, v139
  v_cvt_pk_bf16_f32 v150, v140, v141
  v_cvt_pk_bf16_f32 v151, v142, v143
  v_mfma_f32_32x32x16_bf16 v[128:143], a[32:35], v[16:19], 0
  buffer_load_dwordx4 a[24:27], v4, s[24:27], s9 offen offset:2048 sc1
  v_exp_f32 v112, v112
  v_exp_f32 v113, v113
  v_exp_f32 v114, v114
  v_exp_f32 v115, v115
  v_mfma_f32_32x32x16_bf16 v[80:95], a[44:47], v[148:151], v[80:95]
  buffer_load_dwordx4 v4, s[40:43], s48 offen offset:2048 lds
  v_exp_f32 v116, v116
  v_exp_f32 v117, v117
  v_exp_f32 v118, v118
  v_exp_f32 v119, v119
  v_mfma_f32_32x32x16_bf16 v[128:143], a[36:39], v[20:23], v[128:143]
  v_cvt_pk_bf16_f32 v144, v112, v113
  v_cvt_pk_bf16_f32 v145, v114, v115
  v_cvt_pk_bf16_f32 v146, v116, v117
  v_cvt_pk_bf16_f32 v147, v118, v119
  v_exp_f32 v120, v120
  v_exp_f32 v121, v121
  v_exp_f32 v122, v122
  v_mfma_f32_32x32x16_bf16 v[96:111], a[40:43], v[144:147], v[96:111]
  v_exp_f32 v123, v123
  v_exp_f32 v124, v124
  v_exp_f32 v125, v125
  v_exp_f32 v126, v126
  v_exp_f32 v127, v127
  v_cvt_pk_bf16_f32 v148, v120, v121
  v_cvt_pk_bf16_f32 v149, v122, v123
  v_cvt_pk_bf16_f32 v150, v124, v125
  v_cvt_pk_bf16_f32 v151, v126, v127
  s_waitcnt vmcnt(15)
  v_accvgpr_read_b32 v2, a48
  v_accvgpr_read_b32 v254, a50
  v_max_u32 v3, v2, v254
  v_accvgpr_read_b32 v2, a52
  v_accvgpr_read_b32 v254, a54
  v_max3_u32 v3, v2, v254, v3
  v_accvgpr_read_b32 v2, a56
  v_accvgpr_read_b32 v254, a58
  v_max3_u32 v3, v2, v254, v3
  v_accvgpr_read_b32 v2, a60
  v_accvgpr_read_b32 v254, a62
  v_max3_u32 v3, v2, v254, v3
  v_cmp_eq_u32 vcc, -1, v3
  s_nop 4
  s_cbranch_vccnz mm_l1_st56
mm_l1_st56_b:
  v_mfma_f32_32x32x16_bf16 v[112:127], a[48:51], v[24:27], 0
  buffer_load_dwordx4 a[28:31], v4, s[24:27], s9 offen offset:3072 sc1
  v_exp_f32 v128, v128
  v_exp_f32 v129, v129
  v_exp_f32 v130, v130
  v_exp_f32 v131, v131
  v_mfma_f32_32x32x16_bf16 v[96:111], a[44:47], v[148:151], v[96:111]
  buffer_load_dwordx4 v4, s[40:43], s48 offen offset:3072 lds
  v_exp_f32 v132, v132
  v_exp_f32 v133, v133
  v_exp_f32 v134, v134
  v_exp_f32 v135, v135
  v_mfma_f32_32x32x16_bf16 v[112:127], a[52:55], v[28:31], v[112:127]
  s_add_u32 s57, s57, 16384
  s_cmp_eq_u32 s57, 114688
  s_cselect_b32 s57, 0, s57
  s_add_u32 m0, s63, s57
  s_add_u32 s48, s64, s57
  v_cvt_pk_bf16_f32 v144, v128, v129
  v_cvt_pk_bf16_f32 v145, v130, v131
  v_cvt_pk_bf16_f32 v146, v132, v133
  v_cvt_pk_bf16_f32 v147, v134, v135
  v_exp_f32 v136, v136
  v_exp_f32 v137, v137
  v_exp_f32 v138, v138
  s_waitcnt vmcnt(7)
  v_cmp_eq_u32 vcc, 0, v252
  s_nop 0
  s_and_b32 s28, vcc_lo, 0xffff
  s_lshl_b32 s29, s28, 16
  s_or_b32 s28, s28, s29
  s_lshr_b32 s28, s28, s32
  v_mfma_f32_32x32x16_bf16 v[48:63], a[40:43], v[144:147], v[48:63]
  v_exp_f32 v139, v139
  v_exp_f32 v140, v140
  v_exp_f32 v141, v141
  v_exp_f32 v142, v142
  v_exp_f32 v143, v143
  v_cvt_pk_bf16_f32 v148, v136, v137
  v_cvt_pk_bf16_f32 v149, v138, v139
  v_cvt_pk_bf16_f32 v150, v140, v141
  v_cvt_pk_bf16_f32 v151, v142, v143
  v_mfma_f32_32x32x16_bf16 v[128:143], a[48:51], v[32:35], 0
  s_add_u32 s9, s9, 16384
  s_and_b32 s9, s9, 0x3ffff
  s_bitcmp1_b32 s28, 6
  s_cbranch_scc0 mm_l1_tw57
mm_l1_tw57_b:
  buffer_load_dwordx4 a[32:35], v4, s[24:27], s9 offen offset:0
  v_exp_f32 v112, v112
  v_exp_f32 v113, v113
  v_exp_f32 v114, v114
  v_exp_f32 v115, v115
  v_mfma_f32_32x32x16_bf16 v[48:63], a[44:47], v[148:151], v[48:63]
  buffer_load_dwordx4 v4, s[40:43], s48 offen offset:0 lds
  v_exp_f32 v116, v116
  v_exp_f32 v117, v117
  v_exp_f32 v118, v118
  v_exp_f32 v119, v119
  v_mfma_f32_32x32x16_bf16 v[128:143], a[52:55], v[36:39], v[128:143]
  v_cvt_pk_bf16_f32 v144, v112, v113
  v_cvt_pk_bf16_f32 v145, v114, v115
  v_cvt_pk_bf16_f32 v146, v116, v117
  v_cvt_pk_bf16_f32 v147, v118, v119
  v_exp_f32 v120, v120
  v_exp_f32 v121, v121
  v_exp_f32 v122, v122
  v_mfma_f32_32x32x16_bf16 v[64:79], a[56:59], v[144:147], v[64:79]
  s_add_u32 s44, s6, 3072
  buffer_store_dwordx4 v[248:251], v4, s[40:43], s44 offen sc1
  v_exp_f32 v123, v123
  v_exp_f32 v124, v124
  v_exp_f32 v125, v125
  v_exp_f32 v126, v126
  v_exp_f32 v127, v127
  v_cvt_pk_bf16_f32 v148, v120, v121
  v_cvt_pk_bf16_f32 v149, v122, v123
  v_cvt_pk_bf16_f32 v150, v124, v125
  v_cvt_pk_bf16_f32 v151, v126, v127
  v_mfma_f32_32x32x16_bf16 v[112:127], a[48:51], v[40:43], 0
  buffer_load_dwordx4 a[36:39], v4, s[24:27], s9 offen offset:1024
  v_exp_f32 v128, v128
  v_exp_f32 v129, v129
  v_exp_f32 v130, v130
  v_exp_f32 v131, v131
  v_mfma_f32_32x32x16_bf16 v[64:79], a[60:63], v[148:151], v[64:79]
  buffer_load_dwordx4 v4, s[40:43], s48 offen offset:1024 lds
  v_exp_f32 v132, v132
  v_exp_f32 v133, v133
  v_exp_f32 v134, v134
  v_exp_f32 v135, v135
  v_mfma_f32_32x32x16_bf16 v[112:127], a[52:55], v[44:47], v[112:127]
  v_cvt_pk_bf16_f32 v144, v128, v129
  v_cvt_pk_bf16_f32 v145, v130, v131
  v_cvt_pk_bf16_f32 v146, v132, v133
  v_cvt_pk_bf16_f32 v147, v134, v135
  v_exp_f32 v136, v136
  v_exp_f32 v137, v137
  v_exp_f32 v138, v138
  v_mfma_f32_32x32x16_bf16 v[80:95], a[56:59], v[144:147], v[80:95]
  v_exp_f32 v139, v139
  v_exp_f32 v140, v140
  v_exp_f32 v141, v141
  v_exp_f32 v142, v142
  v_exp_f32 v143, v143
  v_cvt_pk_bf16_f32 v148, v136, v137
  v_cvt_pk_bf16_f32 v149, v138, v139
  v_cvt_pk_bf16_f32 v150, v140, v141
  v_cvt_pk_bf16_f32 v151, v142, v143
  v_mfma_f32_32x32x16_bf16 v[128:143], a[48:51], v[16:19], 0
  buffer_load_dwordx4 a[40:43], v4, s[24:27], s9 offen offset:2048
  v_exp_f32 v112, v112
  v_exp_f32 v113, v113
  v_exp_f32 v114, v114
  v_exp_f32 v115, v115
  v_mfma_f32_32x32x16_bf16 v[80:95], a[60:63], v[148:151], v[80:95]
  buffer_load_dwordx4 v4, s[40:43], s48 offen offset:2048 lds
  v_exp_f32 v116, v116
  v_exp_f32 v117, v117
  v_exp_f32 v118, v118
  v_exp_f32 v119, v119
  v_mfma_f32_32x32x16_bf16 v[128:143], a[52:55], v[20:23], v[128:143]
  v_cvt_pk_bf16_f32 v144, v112, v113
  v_cvt_pk_bf16_f32 v145, v114, v115
  v_cvt_pk_bf16_f32 v146, v116, v117
  v_cvt_pk_bf16_f32 v147, v118, v119
  v_exp_f32 v120, v120
  v_exp_f32 v121, v121
  v_exp_f32 v122, v122
  v_mfma_f32_32x32x16_bf16 v[96:111], a[56:59], v[144:147], v[96:111]
  v_exp_f32 v123, v123
  v_exp_f32 v124, v124
  v_exp_f32 v125, v125
  v_exp_f32 v126, v126
  v_exp_f32 v127, v127
  v_cvt_pk_bf16_f32 v148, v120, v121
  v_cvt_pk_bf16_f32 v149, v122, v123
  v_cvt_pk_bf16_f32 v150, v124, v125
  v_cvt_pk_bf16_f32 v151, v126, v127
  v_accvgpr_read_b32 v2, a0
  v_accvgpr_read_b32 v254, a2
  v_max_u32 v3, v2, v254
  v_accvgpr_read_b32 v2, a4
  v_accvgpr_read_b32 v254, a6
  v_max3_u32 v3, v2, v254, v3
  v_accvgpr_read_b32 v2, a8
  v_accvgpr_read_b32 v254, a10
  v_max3_u32 v3, v2, v254, v3
  v_accvgpr_read_b32 v2, a12
  v_accvgpr_read_b32 v254, a14
  v_max3_u32 v3, v2, v254, v3
  v_cmp_eq_u32 vcc, -1, v3
  s_nop 4
  s_cbranch_vccnz mm_l1_st58
mm_l1_st58_b:
  v_mfma_f32_32x32x16_bf16 v[112:127], a[0:3], v[24:27], 0
  buffer_load_dwordx4 a[44:47], v4, s[24:27], s9 offen offset:3072
  v_exp_f32 v128, v128
  v_exp_f32 v129, v129
  v_exp_f32 v130, v130
  v_exp_f32 v131, v131
  v_mfma_f32_32x32x16_bf16 v[96:111], a[60:63], v[148:151], v[96:111]
  buffer_load_dwordx4 v4, s[40:43], s48 offen offset:3072 lds
  v_exp_f32 v132, v132
  v_exp_f32 v133, v133
  v_exp_f32 v134, v134
  v_exp_f32 v135, v135
  v_mfma_f32_32x32x16_bf16 v[112:127], a[4:7], v[28:31], v[112:127]
  s_add_u32 s57, s57, 16384
  s_cmp_eq_u32 s57, 114688
  s_cselect_b32 s57, 0, s57
  s_add_u32 m0, s63, s57
  s_add_u32 s48, s64, s57
  v_cvt_pk_bf16_f32 v144, v128, v129
  v_cvt_pk_bf16_f32 v145, v130, v131
  v_cvt_pk_bf16_f32 v146, v132, v133
  v_cvt_pk_bf16_f32 v147, v134, v135
  v_exp_f32 v136, v136
  v_exp_f32 v137, v137
  v_exp_f32 v138, v138
  v_mfma_f32_32x32x16_bf16 v[48:63], a[56:59], v[144:147], v[48:63]
  v_exp_f32 v139, v139
  v_exp_f32 v140, v140
  v_exp_f32 v141, v141
  v_exp_f32 v142, v142
  v_exp_f32 v143, v143
  v_cvt_pk_bf16_f32 v148, v136, v137
  v_cvt_pk_bf16_f32 v149, v138, v139
  v_cvt_pk_bf16_f32 v150, v140, v141
  v_cvt_pk_bf16_f32 v151, v142, v143
  v_mfma_f32_32x32x16_bf16 v[128:143], a[0:3], v[32:35], 0
  s_add_u32 s9, s9, 16384
  s_and_b32 s9, s9, 0x3ffff
  s_bitcmp1_b32 s28, 7
  s_cbranch_scc0 mm_l1_tw59
mm_l1_tw59_b:
  buffer_load_dwordx4 a[48:51], v4, s[24:27], s9 offen offset:0
  v_exp_f32 v112, v112
  v_exp_f32 v113, v113
  v_exp_f32 v114, v114
  v_exp_f32 v115, v115
  v_mfma_f32_32x32x16_bf16 v[48:63], a[60:63], v[148:151], v[48:63]
  buffer_load_dwordx4 v4, s[40:43], s48 offen offset:0 lds
  v_exp_f32 v116, v116
  v_exp_f32 v117, v117
  v_exp_f32 v118, v118
  v_exp_f32 v119, v119
  v_mfma_f32_32x32x16_bf16 v[128:143], a[4:7], v[36:39], v[128:143]
  v_cvt_pk_bf16_f32 v144, v112, v113
  v_cvt_pk_bf16_f32 v145, v114, v115
  v_cvt_pk_bf16_f32 v146, v116, v117
  v_cvt_pk_bf16_f32 v147, v118, v119
  v_exp_f32 v120, v120
  v_exp_f32 v121, v121
  v_exp_f32 v122, v122
  v_mfma_f32_32x32x16_bf16 v[64:79], a[8:11], v[144:147], v[64:79]
  buffer_load_dword v252, v15, s[40:43], s36 offen sc1
  s_add_u32 s44, s6, 4096
  buffer_store_dwordx4 v[248:251], v4, s[40:43], s44 offen sc1
  v_exp_f32 v123, v123
  v_exp_f32 v124, v124
  v_exp_f32 v125, v125
  v_exp_f32 v126, v126
  v_exp_f32 v127, v127
  v_cvt_pk_bf16_f32 v148, v120, v121
  v_cvt_pk_bf16_f32 v149, v122, v123
  v_cvt_pk_bf16_f32 v150, v124, v125
  v_cvt_pk_bf16_f32 v151, v126, v127
  v_mfma_f32_32x32x16_bf16 v[112:127], a[0:3], v[40:43], 0
  buffer_load_dwordx4 a[52:55], v4, s[24:27], s9 offen offset:1024
  v_exp_f32 v128, v128
  v_exp_f32 v129, v129
  v_exp_f32 v130, v130
  v_exp_f32 v131, v131
  v_mfma_f32_32x32x16_bf16 v[64:79], a[12:15], v[148:151], v[64:79]
  buffer_load_dwordx4 v4, s[40:43], s48 offen offset:1024 lds
  v_exp_f32 v132, v132
  v_exp_f32 v133, v133
  v_exp_f32 v134, v134
  v_exp_f32 v135, v135
  v_mfma_f32_32x32x16_bf16 v[112:127], a[4:7], v[44:47], v[112:127]
  v_cvt_pk_bf16_f32 v144, v128, v129
  v_cvt_pk_bf16_f32 v145, v130, v131
  v_cvt_pk_bf16_f32 v146, v132, v133
  v_cvt_pk_bf16_f32 v147, v134, v135
  v_exp_f32 v136, v136
  v_exp_f32 v137, v137
  v_exp_f32 v138, v138
  v_mfma_f32_32x32x16_bf16 v[80:95], a[8:11], v[144:147], v[80:95]
  v_exp_f32 v139, v139
  v_exp_f32 v140, v140
  v_exp_f32 v141, v141
  v_exp_f32 v142, v142
  v_exp_f32 v143, v143
  v_cvt_pk_bf16_f32 v148, v136, v137
  v_cvt_pk_bf16_f32 v149, v138, v139
  v_cvt_pk_bf16_f32 v150, v140, v141
  v_cvt_pk_bf16_f32 v151, v142, v143
  v_mfma_f32_32x32x16_bf16 v[128:143], a[0:3], v[16:19], 0
  buffer_load_dwordx4 a[56:59], v4, s[24:27], s9 offen offset:2048
  v_exp_f32 v112, v112
  v_exp_f32 v113, v113
  v_exp_f32 v114, v114
  v_exp_f32 v115, v115
  v_mfma_f32_32x32x16_bf16 v[80:95], a[12:15], v[148:151], v[80:95]
  buffer_load_dwordx4 v4, s[40:43], s48 offen offset:2048 lds
  v_exp_f32 v116, v116
  v_exp_f32 v117, v117
  v_exp_f32 v118, v118
  v_exp_f32 v119, v119
  v_mfma_f32_32x32x16_bf16 v[128:143], a[4:7], v[20:23], v[128:143]
  v_cvt_pk_bf16_f32 v144, v112, v113
  v_cvt_pk_bf16_f32 v145, v114, v115
  v_cvt_pk_bf16_f32 v146, v116, v117
  v_cvt_pk_bf16_f32 v147, v118, v119
  v_exp_f32 v120, v120
  v_exp_f32 v121, v121
  v_exp_f32 v122, v122
  v_mfma_f32_32x32x16_bf16 v[96:111], a[8:11], v[144:147], v[96:111]
  v_exp_f32 v123, v123
  v_exp_f32 v124, v124
  v_exp_f32 v125, v125
  v_exp_f32 v126, v126
  v_exp_f32 v127, v127
  v_cvt_pk_bf16_f32 v148, v120, v121
  v_cvt_pk_bf16_f32 v149, v122, v123
  v_cvt_pk_bf16_f32 v150, v124, v125
  v_cvt_pk_bf16_f32 v151, v126, v127
  s_waitcnt vmcnt(18)
  v_accvgpr_read_b32 v2, a16
  v_accvgpr_read_b32 v254, a18
  v_max_u32 v3, v2, v254
  v_accvgpr_read_b32 v2, a20
  v_accvgpr_read_b32 v254, a22
  v_max3_u32 v3, v2, v254, v3
  v_accvgpr_read_b32 v2, a24
  v_accvgpr_read_b32 v254, a26
  v_max3_u32 v3, v2, v254, v3
  v_accvgpr_read_b32 v2, a28
  v_accvgpr_read_b32 v254, a30
  v_max3_u32 v3, v2, v254, v3
  v_cmp_eq_u32 vcc, -1, v3
  s_nop 4
  s_cbranch_vccnz mm_l1_st60
mm_l1_st60_b:
  v_mfma_f32_32x32x16_bf16 v[112:127], a[16:19], v[24:27], 0
  buffer_load_dwordx4 a[60:63], v4, s[24:27], s9 offen offset:3072
  v_exp_f32 v128, v128
  v_exp_f32 v129, v129
  v_exp_f32 v130, v130
  v_exp_f32 v131, v131
  v_mfma_f32_32x32x16_bf16 v[96:111], a[12:15], v[148:151], v[96:111]
  buffer_load_dwordx4 v4, s[40:43], s48 offen offset:3072 lds
  v_exp_f32 v132, v132
  v_exp_f32 v133, v133
  v_exp_f32 v134, v134
  v_exp_f32 v135, v135
  v_mfma_f32_32x32x16_bf16 v[112:127], a[20:23], v[28:31], v[112:127]
  s_add_u32 s57, s57, 16384
  s_cmp_eq_u32 s57, 114688
  s_cselect_b32 s57, 0, s57
  s_add_u32 m0, s63, s57
  s_add_u32 s48, s64, s57
  v_cvt_pk_bf16_f32 v144, v128, v129
  v_cvt_pk_bf16_f32 v145, v130, v131
  v_cvt_pk_bf16_f32 v146, v132, v133
  v_cvt_pk_bf16_f32 v147, v134, v135
  v_exp_f32 v136, v136
  v_exp_f32 v137, v137
  v_exp_f32 v138, v138
  s_waitcnt vmcnt(7)
  v_cmp_eq_u32 vcc, 0, v252
  s_nop 0
  s_and_b32 s28, vcc_lo, 0xffff
  s_lshl_b32 s29, s28, 16
  s_or_b32 s28, s28, s29
  s_lshr_b32 s28, s28, s32
  v_mfma_f32_32x32x16_bf16 v[48:63], a[8:11], v[144:147], v[48:63]
  v_exp_f32 v139, v139
  v_exp_f32 v140, v140
  v_exp_f32 v141, v141
  v_exp_f32 v142, v142
  v_exp_f32 v143, v143
  v_cvt_pk_bf16_f32 v148, v136, v137
  v_cvt_pk_bf16_f32 v149, v138, v139
  v_cvt_pk_bf16_f32 v150, v140, v141
  v_cvt_pk_bf16_f32 v151, v142, v143
  v_mfma_f32_32x32x16_bf16 v[128:143], a[16:19], v[32:35], 0
  s_add_u32 s9, s9, 16384
  s_and_b32 s9, s9, 0x3ffff
  s_bitcmp1_b32 s28, 8
  s_cbranch_scc0 mm_l1_tw61
mm_l1_tw61_b:
  buffer_load_dwordx4 a[0:3], v4, s[24:27], s9 offen offset:0
  v_exp_f32 v112, v112
  v_exp_f32 v113, v113
  v_exp_f32 v114, v114
  v_exp_f32 v115, v115
  v_mfma_f32_32x32x16_bf16 v[48:63], a[12:15], v[148:151], v[48:63]
  buffer_load_dwordx4 v4, s[40:43], s48 offen offset:0 lds
  v_exp_f32 v116, v116
  v_exp_f32 v117, v117
  v_exp_f32 v118, v118
  v_exp_f32 v119, v119
  v_mfma_f32_32x32x16_bf16 v[128:143], a[20:23], v[36:39], v[128:143]
  v_cvt_pk_bf16_f32 v144, v112, v113
  v_cvt_pk_bf16_f32 v145, v114, v115
  v_cvt_pk_bf16_f32 v146, v116, v117
  v_cvt_pk_bf16_f32 v147, v118, v119
  v_exp_f32 v120, v120
  v_exp_f32 v121, v121
  v_exp_f32 v122, v122
  v_mfma_f32_32x32x16_bf16 v[64:79], a[24:27], v[144:147], v[64:79]
  s_add_u32 s44, s6, 5120
  buffer_store_dwordx4 v[248:251], v4, s[40:43], s44 offen sc1
  v_exp_f32 v123, v123
  v_exp_f32 v124, v124
  v_exp_f32 v125, v125
  v_exp_f32 v126, v126
  v_exp_f32 v127, v127
  v_cvt_pk_bf16_f32 v148, v120, v121
  v_cvt_pk_bf16_f32 v149, v122, v123
  v_cvt_pk_bf16_f32 v150, v124, v125
  v_cvt_pk_bf16_f32 v151, v126, v127
  v_mfma_f32_32x32x16_bf16 v[112:127], a[16:19], v[40:43], 0
  buffer_load_dwordx4 a[4:7], v4, s[24:27], s9 offen offset:1024
  v_exp_f32 v128, v128
  v_exp_f32 v129, v129
  v_exp_f32 v130, v130
  v_exp_f32 v131, v131
  v_mfma_f32_32x32x16_bf16 v[64:79], a[28:31], v[148:151], v[64:79]
  buffer_load_dwordx4 v4, s[40:43], s48 offen offset:1024 lds
  v_exp_f32 v132, v132
  v_exp_f32 v133, v133
  v_exp_f32 v134, v134
  v_exp_f32 v135, v135
  v_mfma_f32_32x32x16_bf16 v[112:127], a[20:23], v[44:47], v[112:127]
  v_cvt_pk_bf16_f32 v144, v128, v129
  v_cvt_pk_bf16_f32 v145, v130, v131
  v_cvt_pk_bf16_f32 v146, v132, v133
  v_cvt_pk_bf16_f32 v147, v134, v135
  v_exp_f32 v136, v136
  v_exp_f32 v137, v137
  v_exp_f32 v138, v138
  v_mfma_f32_32x32x16_bf16 v[80:95], a[24:27], v[144:147], v[80:95]
  v_exp_f32 v139, v139
  v_exp_f32 v140, v140
  v_exp_f32 v141, v141
  v_exp_f32 v142, v142
  v_exp_f32 v143, v143
  v_cvt_pk_bf16_f32 v148, v136, v137
  v_cvt_pk_bf16_f32 v149, v138, v139
  v_cvt_pk_bf16_f32 v150, v140, v141
  v_cvt_pk_bf16_f32 v151, v142, v143
  v_mfma_f32_32x32x16_bf16 v[128:143], a[16:19], v[16:19], 0
  buffer_load_dwordx4 a[8:11], v4, s[24:27], s9 offen offset:2048
  v_exp_f32 v112, v112
  v_exp_f32 v113, v113
  v_exp_f32 v114, v114
  v_exp_f32 v115, v115
  v_mfma_f32_32x32x16_bf16 v[80:95], a[28:31], v[148:151], v[80:95]
  buffer_load_dwordx4 v4, s[40:43], s48 offen offset:2048 lds
  v_exp_f32 v116, v116
  v_exp_f32 v117, v117
  v_exp_f32 v118, v118
  v_exp_f32 v119, v119
  v_mfma_f32_32x32x16_bf16 v[128:143], a[20:23], v[20:23], v[128:143]
  v_cvt_pk_bf16_f32 v144, v112, v113
  v_cvt_pk_bf16_f32 v145, v114, v115
  v_cvt_pk_bf16_f32 v146, v116, v117
  v_cvt_pk_bf16_f32 v147, v118, v119
  v_exp_f32 v120, v120
  v_exp_f32 v121, v121
  v_exp_f32 v122, v122
  v_mfma_f32_32x32x16_bf16 v[96:111], a[24:27], v[144:147], v[96:111]
  v_exp_f32 v123, v123
  v_exp_f32 v124, v124
  v_exp_f32 v125, v125
  v_exp_f32 v126, v126
  v_exp_f32 v127, v127
  v_cvt_pk_bf16_f32 v148, v120, v121
  v_cvt_pk_bf16_f32 v149, v122, v123
  v_cvt_pk_bf16_f32 v150, v124, v125
  v_cvt_pk_bf16_f32 v151, v126, v127
  v_mfma_f32_32x32x16_bf16 v[112:127], a[32:35], v[24:27], 0
  buffer_load_dwordx4 a[12:15], v4, s[24:27], s9 offen offset:3072
  v_exp_f32 v128, v128
  v_exp_f32 v129, v129
  v_exp_f32 v130, v130
  v_exp_f32 v131, v131
  v_mfma_f32_32x32x16_bf16 v[96:111], a[28:31], v[148:151], v[96:111]
  buffer_load_dwordx4 v4, s[40:43], s48 offen offset:3072 lds
  v_exp_f32 v132, v132
  v_exp_f32 v133, v133
  v_exp_f32 v134, v134
  v_exp_f32 v135, v135
  v_mfma_f32_32x32x16_bf16 v[112:127], a[36:39], v[28:31], v[112:127]
  s_add_u32 s57, s57, 16384
  s_cmp_eq_u32 s57, 114688
  s_cselect_b32 s57, 0, s57
  s_add_u32 m0, s63, s57
  s_add_u32 s48, s64, s57
  v_cvt_pk_bf16_f32 v144, v128, v129
  v_cvt_pk_bf16_f32 v145, v130, v131
  v_cvt_pk_bf16_f32 v146, v132, v133
  v_cvt_pk_bf16_f32 v147, v134, v135
  v_exp_f32 v136, v136
  v_exp_f32 v137, v137
  v_exp_f32 v138, v138
  v_mfma_f32_32x32x16_bf16 v[48:63], a[24:27], v[144:147], v[48:63]
  v_exp_f32 v139, v139
  v_exp_f32 v140, v140
  v_exp_f32 v141, v141
  v_exp_f32 v142, v142
  v_exp_f32 v143, v143
  v_cvt_pk_bf16_f32 v148, v136, v137
  v_cvt_pk_bf16_f32 v149, v138, v139
  v_cvt_pk_bf16_f32 v150, v140, v141
  v_cvt_pk_bf16_f32 v151, v142, v143
  v_mfma_f32_32x32x16_bf16 v[128:143], a[32:35], v[32:35], 0
  s_add_u32 s9, s9, 16384
  s_and_b32 s9, s9, 0x3ffff
  s_bitcmp1_b32 s28, 9
  s_cbranch_scc0 mm_l1_tw62
mm_l1_tw62_b:
  buffer_load_dwordx4 a[16:19], v4, s[24:27], s9 offen offset:0
  v_exp_f32 v112, v112
  v_exp_f32 v113, v113
  v_exp_f32 v114, v114
  v_exp_f32 v115, v115
  v_mfma_f32_32x32x16_bf16 v[48:63], a[28:31], v[148:151], v[48:63]
  buffer_load_dwordx4 v4, s[40:43], s48 offen offset:0 lds
  v_exp_f32 v116, v116
  v_exp_f32 v117, v117
  v_exp_f32 v118, v118
  v_exp_f32 v119, v119
  v_mfma_f32_32x32x16_bf16 v[128:143], a[36:39], v[36:39], v[128:143]
  v_cvt_pk_bf16_f32 v144, v112, v113
  v_cvt_pk_bf16_f32 v145, v114, v115
  v_cvt_pk_bf16_f32 v146, v116, v117
  v_cvt_pk_bf16_f32 v147, v118, v119
  v_exp_f32 v120, v120
  v_exp_f32 v121, v121
  v_exp_f32 v122, v122
  v_mfma_f32_32x32x16_bf16 v[64:79], a[40:43], v[144:147], v[64:79]
  s_add_u32 s44, s6, 6144
  buffer_store_dwordx4 v[248:251], v4, s[40:43], s44 offen sc1
  v_exp_f32 v123, v123
  v_exp_f32 v124, v124
  v_exp_f32 v125, v125
  v_exp_f32 v126, v126
  v_exp_f32 v127, v127
  v_cvt_pk_bf16_f32 v148, v120, v121
  v_cvt_pk_bf16_f32 v149, v122, v123
  v_cvt_pk_bf16_f32 v150, v124, v125
  v_cvt_pk_bf16_f32 v151, v126, v127
  v_mfma_f32_32x32x16_bf16 v[112:127], a[32:35], v[40:43], 0
  buffer_load_dwordx4 a[20:23], v4, s[24:27], s9 offen offset:1024
  v_exp_f32 v128, v128
  v_exp_f32 v129, v129
  v_exp_f32 v130, v130
  v_exp_f32 v131, v131
  v_mfma_f32_32x32x16_bf16 v[64:79], a[44:47], v[148:151], v[64:79]
  buffer_load_dwordx4 v4, s[40:43], s48 offen offset:1024 lds
  v_exp_f32 v132, v132
  v_exp_f32 v133, v133
  v_exp_f32 v134, v134
  v_exp_f32 v135, v135
  v_mfma_f32_32x32x16_bf16 v[112:127], a[36:39], v[44:47], v[112:127]
  v_cvt_pk_bf16_f32 v144, v128, v129
  v_cvt_pk_bf16_f32 v145, v130, v131
  v_cvt_pk_bf16_f32 v146, v132, v133
  v_cvt_pk_bf16_f32 v147, v134, v135
  v_exp_f32 v136, v136
  v_exp_f32 v137, v137
  v_exp_f32 v138, v138
  v_mfma_f32_32x32x16_bf16 v[80:95], a[40:43], v[144:147], v[80:95]
  v_exp_f32 v139, v139
  v_exp_f32 v140, v140
  v_exp_f32 v141, v141
  v_exp_f32 v142, v142
  v_exp_f32 v143, v143
  v_cvt_pk_bf16_f32 v148, v136, v137
  v_cvt_pk_bf16_f32 v149, v138, v139
  v_cvt_pk_bf16_f32 v150, v140, v141
  v_cvt_pk_bf16_f32 v151, v142, v143
  v_mfma_f32_32x32x16_bf16 v[128:143], a[32:35], v[16:19], 0
  buffer_load_dwordx4 a[24:27], v4, s[24:27], s9 offen offset:2048
  v_exp_f32 v112, v112
  v_exp_f32 v113, v113
  v_exp_f32 v114, v114
  v_exp_f32 v115, v115
  v_mfma_f32_32x32x16_bf16 v[80:95], a[44:47], v[148:151], v[80:95]
  buffer_load_dwordx4 v4, s[40:43], s48 offen offset:2048 lds
  v_exp_f32 v116, v116
  v_exp_f32 v117, v117
  v_exp_f32 v118, v118
  v_exp_f32 v119, v119
  v_mfma_f32_32x32x16_bf16 v[128:143], a[36:39], v[20:23], v[128:143]
  v_cvt_pk_bf16_f32 v144, v112, v113
  v_cvt_pk_bf16_f32 v145, v114, v115
  v_cvt_pk_bf16_f32 v146, v116, v117
  v_cvt_pk_bf16_f32 v147, v118, v119
  v_exp_f32 v120, v120
  v_exp_f32 v121, v121
  v_exp_f32 v122, v122
  v_mfma_f32_32x32x16_bf16 v[96:111], a[40:43], v[144:147], v[96:111]
  v_exp_f32 v123, v123
  v_exp_f32 v124, v124
  v_exp_f32 v125, v125
  v_exp_f32 v126, v126
  v_exp_f32 v127, v127
  v_cvt_pk_bf16_f32 v148, v120, v121
  v_cvt_pk_bf16_f32 v149, v122, v123
  v_cvt_pk_bf16_f32 v150, v124, v125
  v_cvt_pk_bf16_f32 v151, v126, v127
  s_waitcnt vmcnt(17)
  v_mfma_f32_32x32x16_bf16 v[112:127], a[48:51], v[24:27], 0
  buffer_load_dwordx4 a[28:31], v4, s[24:27], s9 offen offset:3072
  v_exp_f32 v128, v128
  v_exp_f32 v129, v129
  v_exp_f32 v130, v130
  v_exp_f32 v131, v131
  v_mfma_f32_32x32x16_bf16 v[96:111], a[44:47], v[148:151], v[96:111]
  buffer_load_dwordx4 v4, s[40:43], s48 offen offset:3072 lds
  v_exp_f32 v132, v132
  v_exp_f32 v133, v133
  v_exp_f32 v134, v134
  v_exp_f32 v135, v135
  v_mfma_f32_32x32x16_bf16 v[112:127], a[52:55], v[28:31], v[112:127]
  v_cvt_pk_bf16_f32 v144, v128, v129
  v_cvt_pk_bf16_f32 v145, v130, v131
  v_cvt_pk_bf16_f32 v146, v132, v133
  v_cvt_pk_bf16_f32 v147, v134, v135
  v_exp_f32 v136, v136
  v_exp_f32 v137, v137
  v_exp_f32 v138, v138
  v_mfma_f32_32x32x16_bf16 v[48:63], a[40:43], v[144:147], v[48:63]
  v_exp_f32 v139, v139
  v_exp_f32 v140, v140
  v_exp_f32 v141, v141
  v_exp_f32 v142, v142
  v_exp_f32 v143, v143
  v_cvt_pk_bf16_f32 v148, v136, v137
  v_cvt_pk_bf16_f32 v149, v138, v139
  v_cvt_pk_bf16_f32 v150, v140, v141
  v_cvt_pk_bf16_f32 v151, v142, v143
  v_mfma_f32_32x32x16_bf16 v[128:143], a[48:51], v[32:35], 0
  s_add_u32 s9, s9, 16384
  s_and_b32 s9, s9, 0x3ffff
  s_bitcmp1_b32 s28, 10
  s_cbranch_scc0 mm_l1_tw63
mm_l1_tw63_b:
  buffer_load_dwordx4 a[32:35], v4, s[24:27], s9 offen offset:0
  v_exp_f32 v112, v112
  v_exp_f32 v113, v113
  v_exp_f32 v114, v114
  v_exp_f32 v115, v115
  v_mfma_f32_32x32x16_bf16 v[48:63], a[44:47], v[148:151], v[48:63]
  buffer_load_dwordx4 v[152:155], v4, s[68:71], s46 offen offset:0
  v_exp_f32 v116, v116
  v_exp_f32 v117, v117
  v_exp_f32 v118, v118
  v_exp_f32 v119, v119
  v_mfma_f32_32x32x16_bf16 v[128:143], a[52:55], v[36:39], v[128:143]
  v_cvt_pk_bf16_f32 v144, v112, v113
  v_cvt_pk_bf16_f32 v145, v114, v115
  v_cvt_pk_bf16_f32 v146, v116, v117
  v_cvt_pk_bf16_f32 v147, v118, v119
  v_exp_f32 v120, v120
  v_exp_f32 v121, v121
  v_exp_f32 v122, v122
  v_mfma_f32_32x32x16_bf16 v[64:79], a[56:59], v[144:147], v[64:79]
  v_exp_f32 v123, v123
  v_exp_f32 v124, v124
  v_exp_f32 v125, v125
  v_exp_f32 v126, v126
  v_exp_f32 v127, v127
  v_cvt_pk_bf16_f32 v148, v120, v121
  v_cvt_pk_bf16_f32 v149, v122, v123
  v_cvt_pk_bf16_f32 v150, v124, v125
  v_cvt_pk_bf16_f32 v151, v126, v127
  v_mfma_f32_32x32x16_bf16 v[112:127], a[48:51], v[40:43], 0
  buffer_load_dwordx4 a[36:39], v4, s[24:27], s9 offen offset:1024
  v_exp_f32 v128, v128
  v_exp_f32 v129, v129
  v_exp_f32 v130, v130
  v_exp_f32 v131, v131
  v_mfma_f32_32x32x16_bf16 v[64:79], a[60:63], v[148:151], v[64:79]
  buffer_load_dwordx4 v[156:159], v4, s[68:71], s46 offen offset:1024
  v_exp_f32 v132, v132
  v_exp_f32 v133, v133
  v_exp_f32 v134, v134
  v_exp_f32 v135, v135
  v_mfma_f32_32x32x16_bf16 v[112:127], a[52:55], v[44:47], v[112:127]
  v_cvt_pk_bf16_f32 v144, v128, v129
  v_cvt_pk_bf16_f32 v145, v130, v131
  v_cvt_pk_bf16_f32 v146, v132, v133
  v_cvt_pk_bf16_f32 v147, v134, v135
  v_exp_f32 v136, v136
  v_exp_f32 v137, v137
  v_exp_f32 v138, v138
  v_mfma_f32_32x32x16_bf16 v[80:95], a[56:59], v[144:147], v[80:95]
  v_exp_f32 v139, v139
  v_exp_f32 v140, v140
  v_exp_f32 v141, v141
  v_exp_f32 v142, v142
  v_exp_f32 v143, v143
  v_cvt_pk_bf16_f32 v148, v136, v137
  v_cvt_pk_bf16_f32 v149, v138, v139
  v_cvt_pk_bf16_f32 v150, v140, v141
  v_cvt_pk_bf16_f32 v151, v142, v143
  v_mfma_f32_32x32x16_bf16 v[128:143], a[48:51], v[16:19], 0
  buffer_load_dwordx4 a[40:43], v4, s[24:27], s9 offen offset:2048
  v_exp_f32 v112, v112
  v_exp_f32 v113, v113
  v_exp_f32 v114, v114
  v_exp_f32 v115, v115
  v_mfma_f32_32x32x16_bf16 v[80:95], a[60:63], v[148:151], v[80:95]
  buffer_load_dwordx4 v[160:163], v4, s[68:71], s46 offen offset:2048
  v_exp_f32 v116, v116
  v_exp_f32 v117, v117
  v_exp_f32 v118, v118
  v_exp_f32 v119, v119
  v_mfma_f32_32x32x16_bf16 v[128:143], a[52:55], v[20:23], v[128:143]
  v_cvt_pk_bf16_f32 v144, v112, v113
  v_cvt_pk_bf16_f32 v145, v114, v115
  v_cvt_pk_bf16_f32 v146, v116, v117
  v_cvt_pk_bf16_f32 v147, v118, v119
  v_exp_f32 v120, v120
  v_exp_f32 v121, v121
  v_exp_f32 v122, v122
  v_mfma_f32_32x32x16_bf16 v[96:111], a[56:59], v[144:147], v[96:111]
  v_exp_f32 v123, v123
  v_exp_f32 v124, v124
  v_exp_f32 v125, v125
  v_exp_f32 v126, v126
  v_exp_f32 v127, v127
  v_cvt_pk_bf16_f32 v148, v120, v121
  v_cvt_pk_bf16_f32 v149, v122, v123
  v_cvt_pk_bf16_f32 v150, v124, v125
  v_cvt_pk_bf16_f32 v151, v126, v127
  s_waitcnt vmcnt(16)
  v_mfma_f32_32x32x16_bf16 v[112:127], a[0:3], v[24:27], 0
  buffer_load_dwordx4 a[44:47], v4, s[24:27], s9 offen offset:3072
  v_exp_f32 v128, v128
  v_exp_f32 v129, v129
  v_exp_f32 v130, v130
  v_exp_f32 v131, v131
  v_mfma_f32_32x32x16_bf16 v[96:111], a[60:63], v[148:151], v[96:111]
  buffer_load_dwordx4 v[164:167], v4, s[68:71], s46 offen offset:3072
  v_exp_f32 v132, v132
  v_exp_f32 v133, v133
  v_exp_f32 v134, v134
  v_exp_f32 v135, v135
  v_mfma_f32_32x32x16_bf16 v[112:127], a[4:7], v[28:31], v[112:127]
  s_add_u32 s48, s46, 4096
  v_cvt_pk_bf16_f32 v144, v128, v129
  v_cvt_pk_bf16_f32 v145, v130, v131
  v_cvt_pk_bf16_f32 v146, v132, v133
  v_cvt_pk_bf16_f32 v147, v134, v135
  v_exp_f32 v136, v136
  v_exp_f32 v137, v137
  v_exp_f32 v138, v138
  v_mfma_f32_32x32x16_bf16 v[48:63], a[56:59], v[144:147], v[48:63]
  v_exp_f32 v139, v139
  v_exp_f32 v140, v140
  v_exp_f32 v141, v141
  v_exp_f32 v142, v142
  v_exp_f32 v143, v143
  v_cvt_pk_bf16_f32 v148, v136, v137
  v_cvt_pk_bf16_f32 v149, v138, v139
  v_cvt_pk_bf16_f32 v150, v140, v141
  v_cvt_pk_bf16_f32 v151, v142, v143
  v_mfma_f32_32x32x16_bf16 v[128:143], a[0:3], v[32:35], 0
  s_add_u32 s9, s9, 16384
  s_and_b32 s9, s9, 0x3ffff
  s_bitcmp1_b32 s28, 11
  s_cbranch_scc0 mm_l1_tw64
mm_l1_tw64_b:
  buffer_load_dwordx4 a[48:51], v4, s[24:27], s9 offen offset:0
  v_exp_f32 v112, v112
  v_exp_f32 v113, v113
  v_exp_f32 v114, v114
  v_exp_f32 v115, v115
  v_mfma_f32_32x32x16_bf16 v[48:63], a[60:63], v[148:151], v[48:63]
  buffer_load_dwordx4 v[168:171], v4, s[68:71], s48 offen offset:0
  v_exp_f32 v116, v116
  v_exp_f32 v117, v117
  v_exp_f32 v118, v118
  v_exp_f32 v119, v119
  v_mfma_f32_32x32x16_bf16 v[128:143], a[4:7], v[36:39], v[128:143]
  v_cvt_pk_bf16_f32 v144, v112, v113
  v_cvt_pk_bf16_f32 v145, v114, v115
  v_cvt_pk_bf16_f32 v146, v116, v117
  v_cvt_pk_bf16_f32 v147, v118, v119
  v_exp_f32 v120, v120
  v_exp_f32 v121, v121
  v_exp_f32 v122, v122
  v_mfma_f32_32x32x16_bf16 v[64:79], a[8:11], v[144:147], v[64:79]
  v_exp_f32 v123, v123
  v_exp_f32 v124, v124
  v_exp_f32 v125, v125
  v_exp_f32 v126, v126
  v_exp_f32 v127, v127
  v_cvt_pk_bf16_f32 v148, v120, v121
  v_cvt_pk_bf16_f32 v149, v122, v123
  v_cvt_pk_bf16_f32 v150, v124, v125
  v_cvt_pk_bf16_f32 v151, v126, v127
  v_mfma_f32_32x32x16_bf16 v[112:127], a[0:3], v[40:43], 0
  buffer_load_dwordx4 a[52:55], v4, s[24:27], s9 offen offset:1024
  v_exp_f32 v128, v128
  v_exp_f32 v129, v129
  v_exp_f32 v130, v130
  v_exp_f32 v131, v131
  v_mfma_f32_32x32x16_bf16 v[64:79], a[12:15], v[148:151], v[64:79]
  buffer_load_dwordx4 v[172:175], v4, s[68:71], s48 offen offset:1024
  v_exp_f32 v132, v132
  v_exp_f32 v133, v133
  v_exp_f32 v134, v134
  v_exp_f32 v135, v135
  v_mfma_f32_32x32x16_bf16 v[112:127], a[4:7], v[44:47], v[112:127]
  v_cvt_pk_bf16_f32 v144, v128, v129
  v_cvt_pk_bf16_f32 v145, v130, v131
  v_cvt_pk_bf16_f32 v146, v132, v133
  v_cvt_pk_bf16_f32 v147, v134, v135
  v_exp_f32 v136, v136
  v_exp_f32 v137, v137
  v_exp_f32 v138, v138
  v_mfma_f32_32x32x16_bf16 v[80:95], a[8:11], v[144:147], v[80:95]
  v_exp_f32 v139, v139
  v_exp_f32 v140, v140
  v_exp_f32 v141, v141
  v_exp_f32 v142, v142
  v_exp_f32 v143, v143
  v_cvt_pk_bf16_f32 v148, v136, v137
  v_cvt_pk_bf16_f32 v149, v138, v139
  v_cvt_pk_bf16_f32 v150, v140, v141
  v_cvt_pk_bf16_f32 v151, v142, v143
  v_mfma_f32_32x32x16_bf16 v[128:143], a[0:3], v[16:19], 0
  buffer_load_dwordx4 a[56:59], v4, s[24:27], s9 offen offset:2048
  v_exp_f32 v112, v112
  v_exp_f32 v113, v113
  v_exp_f32 v114, v114
  v_exp_f32 v115, v115
  v_mfma_f32_32x32x16_bf16 v[80:95], a[12:15], v[148:151], v[80:95]
  buffer_load_dwordx4 v[176:179], v4, s[68:71], s48 offen offset:2048
  v_exp_f32 v116, v116
  v_exp_f32 v117, v117
  v_exp_f32 v118, v118
  v_exp_f32 v119, v119
  v_mfma_f32_32x32x16_bf16 v[128:143], a[4:7], v[20:23], v[128:143]
  v_cvt_pk_bf16_f32 v144, v112, v113
  v_cvt_pk_bf16_f32 v145, v114, v115
  v_cvt_pk_bf16_f32 v146, v116, v117
  v_cvt_pk_bf16_f32 v147, v118, v119
  v_exp_f32 v120, v120
  v_exp_f32 v121, v121
  v_exp_f32 v122, v122
  v_mfma_f32_32x32x16_bf16 v[96:111], a[8:11], v[144:147], v[96:111]
  v_exp_f32 v123, v123
  v_exp_f32 v124, v124
  v_exp_f32 v125, v125
  v_exp_f32 v126, v126
  v_exp_f32 v127, v127
  v_cvt_pk_bf16_f32 v148, v120, v121
  v_cvt_pk_bf16_f32 v149, v122, v123
  v_cvt_pk_bf16_f32 v150, v124, v125
  v_cvt_pk_bf16_f32 v151, v126, v127
  s_waitcnt vmcnt(15)
  v_mfma_f32_32x32x16_bf16 v[112:127], a[16:19], v[24:27], 0
  buffer_load_dwordx4 a[60:63], v4, s[24:27], s9 offen offset:3072
  v_exp_f32 v128, v128
  v_exp_f32 v129, v129
  v_exp_f32 v130, v130
  v_exp_f32 v131, v131
  v_mfma_f32_32x32x16_bf16 v[96:111], a[12:15], v[148:151], v[96:111]
  buffer_load_dwordx4 v[180:183], v4, s[68:71], s48 offen offset:3072
  v_exp_f32 v132, v132
  v_exp_f32 v133, v133
  v_exp_f32 v134, v134
  v_exp_f32 v135, v135
  v_mfma_f32_32x32x16_bf16 v[112:127], a[20:23], v[28:31], v[112:127]
  v_cvt_pk_bf16_f32 v144, v128, v129
  v_cvt_pk_bf16_f32 v145, v130, v131
  v_cvt_pk_bf16_f32 v146, v132, v133
  v_cvt_pk_bf16_f32 v147, v134, v135
  v_exp_f32 v136, v136
  v_exp_f32 v137, v137
  v_exp_f32 v138, v138
  v_mfma_f32_32x32x16_bf16 v[48:63], a[8:11], v[144:147], v[48:63]
  v_exp_f32 v139, v139
  v_exp_f32 v140, v140
  v_exp_f32 v141, v141
  v_exp_f32 v142, v142
  v_exp_f32 v143, v143
  v_cvt_pk_bf16_f32 v148, v136, v137
  v_cvt_pk_bf16_f32 v149, v138, v139
  v_cvt_pk_bf16_f32 v150, v140, v141
  v_cvt_pk_bf16_f32 v151, v142, v143
  v_mfma_f32_32x32x16_bf16 v[128:143], a[16:19], v[32:35], 0
  s_add_u32 s9, s9, 16384
  s_and_b32 s9, s9, 0x3ffff
  s_bitcmp1_b32 s28, 12
  s_cbranch_scc0 mm_l1_tw65
mm_l1_tw65_b:
  buffer_load_dwordx4 a[0:3], v4, s[24:27], s9 offen offset:0
  v_exp_f32 v112, v112
  v_exp_f32 v113, v113
  v_exp_f32 v114, v114
  v_exp_f32 v115, v115
  v_mfma_f32_32x32x16_bf16 v[48:63], a[12:15], v[148:151], v[48:63]
  buffer_load_dwordx4 v[184:187], v4, s[68:71], s47 offen offset:0
  v_exp_f32 v116, v116
  v_exp_f32 v117, v117
  v_exp_f32 v118, v118
  v_exp_f32 v119, v119
  v_mfma_f32_32x32x16_bf16 v[128:143], a[20:23], v[36:39], v[128:143]
  v_cvt_pk_bf16_f32 v144, v112, v113
  v_cvt_pk_bf16_f32 v145, v114, v115
  v_cvt_pk_bf16_f32 v146, v116, v117
  v_cvt_pk_bf16_f32 v147, v118, v119
  v_exp_f32 v120, v120
  v_exp_f32 v121, v121
  v_exp_f32 v122, v122
  v_mfma_f32_32x32x16_bf16 v[64:79], a[24:27], v[144:147], v[64:79]
  v_exp_f32 v123, v123
  v_exp_f32 v124, v124
  v_exp_f32 v125, v125
  v_exp_f32 v126, v126
  v_exp_f32 v127, v127
  v_cvt_pk_bf16_f32 v148, v120, v121
  v_cvt_pk_bf16_f32 v149, v122, v123
  v_cvt_pk_bf16_f32 v150, v124, v125
  v_cvt_pk_bf16_f32 v151, v126, v127
  v_mfma_f32_32x32x16_bf16 v[112:127], a[16:19], v[40:43], 0
  buffer_load_dwordx4 a[4:7], v4, s[24:27], s9 offen offset:1024
  v_exp_f32 v128, v128
  v_exp_f32 v129, v129
  v_exp_f32 v130, v130
  v_exp_f32 v131, v131
  v_mfma_f32_32x32x16_bf16 v[64:79], a[28:31], v[148:151], v[64:79]
  buffer_load_dwordx4 v[188:191], v4, s[68:71], s47 offen offset:1024
  v_exp_f32 v132, v132
  v_exp_f32 v133, v133
  v_exp_f32 v134, v134
  v_exp_f32 v135, v135
  v_mfma_f32_32x32x16_bf16 v[112:127], a[20:23], v[44:47], v[112:127]
  v_cvt_pk_bf16_f32 v144, v128, v129
  v_cvt_pk_bf16_f32 v145, v130, v131
  v_cvt_pk_bf16_f32 v146, v132, v133
  v_cvt_pk_bf16_f32 v147, v134, v135
  v_exp_f32 v136, v136
  v_exp_f32 v137, v137
  v_exp_f32 v138, v138
  v_mfma_f32_32x32x16_bf16 v[80:95], a[24:27], v[144:147], v[80:95]
  v_exp_f32 v139, v139
  v_exp_f32 v140, v140
  v_exp_f32 v141, v141
  v_exp_f32 v142, v142
  v_exp_f32 v143, v143
  v_cvt_pk_bf16_f32 v148, v136, v137
  v_cvt_pk_bf16_f32 v149, v138, v139
  v_cvt_pk_bf16_f32 v150, v140, v141
  v_cvt_pk_bf16_f32 v151, v142, v143
  v_mfma_f32_32x32x16_bf16 v[128:143], a[16:19], v[16:19], 0
  buffer_load_dwordx4 a[8:11], v4, s[24:27], s9 offen offset:2048
  v_exp_f32 v112, v112
  v_exp_f32 v113, v113
  v_exp_f32 v114, v114
  v_exp_f32 v115, v115
  v_mfma_f32_32x32x16_bf16 v[80:95], a[28:31], v[148:151], v[80:95]
  buffer_load_dwordx4 v[192:195], v4, s[68:71], s47 offen offset:2048
  v_exp_f32 v116, v116
  v_exp_f32 v117, v117
  v_exp_f32 v118, v118
  v_exp_f32 v119, v119
  v_mfma_f32_32x32x16_bf16 v[128:143], a[20:23], v[20:23], v[128:143]
  v_cvt_pk_bf16_f32 v144, v112, v113
  v_cvt_pk_bf16_f32 v145, v114, v115
  v_cvt_pk_bf16_f32 v146, v116, v117
  v_cvt_pk_bf16_f32 v147, v118, v119
  v_exp_f32 v120, v120
  v_exp_f32 v121, v121
  v_exp_f32 v122, v122
  v_mfma_f32_32x32x16_bf16 v[96:111], a[24:27], v[144:147], v[96:111]
  v_exp_f32 v123, v123
  v_exp_f32 v124, v124
  v_exp_f32 v125, v125
  v_exp_f32 v126, v126
  v_exp_f32 v127, v127
  v_cvt_pk_bf16_f32 v148, v120, v121
  v_cvt_pk_bf16_f32 v149, v122, v123
  v_cvt_pk_bf16_f32 v150, v124, v125
  v_cvt_pk_bf16_f32 v151, v126, v127
  s_waitcnt vmcnt(15)
  v_mfma_f32_32x32x16_bf16 v[112:127], a[32:35], v[24:27], 0
  buffer_load_dwordx4 a[12:15], v4, s[24:27], s9 offen offset:3072
  v_exp_f32 v128, v128
  v_exp_f32 v129, v129
  v_exp_f32 v130, v130
  v_exp_f32 v131, v131
  v_mfma_f32_32x32x16_bf16 v[96:111], a[28:31], v[148:151], v[96:111]
  buffer_load_dwordx4 v[196:199], v4, s[68:71], s47 offen offset:3072
  v_exp_f32 v132, v132
  v_exp_f32 v133, v133
  v_exp_f32 v134, v134
  v_exp_f32 v135, v135
  v_mfma_f32_32x32x16_bf16 v[112:127], a[36:39], v[28:31], v[112:127]
  s_add_u32 s48, s47, 4096
  v_cvt_pk_bf16_f32 v144, v128, v129
  v_cvt_pk_bf16_f32 v145, v130, v131
  v_cvt_pk_bf16_f32 v146, v132, v133
  v_cvt_pk_bf16_f32 v147, v134, v135
  v_exp_f32 v136, v136
  v_exp_f32 v137, v137
  v_exp_f32 v138, v138
  v_mfma_f32_32x32x16_bf16 v[48:63], a[24:27], v[144:147], v[48:63]
  v_exp_f32 v139, v139
  v_exp_f32 v140, v140
  v_exp_f32 v141, v141
  v_exp_f32 v142, v142
  v_exp_f32 v143, v143
  v_cvt_pk_bf16_f32 v148, v136, v137
  v_cvt_pk_bf16_f32 v149, v138, v139
  v_cvt_pk_bf16_f32 v150, v140, v141
  v_cvt_pk_bf16_f32 v151, v142, v143
  v_mfma_f32_32x32x16_bf16 v[128:143], a[32:35], v[32:35], 0
  s_add_u32 s9, s9, 16384
  s_and_b32 s9, s9, 0x3ffff
  s_bitcmp1_b32 s28, 13
  s_cbranch_scc0 mm_l1_tw66
mm_l1_tw66_b:
  buffer_load_dwordx4 a[16:19], v4, s[24:27], s9 offen offset:0
  v_exp_f32 v112, v112
  v_exp_f32 v113, v113
  v_exp_f32 v114, v114
  v_exp_f32 v115, v115
  v_mfma_f32_32x32x16_bf16 v[48:63], a[28:31], v[148:151], v[48:63]
  buffer_load_dwordx4 v[200:203], v4, s[68:71], s48 offen offset:0
  v_exp_f32 v116, v116
  v_exp_f32 v117, v117
  v_exp_f32 v118, v118
  v_exp_f32 v119, v119
  v_mfma_f32_32x32x16_bf16 v[128:143], a[36:39], v[36:39], v[128:143]
  v_cvt_pk_bf16_f32 v144, v112, v113
  v_cvt_pk_bf16_f32 v145, v114, v115
  v_cvt_pk_bf16_f32 v146, v116, v117
  v_cvt_pk_bf16_f32 v147, v118, v119
  v_exp_f32 v120, v120
  v_exp_f32 v121, v121
  v_exp_f32 v122, v122
  v_mfma_f32_32x32x16_bf16 v[64:79], a[40:43], v[144:147], v[64:79]
  v_exp_f32 v123, v123
  v_exp_f32 v124, v124
  v_exp_f32 v125, v125
  v_exp_f32 v126, v126
  v_exp_f32 v127, v127
  v_cvt_pk_bf16_f32 v148, v120, v121
  v_cvt_pk_bf16_f32 v149, v122, v123
  v_cvt_pk_bf16_f32 v150, v124, v125
  v_cvt_pk_bf16_f32 v151, v126, v127
  v_mfma_f32_32x32x16_bf16 v[112:127], a[32:35], v[40:43], 0
  buffer_load_dwordx4 a[20:23], v4, s[24:27], s9 offen offset:1024
  v_exp_f32 v128, v128
  v_exp_f32 v129, v129
  v_exp_f32 v130, v130
  v_exp_f32 v131, v131
  v_mfma_f32_32x32x16_bf16 v[64:79], a[44:47], v[148:151], v[64:79]
  buffer_load_dwordx4 v[204:207], v4, s[68:71], s48 offen offset:1024
  v_exp_f32 v132, v132
  v_exp_f32 v133, v133
  v_exp_f32 v134, v134
  v_exp_f32 v135, v135
  v_mfma_f32_32x32x16_bf16 v[112:127], a[36:39], v[44:47], v[112:127]
  v_cvt_pk_bf16_f32 v144, v128, v129
  v_cvt_pk_bf16_f32 v145, v130, v131
  v_cvt_pk_bf16_f32 v146, v132, v133
  v_cvt_pk_bf16_f32 v147, v134, v135
  v_exp_f32 v136, v136
  v_exp_f32 v137, v137
  v_exp_f32 v138, v138
  v_mfma_f32_32x32x16_bf16 v[80:95], a[40:43], v[144:147], v[80:95]
  v_exp_f32 v139, v139
  v_exp_f32 v140, v140
  v_exp_f32 v141, v141
  v_exp_f32 v142, v142
  v_exp_f32 v143, v143
  v_cvt_pk_bf16_f32 v148, v136, v137
  v_cvt_pk_bf16_f32 v149, v138, v139
  v_cvt_pk_bf16_f32 v150, v140, v141
  v_cvt_pk_bf16_f32 v151, v142, v143
  v_mfma_f32_32x32x16_bf16 v[128:143], a[32:35], v[16:19], 0
  buffer_load_dwordx4 a[24:27], v4, s[24:27], s9 offen offset:2048
  v_exp_f32 v112, v112
  v_exp_f32 v113, v113
  v_exp_f32 v114, v114
  v_exp_f32 v115, v115
  v_mfma_f32_32x32x16_bf16 v[80:95], a[44:47], v[148:151], v[80:95]
  buffer_load_dwordx4 v[208:211], v4, s[68:71], s48 offen offset:2048
  v_exp_f32 v116, v116
  v_exp_f32 v117, v117
  v_exp_f32 v118, v118
  v_exp_f32 v119, v119
  v_mfma_f32_32x32x16_bf16 v[128:143], a[36:39], v[20:23], v[128:143]
  v_cvt_pk_bf16_f32 v144, v112, v113
  v_cvt_pk_bf16_f32 v145, v114, v115
  v_cvt_pk_bf16_f32 v146, v116, v117
  v_cvt_pk_bf16_f32 v147, v118, v119
  v_exp_f32 v120, v120
  v_exp_f32 v121, v121
  v_exp_f32 v122, v122
  v_mfma_f32_32x32x16_bf16 v[96:111], a[40:43], v[144:147], v[96:111]
  v_exp_f32 v123, v123
  v_exp_f32 v124, v124
  v_exp_f32 v125, v125
  v_exp_f32 v126, v126
  v_exp_f32 v127, v127
  v_cvt_pk_bf16_f32 v148, v120, v121
  v_cvt_pk_bf16_f32 v149, v122, v123
  v_cvt_pk_bf16_f32 v150, v124, v125
  v_cvt_pk_bf16_f32 v151, v126, v127
  s_waitcnt vmcnt(15)
  v_mfma_f32_32x32x16_bf16 v[112:127], a[48:51], v[24:27], 0
  buffer_load_dwordx4 a[28:31], v4, s[24:27], s9 offen offset:3072
  v_exp_f32 v128, v128
  v_exp_f32 v129, v129
  v_exp_f32 v130, v130
  v_exp_f32 v131, v131
  v_mfma_f32_32x32x16_bf16 v[96:111], a[44:47], v[148:151], v[96:111]
  buffer_load_dwordx4 v[212:215], v4, s[68:71], s48 offen offset:3072
  v_exp_f32 v132, v132
  v_exp_f32 v133, v133
  v_exp_f32 v134, v134
  v_exp_f32 v135, v135
  v_mfma_f32_32x32x16_bf16 v[112:127], a[52:55], v[28:31], v[112:127]
  v_cvt_pk_bf16_f32 v144, v128, v129
  v_cvt_pk_bf16_f32 v145, v130, v131
  v_cvt_pk_bf16_f32 v146, v132, v133
  v_cvt_pk_bf16_f32 v147, v134, v135
  v_exp_f32 v136, v136
  v_exp_f32 v137, v137
  v_exp_f32 v138, v138
  v_mfma_f32_32x32x16_bf16 v[48:63], a[40:43], v[144:147], v[48:63]
  v_exp_f32 v139, v139
  v_exp_f32 v140, v140
  v_exp_f32 v141, v141
  v_exp_f32 v142, v142
  v_exp_f32 v143, v143
  v_cvt_pk_bf16_f32 v148, v136, v137
  v_cvt_pk_bf16_f32 v149, v138, v139
  v_cvt_pk_bf16_f32 v150, v140, v141
  v_cvt_pk_bf16_f32 v151, v142, v143
  v_mfma_f32_32x32x16_bf16 v[128:143], a[48:51], v[32:35], 0
  s_add_u32 s9, s9, 16384
  s_and_b32 s9, s9, 0x3ffff
  s_bitcmp1_b32 s28, 14
  s_cbranch_scc0 mm_l1_tw67
mm_l1_tw67_b:
  buffer_load_dwordx4 a[32:35], v4, s[24:27], s9 offen offset:0
  v_exp_f32 v112, v112
  v_exp_f32 v113, v113
  v_exp_f32 v114, v114
  v_exp_f32 v115, v115
  v_mfma_f32_32x32x16_bf16 v[48:63], a[44:47], v[148:151], v[48:63]
  v_exp_f32 v116, v116
  v_exp_f32 v117, v117
  v_exp_f32 v118, v118
  v_exp_f32 v119, v119
  v_mfma_f32_32x32x16_bf16 v[128:143], a[52:55], v[36:39], v[128:143]
  v_cvt_pk_bf16_f32 v144, v112, v113
  v_cvt_pk_bf16_f32 v145, v114, v115
  v_cvt_pk_bf16_f32 v146, v116, v117
  v_cvt_pk_bf16_f32 v147, v118, v119
  v_exp_f32 v120, v120
  v_exp_f32 v121, v121
  v_exp_f32 v122, v122
  v_mfma_f32_32x32x16_bf16 v[64:79], a[56:59], v[144:147], v[64:79]
  v_exp_f32 v123, v123
  v_exp_f32 v124, v124
  v_exp_f32 v125, v125
  v_exp_f32 v126, v126
  v_exp_f32 v127, v127
  v_cvt_pk_bf16_f32 v148, v120, v121
  v_cvt_pk_bf16_f32 v149, v122, v123
  v_cvt_pk_bf16_f32 v150, v124, v125
  v_cvt_pk_bf16_f32 v151, v126, v127
  v_mfma_f32_32x32x16_bf16 v[112:127], a[48:51], v[40:43], 0
  buffer_load_dwordx4 a[36:39], v4, s[24:27], s9 offen offset:1024
  v_exp_f32 v128, v128
  v_exp_f32 v129, v129
  v_exp_f32 v130, v130
  v_exp_f32 v131, v131
  v_mfma_f32_32x32x16_bf16 v[64:79], a[60:63], v[148:151], v[64:79]
  v_exp_f32 v132, v132
  v_exp_f32 v133, v133
  v_exp_f32 v134, v134
  v_exp_f32 v135, v135
  v_mfma_f32_32x32x16_bf16 v[112:127], a[52:55], v[44:47], v[112:127]
  v_cvt_pk_bf16_f32 v144, v128, v129
  v_cvt_pk_bf16_f32 v145, v130, v131
  v_cvt_pk_bf16_f32 v146, v132, v133
  v_cvt_pk_bf16_f32 v147, v134, v135
  v_exp_f32 v136, v136
  v_exp_f32 v137, v137
  v_exp_f32 v138, v138
  v_mfma_f32_32x32x16_bf16 v[80:95], a[56:59], v[144:147], v[80:95]
  v_exp_f32 v139, v139
  v_exp_f32 v140, v140
  v_exp_f32 v141, v141
  v_exp_f32 v142, v142
  v_exp_f32 v143, v143
  v_cvt_pk_bf16_f32 v148, v136, v137
  v_cvt_pk_bf16_f32 v149, v138, v139
  v_cvt_pk_bf16_f32 v150, v140, v141
  v_cvt_pk_bf16_f32 v151, v142, v143
  v_mfma_f32_32x32x16_bf16 v[128:143], a[48:51], v[16:19], 0
  buffer_load_dwordx4 a[40:43], v4, s[24:27], s9 offen offset:2048
  v_exp_f32 v112, v112
  v_exp_f32 v113, v113
  v_exp_f32 v114, v114
  v_exp_f32 v115, v115
  v_mfma_f32_32x32x16_bf16 v[80:95], a[60:63], v[148:151], v[80:95]
  v_exp_f32 v116, v116
  v_exp_f32 v117, v117
  v_exp_f32 v118, v118
  v_exp_f32 v119, v119
  v_mfma_f32_32x32x16_bf16 v[128:143], a[52:55], v[20:23], v[128:143]
  v_cvt_pk_bf16_f32 v144, v112, v113
  v_cvt_pk_bf16_f32 v145, v114, v115
  v_cvt_pk_bf16_f32 v146, v116, v117
  v_cvt_pk_bf16_f32 v147, v118, v119
  v_exp_f32 v120, v120
  v_exp_f32 v121, v121
  v_exp_f32 v122, v122
  v_mfma_f32_32x32x16_bf16 v[96:111], a[56:59], v[144:147], v[96:111]
  v_exp_f32 v123, v123
  v_exp_f32 v124, v124
  v_exp_f32 v125, v125
  v_exp_f32 v126, v126
  v_exp_f32 v127, v127
  v_cvt_pk_bf16_f32 v148, v120, v121
  v_cvt_pk_bf16_f32 v149, v122, v123
  v_cvt_pk_bf16_f32 v150, v124, v125
  v_cvt_pk_bf16_f32 v151, v126, v127
  s_waitcnt vmcnt(12)
  v_mfma_f32_32x32x16_bf16 v[112:127], a[0:3], v[24:27], 0
  buffer_load_dwordx4 a[44:47], v4, s[24:27], s9 offen offset:3072
  v_exp_f32 v128, v128
  v_exp_f32 v129, v129
  v_exp_f32 v130, v130
  v_exp_f32 v131, v131
  v_mfma_f32_32x32x16_bf16 v[96:111], a[60:63], v[148:151], v[96:111]
  v_exp_f32 v132, v132
  v_exp_f32 v133, v133
  v_exp_f32 v134, v134
  v_exp_f32 v135, v135
  v_mfma_f32_32x32x16_bf16 v[112:127], a[4:7], v[28:31], v[112:127]
  v_cvt_pk_bf16_f32 v144, v128, v129
  v_cvt_pk_bf16_f32 v145, v130, v131
  v_cvt_pk_bf16_f32 v146, v132, v133
  v_cvt_pk_bf16_f32 v147, v134, v135
  v_exp_f32 v136, v136
  v_exp_f32 v137, v137
  v_exp_f32 v138, v138
  v_mfma_f32_32x32x16_bf16 v[48:63], a[56:59], v[144:147], v[48:63]
  v_exp_f32 v139, v139
  v_exp_f32 v140, v140
  v_exp_f32 v141, v141
  v_exp_f32 v142, v142
  v_exp_f32 v143, v143
  v_cvt_pk_bf16_f32 v148, v136, v137
  v_cvt_pk_bf16_f32 v149, v138, v139
  v_cvt_pk_bf16_f32 v150, v140, v141
  v_cvt_pk_bf16_f32 v151, v142, v143
  v_mfma_f32_32x32x16_bf16 v[128:143], a[0:3], v[32:35], 0
  s_add_u32 s9, s9, 16384
  s_and_b32 s9, s9, 0x3ffff
  s_bitcmp1_b32 s28, 15
  s_cbranch_scc0 mm_l1_tw68
mm_l1_tw68_b:
  buffer_load_dwordx4 a[48:51], v4, s[24:27], s9 offen offset:0
  v_exp_f32 v112, v112
  v_exp_f32 v113, v113
  v_exp_f32 v114, v114
  v_exp_f32 v115, v115
  v_mfma_f32_32x32x16_bf16 v[48:63], a[60:63], v[148:151], v[48:63]
  v_exp_f32 v116, v116
  v_exp_f32 v117, v117
  v_exp_f32 v118, v118
  v_exp_f32 v119, v119
  v_mfma_f32_32x32x16_bf16 v[128:143], a[4:7], v[36:39], v[128:143]
  v_cvt_pk_bf16_f32 v144, v112, v113
  v_cvt_pk_bf16_f32 v145, v114, v115
  v_cvt_pk_bf16_f32 v146, v116, v117
  v_cvt_pk_bf16_f32 v147, v118, v119
  v_exp_f32 v120, v120
  v_exp_f32 v121, v121
  v_exp_f32 v122, v122
  v_mfma_f32_32x32x16_bf16 v[64:79], a[8:11], v[144:147], v[64:79]
  v_exp_f32 v123, v123
  v_exp_f32 v124, v124
  v_exp_f32 v125, v125
  v_exp_f32 v126, v126
  v_exp_f32 v127, v127
  v_cvt_pk_bf16_f32 v148, v120, v121
  v_cvt_pk_bf16_f32 v149, v122, v123
  v_cvt_pk_bf16_f32 v150, v124, v125
  v_cvt_pk_bf16_f32 v151, v126, v127
  v_mfma_f32_32x32x16_bf16 v[112:127], a[0:3], v[40:43], 0
  buffer_load_dwordx4 a[52:55], v4, s[24:27], s9 offen offset:1024
  v_exp_f32 v128, v128
  v_exp_f32 v129, v129
  v_exp_f32 v130, v130
  v_exp_f32 v131, v131
  v_mfma_f32_32x32x16_bf16 v[64:79], a[12:15], v[148:151], v[64:79]
  v_exp_f32 v132, v132
  v_exp_f32 v133, v133
  v_exp_f32 v134, v134
  v_exp_f32 v135, v135
  v_mfma_f32_32x32x16_bf16 v[112:127], a[4:7], v[44:47], v[112:127]
  v_cvt_pk_bf16_f32 v144, v128, v129
  v_cvt_pk_bf16_f32 v145, v130, v131
  v_cvt_pk_bf16_f32 v146, v132, v133
  v_cvt_pk_bf16_f32 v147, v134, v135
  v_exp_f32 v136, v136
  v_exp_f32 v137, v137
  v_exp_f32 v138, v138
  v_mfma_f32_32x32x16_bf16 v[80:95], a[8:11], v[144:147], v[80:95]
  v_exp_f32 v139, v139
  v_exp_f32 v140, v140
  v_exp_f32 v141, v141
  v_exp_f32 v142, v142
  v_exp_f32 v143, v143
  v_cvt_pk_bf16_f32 v148, v136, v137
  v_cvt_pk_bf16_f32 v149, v138, v139
  v_cvt_pk_bf16_f32 v150, v140, v141
  v_cvt_pk_bf16_f32 v151, v142, v143
  v_mfma_f32_32x32x16_bf16 v[128:143], a[0:3], v[16:19], 0
  buffer_load_dwordx4 a[56:59], v4, s[24:27], s9 offen offset:2048
  v_exp_f32 v112, v112
  v_exp_f32 v113, v113
  v_exp_f32 v114, v114
  v_exp_f32 v115, v115
  v_mfma_f32_32x32x16_bf16 v[80:95], a[12:15], v[148:151], v[80:95]
  v_exp_f32 v116, v116
  v_exp_f32 v117, v117
  v_exp_f32 v118, v118
  v_exp_f32 v119, v119
  v_mfma_f32_32x32x16_bf16 v[128:143], a[4:7], v[20:23], v[128:143]
  v_cvt_pk_bf16_f32 v144, v112, v113
  v_cvt_pk_bf16_f32 v145, v114, v115
  v_cvt_pk_bf16_f32 v146, v116, v117
  v_cvt_pk_bf16_f32 v147, v118, v119
  v_exp_f32 v120, v120
  v_exp_f32 v121, v121
  v_exp_f32 v122, v122
  v_mfma_f32_32x32x16_bf16 v[96:111], a[8:11], v[144:147], v[96:111]
  v_exp_f32 v123, v123
  v_exp_f32 v124, v124
  v_exp_f32 v125, v125
  v_exp_f32 v126, v126
  v_exp_f32 v127, v127
  v_cvt_pk_bf16_f32 v148, v120, v121
  v_cvt_pk_bf16_f32 v149, v122, v123
  v_cvt_pk_bf16_f32 v150, v124, v125
  v_cvt_pk_bf16_f32 v151, v126, v127
  s_waitcnt vmcnt(8)
  v_mfma_f32_32x32x16_bf16 v[112:127], a[16:19], v[24:27], 0
  buffer_load_dwordx4 a[60:63], v4, s[24:27], s9 offen offset:3072
  v_exp_f32 v128, v128
  v_exp_f32 v129, v129
  v_exp_f32 v130, v130
  v_exp_f32 v131, v131
  v_mfma_f32_32x32x16_bf16 v[96:111], a[12:15], v[148:151], v[96:111]
  v_exp_f32 v132, v132
  v_exp_f32 v133, v133
  v_exp_f32 v134, v134
  v_exp_f32 v135, v135
  v_mfma_f32_32x32x16_bf16 v[112:127], a[20:23], v[28:31], v[112:127]
  v_cvt_pk_bf16_f32 v144, v128, v129
  v_cvt_pk_bf16_f32 v145, v130, v131
  v_cvt_pk_bf16_f32 v146, v132, v133
  v_cvt_pk_bf16_f32 v147, v134, v135
  v_exp_f32 v136, v136
  v_exp_f32 v137, v137
  v_exp_f32 v138, v138
  v_mfma_f32_32x32x16_bf16 v[48:63], a[8:11], v[144:147], v[48:63]
  v_exp_f32 v139, v139
  v_exp_f32 v140, v140
  v_exp_f32 v141, v141
  v_exp_f32 v142, v142
  v_exp_f32 v143, v143
  v_cvt_pk_bf16_f32 v148, v136, v137
  v_cvt_pk_bf16_f32 v149, v138, v139
  v_cvt_pk_bf16_f32 v150, v140, v141
  v_cvt_pk_bf16_f32 v151, v142, v143
  v_mfma_f32_32x32x16_bf16 v[128:143], a[16:19], v[32:35], 0
  v_exp_f32 v112, v112
  v_exp_f32 v113, v113
  v_exp_f32 v114, v114
  v_exp_f32 v115, v115
  v_mfma_f32_32x32x16_bf16 v[48:63], a[12:15], v[148:151], v[48:63]
  v_exp_f32 v116, v116
  v_exp_f32 v117, v117
  v_exp_f32 v118, v118
  v_exp_f32 v119, v119
  v_mfma_f32_32x32x16_bf16 v[128:143], a[20:23], v[36:39], v[128:143]
  v_cvt_pk_bf16_f32 v144, v112, v113
  v_cvt_pk_bf16_f32 v145, v114, v115
  v_cvt_pk_bf16_f32 v146, v116, v117
  v_cvt_pk_bf16_f32 v147, v118, v119
  v_exp_f32 v120, v120
  v_exp_f32 v121, v121
  v_exp_f32 v122, v122
  v_mfma_f32_32x32x16_bf16 v[64:79], a[24:27], v[144:147], v[64:79]
  v_exp_f32 v123, v123
  v_exp_f32 v124, v124
  v_exp_f32 v125, v125
  v_exp_f32 v126, v126
  v_exp_f32 v127, v127
  v_cvt_pk_bf16_f32 v148, v120, v121
  v_cvt_pk_bf16_f32 v149, v122, v123
  v_cvt_pk_bf16_f32 v150, v124, v125
  v_cvt_pk_bf16_f32 v151, v126, v127
  v_mfma_f32_32x32x16_bf16 v[112:127], a[16:19], v[40:43], 0
  v_exp_f32 v128, v128
  v_exp_f32 v129, v129
  v_exp_f32 v130, v130
  v_exp_f32 v131, v131
  v_mfma_f32_32x32x16_bf16 v[64:79], a[28:31], v[148:151], v[64:79]
  v_exp_f32 v132, v132
  v_exp_f32 v133, v133
  v_exp_f32 v134, v134
  v_exp_f32 v135, v135
  v_mfma_f32_32x32x16_bf16 v[112:127], a[20:23], v[44:47], v[112:127]
  v_cvt_pk_bf16_f32 v144, v128, v129
  v_cvt_pk_bf16_f32 v145, v130, v131
  v_cvt_pk_bf16_f32 v146, v132, v133
  v_cvt_pk_bf16_f32 v147, v134, v135
  v_exp_f32 v136, v136
  v_exp_f32 v137, v137
  v_exp_f32 v138, v138
  v_mfma_f32_32x32x16_bf16 v[80:95], a[24:27], v[144:147], v[80:95]
  v_exp_f32 v139, v139
  v_exp_f32 v140, v140
  v_exp_f32 v141, v141
  v_exp_f32 v142, v142
  v_exp_f32 v143, v143
  v_cvt_pk_bf16_f32 v148, v136, v137
  v_cvt_pk_bf16_f32 v149, v138, v139
  v_cvt_pk_bf16_f32 v150, v140, v141
  v_cvt_pk_bf16_f32 v151, v142, v143
  v_mfma_f32_32x32x16_bf16 v[128:143], a[16:19], v[16:19], 0
  v_exp_f32 v112, v112
  v_exp_f32 v113, v113
  v_exp_f32 v114, v114
  v_exp_f32 v115, v115
  v_mfma_f32_32x32x16_bf16 v[80:95], a[28:31], v[148:151], v[80:95]
  v_exp_f32 v116, v116
  v_exp_f32 v117, v117
  v_exp_f32 v118, v118
  v_exp_f32 v119, v119
  v_mfma_f32_32x32x16_bf16 v[128:143], a[20:23], v[20:23], v[128:143]
  v_cvt_pk_bf16_f32 v144, v112, v113
  v_cvt_pk_bf16_f32 v145, v114, v115
  v_cvt_pk_bf16_f32 v146, v116, v117
  v_cvt_pk_bf16_f32 v147, v118, v119
  v_exp_f32 v120, v120
  v_exp_f32 v121, v121
  v_exp_f32 v122, v122
  v_mfma_f32_32x32x16_bf16 v[96:111], a[24:27], v[144:147], v[96:111]
  v_exp_f32 v123, v123
  v_exp_f32 v124, v124
  v_exp_f32 v125, v125
  v_exp_f32 v126, v126
  v_exp_f32 v127, v127
  v_cvt_pk_bf16_f32 v148, v120, v121
  v_cvt_pk_bf16_f32 v149, v122, v123
  v_cvt_pk_bf16_f32 v150, v124, v125
  v_cvt_pk_bf16_f32 v151, v126, v127
  s_waitcnt vmcnt(4)
  v_mfma_f32_32x32x16_bf16 v[112:127], a[32:35], v[24:27], 0
  v_exp_f32 v128, v128
  v_exp_f32 v129, v129
  v_exp_f32 v130, v130
  v_exp_f32 v131, v131
  v_mfma_f32_32x32x16_bf16 v[96:111], a[28:31], v[148:151], v[96:111]
  v_exp_f32 v132, v132
  v_exp_f32 v133, v133
  v_exp_f32 v134, v134
  v_exp_f32 v135, v135
  v_mfma_f32_32x32x16_bf16 v[112:127], a[36:39], v[28:31], v[112:127]
  v_cvt_pk_bf16_f32 v144, v128, v129
  v_cvt_pk_bf16_f32 v145, v130, v131
  v_cvt_pk_bf16_f32 v146, v132, v133
  v_cvt_pk_bf16_f32 v147, v134, v135
  v_exp_f32 v136, v136
  v_exp_f32 v137, v137
  v_exp_f32 v138, v138
  v_mfma_f32_32x32x16_bf16 v[48:63], a[24:27], v[144:147], v[48:63]
  v_exp_f32 v139, v139
  v_exp_f32 v140, v140
  v_exp_f32 v141, v141
  v_exp_f32 v142, v142
  v_exp_f32 v143, v143
  v_cvt_pk_bf16_f32 v148, v136, v137
  v_cvt_pk_bf16_f32 v149, v138, v139
  v_cvt_pk_bf16_f32 v150, v140, v141
  v_cvt_pk_bf16_f32 v151, v142, v143
  v_mfma_f32_32x32x16_bf16 v[128:143], a[32:35], v[32:35], 0
  v_exp_f32 v112, v112
  v_exp_f32 v113, v113
  v_exp_f32 v114, v114
  v_exp_f32 v115, v115
  v_mfma_f32_32x32x16_bf16 v[48:63], a[28:31], v[148:151], v[48:63]
  v_exp_f32 v116, v116
  v_exp_f32 v117, v117
  v_exp_f32 v118, v118
  v_exp_f32 v119, v119
  v_mfma_f32_32x32x16_bf16 v[128:143], a[36:39], v[36:39], v[128:143]
  v_cvt_pk_bf16_f32 v144, v112, v113
  v_cvt_pk_bf16_f32 v145, v114, v115
  v_cvt_pk_bf16_f32 v146, v116, v117
  v_cvt_pk_bf16_f32 v147, v118, v119
  v_exp_f32 v120, v120
  v_exp_f32 v121, v121
  v_exp_f32 v122, v122
  v_mfma_f32_32x32x16_bf16 v[64:79], a[40:43], v[144:147], v[64:79]
  v_exp_f32 v123, v123
  v_exp_f32 v124, v124
  v_exp_f32 v125, v125
  v_exp_f32 v126, v126
  v_exp_f32 v127, v127
  v_cvt_pk_bf16_f32 v148, v120, v121
  v_cvt_pk_bf16_f32 v149, v122, v123
  v_cvt_pk_bf16_f32 v150, v124, v125
  v_cvt_pk_bf16_f32 v151, v126, v127
  v_mfma_f32_32x32x16_bf16 v[112:127], a[32:35], v[40:43], 0
  v_exp_f32 v128, v128
  v_exp_f32 v129, v129
  v_exp_f32 v130, v130
  v_exp_f32 v131, v131
  v_mfma_f32_32x32x16_bf16 v[64:79], a[44:47], v[148:151], v[64:79]
  v_exp_f32 v132, v132
  v_exp_f32 v133, v133
  v_exp_f32 v134, v134
  v_exp_f32 v135, v135
  v_mfma_f32_32x32x16_bf16 v[112:127], a[36:39], v[44:47], v[112:127]
  v_cvt_pk_bf16_f32 v144, v128, v129
  v_cvt_pk_bf16_f32 v145, v130, v131
  v_cvt_pk_bf16_f32 v146, v132, v133
  v_cvt_pk_bf16_f32 v147, v134, v135
  v_exp_f32 v136, v136
  v_exp_f32 v137, v137
  v_exp_f32 v138, v138
  v_mfma_f32_32x32x16_bf16 v[80:95], a[40:43], v[144:147], v[80:95]
  v_exp_f32 v139, v139
  v_exp_f32 v140, v140
  v_exp_f32 v141, v141
  v_exp_f32 v142, v142
  v_exp_f32 v143, v143
  v_cvt_pk_bf16_f32 v148, v136, v137
  v_cvt_pk_bf16_f32 v149, v138, v139
  v_cvt_pk_bf16_f32 v150, v140, v141
  v_cvt_pk_bf16_f32 v151, v142, v143
  v_mfma_f32_32x32x16_bf16 v[128:143], a[32:35], v[16:19], 0
  v_exp_f32 v112, v112
  v_exp_f32 v113, v113
  v_exp_f32 v114, v114
  v_exp_f32 v115, v115
  v_mfma_f32_32x32x16_bf16 v[80:95], a[44:47], v[148:151], v[80:95]
  v_exp_f32 v116, v116
  v_exp_f32 v117, v117
  v_exp_f32 v118, v118
  v_exp_f32 v119, v119
  v_mfma_f32_32x32x16_bf16 v[128:143], a[36:39], v[20:23], v[128:143]
  v_cvt_pk_bf16_f32 v144, v112, v113
  v_cvt_pk_bf16_f32 v145, v114, v115
  v_cvt_pk_bf16_f32 v146, v116, v117
  v_cvt_pk_bf16_f32 v147, v118, v119
  v_exp_f32 v120, v120
  v_exp_f32 v121, v121
  v_exp_f32 v122, v122
  v_mfma_f32_32x32x16_bf16 v[96:111], a[40:43], v[144:147], v[96:111]
  v_exp_f32 v123, v123
  v_exp_f32 v124, v124
  v_exp_f32 v125, v125
  v_exp_f32 v126, v126
  v_exp_f32 v127, v127
  v_cvt_pk_bf16_f32 v148, v120, v121
  v_cvt_pk_bf16_f32 v149, v122, v123
  v_cvt_pk_bf16_f32 v150, v124, v125
  v_cvt_pk_bf16_f32 v151, v126, v127
  s_waitcnt vmcnt(0)
  v_mfma_f32_32x32x16_bf16 v[112:127], a[48:51], v[24:27], 0
  v_exp_f32 v128, v128
  v_exp_f32 v129, v129
  v_exp_f32 v130, v130
  v_exp_f32 v131, v131
  v_mfma_f32_32x32x16_bf16 v[96:111], a[44:47], v[148:151], v[96:111]
  v_exp_f32 v132, v132
  v_exp_f32 v133, v133
  v_exp_f32 v134, v134
  v_exp_f32 v135, v135
  v_mfma_f32_32x32x16_bf16 v[112:127], a[52:55], v[28:31], v[112:127]
  v_cvt_pk_bf16_f32 v144, v128, v129
  v_cvt_pk_bf16_f32 v145, v130, v131
  v_cvt_pk_bf16_f32 v146, v132, v133
  v_cvt_pk_bf16_f32 v147, v134, v135
  v_exp_f32 v136, v136
  v_exp_f32 v137, v137
  v_exp_f32 v138, v138
  v_mfma_f32_32x32x16_bf16 v[48:63], a[40:43], v[144:147], v[48:63]
  v_exp_f32 v139, v139
  v_exp_f32 v140, v140
  v_exp_f32 v141, v141
  v_exp_f32 v142, v142
  v_exp_f32 v143, v143
  v_cvt_pk_bf16_f32 v148, v136, v137
  v_cvt_pk_bf16_f32 v149, v138, v139
  v_cvt_pk_bf16_f32 v150, v140, v141
  v_cvt_pk_bf16_f32 v151, v142, v143
  v_mfma_f32_32x32x16_bf16 v[128:143], a[48:51], v[32:35], 0
  v_exp_f32 v112, v112
  v_exp_f32 v113, v113
  v_exp_f32 v114, v114
  v_exp_f32 v115, v115
  v_mfma_f32_32x32x16_bf16 v[48:63], a[44:47], v[148:151], v[48:63]
  v_exp_f32 v116, v116
  v_exp_f32 v117, v117
  v_exp_f32 v118, v118
  v_exp_f32 v119, v119
  v_mfma_f32_32x32x16_bf16 v[128:143], a[52:55], v[36:39], v[128:143]
  v_cvt_pk_bf16_f32 v144, v112, v113
  v_cvt_pk_bf16_f32 v145, v114, v115
  v_cvt_pk_bf16_f32 v146, v116, v117
  v_cvt_pk_bf16_f32 v147, v118, v119
  v_exp_f32 v120, v120
  v_exp_f32 v121, v121
  v_exp_f32 v122, v122
  v_mfma_f32_32x32x16_bf16 v[64:79], a[56:59], v[144:147], v[64:79]
  v_exp_f32 v123, v123
  v_exp_f32 v124, v124
  v_exp_f32 v125, v125
  v_exp_f32 v126, v126
  v_exp_f32 v127, v127
  v_cvt_pk_bf16_f32 v148, v120, v121
  v_cvt_pk_bf16_f32 v149, v122, v123
  v_cvt_pk_bf16_f32 v150, v124, v125
  v_cvt_pk_bf16_f32 v151, v126, v127
  v_mfma_f32_32x32x16_bf16 v[112:127], a[48:51], v[40:43], 0
  v_exp_f32 v128, v128
  v_exp_f32 v129, v129
  v_exp_f32 v130, v130
  v_exp_f32 v131, v131
  v_mfma_f32_32x32x16_bf16 v[64:79], a[60:63], v[148:151], v[64:79]
  v_exp_f32 v132, v132
  v_exp_f32 v133, v133
  v_exp_f32 v134, v134
  v_exp_f32 v135, v135
  v_mfma_f32_32x32x16_bf16 v[112:127], a[52:55], v[44:47], v[112:127]
  v_cvt_pk_bf16_f32 v144, v128, v129
  v_cvt_pk_bf16_f32 v145, v130, v131
  v_cvt_pk_bf16_f32 v146, v132, v133
  v_cvt_pk_bf16_f32 v147, v134, v135
  v_exp_f32 v136, v136
  v_exp_f32 v137, v137
  v_exp_f32 v138, v138
  v_mfma_f32_32x32x16_bf16 v[80:95], a[56:59], v[144:147], v[80:95]
  v_exp_f32 v139, v139
  v_exp_f32 v140, v140
  v_exp_f32 v141, v141
  v_exp_f32 v142, v142
  v_exp_f32 v143, v143
  v_cvt_pk_bf16_f32 v148, v136, v137
  v_cvt_pk_bf16_f32 v149, v138, v139
  v_cvt_pk_bf16_f32 v150, v140, v141
  v_cvt_pk_bf16_f32 v151, v142, v143
  v_mfma_f32_32x32x16_bf16 v[128:143], a[48:51], v[16:19], 0
  v_exp_f32 v112, v112
  v_exp_f32 v113, v113
  v_exp_f32 v114, v114
  v_exp_f32 v115, v115
  v_mfma_f32_32x32x16_bf16 v[80:95], a[60:63], v[148:151], v[80:95]
  v_exp_f32 v116, v116
  v_exp_f32 v117, v117
  v_exp_f32 v118, v118
  v_exp_f32 v119, v119
  v_mfma_f32_32x32x16_bf16 v[128:143], a[52:55], v[20:23], v[128:143]
  v_cvt_pk_bf16_f32 v144, v112, v113
  v_cvt_pk_bf16_f32 v145, v114, v115
  v_cvt_pk_bf16_f32 v146, v116, v117
  v_cvt_pk_bf16_f32 v147, v118, v119
  v_exp_f32 v120, v120
  v_exp_f32 v121, v121
  v_exp_f32 v122, v122
  v_mfma_f32_32x32x16_bf16 v[96:111], a[56:59], v[144:147], v[96:111]
  v_exp_f32 v123, v123
  ds_write_b128 v6, v[64:67] offset:0
  v_exp_f32 v124, v124
  ds_write_b128 v6, v[68:71] offset:1024
  v_exp_f32 v125, v125
  ds_write_b128 v6, v[72:75] offset:2048
  v_exp_f32 v126, v126
  ds_write_b128 v6, v[76:79] offset:3072
  v_exp_f32 v127, v127
  v_cvt_pk_bf16_f32 v148, v120, v121
  v_cvt_pk_bf16_f32 v149, v122, v123
  v_cvt_pk_bf16_f32 v150, v124, v125
  v_cvt_pk_bf16_f32 v151, v126, v127
  v_exp_f32 v128, v128
  v_exp_f32 v129, v129
  v_exp_f32 v130, v130
  v_exp_f32 v131, v131
  v_mfma_f32_32x32x16_bf16 v[96:111], a[60:63], v[148:151], v[96:111]
  v_exp_f32 v132, v132
  v_exp_f32 v133, v133
  v_exp_f32 v134, v134
  v_exp_f32 v135, v135
  v_cvt_pk_bf16_f32 v144, v128, v129
  v_cvt_pk_bf16_f32 v145, v130, v131
  v_cvt_pk_bf16_f32 v146, v132, v133
  v_cvt_pk_bf16_f32 v147, v134, v135
  v_exp_f32 v136, v136
  v_exp_f32 v137, v137
  v_exp_f32 v138, v138
  v_mfma_f32_32x32x16_bf16 v[48:63], a[56:59], v[144:147], v[48:63]
  v_exp_f32 v139, v139
  ds_write_b128 v7, v[80:83] offset:0
  v_exp_f32 v140, v140
  ds_write_b128 v7, v[84:87] offset:1024
  v_exp_f32 v141, v141
  ds_write_b128 v7, v[88:91] offset:2048
  v_exp_f32 v142, v142
  ds_write_b128 v7, v[92:95] offset:3072
  v_exp_f32 v143, v143
  ds_write_b128 v8, v[96:99] offset:0
  v_cvt_pk_bf16_f32 v148, v136, v137
  ds_write_b128 v8, v[100:103] offset:1024
  v_cvt_pk_bf16_f32 v149, v138, v139
  ds_write_b128 v8, v[104:107] offset:2048
  v_cvt_pk_bf16_f32 v150, v140, v141
  ds_write_b128 v8, v[108:111] offset:3072
  v_cvt_pk_bf16_f32 v151, v142, v143
  s_nop 1
  v_mfma_f32_32x32x16_bf16 v[48:63], a[60:63], v[148:151], v[48:63]
  s_add_u32 s44, s12, 25690112
  buffer_load_dwordx4 v[248:251], v4, s[68:71], s44 offen offset:0 sc1
  buffer_load_dwordx4 v[252:255], v4, s[68:71], s44 offen offset:1024 sc1
  s_waitcnt lgkmcnt(0)
  s_barrier
  ds_read_b128 v[64:67], v5 offset:0
  ds_read_b128 v[68:71], v5 offset:1024
  ds_read_b128 v[72:75], v5 offset:2048
  ds_read_b128 v[76:79], v5 offset:3072
  ds_read_b128 v[80:83], v5 offset:4096
  ds_read_b128 v[84:87], v5 offset:5120
  ds_read_b128 v[88:91], v5 offset:6144
  ds_read_b128 v[92:95], v5 offset:7168
  ds_read_b128 v[96:99], v5 offset:8192
  ds_read_b128 v[100:103], v5 offset:9216
  ds_read_b128 v[104:107], v5 offset:10240
  ds_read_b128 v[108:111], v5 offset:11264
  s_waitcnt lgkmcnt(8)
  v_pk_add_f32 v[48:49], v[48:49], v[64:65]
  v_pk_add_f32 v[50:51], v[50:51], v[66:67]
  v_pk_add_f32 v[52:53], v[52:53], v[68:69]
  v_pk_add_f32 v[54:55], v[54:55], v[70:71]
  v_pk_add_f32 v[56:57], v[56:57], v[72:73]
  v_pk_add_f32 v[58:59], v[58:59], v[74:75]
  v_pk_add_f32 v[60:61], v[60:61], v[76:77]
  v_pk_add_f32 v[62:63], v[62:63], v[78:79]
  s_waitcnt lgkmcnt(4)
  v_pk_add_f32 v[48:49], v[48:49], v[80:81]
  v_pk_add_f32 v[50:51], v[50:51], v[82:83]
  v_pk_add_f32 v[52:53], v[52:53], v[84:85]
  v_pk_add_f32 v[54:55], v[54:55], v[86:87]
  v_pk_add_f32 v[56:57], v[56:57], v[88:89]
  v_pk_add_f32 v[58:59], v[58:59], v[90:91]
  v_pk_add_f32 v[60:61], v[60:61], v[92:93]
  v_pk_add_f32 v[62:63], v[62:63], v[94:95]
  s_waitcnt lgkmcnt(0)
  v_pk_add_f32 v[60:61], v[60:61], v[108:109]
  v_mov_b32 v9, v60
  v_mov_b32 v8, v60
  v_pk_add_f32 v[48:49], v[48:49], v[96:97]
  v_pk_add_f32 v[50:51], v[50:51], v[98:99]
  v_permlane32_swap_b32 v9, v8
  v_pk_add_f32 v[52:53], v[52:53], v[100:101]
  v_rcp_f32 v9, v8
  v_cmp_nle_f32 vcc, s14, v8
  v_cmp_nge_f32 s[46:47], s15, v8
  v_pk_add_f32 v[54:55], v[54:55], v[102:103]
  v_pk_add_f32 v[56:57], v[56:57], v[104:105]
  v_pk_add_f32 v[58:59], v[58:59], v[106:107]
  s_or_b64 vcc, vcc, s[46:47]
  v_pk_add_f32 v[62:63], v[62:63], v[110:111]
  s_cbranch_vccnz mm_l1_fb
mm_l1_norm:
  v_pk_mul_f32 v[48:49], v[48:49], v[8:9] op_sel:[0,1] op_sel_hi:[1,1]
  v_pk_mul_f32 v[50:51], v[50:51], v[8:9] op_sel:[0,1] op_sel_hi:[1,1]
  v_pk_mul_f32 v[52:53], v[52:53], v[8:9] op_sel:[0,1] op_sel_hi:[1,1]
  v_pk_mul_f32 v[54:55], v[54:55], v[8:9] op_sel:[0,1] op_sel_hi:[1,1]
  v_cvt_pk_bf16_f32 v144, v48, v49
  v_cvt_pk_bf16_f32 v145, v50, v51
  v_cvt_pk_bf16_f32 v146, v52, v53
  v_cvt_pk_bf16_f32 v147, v54, v55
  buffer_store_dwordx4 v[144:147], v13, s[40:43], s49 offen offset:0 sc1
  v_pk_mul_f32 v[56:57], v[56:57], v[8:9] op_sel:[0,1] op_sel_hi:[1,1]
  v_pk_mul_f32 v[58:59], v[58:59], v[8:9] op_sel:[0,1] op_sel_hi:[1,1]
  v_pk_mul_f32 v[60:61], v[60:61], v[8:9] op_sel:[0,1] op_sel_hi:[1,1]
  v_pk_mul_f32 v[62:63], v[62:63], v[8:9] op_sel:[0,1] op_sel_hi:[1,1]
  v_cvt_pk_bf16_f32 v148, v56, v57
  v_cvt_pk_bf16_f32 v149, v58, v59
  v_cvt_pk_bf16_f32 v150, v60, v61
  v_cvt_pk_bf16_f32 v151, v62, v63
  buffer_store_dwordx4 v[148:151], v13, s[40:43], s49 offen offset:1024 sc1
  s_barrier
  s_waitcnt vmcnt(2)
  v_lshlrev_b32 v80, 16, v248
  v_and_b32 v81, s61, v248
  v_lshlrev_b32 v82, 16, v249
  v_and_b32 v83, s61, v249
  v_lshlrev_b32 v84, 16, v250
  v_and_b32 v85, s61, v250
  v_lshlrev_b32 v86, 16, v251
  v_and_b32 v87, s61, v251
  v_lshlrev_b32 v88, 16, v252
  v_and_b32 v89, s61, v252
  v_lshlrev_b32 v90, 16, v253
  v_and_b32 v91, s61, v253
  v_lshlrev_b32 v92, 16, v254
  v_and_b32 v93, s61, v254
  v_lshlrev_b32 v94, 16, v255
  v_and_b32 v95, s61, v255
  s_waitcnt vmcnt(0)
mm_l1_pr69:
  s_add_u32 s15, s51, 0
  buffer_load_dwordx4 v[20:23], v4, s[40:43], s15 offen offset:0 sc1
  buffer_load_dwordx4 v[28:31], v4, s[40:43], s15 offen offset:1024 sc1
  buffer_load_dwordx4 v[36:39], v4, s[40:43], s15 offen offset:2048 sc1
  buffer_load_dwordx4 v[44:47], v4, s[40:43], s15 offen offset:3072 sc1
  s_add_u32 s15, s51, 4096
  buffer_load_dwordx4 v[52:55], v4, s[40:43], s15 offen offset:0 sc1
  buffer_load_dwordx4 v[60:63], v4, s[40:43], s15 offen offset:1024 sc1
  buffer_load_dwordx4 v[68:71], v4, s[40:43], s15 offen offset:2048 sc1
  buffer_load_dwordx4 v[76:79], v4, s[40:43], s15 offen offset:3072 sc1
  s_add_u32 s15, s50, 0
  buffer_load_dwordx4 v[16:19], v4, s[40:43], s15 offen offset:0 sc1
  buffer_load_dwordx4 v[24:27], v4, s[40:43], s15 offen offset:1024 sc1
  buffer_load_dwordx4 v[32:35], v4, s[40:43], s15 offen offset:2048 sc1
  buffer_load_dwordx4 v[40:43], v4, s[40:43], s15 offen offset:3072 sc1
  s_add_u32 s15, s50, 4096
  buffer_load_dwordx4 v[48:51], v4, s[40:43], s15 offen offset:0 sc1
  buffer_load_dwordx4 v[56:59], v4, s[40:43], s15 offen offset:1024 sc1
  buffer_load_dwordx4 v[64:67], v4, s[40:43], s15 offen offset:2048 sc1
  buffer_load_dwordx4 v[72:75], v4, s[40:43], s15 offen offset:3072 sc1
  s_sub_i32 s13, s13, 1
  s_cmp_lt_i32 s13, 0
  s_waitcnt vmcnt(8)
  v_max_u32 v3, v20, v22
  v_max3_u32 v3, v28, v30, v3
  v_max3_u32 v3, v36, v38, v3
  v_max3_u32 v3, v44, v46, v3
  v_max3_u32 v3, v52, v54, v3
  v_max3_u32 v3, v60, v62, v3
  v_max3_u32 v3, v68, v70, v3
  v_max3_u32 v3, v76, v78, v3
  v_cmp_eq_u32 vcc, -1, v3
  s_cbranch_scc1 mm_l1_pr69_b
  s_nop 3
  s_cbranch_vccnz mm_l1_pr69
mm_l1_pr69_b:
  v_mfma_f32_32x32x16_bf16 v[128:143], v[184:187], v[20:23], 0
  v_mfma_f32_32x32x16_bf16 v[128:143], v[188:191], v[28:31], v[128:143]
  v_mfma_f32_32x32x16_bf16 v[128:143], v[192:195], v[36:39], v[128:143]
  v_mfma_f32_32x32x16_bf16 v[128:143], v[196:199], v[44:47], v[128:143]
  v_mfma_f32_32x32x16_bf16 v[128:143], v[200:203], v[52:55], v[128:143]
  v_mfma_f32_32x32x16_bf16 v[128:143], v[204:207], v[60:63], v[128:143]
  v_mfma_f32_32x32x16_bf16 v[128:143], v[208:211], v[68:71], v[128:143]
  v_mfma_f32_32x32x16_bf16 v[128:143], v[212:215], v[76:79], v[128:143]
  v_mfma_f32_32x32x16_bf16 v[112:127], v[152:155], v[20:23], 0
  v_mfma_f32_32x32x16_bf16 v[112:127], v[156:159], v[28:31], v[112:127]
  s_nop 9
  ds_write_b128 v12, v[128:131] offset:0
  v_mfma_f32_32x32x16_bf16 v[112:127], v[160:163], v[36:39], v[112:127]
  s_waitcnt vmcnt(0)
  v_max_u32 v3, v16, v18
  v_max3_u32 v3, v24, v26, v3
  v_max3_u32 v3, v32, v34, v3
  v_mfma_f32_32x32x16_bf16 v[112:127], v[164:167], v[44:47], v[112:127]
  ds_write_b128 v12, v[132:135] offset:1024
  v_max3_u32 v3, v40, v42, v3
  v_max3_u32 v3, v48, v50, v3
  v_max3_u32 v3, v56, v58, v3
  v_mfma_f32_32x32x16_bf16 v[112:127], v[168:171], v[52:55], v[112:127]
  v_max3_u32 v3, v64, v66, v3
  v_max3_u32 v3, v72, v74, v3
  v_cmp_eq_u32 vcc, -1, v3
  v_mfma_f32_32x32x16_bf16 v[112:127], v[172:175], v[60:63], v[112:127]
  ds_write_b128 v12, v[136:139] offset:2048
  v_mfma_f32_32x32x16_bf16 v[112:127], v[176:179], v[68:71], v[112:127]
  v_mfma_f32_32x32x16_bf16 v[112:127], v[180:183], v[76:79], v[112:127]
  ds_write_b128 v12, v[140:143] offset:3072
  s_cbranch_vccnz mm_l1_st70
mm_l1_st70_b:
  v_mfma_f32_32x32x16_bf16 v[96:111], v[184:187], v[16:19], 0
  v_mfma_f32_32x32x16_bf16 v[96:111], v[188:191], v[24:27], v[96:111]
  s_nop 7
  ds_write_b128 v11, v[112:115] offset:0
  v_mfma_f32_32x32x16_bf16 v[96:111], v[192:195], v[32:35], v[96:111]
  v_mfma_f32_32x32x16_bf16 v[96:111], v[196:199], v[40:43], v[96:111]
  ds_write_b128 v11, v[116:119] offset:1024
  v_mfma_f32_32x32x16_bf16 v[96:111], v[200:203], v[48:51], v[96:111]
  v_mfma_f32_32x32x16_bf16 v[96:111], v[204:207], v[56:59], v[96:111]
  ds_write_b128 v11, v[120:123] offset:2048
  v_mfma_f32_32x32x16_bf16 v[96:111], v[208:211], v[64:67], v[96:111]
  v_mfma_f32_32x32x16_bf16 v[96:111], v[212:215], v[72:75], v[96:111]
  ds_write_b128 v11, v[124:127] offset:3072
  v_mfma_f32_32x32x16_bf16 v[80:95], v[152:155], v[16:19], v[80:95]
  v_mfma_f32_32x32x16_bf16 v[80:95], v[156:159], v[24:27], v[80:95]
  s_nop 8
  ds_write_b128 v10, v[96:99] offset:0
  v_mfma_f32_32x32x16_bf16 v[80:95], v[160:163], v[32:35], v[80:95]
  v_mfma_f32_32x32x16_bf16 v[80:95], v[164:167], v[40:43], v[80:95]
  ds_write_b128 v10, v[100:103] offset:1024
  v_mfma_f32_32x32x16_bf16 v[80:95], v[168:171], v[48:51], v[80:95]
  v_mfma_f32_32x32x16_bf16 v[80:95], v[172:175], v[56:59], v[80:95]
  ds_write_b128 v10, v[104:107] offset:2048
  v_mfma_f32_32x32x16_bf16 v[80:95], v[176:179], v[64:67], v[80:95]
  v_mfma_f32_32x32x16_bf16 v[80:95], v[180:183], v[72:75], v[80:95]
  ds_write_b128 v10, v[108:111] offset:3072
  s_add_u32 s9, s12, 8912896
  s_lshr_b32 s15, s4, 3
  s_lshl_b32 s15, s15, 2
  s_add_u32 s15, s15, s3
  s_lshl_b32 s15, s15, 12
  s_add_u32 s15, s15, 33460224
  s_cmp_eq_u32 s70, 0
  s_cselect_b32 s9, s15, s9
  s_add_u32 s15, s15, 2048
  s_cmp_eq_u32 s70, 0
  s_cselect_b32 s56, s15, s56
  s_waitcnt lgkmcnt(0)
  s_barrier
  ds_read_b128 v[16:19], v5 offset:0
  ds_read_b128 v[20:23], v5 offset:1024
  ds_read_b128 v[24:27], v5 offset:2048
  ds_read_b128 v[28:31], v5 offset:3072
  ds_read_b128 v[32:35], v5 offset:4096
  ds_read_b128 v[36:39], v5 offset:5120
  ds_read_b128 v[40:43], v5 offset:6144
  ds_read_b128 v[44:47], v5 offset:7168
  ds_read_b128 v[48:51], v5 offset:8192
  ds_read_b128 v[52:55], v5 offset:9216
  ds_read_b128 v[56:59], v5 offset:10240
  ds_read_b128 v[60:63], v5 offset:11264
  s_waitcnt lgkmcnt(8)
  v_pk_add_f32 v[80:81], v[80:81], v[16:17]
  v_pk_add_f32 v[82:83], v[82:83], v[18:19]
  v_pk_add_f32 v[84:85], v[84:85], v[20:21]
  v_pk_add_f32 v[86:87], v[86:87], v[22:23]
  v_pk_add_f32 v[88:89], v[88:89], v[24:25]
  v_pk_add_f32 v[90:91], v[90:91], v[26:27]
  v_pk_add_f32 v[92:93], v[92:93], v[28:29]
  v_pk_add_f32 v[94:95], v[94:95], v[30:31]
  s_waitcnt lgkmcnt(4)
  v_pk_add_f32 v[80:81], v[80:81], v[32:33]
  v_pk_add_f32 v[82:83], v[82:83], v[34:35]
  v_pk_add_f32 v[84:85], v[84:85], v[36:37]
  v_pk_add_f32 v[86:87], v[86:87], v[38:39]
  v_pk_add_f32 v[88:89], v[88:89], v[40:41]
  v_pk_add_f32 v[90:91], v[90:91], v[42:43]
  v_pk_add_f32 v[92:93], v[92:93], v[44:45]
  v_pk_add_f32 v[94:95], v[94:95], v[46:47]
  s_waitcnt lgkmcnt(0)
  v_pk_add_f32 v[80:81], v[80:81], v[48:49]
  v_pk_add_f32 v[82:83], v[82:83], v[50:51]
  v_pk_add_f32 v[84:85], v[84:85], v[52:53]
  v_pk_add_f32 v[86:87], v[86:87], v[54:55]
  v_pk_add_f32 v[88:89], v[88:89], v[56:57]
  v_pk_add_f32 v[90:91], v[90:91], v[58:59]
  v_pk_add_f32 v[92:93], v[92:93], v[60:61]
  v_pk_add_f32 v[94:95], v[94:95], v[62:63]
  v_cvt_pk_bf16_f32 v248, v80, v81
  v_cvt_pk_bf16_f32 v249, v82, v83
  v_cvt_pk_bf16_f32 v250, v84, v85
  v_cvt_pk_bf16_f32 v251, v86, v87
  buffer_store_dwordx4 v[248:251], v4, s[40:43], s9 offen offset:0 sc1
  v_cvt_pk_bf16_f32 v252, v88, v89
  v_cvt_pk_bf16_f32 v253, v90, v91
  v_cvt_pk_bf16_f32 v254, v92, v93
  v_cvt_pk_bf16_f32 v255, v94, v95
  buffer_store_dwordx4 v[252:255], v4, s[40:43], s9 offen offset:1024 sc1
  v_pk_add_f32 v[6:7], v[80:81], v[82:83]
  v_pk_mul_f32 v[8:9], v[80:81], v[80:81]
  v_pk_fma_f32 v[8:9], v[82:83], v[82:83], v[8:9]
  v_pk_add_f32 v[6:7], v[6:7], v[84:85]
  v_pk_fma_f32 v[8:9], v[84:85], v[84:85], v[8:9]
  v_pk_add_f32 v[6:7], v[6:7], v[86:87]
  v_pk_fma_f32 v[8:9], v[86:87], v[86:87], v[8:9]
  v_pk_add_f32 v[6:7], v[6:7], v[88:89]
  v_pk_fma_f32 v[8:9], v[88:89], v[88:89], v[8:9]
  v_pk_add_f32 v[6:7], v[6:7], v[90:91]
  v_pk_fma_f32 v[8:9], v[90:91], v[90:91], v[8:9]
  v_pk_add_f32 v[6:7], v[6:7], v[92:93]
  v_pk_fma_f32 v[8:9], v[92:93], v[92:93], v[8:9]
  v_pk_add_f32 v[6:7], v[6:7], v[94:95]
  v_pk_fma_f32 v[8:9], v[94:95], v[94:95], v[8:9]
  v_add_f32 v6, v6, v7
  v_add_f32 v7, v8, v9
  v_mov_b32 v8, v6
  v_mov_b32 v9, v7
  s_nop 0
  v_permlane32_swap_b32 v6, v8
  v_permlane32_swap_b32 v7, v9
  s_mov_b32 exec_hi, 0
  v_pk_add_f32 v[6:7], v[6:7], v[8:9]
  buffer_store_dwordx2 v[6:7], v4, s[40:43], s56 offen sc1
  s_mov_b32 exec_hi, -1
mm_l1_xjoin:
  s_barrier
  v_add_u32 v5, 0x10000, v4
  v_add_u32 v6, 0x20000, v4
  v_mov_b32 v172, 0
  v_mov_b32 v173, 0
  v_mov_b32 v174, 0
  v_mov_b32 v175, 0
  s_waitcnt vmcnt(1)
  ds_read_b128 v[128:131], v4 offset:49152
  ds_read_b128 v[132:135], v4 offset:50176
  ds_read_b128 v[136:139], v4 offset:51200
  ds_read_b128 v[140:143], v4 offset:52224
  ds_read_b128 v[144:147], v4 offset:53248
  ds_read_b128 v[148:151], v4 offset:54272
mm_l1_pr71:
  s_add_u32 s15, s5, 6144
  buffer_load_dwordx4 v[176:179], v4, s[40:43], s15 offen offset:0 sc1
  s_add_u32 s15, s5, 13312
  buffer_load_dwordx4 v[180:183], v4, s[40:43], s15 offen offset:0 sc1
  s_add_u32 s15, s5, 20480
  buffer_load_dwordx4 v[184:187], v4, s[40:43], s15 offen offset:0 sc1
  s_add_u32 s15, s5, 27648
  buffer_load_dwordx4 v[188:191], v4, s[40:43], s15 offen offset:0 sc1
  s_add_u32 s15, s5, 0
  buffer_load_dwordx4 v[192:195], v4, s[40:43], s15 offen offset:0 sc1
  buffer_load_dwordx4 v[196:199], v4, s[40:43], s15 offen offset:1024 sc1
  buffer_load_dwordx4 v[200:203], v4, s[40:43], s15 offen offset:2048 sc1
  buffer_load_dwordx4 v[204:207], v4, s[40:43], s15 offen offset:3072 sc1
  s_add_u32 s15, s5, 4096
  buffer_load_dwordx4 v[208:211], v4, s[40:43], s15 offen offset:0 sc1
  buffer_load_dwordx4 v[212:215], v4, s[40:43], s15 offen offset:1024 sc1
  s_sub_i32 s13, s13, 1
  s_cmp_lt_i32 s13, 0
  s_waitcnt vmcnt(6)
  v_max_u32 v3, v176, v178
  v_max3_u32 v3, v180, v182, v3
  v_max3_u32 v3, v184, v186, v3
  v_max3_u32 v3, v188, v190, v3
  v_cmp_eq_u32 vcc, -1, v3
  s_cbranch_scc1 mm_l1_pr71_b
  s_nop 3
  s_cbranch_vccnz mm_l1_pr71
mm_l1_pr71_b:
  ds_read_b128 v[152:155], v4 offset:55296
  s_waitcnt lgkmcnt(5)
  v_mfma_f32_32x32x16_bf16 v[16:31], v[128:131], v[176:179], 0
  s_add_u32 s44, s5, 7168
  buffer_load_dwordx4 v[8:11], v4, s[40:43], s44 offen offset:0 sc1
  ds_read_b128 v[156:159], v4 offset:56320
  v_mfma_f32_32x32x16_bf16 v[32:47], v[132:135], v[176:179], 0
  ds_read_b128 v[128:131], v4 offset:57344
  s_waitcnt lgkmcnt(5)
  v_mfma_f32_32x32x16_bf16 v[48:63], v[136:139], v[176:179], 0
  buffer_load_dwordx4 v[12:15], v4, s[40:43], s44 offen offset:1024 sc1
  ds_read_b128 v[132:135], v4 offset:58368
  v_mfma_f32_32x32x16_bf16 v[16:31], v[140:143], v[180:183], v[16:31]
  ds_read_b128 v[136:139], v4 offset:59392
  s_waitcnt lgkmcnt(5)
  v_mfma_f32_32x32x16_bf16 v[32:47], v[144:147], v[180:183], v[32:47]
  ds_read_b128 v[140:143], v4 offset:60416
  v_mfma_f32_32x32x16_bf16 v[48:63], v[148:151], v[180:183], v[48:63]
  buffer_load_dwordx4 a[0:3], v4, s[40:43], s44 offen offset:2048 sc1
  ds_read_b128 v[144:147], v4 offset:61440
  s_waitcnt lgkmcnt(5)
  v_mfma_f32_32x32x16_bf16 v[16:31], v[152:155], v[184:187], v[16:31]
  ds_read_b128 v[148:151], v4 offset:62464
  v_mfma_f32_32x32x16_bf16 v[32:47], v[156:159], v[184:187], v[32:47]
  buffer_load_dwordx4 a[4:7], v4, s[40:43], s44 offen offset:3072 sc1
  ds_read_b128 v[152:155], v4 offset:63488
  s_waitcnt vmcnt(8)
  v_max_u32 v3, v192, v194
  v_max3_u32 v3, v196, v198, v3
  s_waitcnt lgkmcnt(5)
  v_mfma_f32_32x32x16_bf16 v[48:63], v[128:131], v[184:187], v[48:63]
  ds_read_b128 v[156:159], v4 offset:64512
  v_cmp_eq_u32 vcc, -1, v3
  v_mfma_f32_32x32x16_bf16 v[16:31], v[132:135], v[188:191], v[16:31]
  ds_read_b128 v[128:131], v5 offset:0
  s_nop 2
  s_cbranch_vccnz mm_l1_st72
mm_l1_st72_b:
  s_waitcnt lgkmcnt(5)
  v_mfma_f32_32x32x16_bf16 v[32:47], v[136:139], v[188:191], v[32:47]
  s_add_u32 s44, s5, 11264
  buffer_load_dwordx4 a[8:11], v4, s[40:43], s44 offen offset:0 sc1
  ds_read_b128 v[132:135], v5 offset:1024
  v_mfma_f32_32x32x16_bf16 v[48:63], v[140:143], v[188:191], v[48:63]
  ds_read_b128 v[136:139], v5 offset:2048
  s_waitcnt lgkmcnt(5)
  v_mfma_f32_32x32x16_bf16 v[16:31], v[144:147], v[192:195], v[16:31]
  buffer_load_dwordx4 a[12:15], v4, s[40:43], s44 offen offset:1024 sc1
  ds_read_b128 v[140:143], v5 offset:3072
  v_mfma_f32_32x32x16_bf16 v[32:47], v[148:151], v[192:195], v[32:47]
  ds_read_b128 v[144:147], v5 offset:4096
  s_waitcnt vmcnt(8)
  v_max_u32 v3, v200, v202
  v_max3_u32 v3, v204, v206, v3
  s_waitcnt lgkmcnt(5)
  v_mfma_f32_32x32x16_bf16 v[48:63], v[152:155], v[192:195], v[48:63]
  ds_read_b128 v[148:151], v5 offset:5120
  v_cmp_eq_u32 vcc, -1, v3
  v_mfma_f32_32x32x16_bf16 v[16:31], v[156:159], v[196:199], v[16:31]
  buffer_load_dwordx4 a[16:19], v4, s[40:43], s44 offen offset:3072 sc1
  ds_read_b128 v[152:155], v5 offset:6144
  s_nop 1
  s_cbranch_vccnz mm_l1_st73
mm_l1_st73_b:
  s_waitcnt lgkmcnt(5)
  v_mfma_f32_32x32x16_bf16 v[32:47], v[128:131], v[196:199], v[32:47]
  ds_read_b128 v[156:159], v5 offset:7168
  v_mfma_f32_32x32x16_bf16 v[48:63], v[132:135], v[196:199], v[48:63]
  s_add_u32 s44, s5, 15360
  buffer_load_dwordx4 a[20:23], v4, s[40:43], s44 offen offset:0 sc1
  ds_read_b128 v[128:131], v5 offset:8192
  s_waitcnt lgkmcnt(5)
  v_mfma_f32_32x32x16_bf16 v[16:31], v[136:139], v[200:203], v[16:31]
  ds_read_b128 v[132:135], v5 offset:9216
  v_mfma_f32_32x32x16_bf16 v[32:47], v[140:143], v[200:203], v[32:47]
  ds_read_b128 v[136:139], v5 offset:10240
  s_waitcnt vmcnt(8)
  v_max_u32 v3, v208, v210
  v_max3_u32 v3, v212, v214, v3
  s_waitcnt lgkmcnt(5)
  v_mfma_f32_32x32x16_bf16 v[48:63], v[144:147], v[200:203], v[48:63]
  ds_read_b128 v[140:143], v5 offset:11264
  v_cmp_eq_u32 vcc, -1, v3
  v_mfma_f32_32x32x16_bf16 v[16:31], v[148:151], v[204:207], v[16:31]
  buffer_load_dwordx4 a[24:27], v4, s[40:43], s44 offen offset:1024 sc1
  ds_read_b128 v[144:147], v5 offset:12288
  s_nop 1
  s_cbranch_vccnz mm_l1_st74
mm_l1_st74_b:
  s_waitcnt lgkmcnt(5)
  v_mfma_f32_32x32x16_bf16 v[32:47], v[152:155], v[204:207], v[32:47]
  ds_read_b128 v[148:151], v5 offset:13312
  v_mfma_f32_32x32x16_bf16 v[48:63], v[156:159], v[204:207], v[48:63]
  buffer_load_dwordx4 a[28:31], v4, s[40:43], s44 offen offset:2048 sc1
  ds_read_b128 v[152:155], v5 offset:14336
  s_waitcnt lgkmcnt(5)
  v_mfma_f32_32x32x16_bf16 v[16:31], v[128:131], v[208:211], v[16:31]
  ds_read_b128 v[156:159], v5 offset:15360
  v_mfma_f32_32x32x16_bf16 v[32:47], v[132:135], v[208:211], v[32:47]
  ds_read_b128 v[128:131], v5 offset:16384
  s_waitcnt vmcnt(8)
  v_max_u32 v3, v8, v10
  v_max3_u32 v3, v12, v14, v3
  s_waitcnt lgkmcnt(5)
  v_mfma_f32_32x32x16_bf16 v[48:63], v[136:139], v[208:211], v[48:63]
  ds_read_b128 v[132:135], v5 offset:17408
  v_cmp_eq_u32 vcc, -1, v3
  v_mfma_f32_32x32x16_bf16 v[16:31], v[140:143], v[212:215], v[16:31]
  buffer_load_dwordx4 a[32:35], v4, s[40:43], s44 offen offset:3072 sc1
  ds_read_b128 v[136:139], v5 offset:18432
  s_nop 1
  s_cbranch_vccnz mm_l1_st75
mm_l1_st75_b:
  s_waitcnt lgkmcnt(5)
  v_mfma_f32_32x32x16_bf16 v[32:47], v[144:147], v[212:215], v[32:47]
  ds_read_b128 v[140:143], v5 offset:19456
  v_mfma_f32_32x32x16_bf16 v[48:63], v[148:151], v[212:215], v[48:63]
  s_add_u32 s14, s7, 0
  buffer_load_dwordx4 v[160:163], v4, s[40:43], s14 offen offset:0 sc1
  ds_read_b128 v[144:147], v5 offset:20480
  s_waitcnt lgkmcnt(5)
  v_mfma_f32_32x32x16_bf16 v[16:31], v[152:155], v[8:11], v[16:31]
  ds_read_b128 v[148:151], v5 offset:21504
  s_waitcnt vmcnt(8)
  v_accvgpr_read_b32 v2, a0
  v_accvgpr_read_b32 v7, a2
  v_mfma_f32_32x32x16_bf16 v[32:47], v[156:159], v[8:11], v[32:47]
  ds_read_b128 v[152:155], v5 offset:22528
  v_max_u32 v3, v2, v7
  v_accvgpr_read_b32 v2, a4
  v_accvgpr_read_b32 v7, a6
  s_waitcnt lgkmcnt(5)
  v_mfma_f32_32x32x16_bf16 v[48:63], v[128:131], v[8:11], v[48:63]
  ds_read_b128 v[156:159], v5 offset:23552
  v_max3_u32 v3, v2, v7, v3
  v_cmp_eq_u32 vcc, -1, v3
  v_mfma_f32_32x32x16_bf16 v[16:31], v[132:135], v[12:15], v[16:31]
  buffer_load_dwordx4 v[164:167], v4, s[40:43], s14 offen offset:1024 sc1
  ds_read_b128 v[128:131], v5 offset:24576
  s_nop 1
  s_cbranch_vccnz mm_l1_st76
mm_l1_st76_b:
  s_waitcnt lgkmcnt(5)
  v_mfma_f32_32x32x16_bf16 v[32:47], v[136:139], v[12:15], v[32:47]
  ds_read_b128 v[132:135], v5 offset:25600
  v_mfma_f32_32x32x16_bf16 v[48:63], v[140:143], v[12:15], v[48:63]
  buffer_load_dwordx4 v[168:171], v4, s[40:43], s14 offen offset:2048 sc1
  ds_read_b128 v[136:139], v5 offset:26624
  s_waitcnt lgkmcnt(5)
  v_mfma_f32_32x32x16_bf16 v[16:31], v[144:147], a[0:3], v[16:31]
  ds_read_b128 v[140:143], v5 offset:27648
  s_waitcnt vmcnt(8)
  v_accvgpr_read_b32 v2, a8
  v_accvgpr_read_b32 v7, a10
  v_mfma_f32_32x32x16_bf16 v[32:47], v[148:151], a[0:3], v[32:47]
  ds_read_b128 v[144:147], v5 offset:28672
  v_max_u32 v3, v2, v7
  v_accvgpr_read_b32 v2, a12
  v_accvgpr_read_b32 v7, a14
  s_waitcnt lgkmcnt(5)
  v_mfma_f32_32x32x16_bf16 v[48:63], v[152:155], a[0:3], v[48:63]
  ds_read_b128 v[148:151], v5 offset:29696
  v_max3_u32 v3, v2, v7, v3
  v_cmp_eq_u32 vcc, -1, v3
  v_mfma_f32_32x32x16_bf16 v[16:31], v[156:159], a[4:7], v[16:31]
  s_mov_b32 exec_hi, 0
  buffer_load_dwordx4 v[172:175], v4, s[40:43], s14 offen offset:3072 sc1
  s_mov_b32 exec_hi, -1
  ds_read_b128 v[152:155], v5 offset:30720
  s_cbranch_vccnz mm_l1_st77
mm_l1_st77_b:
  s_waitcnt lgkmcnt(5)
  v_mfma_f32_32x32x16_bf16 v[32:47], v[128:131], a[4:7], v[32:47]
  ds_read_b128 v[156:159], v5 offset:31744
  v_mfma_f32_32x32x16_bf16 v[48:63], v[132:135], a[4:7], v[48:63]
  s_add_u32 s44, s5, 19456
  buffer_load_dwordx4 a[36:39], v4, s[40:43], s44 offen offset:0 sc1
  ds_read_b128 v[128:131], v5 offset:32768
  s_waitcnt lgkmcnt(5)
  v_mfma_f32_32x32x16_bf16 v[16:31], v[136:139], a[8:11], v[16:31]
  ds_read_b128 v[132:135], v5 offset:33792
  s_waitcnt vmcnt(8)
  v_accvgpr_read_b32 v2, a16
  v_accvgpr_read_b32 v7, a18
  v_mfma_f32_32x32x16_bf16 v[32:47], v[140:143], a[8:11], v[32:47]
  ds_read_b128 v[136:139], v5 offset:34816
  v_max_u32 v3, v2, v7
  v_accvgpr_read_b32 v2, a20
  v_accvgpr_read_b32 v7, a22
  s_waitcnt lgkmcnt(5)
  v_mfma_f32_32x32x16_bf16 v[48:63], v[144:147], a[8:11], v[48:63]
  ds_read_b128 v[140:143], v5 offset:35840
  v_max3_u32 v3, v2, v7, v3
  v_cmp_eq_u32 vcc, -1, v3
  v_mfma_f32_32x32x16_bf16 v[16:31], v[148:151], a[12:15], v[16:31]
  buffer_load_dwordx4 a[40:43], v4, s[40:43], s44 offen offset:2048 sc1
  ds_read_b128 v[144:147], v5 offset:36864
  s_nop 1
  s_cbranch_vccnz mm_l1_st78
mm_l1_st78_b:
  s_waitcnt lgkmcnt(5)
  v_mfma_f32_32x32x16_bf16 v[32:47], v[152:155], a[12:15], v[32:47]
  ds_read_b128 v[148:151], v5 offset:37888
  v_mfma_f32_32x32x16_bf16 v[48:63], v[156:159], a[12:15], v[48:63]
  buffer_load_dwordx4 a[44:47], v4, s[40:43], s44 offen offset:3072 sc1
  ds_read_b128 v[152:155], v5 offset:38912
  s_waitcnt lgkmcnt(5)
  v_mfma_f32_32x32x16_bf16 v[16:31], v[128:131], a[16:19], v[16:31]
  ds_read_b128 v[156:159], v5 offset:39936
  s_waitcnt vmcnt(8)
  v_accvgpr_read_b32 v2, a24
  v_accvgpr_read_b32 v7, a26
  v_mfma_f32_32x32x16_bf16 v[32:47], v[132:135], a[16:19], v[32:47]
  ds_read_b128 v[128:131], v5 offset:40960
  v_max_u32 v3, v2, v7
  v_accvgpr_read_b32 v2, a28
  v_accvgpr_read_b32 v7, a30
  s_waitcnt lgkmcnt(5)
  v_mfma_f32_32x32x16_bf16 v[48:63], v[136:139], a[16:19], v[48:63]
  ds_read_b128 v[132:135], v5 offset:41984
  v_max3_u32 v3, v2, v7, v3
  v_cmp_eq_u32 vcc, -1, v3
  v_mfma_f32_32x32x16_bf16 v[16:31], v[140:143], a[20:23], v[16:31]
  s_add_u32 s44, s5, 23552
  buffer_load_dwordx4 a[48:51], v4, s[40:43], s44 offen offset:0 sc1
  ds_read_b128 v[136:139], v5 offset:43008
  s_nop 0
  s_cbranch_vccnz mm_l1_st79
mm_l1_st79_b:
  s_waitcnt lgkmcnt(5)
  v_mfma_f32_32x32x16_bf16 v[32:47], v[144:147], a[20:23], v[32:47]
  ds_read_b128 v[140:143], v5 offset:44032
  v_mfma_f32_32x32x16_bf16 v[48:63], v[148:151], a[20:23], v[48:63]
  buffer_load_dwordx4 a[52:55], v4, s[40:43], s44 offen offset:1024 sc1
  ds_read_b128 v[144:147], v5 offset:45056
  s_waitcnt lgkmcnt(5)
  v_mfma_f32_32x32x16_bf16 v[16:31], v[152:155], a[24:27], v[16:31]
  ds_read_b128 v[148:151], v5 offset:46080
  s_waitcnt vmcnt(4)
  v_accvgpr_read_b32 v2, a32
  v_accvgpr_read_b32 v7, a34
  v_mfma_f32_32x32x16_bf16 v[32:47], v[156:159], a[24:27], v[32:47]
  ds_read_b128 v[152:155], v5 offset:47104
  v_max_u32 v3, v2, v7
  v_accvgpr_read_b32 v2, a36
  v_accvgpr_read_b32 v7, a38
  s_waitcnt lgkmcnt(5)
  v_mfma_f32_32x32x16_bf16 v[48:63], v[128:131], a[24:27], v[48:63]
  ds_read_b128 v[156:159], v5 offset:48128
  v_max3_u32 v3, v2, v7, v3
  v_cmp_eq_u32 vcc, -1, v3
  v_mfma_f32_32x32x16_bf16 v[16:31], v[132:135], a[28:31], v[16:31]
  buffer_load_dwordx4 a[56:59], v4, s[40:43], s44 offen offset:2048 sc1
  ds_read_b128 v[128:131], v5 offset:49152
  s_nop 1
  s_cbranch_vccnz mm_l1_st80
mm_l1_st80_b:
  v_max_u32 v3, v160, v162
  v_max3_u32 v3, v164, v166, v3
  s_waitcnt lgkmcnt(5)
  v_mfma_f32_32x32x16_bf16 v[32:47], v[136:139], a[28:31], v[32:47]
  ds_read_b128 v[132:135], v5 offset:50176
  v_max3_u32 v3, v168, v170, v3
  v_max3_u32 v3, v172, v174, v3
  v_cmp_eq_u32 vcc, -1, v3
  v_mfma_f32_32x32x16_bf16 v[48:63], v[140:143], a[28:31], v[48:63]
  buffer_load_dwordx4 a[60:63], v4, s[40:43], s44 offen offset:3072 sc1
  ds_read_b128 v[136:139], v5 offset:51200
  s_waitcnt lgkmcnt(5)
  v_mfma_f32_32x32x16_bf16 v[16:31], v[144:147], a[32:35], v[16:31]
  ds_read_b128 v[140:143], v5 offset:52224
  s_cbranch_vccnz mm_l1_st81
mm_l1_st81_b:
  s_waitcnt vmcnt(4)
  v_accvgpr_read_b32 v2, a40
  v_mfma_f32_32x32x16_bf16 v[32:47], v[148:151], a[32:35], v[32:47]
  v_add_f32 v160, v160, v162
  v_add_f32 v161, v161, v163
  ds_read_b128 v[144:147], v5 offset:53248
  v_accvgpr_read_b32 v7, a42
  v_max_u32 v3, v2, v7
  v_accvgpr_read_b32 v2, a44
  s_waitcnt lgkmcnt(5)
  v_mfma_f32_32x32x16_bf16 v[48:63], v[152:155], a[32:35], v[48:63]
  v_add_f32 v164, v164, v166
  ds_read_b128 v[148:151], v5 offset:54272
  v_accvgpr_read_b32 v7, a46
  v_max3_u32 v3, v2, v7, v3
  v_cmp_eq_u32 vcc, -1, v3
  v_mfma_f32_32x32x16_bf16 v[16:31], v[156:159], a[36:39], v[16:31]
  s_sub_u32 m0, s63, 49152
  s_add_u32 s48, s64, 114688
  buffer_load_dwordx4 v4, s[40:43], s48 offen offset:0 lds
  ds_read_b128 v[152:155], v5 offset:55296
  s_waitcnt lgkmcnt(5)
  v_mfma_f32_32x32x16_bf16 v[32:47], v[128:131], a[36:39], v[32:47]
  v_add_f32 v165, v165, v167
  v_add_f32 v168, v168, v170
  v_add_f32 v169, v169, v171
  v_add_f32 v172, v172, v174
  ds_read_b128 v[156:159], v5 offset:56320
  s_cbranch_vccnz mm_l1_st82
mm_l1_st82_b:
  v_mfma_f32_32x32x16_bf16 v[48:63], v[132:135], a[36:39], v[48:63]
  buffer_load_dwordx4 v4, s[40:43], s48 offen offset:1024 lds
  v_add_f32 v173, v173, v175
  v_add_f32 v160, v160, v164
  ds_read_b128 v[128:131], v5 offset:57344
  s_waitcnt lgkmcnt(5)
  v_mfma_f32_32x32x16_bf16 v[16:31], v[136:139], a[40:43], v[16:31]
  v_add_f32 v161, v161, v165
  v_add_f32 v168, v168, v172
  v_add_f32 v169, v169, v173
  v_add_f32 v160, v160, v168
  ds_read_b128 v[132:135], v5 offset:58368
  s_waitcnt vmcnt(4)
  v_accvgpr_read_b32 v2, a48
  v_accvgpr_read_b32 v7, a50
  v_mfma_f32_32x32x16_bf16 v[32:47], v[140:143], a[40:43], v[32:47]
  v_add_f32 v161, v161, v169
  v_mov_b32 v164, v160
  ds_read_b128 v[136:139], v5 offset:59392
  v_max_u32 v3, v2, v7
  v_accvgpr_read_b32 v2, a52
  v_accvgpr_read_b32 v7, a54
  s_waitcnt lgkmcnt(5)
  v_mfma_f32_32x32x16_bf16 v[48:63], v[144:147], a[40:43], v[48:63]
  v_mov_b32 v165, v161
  ds_read_b128 v[140:143], v5 offset:60416
  v_max3_u32 v3, v2, v7, v3
  v_cmp_eq_u32 vcc, -1, v3
  v_mfma_f32_32x32x16_bf16 v[16:31], v[148:151], a[44:47], v[16:31]
  buffer_load_dwordx4 v4, s[40:43], s48 offen offset:2048 lds
  ds_read_b128 v[144:147], v5 offset:61440
  s_nop 1
  s_cbranch_vccnz mm_l1_st83
mm_l1_st83_b:
  s_waitcnt lgkmcnt(5)
  v_mfma_f32_32x32x16_bf16 v[32:47], v[152:155], a[44:47], v[32:47]
  v_permlane32_swap_b32 v160, v164
  v_permlane32_swap_b32 v161, v165
  v_add_f32 v160, v160, v164
  ds_read_b128 v[148:151], v5 offset:62464
  v_mfma_f32_32x32x16_bf16 v[48:63], v[156:159], a[44:47], v[48:63]
  buffer_load_dwordx4 v4, s[40:43], s48 offen offset:3072 lds
  v_add_f32 v161, v161, v165
  v_mul_f32 v160, 0xbb124925, v160
  v_mul_f32 v161, 0x3b124925, v161
  ds_read_b128 v[152:155], v5 offset:63488
  s_waitcnt lgkmcnt(5)
  v_mfma_f32_32x32x16_bf16 v[16:31], v[128:131], a[48:51], v[16:31]
  v_fma_f32 v161, -v160, v160, v161
  v_max_f32 v161, 0, v161
  v_add_f32 v161, 0x3727c5ac, v161
  v_rcp_f32 v172, v161
  ds_read_b128 v[156:159], v5 offset:64512
  s_waitcnt vmcnt(4)
  v_accvgpr_read_b32 v2, a56
  v_accvgpr_read_b32 v7, a58
  v_mfma_f32_32x32x16_bf16 v[32:47], v[132:135], a[48:51], v[32:47]
  v_cvt_pk_bf16_f32 v168, v160, v160
  v_lshlrev_b32 v164, 16, v168
  ds_read_b128 v[128:131], v6 offset:0
  v_max_u32 v3, v2, v7
  v_accvgpr_read_b32 v2, a60
  v_accvgpr_read_b32 v7, a62
  s_waitcnt lgkmcnt(5)
  v_mfma_f32_32x32x16_bf16 v[48:63], v[136:139], a[48:51], v[48:63]
  v_sub_f32 v164, v160, v164
  ds_read_b128 v[132:135], v6 offset:1024
  v_max3_u32 v3, v2, v7, v3
  v_cmp_eq_u32 vcc, -1, v3
  v_mfma_f32_32x32x16_bf16 v[16:31], v[140:143], a[52:55], v[16:31]
  s_sub_u32 m0, s63, 32768
  s_add_u32 s48, s64, 131072
  buffer_load_dwordx4 v4, s[40:43], s48 offen offset:0 lds
  ds_read_b128 v[136:139], v6 offset:2048
  s_cbranch_vccnz mm_l1_st84
mm_l1_st84_b:
  s_waitcnt lgkmcnt(5)
  v_mfma_f32_32x32x16_bf16 v[32:47], v[144:147], a[52:55], v[32:47]
  v_mov_b32 v173, v172
  s_mov_b32 exec_lo, 0
  v_cvt_pk_bf16_f32 v168, v164, v164
  s_mov_b32 exec_lo, -1
  ds_read_b128 v[140:143], v6 offset:3072
  v_mfma_f32_32x32x16_bf16 v[48:63], v[148:151], a[52:55], v[48:63]
  buffer_load_dwordx4 v4, s[40:43], s48 offen offset:1024 lds
  v_mov_b32 v169, v168
  v_mov_b32 v170, v168
  v_mov_b32 v171, v168
  v_lshlrev_b32 v147, 2, v1
  v_add_u32 v147, 131072, v147
  ds_read2st64_b32 v[144:145], v147 offset0:16 offset1:17
  ds_read2st64_b32 v[146:147], v147 offset0:18 offset1:19
  s_waitcnt lgkmcnt(6)
  v_mfma_f32_32x32x16_bf16 v[16:31], v[152:155], a[56:59], v[16:31]
  v_lshlrev_b32 v151, 2, v1
  v_add_u32 v151, 131072, v151
  ds_read2st64_b32 v[148:149], v151 offset0:20 offset1:21
  ds_read2st64_b32 v[150:151], v151 offset0:22 offset1:23
  v_mfma_f32_32x32x16_bf16 v[32:47], v[156:159], a[56:59], v[32:47]
  v_lshlrev_b32 v155, 2, v1
  v_add_u32 v155, 131072, v155
  ds_read2st64_b32 v[152:153], v155 offset0:24 offset1:25
  ds_read2st64_b32 v[154:155], v155 offset0:26 offset1:27
  s_waitcnt lgkmcnt(8)
  v_mfma_f32_32x32x16_bf16 v[48:63], v[128:131], a[56:59], v[48:63]
  buffer_load_dwordx4 v4, s[40:43], s48 offen offset:2048 lds
  ds_read_b128 v[156:159], v6 offset:7168
  v_mfma_f32_32x32x16_bf16 v[16:31], v[132:135], a[60:63], v[16:31]
  ds_read_b128 v[128:131], v6 offset:8192
  s_waitcnt lgkmcnt(8)
  v_mfma_f32_32x32x16_bf16 v[32:47], v[136:139], a[60:63], v[32:47]
  buffer_load_dwordx4 v4, s[40:43], s48 offen offset:3072 lds
  ds_read_b128 v[132:135], v6 offset:9216
  v_mfma_f32_32x32x16_bf16 v[48:63], v[140:143], a[60:63], v[48:63]
  ds_read_b128 v[136:139], v6 offset:10240
  s_waitcnt lgkmcnt(6)
  v_mfma_f32_32x32x16_bf16 v[16:31], v[144:147], v[168:171], v[16:31]
  ds_read_b128 v[140:143], v6 offset:11264
  v_mfma_f32_32x32x16_bf16 v[32:47], v[148:151], v[168:171], v[32:47]
  s_sub_u32 m0, s63, 16384
  s_add_u32 s48, s64, 147456
  buffer_load_dwordx4 v4, s[40:43], s48 offen offset:0 lds
  ds_read_b128 v[144:147], v6 offset:12288
  s_waitcnt lgkmcnt(5)
  v_mfma_f32_32x32x16_bf16 v[48:63], v[152:155], v[168:171], v[48:63]
  ds_read_b128 v[148:151], v6 offset:13312
  v_mfma_f32_32x32x16_bf16 v[64:79], v[156:159], v[192:195], 0
  buffer_load_dwordx4 v4, s[40:43], s48 offen offset:1024 lds
  s_nop 0
  v_mul_f32 v16, v16, v24
  v_mul_f32 v17, v17, v25
  v_mul_f32 v16, v172, v16
  ds_read_b128 v[152:155], v6 offset:14336
  s_waitcnt lgkmcnt(5)
  v_mfma_f32_32x32x16_bf16 v[80:95], v[128:131], v[192:195], 0
  v_mul_f32 v17, v172, v17
  v_cvt_pk_bf16_f32 v160, v16, v17
  v_mul_f32 v18, v18, v26
  v_mul_f32 v19, v19, v27
  ds_read_b128 v[156:159], v6 offset:15360
  v_mfma_f32_32x32x16_bf16 v[64:79], v[132:135], v[196:199], v[64:79]
  v_mul_f32 v18, v172, v18
  v_mul_f32 v19, v172, v19
  v_cvt_pk_bf16_f32 v161, v18, v19
  v_mul_f32 v20, v20, v28
  v_mul_f32 v21, v21, v29
  ds_read_b128 v[128:131], v6 offset:16384
  s_waitcnt lgkmcnt(5)
  v_mfma_f32_32x32x16_bf16 v[80:95], v[136:139], v[196:199], v[80:95]
  buffer_load_dwordx4 v4, s[40:43], s48 offen offset:2048 lds
  v_mul_f32 v20, v172, v20
  v_mul_f32 v21, v172, v21
  ds_read_b128 v[132:135], v6 offset:17408
  v_mfma_f32_32x32x16_bf16 v[64:79], v[140:143], v[200:203], v[64:79]
  v_cvt_pk_bf16_f32 v162, v20, v21
  v_mul_f32 v22, v22, v30
  v_mul_f32 v23, v23, v31
  v_mul_f32 v22, v172, v22
  v_mul_f32 v23, v172, v23
  ds_read_b128 v[136:139], v6 offset:18432
  s_waitcnt lgkmcnt(5)
  v_mfma_f32_32x32x16_bf16 v[80:95], v[144:147], v[200:203], v[80:95]
  buffer_load_dwordx4 v4, s[40:43], s48 offen offset:3072 lds
  v_cvt_pk_bf16_f32 v163, v22, v23
  s_add_u32 s14, s6, 0
  buffer_store_dwordx4 v[160:163], v4, s[40:43], s14 offen sc1
  ds_read_b128 v[140:143], v6 offset:19456
  v_mfma_f32_32x32x16_bf16 v[64:79], v[148:151], v[204:207], v[64:79]
  v_mul_f32 v32, v32, v40
  v_mul_f32 v33, v33, v41
  v_mul_f32 v32, v172, v32
  v_mul_f32 v33, v172, v33
  v_cvt_pk_bf16_f32 v164, v32, v33
  ds_read_b128 v[144:147], v6 offset:20480
  s_waitcnt lgkmcnt(5)
  v_mfma_f32_32x32x16_bf16 v[80:95], v[152:155], v[204:207], v[80:95]
  v_mul_f32 v34, v34, v42
  v_mul_f32 v35, v35, v43
  v_mul_f32 v34, v172, v34
  v_mul_f32 v35, v172, v35
  ds_read_b128 v[148:151], v6 offset:21504
  v_mfma_f32_32x32x16_bf16 v[64:79], v[156:159], v[208:211], v[64:79]
  v_cvt_pk_bf16_f32 v165, v34, v35
  v_mul_f32 v36, v36, v44
  v_mul_f32 v37, v37, v45
  v_mul_f32 v36, v172, v36
  v_mul_f32 v37, v172, v37
  ds_read_b128 v[152:155], v6 offset:22528
  s_waitcnt lgkmcnt(5)
  v_mfma_f32_32x32x16_bf16 v[80:95], v[128:131], v[208:211], v[80:95]
  v_cvt_pk_bf16_f32 v166, v36, v37
  v_mul_f32 v38, v38, v46
  v_mul_f32 v39, v39, v47
  v_mul_f32 v38, v172, v38
  ds_read_b128 v[156:159], v6 offset:23552
  v_mfma_f32_32x32x16_bf16 v[64:79], v[132:135], v[212:215], v[64:79]
  v_mul_f32 v39, v172, v39
  v_cvt_pk_bf16_f32 v167, v38, v39
  s_add_u32 s14, s6, 1024
  buffer_store_dwordx4 v[164:167], v4, s[40:43], s14 offen sc1
  ds_read_b128 v[128:131], v6 offset:24576
  s_waitcnt lgkmcnt(5)
  v_mfma_f32_32x32x16_bf16 v[80:95], v[136:139], v[212:215], v[80:95]
  v_mul_f32 v48, v48, v56
  v_mul_f32 v49, v49, v57
  v_mul_f32 v48, v172, v48
  v_mul_f32 v49, v172, v49
  ds_read_b128 v[132:135], v6 offset:25600
  v_mfma_f32_32x32x16_bf16 v[64:79], v[140:143], v[176:179], v[64:79]
  v_cvt_pk_bf16_f32 v160, v48, v49
  v_mul_f32 v50, v50, v58
  v_mul_f32 v51, v51, v59
  v_mul_f32 v50, v172, v50
  v_mul_f32 v51, v172, v51
  ds_read_b128 v[136:139], v6 offset:26624
  s_waitcnt lgkmcnt(5)
  v_mfma_f32_32x32x16_bf16 v[80:95], v[144:147], v[176:179], v[80:95]
  v_cvt_pk_bf16_f32 v161, v50, v51
  v_mul_f32 v52, v52, v60
  v_mul_f32 v53, v53, v61
  v_mul_f32 v52, v172, v52
  ds_read_b128 v[140:143], v6 offset:27648
  v_mfma_f32_32x32x16_bf16 v[64:79], v[148:151], v[8:11], v[64:79]
  v_mul_f32 v53, v172, v53
  v_cvt_pk_bf16_f32 v162, v52, v53
  v_mul_f32 v54, v54, v62
  v_mul_f32 v55, v55, v63
  v_mul_f32 v54, v172, v54
  ds_read_b128 v[144:147], v6 offset:28672
  s_waitcnt lgkmcnt(5)
  v_mfma_f32_32x32x16_bf16 v[80:95], v[152:155], v[8:11], v[80:95]
  v_mul_f32 v55, v172, v55
  v_cvt_pk_bf16_f32 v163, v54, v55
  s_add_u32 s14, s6, 2048
  buffer_store_dwordx4 v[160:163], v4, s[40:43], s14 offen sc1
  ds_read_b128 v[148:151], v6 offset:29696
  v_mfma_f32_32x32x16_bf16 v[64:79], v[156:159], v[12:15], v[64:79]
  ds_read_b128 v[152:155], v6 offset:30720
  s_waitcnt lgkmcnt(5)
  v_mfma_f32_32x32x16_bf16 v[80:95], v[128:131], v[12:15], v[80:95]
  ds_read_b128 v[156:159], v6 offset:31744
  v_mfma_f32_32x32x16_bf16 v[64:79], v[132:135], a[0:3], v[64:79]
  s_waitcnt vmcnt(3)
  s_barrier
  ds_read_b128 v[128:131], v4 offset:0
  s_waitcnt lgkmcnt(5)
  v_mfma_f32_32x32x16_bf16 v[80:95], v[136:139], a[0:3], v[80:95]
  s_add_u32 m0, s63, 0
  s_add_u32 s48, s64, 163840
  buffer_load_dwordx4 v4, s[40:43], s48 offen offset:0 lds
  ds_read_b128 v[132:135], v4 offset:1024
  v_mfma_f32_32x32x16_bf16 v[64:79], v[140:143], a[4:7], v[64:79]
  ds_read_b128 v[136:139], v4 offset:2048
  s_waitcnt lgkmcnt(5)
  v_mfma_f32_32x32x16_bf16 v[80:95], v[144:147], a[4:7], v[80:95]
  buffer_load_dwordx4 v4, s[40:43], s48 offen offset:1024 lds
  ds_read_b128 v[140:143], v4 offset:3072
  v_mfma_f32_32x32x16_bf16 v[64:79], v[148:151], a[8:11], v[64:79]
  ds_read_b128 v[144:147], v4 offset:4096
  s_waitcnt lgkmcnt(5)
  v_mfma_f32_32x32x16_bf16 v[80:95], v[152:155], a[8:11], v[80:95]
  ds_read_b128 v[148:151], v4 offset:5120
  v_mfma_f32_32x32x16_bf16 v[64:79], v[156:159], a[12:15], v[64:79]
  buffer_load_dwordx4 v4, s[40:43], s48 offen offset:2048 lds
  ds_read_b128 v[152:155], v4 offset:6144
  s_waitcnt lgkmcnt(5)
  v_mfma_f32_32x32x16_bf16 v[80:95], v[128:131], a[12:15], v[80:95]
  ds_read_b128 v[156:159], v4 offset:7168
  v_mfma_f32_32x32x16_bf16 v[64:79], v[132:135], v[180:183], v[64:79]
  buffer_load_dwordx4 v4, s[40:43], s48 offen offset:3072 lds
  ds_read_b128 v[128:131], v4 offset:8192
  s_waitcnt lgkmcnt(5)
  v_mfma_f32_32x32x16_bf16 v[80:95], v[136:139], v[180:183], v[80:95]
  ds_read_b128 v[132:135], v4 offset:9216
  v_mfma_f32_32x32x16_bf16 v[64:79], v[140:143], a[16:19], v[64:79]
  ds_read_b128 v[136:139], v4 offset:10240
  s_waitcnt lgkmcnt(5)
  v_mfma_f32_32x32x16_bf16 v[80:95], v[144:147], a[16:19], v[80:95]
  s_add_u32 m0, s63, 16384
  s_add_u32 s48, s64, 180224
  buffer_load_dwordx4 v4, s[40:43], s48 offen offset:0 lds
  ds_read_b128 v[140:143], v4 offset:11264
  v_mfma_f32_32x32x16_bf16 v[64:79], v[148:151], a[20:23], v[64:79]
  ds_read_b128 v[144:147], v4 offset:12288
  s_waitcnt lgkmcnt(5)
  v_mfma_f32_32x32x16_bf16 v[80:95], v[152:155], a[20:23], v[80:95]
  buffer_load_dwordx4 v4, s[40:43], s48 offen offset:1024 lds
  ds_read_b128 v[148:151], v4 offset:13312
  v_mfma_f32_32x32x16_bf16 v[64:79], v[156:159], a[24:27], v[64:79]
  ds_read_b128 v[152:155], v4 offset:14336
  s_waitcnt lgkmcnt(5)
  v_mfma_f32_32x32x16_bf16 v[80:95], v[128:131], a[24:27], v[80:95]
  ds_read_b128 v[156:159], v4 offset:15360
  v_mfma_f32_32x32x16_bf16 v[64:79], v[132:135], a[28:31], v[64:79]
  buffer_load_dwordx4 v4, s[40:43], s48 offen offset:2048 lds
  ds_read_b128 v[128:131], v4 offset:16384
  s_waitcnt lgkmcnt(5)
  v_mfma_f32_32x32x16_bf16 v[80:95], v[136:139], a[28:31], v[80:95]
  ds_read_b128 v[132:135], v4 offset:17408
  v_mfma_f32_32x32x16_bf16 v[64:79], v[140:143], a[32:35], v[64:79]
  buffer_load_dwordx4 v4, s[40:43], s48 offen offset:3072 lds
  ds_read_b128 v[136:139], v4 offset:18432
  s_waitcnt lgkmcnt(5)
  v_mfma_f32_32x32x16_bf16 v[80:95], v[144:147], a[32:35], v[80:95]
  ds_read_b128 v[140:143], v4 offset:19456
  v_mfma_f32_32x32x16_bf16 v[64:79], v[148:151], a[36:39], v[64:79]
  ds_read_b128 v[144:147], v4 offset:20480
  s_waitcnt lgkmcnt(5)
  v_mfma_f32_32x32x16_bf16 v[80:95], v[152:155], a[36:39], v[80:95]
  s_add_u32 m0, s63, 32768
  s_add_u32 s48, s64, 196608
  buffer_load_dwordx4 v4, s[40:43], s48 offen offset:0 lds
  ds_read_b128 v[148:151], v4 offset:21504
  v_mfma_f32_32x32x16_bf16 v[64:79], v[156:159], v[184:187], v[64:79]
  ds_read_b128 v[152:155], v4 offset:22528
  s_waitcnt lgkmcnt(5)
  v_mfma_f32_32x32x16_bf16 v[80:95], v[128:131], v[184:187], v[80:95]
  buffer_load_dwordx4 v4, s[40:43], s48 offen offset:1024 lds
  ds_read_b128 v[156:159], v4 offset:23552
  v_mfma_f32_32x32x16_bf16 v[64:79], v[132:135], a[40:43], v[64:79]
  ds_read_b128 v[128:131], v4 offset:24576
  s_waitcnt lgkmcnt(5)
  v_mfma_f32_32x32x16_bf16 v[80:95], v[136:139], a[40:43], v[80:95]
  ds_read_b128 v[132:135], v4 offset:25600
  v_mfma_f32_32x32x16_bf16 v[64:79], v[140:143], a[44:47], v[64:79]
  buffer_load_dwordx4 v4, s[40:43], s48 offen offset:2048 lds
  ds_read_b128 v[136:139], v4 offset:26624
  s_waitcnt lgkmcnt(5)
  v_mfma_f32_32x32x16_bf16 v[80:95], v[144:147], a[44:47], v[80:95]
  ds_read_b128 v[140:143], v4 offset:27648
  v_mfma_f32_32x32x16_bf16 v[64:79], v[148:151], a[48:51], v[64:79]
  buffer_load_dwordx4 v4, s[40:43], s48 offen offset:3072 lds
  ds_read_b128 v[144:147], v4 offset:28672
  s_waitcnt lgkmcnt(5)
  v_mfma_f32_32x32x16_bf16 v[80:95], v[152:155], a[48:51], v[80:95]
  ds_read_b128 v[148:151], v4 offset:29696
  v_mfma_f32_32x32x16_bf16 v[64:79], v[156:159], a[52:55], v[64:79]
  ds_read_b128 v[152:155], v4 offset:30720
  s_waitcnt lgkmcnt(5)
  v_mfma_f32_32x32x16_bf16 v[80:95], v[128:131], a[52:55], v[80:95]
  v_lshlrev_b32 v159, 2, v1
  ds_read2st64_b32 v[156:157], v159 offset0:124 offset1:125
  ds_read2st64_b32 v[158:159], v159 offset0:126 offset1:127
  v_mfma_f32_32x32x16_bf16 v[64:79], v[132:135], a[56:59], v[64:79]
  v_lshlrev_b32 v131, 2, v1
  ds_read2st64_b32 v[128:129], v131 offset0:128 offset1:129
  ds_read2st64_b32 v[130:131], v131 offset0:130 offset1:131
  s_waitcnt lgkmcnt(7)
  v_mfma_f32_32x32x16_bf16 v[80:95], v[136:139], a[56:59], v[80:95]
  ds_read_b128 v[132:135], v4 offset:33792
  v_mfma_f32_32x32x16_bf16 v[64:79], v[140:143], a[60:63], v[64:79]
  ds_read_b128 v[136:139], v4 offset:34816
  s_waitcnt lgkmcnt(7)
  v_mfma_f32_32x32x16_bf16 v[80:95], v[144:147], a[60:63], v[80:95]
  ds_read_b128 v[140:143], v4 offset:35840
  v_mfma_f32_32x32x16_bf16 v[64:79], v[148:151], v[188:191], v[64:79]
  ds_read_b128 v[144:147], v4 offset:36864
  s_waitcnt lgkmcnt(6)
  v_mfma_f32_32x32x16_bf16 v[80:95], v[152:155], v[188:191], v[80:95]
  ds_read_b128 v[148:151], v4 offset:37888
  v_mfma_f32_32x32x16_bf16 v[64:79], v[156:159], v[168:171], v[64:79]
  ds_read_b128 v[152:155], v4 offset:38912
  s_waitcnt lgkmcnt(5)
  v_mfma_f32_32x32x16_bf16 v[80:95], v[128:131], v[168:171], v[80:95]
  ds_read_b128 v[156:159], v4 offset:39936
  v_mfma_f32_32x32x16_bf16 v[96:111], v[132:135], v[192:195], 0
  ds_read_b128 v[128:131], v4 offset:40960
  s_waitcnt lgkmcnt(5)
  v_mfma_f32_32x32x16_bf16 v[112:127], v[136:139], v[192:195], 0
  s_nop 3
  v_mul_f32 v64, v64, v72
  v_mul_f32 v65, v65, v73
  v_mul_f32 v64, v172, v64
  v_mul_f32 v65, v172, v65
  ds_read_b128 v[132:135], v4 offset:41984
  v_mfma_f32_32x32x16_bf16 v[96:111], v[140:143], v[196:199], v[96:111]
  v_cvt_pk_bf16_f32 v164, v64, v65
  v_mul_f32 v66, v66, v74
  v_mul_f32 v67, v67, v75
  v_mul_f32 v66, v172, v66
  v_mul_f32 v67, v172, v67
  ds_read_b128 v[136:139], v4 offset:43008
  s_waitcnt lgkmcnt(5)
  v_mfma_f32_32x32x16_bf16 v[112:127], v[144:147], v[196:199], v[112:127]
  v_cvt_pk_bf16_f32 v165, v66, v67
  v_mul_f32 v68, v68, v76
  v_mul_f32 v69, v69, v77
  v_mul_f32 v68, v172, v68
  ds_read_b128 v[140:143], v4 offset:44032
  v_mfma_f32_32x32x16_bf16 v[96:111], v[148:151], v[200:203], v[96:111]
  v_mul_f32 v69, v172, v69
  v_cvt_pk_bf16_f32 v166, v68, v69
  v_mul_f32 v70, v70, v78
  v_mul_f32 v71, v71, v79
  v_mul_f32 v70, v172, v70
  ds_read_b128 v[144:147], v4 offset:45056
  s_waitcnt lgkmcnt(5)
  v_mfma_f32_32x32x16_bf16 v[112:127], v[152:155], v[200:203], v[112:127]
  s_add_u32 s44, s10, s52
  buffer_load_dwordx4 v[16:19], v4, s[68:71], s44 offen offset:0 sc1
  v_mul_f32 v71, v172, v71
  ds_read_b128 v[148:151], v4 offset:46080
  v_mfma_f32_32x32x16_bf16 v[96:111], v[156:159], v[204:207], v[96:111]
  v_cvt_pk_bf16_f32 v167, v70, v71
  s_add_u32 s14, s6, 3072
  buffer_store_dwordx4 v[164:167], v4, s[40:43], s14 offen sc1
  v_mul_f32 v80, v80, v88
  ds_read_b128 v[152:155], v4 offset:47104
  s_waitcnt lgkmcnt(5)
  v_mfma_f32_32x32x16_bf16 v[112:127], v[128:131], v[204:207], v[112:127]
  s_add_u32 s45, s11, s52
  buffer_load_dwordx4 v[20:23], v4, s[68:71], s45 offen offset:0 sc1
  v_mul_f32 v81, v81, v89
  ds_read_b128 v[156:159], v4 offset:48128
  v_mfma_f32_32x32x16_bf16 v[96:111], v[132:135], v[208:211], v[96:111]
  v_mul_f32 v80, v172, v80
  v_mul_f32 v81, v172, v81
  v_cvt_pk_bf16_f32 v160, v80, v81
  v_mul_f32 v82, v82, v90
  v_mul_f32 v83, v83, v91
  s_waitcnt vmcnt(3)
  s_barrier
  ds_read_b128 v[128:131], v4 offset:49152
  s_waitcnt lgkmcnt(5)
  v_mfma_f32_32x32x16_bf16 v[112:127], v[136:139], v[208:211], v[112:127]
  v_mul_f32 v82, v172, v82
  v_mul_f32 v83, v172, v83
  ds_read_b128 v[132:135], v4 offset:50176
  v_mfma_f32_32x32x16_bf16 v[96:111], v[140:143], v[212:215], v[96:111]
  buffer_load_dwordx4 v[24:27], v4, s[68:71], s44 offen offset:1024 sc1
  v_cvt_pk_bf16_f32 v161, v82, v83
  v_mul_f32 v84, v84, v92
  v_mul_f32 v85, v85, v93
  ds_read_b128 v[136:139], v4 offset:51200
  s_waitcnt lgkmcnt(5)
  v_mfma_f32_32x32x16_bf16 v[112:127], v[144:147], v[212:215], v[112:127]
  v_mul_f32 v84, v172, v84
  v_mul_f32 v85, v172, v85
  v_cvt_pk_bf16_f32 v162, v84, v85
  v_mul_f32 v86, v86, v94
  ds_read_b128 v[140:143], v4 offset:52224
  v_mfma_f32_32x32x16_bf16 v[96:111], v[148:151], v[176:179], v[96:111]
  buffer_load_dwordx4 v[28:31], v4, s[68:71], s45 offen offset:1024 sc1
  v_mul_f32 v87, v87, v95
  v_mul_f32 v86, v172, v86
  v_mul_f32 v87, v172, v87
  ds_read_b128 v[144:147], v4 offset:53248
  s_waitcnt lgkmcnt(5)
  v_mfma_f32_32x32x16_bf16 v[112:127], v[152:155], v[176:179], v[112:127]
  v_cvt_pk_bf16_f32 v163, v86, v87
  s_add_u32 s14, s6, 4096
  buffer_store_dwordx4 v[160:163], v4, s[40:43], s14 offen sc1
  ds_read_b128 v[148:151], v4 offset:54272
  v_mfma_f32_32x32x16_bf16 v[96:111], v[156:159], v[8:11], v[96:111]
  v_lshlrev_b32 v64, 16, v248
  v_and_b32 v65, s61, v248
  v_lshlrev_b32 v66, 16, v249
  v_and_b32 v67, s61, v249
  v_lshlrev_b32 v68, 16, v250
  ds_read_b128 v[152:155], v4 offset:55296
  s_waitcnt lgkmcnt(5)
  v_mfma_f32_32x32x16_bf16 v[112:127], v[128:131], v[8:11], v[112:127]
  buffer_load_dwordx4 v[32:35], v4, s[68:71], s44 offen offset:2048 sc1
  v_and_b32 v69, s61, v250
  v_lshlrev_b32 v70, 16, v251
  ds_read_b128 v[156:159], v4 offset:56320
  v_mfma_f32_32x32x16_bf16 v[96:111], v[132:135], v[12:15], v[96:111]
  v_and_b32 v71, s61, v251
  v_lshlrev_b32 v72, 16, v252
  v_and_b32 v73, s61, v252
  v_lshlrev_b32 v74, 16, v253
  v_and_b32 v75, s61, v253
  ds_read_b128 v[128:131], v4 offset:57344
  s_waitcnt lgkmcnt(5)
  v_mfma_f32_32x32x16_bf16 v[112:127], v[136:139], v[12:15], v[112:127]
  buffer_load_dwordx4 v[36:39], v4, s[68:71], s45 offen offset:2048 sc1
  v_lshlrev_b32 v76, 16, v254
  v_and_b32 v77, s61, v254
  ds_read_b128 v[132:135], v4 offset:58368
  v_mfma_f32_32x32x16_bf16 v[96:111], v[140:143], a[0:3], v[96:111]
  v_lshlrev_b32 v78, 16, v255
  v_and_b32 v79, s61, v255
  ds_read_b128 v[136:139], v4 offset:59392
  s_waitcnt lgkmcnt(5)
  v_mfma_f32_32x32x16_bf16 v[112:127], v[144:147], a[0:3], v[112:127]
  ds_read_b128 v[140:143], v4 offset:60416
  v_mfma_f32_32x32x16_bf16 v[96:111], v[148:151], a[4:7], v[96:111]
  s_add_u32 s44, s10, s53
  buffer_load_dwordx4 v[40:43], v4, s[68:71], s44 offen offset:0 sc1
  ds_read_b128 v[144:147], v4 offset:61440
  s_waitcnt lgkmcnt(5)
  v_mfma_f32_32x32x16_bf16 v[112:127], v[152:155], a[4:7], v[112:127]
  ds_read_b128 v[148:151], v4 offset:62464
  v_mfma_f32_32x32x16_bf16 v[96:111], v[156:159], a[8:11], v[96:111]
  s_add_u32 s45, s11, s53
  buffer_load_dwordx4 v[44:47], v4, s[68:71], s45 offen offset:0 sc1
  ds_read_b128 v[152:155], v4 offset:63488
  s_waitcnt lgkmcnt(5)
  v_mfma_f32_32x32x16_bf16 v[112:127], v[128:131], a[8:11], v[112:127]
  ds_read_b128 v[156:159], v4 offset:64512
  v_mfma_f32_32x32x16_bf16 v[96:111], v[132:135], a[12:15], v[96:111]
  ds_read_b128 v[128:131], v5 offset:0
  s_waitcnt lgkmcnt(5)
  v_mfma_f32_32x32x16_bf16 v[112:127], v[136:139], a[12:15], v[112:127]
  buffer_load_dwordx4 v[48:51], v4, s[68:71], s44 offen offset:1024 sc1
  ds_read_b128 v[132:135], v5 offset:1024
  v_mfma_f32_32x32x16_bf16 v[96:111], v[140:143], v[180:183], v[96:111]
  ds_read_b128 v[136:139], v5 offset:2048
  s_waitcnt lgkmcnt(5)
  v_mfma_f32_32x32x16_bf16 v[112:127], v[144:147], v[180:183], v[112:127]
  buffer_load_dwordx4 v[52:55], v4, s[68:71], s45 offen offset:1024 sc1
  ds_read_b128 v[140:143], v5 offset:3072
  v_mfma_f32_32x32x16_bf16 v[96:111], v[148:151], a[16:19], v[96:111]
  ds_read_b128 v[144:147], v5 offset:4096
  s_waitcnt lgkmcnt(5)
  v_mfma_f32_32x32x16_bf16 v[112:127], v[152:155], a[16:19], v[112:127]
  ds_read_b128 v[148:151], v5 offset:5120
  v_mfma_f32_32x32x16_bf16 v[96:111], v[156:159], a[20:23], v[96:111]
  buffer_load_dwordx4 v[56:59], v4, s[68:71], s44 offen offset:2048 sc1
  ds_read_b128 v[152:155], v5 offset:6144
  s_waitcnt lgkmcnt(5)
  v_mfma_f32_32x32x16_bf16 v[112:127], v[128:131], a[20:23], v[112:127]
  ds_read_b128 v[156:159], v5 offset:7168
  v_mfma_f32_32x32x16_bf16 v[96:111], v[132:135], a[24:27], v[96:111]
  buffer_load_dwordx4 v[60:63], v4, s[68:71], s45 offen offset:2048 sc1
  ds_read_b128 v[128:131], v5 offset:8192
  s_waitcnt lgkmcnt(5)
  v_mfma_f32_32x32x16_bf16 v[112:127], v[136:139], a[24:27], v[112:127]
  ds_read_b128 v[132:135], v5 offset:9216
  v_mfma_f32_32x32x16_bf16 v[96:111], v[140:143], a[28:31], v[96:111]
  ds_read_b128 v[136:139], v5 offset:10240
  s_waitcnt lgkmcnt(5)
  v_mfma_f32_32x32x16_bf16 v[112:127], v[144:147], a[28:31], v[112:127]
  s_add_u32 s44, s10, s54
  buffer_load_dwordx4 v[192:195], v4, s[68:71], s44 offen offset:0 sc1
  ds_read_b128 v[140:143], v5 offset:11264
  v_mfma_f32_32x32x16_bf16 v[96:111], v[148:151], a[32:35], v[96:111]
  ds_read_b128 v[144:147], v5 offset:12288
  s_waitcnt lgkmcnt(5)
  v_mfma_f32_32x32x16_bf16 v[112:127], v[152:155], a[32:35], v[112:127]
  s_add_u32 s45, s11, s54
  buffer_load_dwordx4 v[196:199], v4, s[68:71], s45 offen offset:0 sc1
  ds_read_b128 v[148:151], v5 offset:13312
  v_mfma_f32_32x32x16_bf16 v[96:111], v[156:159], a[36:39], v[96:111]
  ds_read_b128 v[152:155], v5 offset:14336
  s_waitcnt lgkmcnt(5)
  v_mfma_f32_32x32x16_bf16 v[112:127], v[128:131], a[36:39], v[112:127]
  ds_read_b128 v[156:159], v5 offset:15360
  v_mfma_f32_32x32x16_bf16 v[96:111], v[132:135], v[184:187], v[96:111]
  buffer_load_dwordx4 v[200:203], v4, s[68:71], s44 offen offset:1024 sc1
  ds_read_b128 v[128:131], v5 offset:16384
  s_waitcnt lgkmcnt(5)
  v_mfma_f32_32x32x16_bf16 v[112:127], v[136:139], v[184:187], v[112:127]
  ds_read_b128 v[132:135], v5 offset:17408
  v_mfma_f32_32x32x16_bf16 v[96:111], v[140:143], a[40:43], v[96:111]
  buffer_load_dwordx4 v[204:207], v4, s[68:71], s45 offen offset:1024 sc1
  ds_read_b128 v[136:139], v5 offset:18432
  s_waitcnt lgkmcnt(5)
  v_mfma_f32_32x32x16_bf16 v[112:127], v[144:147], a[40:43], v[112:127]
  ds_read_b128 v[140:143], v5 offset:19456
  v_mfma_f32_32x32x16_bf16 v[96:111], v[148:151], a[44:47], v[96:111]
  ds_read_b128 v[144:147], v5 offset:20480
  s_waitcnt lgkmcnt(5)
  v_mfma_f32_32x32x16_bf16 v[112:127], v[152:155], a[44:47], v[112:127]
  buffer_load_dwordx4 v[208:211], v4, s[68:71], s44 offen offset:2048 sc1
  ds_read_b128 v[148:151], v5 offset:21504
  v_mfma_f32_32x32x16_bf16 v[96:111], v[156:159], a[48:51], v[96:111]
  ds_read_b128 v[152:155], v5 offset:22528
  s_waitcnt lgkmcnt(5)
  v_mfma_f32_32x32x16_bf16 v[112:127], v[128:131], a[48:51], v[112:127]
  buffer_load_dwordx4 v[212:215], v4, s[68:71], s45 offen offset:2048 sc1
  ds_read_b128 v[156:159], v5 offset:23552
  v_mfma_f32_32x32x16_bf16 v[96:111], v[132:135], a[52:55], v[96:111]
  ds_read_b128 v[128:131], v5 offset:24576
  s_waitcnt lgkmcnt(5)
  v_mfma_f32_32x32x16_bf16 v[112:127], v[136:139], a[52:55], v[112:127]
  v_lshlrev_b32 v135, 2, v1
  v_add_u32 v135, 65536, v135
  ds_read2st64_b32 v[132:133], v135 offset0:100 offset1:101
  ds_read2st64_b32 v[134:135], v135 offset0:102 offset1:103
  v_mfma_f32_32x32x16_bf16 v[96:111], v[140:143], a[56:59], v[96:111]
  s_add_u32 s44, s10, s55
  buffer_load_dwordx4 v[176:179], v4, s[68:71], s44 offen offset:0 sc1
  v_lshlrev_b32 v139, 2, v1
  v_add_u32 v139, 65536, v139
  ds_read2st64_b32 v[136:137], v139 offset0:104 offset1:105
  ds_read2st64_b32 v[138:139], v139 offset0:106 offset1:107
  s_waitcnt lgkmcnt(7)
  v_mfma_f32_32x32x16_bf16 v[112:127], v[144:147], a[56:59], v[112:127]
  v_mfma_f32_32x32x16_bf16 v[96:111], v[148:151], a[60:63], v[96:111]
  s_add_u32 s45, s11, s55
  buffer_load_dwordx4 v[8:11], v4, s[68:71], s45 offen offset:0 sc1
  s_waitcnt lgkmcnt(5)
  v_mfma_f32_32x32x16_bf16 v[112:127], v[152:155], a[60:63], v[112:127]
  s_waitcnt vmcnt(19)
  v_max_u32 v3, v16, v18
  v_max3_u32 v3, v20, v22, v3
  v_mfma_f32_32x32x16_bf16 v[96:111], v[156:159], v[188:191], v[96:111]
  v_cmp_eq_u32 vcc, -1, v3
  s_waitcnt lgkmcnt(2)
  v_mfma_f32_32x32x16_bf16 v[112:127], v[128:131], v[188:191], v[112:127]
  buffer_load_dwordx4 v[12:15], v4, s[68:71], s44 offen offset:1024 sc1
  s_nop 1
  s_cbranch_vccnz mm_l1_st85
mm_l1_st85_b:
  s_waitcnt vmcnt(18)
  v_max_u32 v3, v24, v26
  v_mfma_f32_32x32x16_bf16 v[96:111], v[132:135], v[168:171], v[96:111]
  v_max3_u32 v3, v28, v30, v3
  v_cmp_eq_u32 vcc, -1, v3
  s_waitcnt lgkmcnt(0)
  v_mfma_f32_32x32x16_bf16 v[112:127], v[136:139], v[168:171], v[112:127]
  s_cmp_eq_u32 s70, 0
  s_cbranch_scc1 mm_l1_norole
  buffer_load_dwordx4 a[0:3], v4, s[68:71], s45 offen offset:1024 sc1
  s_cbranch_vccnz mm_l1_st86
mm_l1_st86_b:
  s_waitcnt vmcnt(16)
  v_max_u32 v3, v32, v34
  v_mfma_f32_32x32x16_bf16 v[64:79], a[64:67], v[16:19], v[64:79]
  s_nop 0
  v_mul_f32 v96, v96, v104
  v_mul_f32 v97, v97, v105
  v_mul_f32 v96, v172, v96
  v_mul_f32 v97, v172, v97
  v_cvt_pk_bf16_f32 v164, v96, v97
  v_mul_f32 v98, v98, v106
  v_max3_u32 v3, v36, v38, v3
  v_cmp_eq_u32 vcc, -1, v3
  v_mfma_f32_32x32x16_bf16 v[80:95], a[64:67], v[20:23], 0
  v_mul_f32 v99, v99, v107
  v_mul_f32 v98, v172, v98
  v_mul_f32 v99, v172, v99
  v_cvt_pk_bf16_f32 v165, v98, v99
  v_mul_f32 v100, v100, v108
  v_mul_f32 v101, v101, v109
  s_cbranch_vccnz mm_l1_st87
mm_l1_st87_b:
  s_waitcnt vmcnt(14)
  v_max_u32 v3, v40, v42
  v_mfma_f32_32x32x16_bf16 v[64:79], a[68:71], v[24:27], v[64:79]
  buffer_load_dwordx4 a[4:7], v4, s[68:71], s44 offen offset:2048 sc1
  v_mul_f32 v100, v172, v100
  v_mul_f32 v101, v172, v101
  v_cvt_pk_bf16_f32 v166, v100, v101
  v_mul_f32 v102, v102, v110
  v_mul_f32 v103, v103, v111
  v_mul_f32 v102, v172, v102
  v_max3_u32 v3, v44, v46, v3
  v_cmp_eq_u32 vcc, -1, v3
  v_mfma_f32_32x32x16_bf16 v[80:95], a[68:71], v[28:31], v[80:95]
  v_mul_f32 v103, v172, v103
  v_cvt_pk_bf16_f32 v167, v102, v103
  s_add_u32 s14, s6, 5120
  buffer_store_dwordx4 v[164:167], v4, s[40:43], s14 offen sc1
  v_mul_f32 v112, v112, v120
  s_cbranch_vccnz mm_l1_st88
mm_l1_st88_b:
  v_mfma_f32_32x32x16_bf16 v[64:79], a[72:75], v[32:35], v[64:79]
  buffer_load_dwordx4 a[8:11], v4, s[68:71], s45 offen offset:2048 sc1
  v_mul_f32 v113, v113, v121
  v_mul_f32 v112, v172, v112
  v_mul_f32 v113, v172, v113
  v_cvt_pk_bf16_f32 v160, v112, v113
  v_mul_f32 v114, v114, v122
  v_mul_f32 v115, v115, v123
  v_mfma_f32_32x32x16_bf16 v[80:95], a[72:75], v[36:39], v[80:95]
  v_mul_f32 v114, v172, v114
  v_mul_f32 v115, v172, v115
  v_cvt_pk_bf16_f32 v161, v114, v115
  v_mul_f32 v116, v116, v124
  v_mul_f32 v117, v117, v125
  v_mul_f32 v116, v172, v116
  v_mfma_f32_32x32x16_bf16 v[64:79], a[92:95], v[40:43], v[64:79]
  s_add_u32 s44, s10, s52
  s_add_u32 s44, s44, 3072
  buffer_load_dwordx4 a[12:15], v4, s[68:71], s44 offen offset:0 sc1
  v_mul_f32 v117, v172, v117
  v_cvt_pk_bf16_f32 v162, v116, v117
  v_mul_f32 v118, v118, v126
  v_mul_f32 v119, v119, v127
  v_mul_f32 v118, v172, v118
  v_mul_f32 v119, v172, v119
  v_mfma_f32_32x32x16_bf16 v[80:95], a[92:95], v[44:47], v[80:95]
  v_cvt_pk_bf16_f32 v163, v118, v119
  s_add_u32 s14, s6, 6144
  buffer_store_dwordx4 v[160:163], v4, s[40:43], s14 offen sc1
  v_mfma_f32_32x32x16_bf16 v[96:111], a[176:179], v[16:19], 0
  s_add_u32 s45, s11, s52
  s_add_u32 s45, s45, 3072
  buffer_load_dwordx4 v[180:183], v4, s[68:71], s45 offen offset:0 sc1
  v_mfma_f32_32x32x16_bf16 v[112:127], a[176:179], v[20:23], 0
  v_mfma_f32_32x32x16_bf16 v[96:111], a[180:183], v[24:27], v[96:111]
  buffer_load_dwordx4 a[16:19], v4, s[68:71], s44 offen offset:1024 sc1
  v_mfma_f32_32x32x16_bf16 v[112:127], a[180:183], v[28:31], v[112:127]
  s_waitcnt vmcnt(19)
  v_max_u32 v3, v48, v50
  v_max3_u32 v3, v52, v54, v3
  v_mfma_f32_32x32x16_bf16 v[96:111], a[184:187], v[32:35], v[96:111]
  buffer_load_dwordx4 a[20:23], v4, s[68:71], s45 offen offset:1024 sc1
  v_cmp_eq_u32 vcc, -1, v3
  v_mfma_f32_32x32x16_bf16 v[112:127], a[184:187], v[36:39], v[112:127]
  s_nop 3
  s_cbranch_vccnz mm_l1_st89
mm_l1_st89_b:
  v_mfma_f32_32x32x16_bf16 v[96:111], a[204:207], v[40:43], v[96:111]
  s_add_u32 s44, s10, s53
  s_add_u32 s44, s44, 3072
  buffer_load_dwordx4 a[24:27], v4, s[68:71], s44 offen offset:0 sc1
  v_mfma_f32_32x32x16_bf16 v[112:127], a[204:207], v[44:47], v[112:127]
  s_waitcnt vmcnt(19)
  v_max_u32 v3, v56, v58
  v_max3_u32 v3, v60, v62, v3
  v_mfma_f32_32x32x16_bf16 v[64:79], a[96:99], v[48:51], v[64:79]
  s_add_u32 s45, s11, s53
  s_add_u32 s45, s45, 3072
  buffer_load_dwordx4 a[28:31], v4, s[68:71], s45 offen offset:0 sc1
  v_cmp_eq_u32 vcc, -1, v3
  v_mfma_f32_32x32x16_bf16 v[80:95], a[96:99], v[52:55], v[80:95]
  s_nop 3
  s_cbranch_vccnz mm_l1_st90
mm_l1_st90_b:
  v_mfma_f32_32x32x16_bf16 v[96:111], a[208:211], v[48:51], v[96:111]
  buffer_load_dwordx4 a[32:35], v4, s[68:71], s44 offen offset:1024 sc1
  v_mfma_f32_32x32x16_bf16 v[112:127], a[208:211], v[52:55], v[112:127]
  s_waitcnt vmcnt(19)
  v_max_u32 v3, v192, v194
  v_max3_u32 v3, v196, v198, v3
  v_mfma_f32_32x32x16_bf16 v[64:79], a[100:103], v[56:59], v[64:79]
  buffer_load_dwordx4 a[36:39], v4, s[68:71], s45 offen offset:1024 sc1
  v_cmp_eq_u32 vcc, -1, v3
  v_mfma_f32_32x32x16_bf16 v[80:95], a[100:103], v[60:63], v[80:95]
  s_nop 3
  s_cbranch_vccnz mm_l1_st91
mm_l1_st91_b:
  v_mfma_f32_32x32x16_bf16 v[96:111], a[212:215], v[56:59], v[96:111]
  s_add_u32 s44, s10, s54
  s_add_u32 s44, s44, 3072
  buffer_load_dwordx4 v[184:187], v4, s[68:71], s44 offen offset:0 sc1
  v_mfma_f32_32x32x16_bf16 v[112:127], a[212:215], v[60:63], v[112:127]
  s_waitcnt vmcnt(19)
  v_max_u32 v3, v200, v202
  v_max3_u32 v3, v204, v206, v3
  v_mfma_f32_32x32x16_bf16 v[64:79], a[120:123], v[192:195], v[64:79]
  s_add_u32 s45, s11, s54
  s_add_u32 s45, s45, 3072
  buffer_load_dwordx4 a[40:43], v4, s[68:71], s45 offen offset:0 sc1
  v_cmp_eq_u32 vcc, -1, v3
  v_mfma_f32_32x32x16_bf16 v[80:95], a[120:123], v[196:199], v[80:95]
  s_nop 3
  s_cbranch_vccnz mm_l1_st92
mm_l1_st92_b:
  v_mfma_f32_32x32x16_bf16 v[96:111], a[232:235], v[192:195], v[96:111]
  buffer_load_dwordx4 a[44:47], v4, s[68:71], s44 offen offset:1024 sc1
  v_mfma_f32_32x32x16_bf16 v[112:127], a[232:235], v[196:199], v[112:127]
  s_waitcnt vmcnt(19)
  v_max_u32 v3, v208, v210
  v_max3_u32 v3, v212, v214, v3
  v_mfma_f32_32x32x16_bf16 v[64:79], a[124:127], v[200:203], v[64:79]
  buffer_load_dwordx4 a[48:51], v4, s[68:71], s45 offen offset:1024 sc1
  v_cmp_eq_u32 vcc, -1, v3
  v_mfma_f32_32x32x16_bf16 v[80:95], a[124:127], v[204:207], v[80:95]
  s_nop 3
  s_cbranch_vccnz mm_l1_st93
mm_l1_st93_b:
  v_mfma_f32_32x32x16_bf16 v[96:111], a[236:239], v[200:203], v[96:111]
  s_add_u32 s44, s10, s55
  s_add_u32 s44, s44, 3072
  buffer_load_dwordx4 a[52:55], v4, s[68:71], s44 offen offset:0 sc1
  v_mfma_f32_32x32x16_bf16 v[112:127], a[236:239], v[204:207], v[112:127]
  s_waitcnt vmcnt(19)
  v_max_u32 v3, v176, v178
  v_max3_u32 v3, v8, v10, v3
  v_mfma_f32_32x32x16_bf16 v[64:79], a[128:131], v[208:211], v[64:79]
  s_add_u32 s45, s11, s55
  s_add_u32 s45, s45, 3072
  buffer_load_dwordx4 a[56:59], v4, s[68:71], s45 offen offset:0 sc1
  v_cmp_eq_u32 vcc, -1, v3
  v_mfma_f32_32x32x16_bf16 v[80:95], a[128:131], v[212:215], v[80:95]
  s_nop 3
  s_cbranch_vccnz mm_l1_st94
mm_l1_st94_b:
  v_mfma_f32_32x32x16_bf16 v[96:111], a[240:243], v[208:211], v[96:111]
  buffer_load_dwordx4 a[60:63], v4, s[68:71], s44 offen offset:1024 sc1
  s_waitcnt vmcnt(19)
  v_max_u32 v3, v12, v14
  v_accvgpr_read_b32 v2, a0
  v_mfma_f32_32x32x16_bf16 v[112:127], a[240:243], v[212:215], v[112:127]
  v_accvgpr_read_b32 v7, a2
  v_max3_u32 v3, v2, v7, v3
  v_cmp_eq_u32 vcc, -1, v3
  v_mfma_f32_32x32x16_bf16 v[64:79], a[148:151], v[176:179], v[64:79]
  buffer_load_dwordx4 v[188:191], v4, s[68:71], s45 offen offset:1024 sc1
  v_mfma_f32_32x32x16_bf16 v[80:95], a[148:151], v[8:11], v[80:95]
  s_nop 1
  s_cbranch_vccnz mm_l1_st95
mm_l1_st95_b:
  v_mfma_f32_32x32x16_bf16 v[96:111], v[220:223], v[176:179], v[96:111]
  s_waitcnt vmcnt(17)
  v_accvgpr_read_b32 v2, a4
  v_accvgpr_read_b32 v7, a6
  v_mfma_f32_32x32x16_bf16 v[112:127], v[220:223], v[8:11], v[112:127]
  v_max_u32 v3, v2, v7
  v_accvgpr_read_b32 v2, a8
  v_accvgpr_read_b32 v7, a10
  v_mfma_f32_32x32x16_bf16 v[64:79], a[152:155], v[12:15], v[64:79]
  v_max3_u32 v3, v2, v7, v3
  v_cmp_eq_u32 vcc, -1, v3
  v_mfma_f32_32x32x16_bf16 v[80:95], a[152:155], a[0:3], v[80:95]
  s_nop 3
  s_cbranch_vccnz mm_l1_st96
mm_l1_st96_b:
  v_mfma_f32_32x32x16_bf16 v[96:111], v[224:227], v[12:15], v[96:111]
  s_waitcnt vmcnt(14)
  v_accvgpr_read_b32 v2, a12
  v_accvgpr_read_b32 v7, a14
  v_mfma_f32_32x32x16_bf16 v[112:127], v[224:227], a[0:3], v[112:127]
  v_max_u32 v3, v2, v7
  v_max3_u32 v3, v180, v182, v3
  v_cmp_eq_u32 vcc, -1, v3
  v_mfma_f32_32x32x16_bf16 v[64:79], a[156:159], a[4:7], v[64:79]
  v_mfma_f32_32x32x16_bf16 v[80:95], a[156:159], a[8:11], v[80:95]
  s_nop 2
  s_cbranch_vccnz mm_l1_st97
mm_l1_st97_b:
  v_mfma_f32_32x32x16_bf16 v[96:111], v[228:231], a[4:7], v[96:111]
  s_waitcnt vmcnt(12)
  v_accvgpr_read_b32 v2, a16
  v_accvgpr_read_b32 v7, a18
  v_mfma_f32_32x32x16_bf16 v[112:127], v[228:231], a[8:11], v[112:127]
  v_max_u32 v3, v2, v7
  v_accvgpr_read_b32 v2, a20
  v_accvgpr_read_b32 v7, a22
  v_mfma_f32_32x32x16_bf16 v[64:79], a[76:79], a[12:15], v[64:79]
  v_max3_u32 v3, v2, v7, v3
  v_cmp_eq_u32 vcc, -1, v3
  v_mfma_f32_32x32x16_bf16 v[80:95], a[76:79], v[180:183], v[80:95]
  s_add_u32 s45, s11, s52
  s_add_u32 s45, s45, 5120
  buffer_load_dwordx4 v[128:131], v4, s[68:71], s45 offen offset:0 sc1
  s_nop 0
  s_cbranch_vccnz mm_l1_st98
mm_l1_st98_b:
  v_mfma_f32_32x32x16_bf16 v[96:111], a[188:191], a[12:15], v[96:111]
  s_waitcnt vmcnt(11)
  v_accvgpr_read_b32 v2, a24
  v_accvgpr_read_b32 v7, a26
  v_mfma_f32_32x32x16_bf16 v[112:127], a[188:191], v[180:183], v[112:127]
  buffer_load_dwordx4 v[132:135], v4, s[68:71], s45 offen offset:1024 sc1
  v_max_u32 v3, v2, v7
  v_accvgpr_read_b32 v2, a28
  v_accvgpr_read_b32 v7, a30
  v_mfma_f32_32x32x16_bf16 v[64:79], a[80:83], a[16:19], v[64:79]
  v_max3_u32 v3, v2, v7, v3
  v_cmp_eq_u32 vcc, -1, v3
  v_mfma_f32_32x32x16_bf16 v[80:95], a[80:83], a[20:23], v[80:95]
  s_add_u32 s45, s11, s53
  s_add_u32 s45, s45, 5120
  buffer_load_dwordx4 v[136:139], v4, s[68:71], s45 offen offset:0 sc1
  s_nop 0
  s_cbranch_vccnz mm_l1_st99
mm_l1_st99_b:
  v_mfma_f32_32x32x16_bf16 v[96:111], a[192:195], a[16:19], v[96:111]
  s_waitcnt vmcnt(11)
  v_accvgpr_read_b32 v2, a32
  v_accvgpr_read_b32 v7, a34
  v_mfma_f32_32x32x16_bf16 v[112:127], a[192:195], a[20:23], v[112:127]
  buffer_load_dwordx4 v[140:143], v4, s[68:71], s45 offen offset:1024 sc1
  v_max_u32 v3, v2, v7
  v_accvgpr_read_b32 v2, a36
  v_accvgpr_read_b32 v7, a38
  v_mfma_f32_32x32x16_bf16 v[64:79], a[104:107], a[24:27], v[64:79]
  v_max3_u32 v3, v2, v7, v3
  v_cmp_eq_u32 vcc, -1, v3
  v_mfma_f32_32x32x16_bf16 v[80:95], a[104:107], a[28:31], v[80:95]
  s_add_u32 s45, s11, s54
  s_add_u32 s45, s45, 5120
  buffer_load_dwordx4 v[144:147], v4, s[68:71], s45 offen offset:0 sc1
  s_nop 0
  s_cbranch_vccnz mm_l1_st100
mm_l1_st100_b:
  v_mfma_f32_32x32x16_bf16 v[96:111], a[216:219], a[24:27], v[96:111]
  s_waitcnt vmcnt(11)
  v_max_u32 v3, v184, v186
  v_accvgpr_read_b32 v2, a40
  v_mfma_f32_32x32x16_bf16 v[112:127], a[216:219], a[28:31], v[112:127]
  buffer_load_dwordx4 v[148:151], v4, s[68:71], s45 offen offset:1024 sc1
  v_accvgpr_read_b32 v7, a42
  v_max3_u32 v3, v2, v7, v3
  v_cmp_eq_u32 vcc, -1, v3
  v_mfma_f32_32x32x16_bf16 v[64:79], a[108:111], a[32:35], v[64:79]
  v_mfma_f32_32x32x16_bf16 v[80:95], a[108:111], a[36:39], v[80:95]
  s_add_u32 s45, s11, s55
  s_add_u32 s45, s45, 5120
  buffer_load_dwordx4 v[152:155], v4, s[68:71], s45 offen offset:0 sc1
  s_cbranch_vccnz mm_l1_st101
mm_l1_st101_b:
  v_mfma_f32_32x32x16_bf16 v[96:111], a[220:223], a[32:35], v[96:111]
  s_waitcnt vmcnt(11)
  v_accvgpr_read_b32 v2, a44
  v_accvgpr_read_b32 v7, a46
  v_mfma_f32_32x32x16_bf16 v[112:127], a[220:223], a[36:39], v[112:127]
  buffer_load_dwordx4 v[156:159], v4, s[68:71], s45 offen offset:1024 sc1
  v_max_u32 v3, v2, v7
  v_accvgpr_read_b32 v2, a48
  v_accvgpr_read_b32 v7, a50
  v_mfma_f32_32x32x16_bf16 v[64:79], a[132:135], v[184:187], v[64:79]
  v_max3_u32 v3, v2, v7, v3
  v_cmp_eq_u32 vcc, -1, v3
  v_mfma_f32_32x32x16_bf16 v[80:95], a[132:135], a[40:43], v[80:95]
  s_add_u32 s44, s10, s52
  s_add_u32 s44, s44, 5120
  buffer_load_dwordx4 v[16:19], v4, s[68:71], s44 offen offset:0 sc1
  s_nop 0
  s_cbranch_vccnz mm_l1_st102
mm_l1_st102_b:
  v_mfma_f32_32x32x16_bf16 v[96:111], a[244:247], v[184:187], v[96:111]
  s_waitcnt vmcnt(11)
  v_accvgpr_read_b32 v2, a52
  v_accvgpr_read_b32 v7, a54
  v_mfma_f32_32x32x16_bf16 v[112:127], a[244:247], a[40:43], v[112:127]
  buffer_load_dwordx4 v[20:23], v4, s[68:71], s44 offen offset:1024 sc1
  v_max_u32 v3, v2, v7
  v_accvgpr_read_b32 v2, a56
  v_accvgpr_read_b32 v7, a58
  v_mfma_f32_32x32x16_bf16 v[64:79], a[136:139], a[44:47], v[64:79]
  v_max3_u32 v3, v2, v7, v3
  v_cmp_eq_u32 vcc, -1, v3
  v_mfma_f32_32x32x16_bf16 v[80:95], a[136:139], a[48:51], v[80:95]
  s_add_u32 s44, s10, s53
  s_add_u32 s44, s44, 5120
  buffer_load_dwordx4 v[24:27], v4, s[68:71], s44 offen offset:0 sc1
  s_nop 0
  s_cbranch_vccnz mm_l1_st103
mm_l1_st103_b:
  v_mfma_f32_32x32x16_bf16 v[96:111], a[248:251], a[44:47], v[96:111]
  s_waitcnt vmcnt(11)
  v_accvgpr_read_b32 v2, a60
  v_accvgpr_read_b32 v7, a62
  v_mfma_f32_32x32x16_bf16 v[112:127], a[248:251], a[48:51], v[112:127]
  buffer_load_dwordx4 v[28:31], v4, s[68:71], s44 offen offset:1024 sc1
  v_max_u32 v3, v2, v7
  v_max3_u32 v3, v188, v190, v3
  v_cmp_eq_u32 vcc, -1, v3
  v_mfma_f32_32x32x16_bf16 v[64:79], a[160:163], a[52:55], v[64:79]
  v_mfma_f32_32x32x16_bf16 v[80:95], a[160:163], a[56:59], v[80:95]
  s_add_u32 s44, s10, s54
  s_add_u32 s44, s44, 5120
  buffer_load_dwordx4 v[32:35], v4, s[68:71], s44 offen offset:0 sc1
  s_cbranch_vccnz mm_l1_st104
mm_l1_st104_b:
  v_mfma_f32_32x32x16_bf16 v[96:111], v[232:235], a[52:55], v[96:111]
  v_mfma_f32_32x32x16_bf16 v[112:127], v[232:235], a[56:59], v[112:127]
  buffer_load_dwordx4 v[36:39], v4, s[68:71], s44 offen offset:1024 sc1
  s_waitcnt vmcnt(12)
  v_max_u32 v3, v128, v130
  v_max3_u32 v3, v132, v134, v3
  v_mfma_f32_32x32x16_bf16 v[64:79], a[164:167], a[60:63], v[64:79]
  v_cmp_eq_u32 vcc, -1, v3
  v_mfma_f32_32x32x16_bf16 v[80:95], a[164:167], v[188:191], v[80:95]
  s_add_u32 s44, s10, s55
  s_add_u32 s44, s44, 5120
  buffer_load_dwordx4 v[40:43], v4, s[68:71], s44 offen offset:0 sc1
  s_nop 0
  s_cbranch_vccnz mm_l1_st105
mm_l1_st105_b:
  s_waitcnt vmcnt(11)
  v_max_u32 v3, v136, v138
  v_mfma_f32_32x32x16_bf16 v[96:111], v[236:239], a[60:63], v[96:111]
  v_max3_u32 v3, v140, v142, v3
  v_cmp_eq_u32 vcc, -1, v3
  v_mfma_f32_32x32x16_bf16 v[112:127], v[236:239], v[188:191], v[112:127]
  buffer_load_dwordx4 v[44:47], v4, s[68:71], s44 offen offset:1024 sc1
  s_nop 2
  s_cbranch_vccnz mm_l1_st106
mm_l1_st106_b:
  s_waitcnt vmcnt(10)
  v_max_u32 v3, v144, v146
  v_mfma_f32_32x32x16_bf16 v[112:127], a[196:199], v[128:131], v[112:127]
  v_max3_u32 v3, v148, v150, v3
  v_cmp_eq_u32 vcc, -1, v3
  v_mfma_f32_32x32x16_bf16 v[112:127], a[200:203], v[132:135], v[112:127]
  s_nop 3
  s_cbranch_vccnz mm_l1_st107
mm_l1_st107_b:
  s_waitcnt vmcnt(8)
  v_max_u32 v3, v152, v154
  v_mfma_f32_32x32x16_bf16 v[112:127], a[224:227], v[136:139], v[112:127]
  v_max3_u32 v3, v156, v158, v3
  v_cmp_eq_u32 vcc, -1, v3
  v_mfma_f32_32x32x16_bf16 v[112:127], a[228:231], v[140:143], v[112:127]
  s_nop 3
  s_cbranch_vccnz mm_l1_st108
mm_l1_st108_b:
  v_mfma_f32_32x32x16_bf16 v[112:127], a[252:255], v[144:147], v[112:127]
  v_mfma_f32_32x32x16_bf16 v[112:127], v[216:219], v[148:151], v[112:127]
  v_mfma_f32_32x32x16_bf16 v[112:127], v[240:243], v[152:155], v[112:127]
  s_xor_b32 s9, s3, 1
  s_mul_i32 s9, s9, 12288
  s_add_u32 s9, s9, 98304
  v_add_u32 v5, s9, v4
  s_xor_b32 s9, s3, 2
  s_mul_i32 s9, s9, 12288
  s_add_u32 s9, s9, 102400
  v_add_u32 v6, s9, v4
  s_xor_b32 s9, s3, 3
  s_mul_i32 s9, s9, 12288
  s_add_u32 s9, s9, 106496
  v_add_u32 v7, s9, v4
  s_mul_i32 s9, s3, 12288
  s_add_u32 s9, s9, 98304
  v_add_u32 v2, s9, v4
  v_mfma_f32_32x32x16_bf16 v[112:127], v[244:247], v[156:159], v[112:127]
  v_mfma_f32_32x32x16_bf16 v[80:95], a[84:87], v[128:131], v[80:95]
  v_mfma_f32_32x32x16_bf16 v[80:95], a[88:91], v[132:135], v[80:95]
  s_nop 9
  ds_write_b128 v7, v[112:115] offset:0
  v_mfma_f32_32x32x16_bf16 v[80:95], a[112:115], v[136:139], v[80:95]
  v_mfma_f32_32x32x16_bf16 v[80:95], a[116:119], v[140:143], v[80:95]
  ds_write_b128 v7, v[116:119] offset:1024
  s_waitcnt vmcnt(6)
  v_max_u32 v3, v16, v18
  v_max3_u32 v3, v20, v22, v3
  v_mfma_f32_32x32x16_bf16 v[80:95], a[140:143], v[144:147], v[80:95]
  v_cmp_eq_u32 vcc, -1, v3
  v_mfma_f32_32x32x16_bf16 v[80:95], a[144:147], v[148:151], v[80:95]
  ds_write_b128 v7, v[120:123] offset:2048
  s_nop 2
  s_cbranch_vccnz mm_l1_st109
mm_l1_st109_b:
  s_waitcnt vmcnt(4)
  v_max_u32 v3, v24, v26
  v_mfma_f32_32x32x16_bf16 v[80:95], a[168:171], v[152:155], v[80:95]
  v_max3_u32 v3, v28, v30, v3
  v_cmp_eq_u32 vcc, -1, v3
  v_mfma_f32_32x32x16_bf16 v[80:95], a[172:175], v[156:159], v[80:95]
  ds_write_b128 v7, v[124:127] offset:3072
  s_nop 2
  s_cbranch_vccnz mm_l1_st110
mm_l1_st110_b:
  s_waitcnt vmcnt(2)
  v_max_u32 v3, v32, v34
  v_mfma_f32_32x32x16_bf16 v[96:111], a[196:199], v[16:19], v[96:111]
  v_max3_u32 v3, v36, v38, v3
  v_cmp_eq_u32 vcc, -1, v3
  v_mfma_f32_32x32x16_bf16 v[96:111], a[200:203], v[20:23], v[96:111]
  s_nop 0
  ds_write_b128 v6, v[80:83] offset:0
  s_nop 1
  s_cbranch_vccnz mm_l1_st111
mm_l1_st111_b:
  s_waitcnt vmcnt(0)
  v_max_u32 v3, v40, v42
  v_mfma_f32_32x32x16_bf16 v[96:111], a[224:227], v[24:27], v[96:111]
  v_max3_u32 v3, v44, v46, v3
  v_cmp_eq_u32 vcc, -1, v3
  v_mfma_f32_32x32x16_bf16 v[96:111], a[228:231], v[28:31], v[96:111]
  ds_write_b128 v6, v[84:87] offset:1024
  s_nop 2
  s_cbranch_vccnz mm_l1_st112
mm_l1_st112_b:
  v_mfma_f32_32x32x16_bf16 v[96:111], a[252:255], v[32:35], v[96:111]
  v_mfma_f32_32x32x16_bf16 v[96:111], v[216:219], v[36:39], v[96:111]
  ds_write_b128 v6, v[88:91] offset:2048
  v_mfma_f32_32x32x16_bf16 v[96:111], v[240:243], v[40:43], v[96:111]
  v_mfma_f32_32x32x16_bf16 v[96:111], v[244:247], v[44:47], v[96:111]
  ds_write_b128 v6, v[92:95] offset:3072
  v_mfma_f32_32x32x16_bf16 v[64:79], a[84:87], v[16:19], v[64:79]
  v_mfma_f32_32x32x16_bf16 v[64:79], a[88:91], v[20:23], v[64:79]
  s_nop 8
  ds_write_b128 v5, v[96:99] offset:0
  v_mfma_f32_32x32x16_bf16 v[64:79], a[112:115], v[24:27], v[64:79]
  v_mfma_f32_32x32x16_bf16 v[64:79], a[116:119], v[28:31], v[64:79]
  ds_write_b128 v5, v[100:103] offset:1024
  v_mfma_f32_32x32x16_bf16 v[64:79], a[140:143], v[32:35], v[64:79]
  v_mfma_f32_32x32x16_bf16 v[64:79], a[144:147], v[36:39], v[64:79]
  ds_write_b128 v5, v[104:107] offset:2048
  v_mfma_f32_32x32x16_bf16 v[64:79], a[168:171], v[40:43], v[64:79]
  v_mfma_f32_32x32x16_bf16 v[64:79], a[172:175], v[44:47], v[64:79]
  ds_write_b128 v5, v[108:111] offset:3072
  s_mov_b32 s44, s34
  s_and_b32 s45, s35, 0xffff
  s_mov_b32 s46, 1835008
  s_mov_b32 s47, 0x20000
  v_and_b32 v7, 31, v1
  s_lshl_b32 s9, s66, 5
  v_add_u32 v7, s9, v7
  v_mul_u32_u24 v7, 896, v7
  v_lshrrev_b32 v3, 5, v1
  v_lshl_add_u32 v7, v3, 4, v7
  s_lshl_b32 s9, s67, 6
  s_waitcnt lgkmcnt(0)
  s_barrier
  ds_read_b128 v[16:19], v2 offset:0
  ds_read_b128 v[20:23], v2 offset:1024
  ds_read_b128 v[24:27], v2 offset:2048
  ds_read_b128 v[28:31], v2 offset:3072
  ds_read_b128 v[32:35], v2 offset:4096
  ds_read_b128 v[36:39], v2 offset:5120
  ds_read_b128 v[40:43], v2 offset:6144
  ds_read_b128 v[44:47], v2 offset:7168
  ds_read_b128 v[48:51], v2 offset:8192
  ds_read_b128 v[52:55], v2 offset:9216
  ds_read_b128 v[56:59], v2 offset:10240
  ds_read_b128 v[60:63], v2 offset:11264
  s_waitcnt lgkmcnt(8)
  v_pk_add_f32 v[64:65], v[64:65], v[16:17]
  v_pk_add_f32 v[66:67], v[66:67], v[18:19]
  v_pk_add_f32 v[68:69], v[68:69], v[20:21]
  v_pk_add_f32 v[70:71], v[70:71], v[22:23]
  v_pk_add_f32 v[72:73], v[72:73], v[24:25]
  v_pk_add_f32 v[74:75], v[74:75], v[26:27]
  v_pk_add_f32 v[76:77], v[76:77], v[28:29]
  v_pk_add_f32 v[78:79], v[78:79], v[30:31]
  s_waitcnt lgkmcnt(4)
  v_pk_add_f32 v[64:65], v[64:65], v[32:33]
  v_pk_add_f32 v[66:67], v[66:67], v[34:35]
  v_pk_add_f32 v[68:69], v[68:69], v[36:37]
  v_pk_add_f32 v[70:71], v[70:71], v[38:39]
  v_pk_add_f32 v[72:73], v[72:73], v[40:41]
  v_pk_add_f32 v[74:75], v[74:75], v[42:43]
  v_pk_add_f32 v[76:77], v[76:77], v[44:45]
  v_pk_add_f32 v[78:79], v[78:79], v[46:47]
  s_waitcnt lgkmcnt(0)
  v_pk_add_f32 v[64:65], v[64:65], v[48:49]
  v_pk_add_f32 v[66:67], v[66:67], v[50:51]
  v_pk_add_f32 v[68:69], v[68:69], v[52:53]
  v_pk_add_f32 v[70:71], v[70:71], v[54:55]
  v_pk_add_f32 v[72:73], v[72:73], v[56:57]
  v_pk_add_f32 v[74:75], v[74:75], v[58:59]
  v_pk_add_f32 v[76:77], v[76:77], v[60:61]
  v_pk_add_f32 v[78:79], v[78:79], v[62:63]
  v_cvt_pk_bf16_f32 v8, v64, v65
  v_cvt_pk_bf16_f32 v9, v66, v67
  v_cvt_pk_bf16_f32 v10, v68, v69
  v_cvt_pk_bf16_f32 v11, v70, v71
  v_cvt_pk_bf16_f32 v12, v72, v73
  v_cvt_pk_bf16_f32 v13, v74, v75
  v_cvt_pk_bf16_f32 v14, v76, v77
  v_cvt_pk_bf16_f32 v15, v78, v79
  v_permlane32_swap_b32 v8, v10
  v_permlane32_swap_b32 v9, v11
  v_permlane32_swap_b32 v12, v14
  v_permlane32_swap_b32 v13, v15
  buffer_store_dwordx4 v[8:11], v7, s[44:47], s9 offen
  buffer_store_dwordx4 v[12:15], v7, s[44:47], s9 offen offset:32
  s_endpgm
mm_l1_norole:
  s_nop 15
  v_pk_mul_f32 v[96:97], v[96:97], v[104:105]
  v_pk_mul_f32 v[98:99], v[98:99], v[106:107]
  v_pk_mul_f32 v[100:101], v[100:101], v[108:109]
  v_pk_mul_f32 v[102:103], v[102:103], v[110:111]
  v_pk_mul_f32 v[96:97], v[96:97], v[172:173]
  v_pk_mul_f32 v[98:99], v[98:99], v[172:173]
  v_pk_mul_f32 v[100:101], v[100:101], v[172:173]
  v_pk_mul_f32 v[102:103], v[102:103], v[172:173]
  v_cvt_pk_bf16_f32 v164, v96, v97
  v_cvt_pk_bf16_f32 v165, v98, v99
  v_cvt_pk_bf16_f32 v166, v100, v101
  v_cvt_pk_bf16_f32 v167, v102, v103
  s_add_u32 s14, s6, 5120
  buffer_store_dwordx4 v[164:167], v4, s[40:43], s14 offen sc1
  v_pk_mul_f32 v[112:113], v[112:113], v[120:121]
  v_pk_mul_f32 v[114:115], v[114:115], v[122:123]
  v_pk_mul_f32 v[116:117], v[116:117], v[124:125]
  v_pk_mul_f32 v[118:119], v[118:119], v[126:127]
  v_pk_mul_f32 v[112:113], v[112:113], v[172:173]
  v_pk_mul_f32 v[114:115], v[114:115], v[172:173]
  v_pk_mul_f32 v[116:117], v[116:117], v[172:173]
  v_pk_mul_f32 v[118:119], v[118:119], v[172:173]
  v_cvt_pk_bf16_f32 v160, v112, v113
  v_cvt_pk_bf16_f32 v161, v114, v115
  v_cvt_pk_bf16_f32 v162, v116, v117
  v_cvt_pk_bf16_f32 v163, v118, v119
  s_add_u32 s14, s6, 6144
  buffer_store_dwordx4 v[160:163], v4, s[40:43], s14 offen sc1
  s_endpgm
mm_l1_st48:
  s_add_u32 s45, s21, 0
  buffer_load_dwordx4 v[24:27], v13, s[40:43], s45 offen offset:0 sc1
  buffer_load_dwordx4 v[28:31], v13, s[40:43], s45 offen offset:1024 sc1
  s_add_u32 s45, s33, 0
  s_and_b32 s45, s45, 0x3ffff
  buffer_load_dwordx4 a[0:3], v4, s[24:27], s45 offen offset:0 sc1
  buffer_load_dwordx4 a[4:7], v4, s[24:27], s45 offen offset:1024 sc1
  s_sub_i32 s13, s13, 1
  s_cmp_lt_i32 s13, 0
  s_waitcnt vmcnt(0)
  v_max_u32 v3, v24, v26
  v_max3_u32 v3, v28, v30, v3
  v_accvgpr_read_b32 v2, a0
  v_accvgpr_read_b32 v254, a2
  v_max3_u32 v3, v2, v254, v3
  v_accvgpr_read_b32 v2, a4
  v_accvgpr_read_b32 v254, a6
  v_max3_u32 v3, v2, v254, v3
  v_cmp_eq_u32 vcc, -1, v3
  s_cbranch_scc1 mm_l1_st48_b
  s_nop 3
  s_cbranch_vccnz mm_l1_st48
  s_branch mm_l1_st48_b
mm_l1_st50:
  s_add_u32 s45, s22, 0
  buffer_load_dwordx4 v[32:35], v13, s[40:43], s45 offen offset:0 sc1
  buffer_load_dwordx4 v[36:39], v13, s[40:43], s45 offen offset:1024 sc1
  s_sub_i32 s13, s13, 1
  s_cmp_lt_i32 s13, 0
  s_waitcnt vmcnt(0)
  v_max_u32 v3, v32, v34
  v_max3_u32 v3, v36, v38, v3
  v_cmp_eq_u32 vcc, -1, v3
  s_cbranch_scc1 mm_l1_st50_b
  s_nop 3
  s_cbranch_vccnz mm_l1_st50
  s_branch mm_l1_st50_b
mm_l1_st51:
  s_add_u32 s45, s33, 2048
  s_and_b32 s45, s45, 0x3ffff
  buffer_load_dwordx4 a[8:11], v4, s[24:27], s45 offen offset:0 sc1
  buffer_load_dwordx4 a[12:15], v4, s[24:27], s45 offen offset:1024 sc1
  s_sub_i32 s13, s13, 1
  s_cmp_lt_i32 s13, 0
  s_waitcnt vmcnt(0)
  v_accvgpr_read_b32 v2, a8
  v_accvgpr_read_b32 v254, a10
  v_max_u32 v3, v2, v254
  v_accvgpr_read_b32 v2, a12
  v_accvgpr_read_b32 v254, a14
  v_max3_u32 v3, v2, v254, v3
  v_cmp_eq_u32 vcc, -1, v3
  s_cbranch_scc1 mm_l1_st51_b
  s_nop 3
  s_cbranch_vccnz mm_l1_st51
  s_branch mm_l1_st51_b
mm_l1_st52:
  s_add_u32 s45, s23, 0
  buffer_load_dwordx4 v[40:43], v13, s[40:43], s45 offen offset:0 sc1
  buffer_load_dwordx4 v[44:47], v13, s[40:43], s45 offen offset:1024 sc1
  s_sub_i32 s13, s13, 1
  s_cmp_lt_i32 s13, 0
  s_waitcnt vmcnt(0)
  v_max_u32 v3, v40, v42
  v_max3_u32 v3, v44, v46, v3
  v_cmp_eq_u32 vcc, -1, v3
  s_cbranch_scc1 mm_l1_st52_b
  s_nop 3
  s_cbranch_vccnz mm_l1_st52
  s_branch mm_l1_st52_b
mm_l1_st53:
  s_add_u32 s45, s20, 0
  buffer_load_dwordx4 v[16:19], v13, s[40:43], s45 offen offset:0 sc1
  buffer_load_dwordx4 v[20:23], v13, s[40:43], s45 offen offset:1024 sc1
  s_sub_i32 s13, s13, 1
  s_cmp_lt_i32 s13, 0
  s_waitcnt vmcnt(0)
  v_max_u32 v3, v16, v18
  v_max3_u32 v3, v20, v22, v3
  v_cmp_eq_u32 vcc, -1, v3
  s_cbranch_scc1 mm_l1_st53_b
  s_nop 3
  s_cbranch_vccnz mm_l1_st53
  s_branch mm_l1_st53_b
mm_l1_st54:
  s_add_u32 s45, s33, 16384
  s_and_b32 s45, s45, 0x3ffff
  buffer_load_dwordx4 a[16:19], v4, s[24:27], s45 offen offset:0 sc1
  buffer_load_dwordx4 a[20:23], v4, s[24:27], s45 offen offset:1024 sc1
  buffer_load_dwordx4 a[24:27], v4, s[24:27], s45 offen offset:2048 sc1
  buffer_load_dwordx4 a[28:31], v4, s[24:27], s45 offen offset:3072 sc1
  s_sub_i32 s13, s13, 1
  s_cmp_lt_i32 s13, 0
  s_waitcnt vmcnt(0)
  v_accvgpr_read_b32 v2, a16
  v_accvgpr_read_b32 v254, a18
  v_max_u32 v3, v2, v254
  v_accvgpr_read_b32 v2, a20
  v_accvgpr_read_b32 v254, a22
  v_max3_u32 v3, v2, v254, v3
  v_accvgpr_read_b32 v2, a24
  v_accvgpr_read_b32 v254, a26
  v_max3_u32 v3, v2, v254, v3
  v_accvgpr_read_b32 v2, a28
  v_accvgpr_read_b32 v254, a30
  v_max3_u32 v3, v2, v254, v3
  v_cmp_eq_u32 vcc, -1, v3
  s_cbranch_scc1 mm_l1_st54_b
  s_nop 3
  s_cbranch_vccnz mm_l1_st54
  s_branch mm_l1_st54_b
mm_l1_st55:
  s_add_u32 s45, s33, 32768
  s_and_b32 s45, s45, 0x3ffff
  buffer_load_dwordx4 a[32:35], v4, s[24:27], s45 offen offset:0 sc1
  buffer_load_dwordx4 a[36:39], v4, s[24:27], s45 offen offset:1024 sc1
  buffer_load_dwordx4 a[40:43], v4, s[24:27], s45 offen offset:2048 sc1
  buffer_load_dwordx4 a[44:47], v4, s[24:27], s45 offen offset:3072 sc1
  s_sub_i32 s13, s13, 1
  s_cmp_lt_i32 s13, 0
  s_waitcnt vmcnt(0)
  v_accvgpr_read_b32 v2, a32
  v_accvgpr_read_b32 v254, a34
  v_max_u32 v3, v2, v254
  v_accvgpr_read_b32 v2, a36
  v_accvgpr_read_b32 v254, a38
  v_max3_u32 v3, v2, v254, v3
  v_accvgpr_read_b32 v2, a40
  v_accvgpr_read_b32 v254, a42
  v_max3_u32 v3, v2, v254, v3
  v_accvgpr_read_b32 v2, a44
  v_accvgpr_read_b32 v254, a46
  v_max3_u32 v3, v2, v254, v3
  v_cmp_eq_u32 vcc, -1, v3
  s_cbranch_scc1 mm_l1_st55_b
  s_nop 3
  s_cbranch_vccnz mm_l1_st55
  s_branch mm_l1_st55_b
mm_l1_st56:
  s_add_u32 s45, s33, 49152
  s_and_b32 s45, s45, 0x3ffff
  buffer_load_dwordx4 a[48:51], v4, s[24:27], s45 offen offset:0 sc1
  buffer_load_dwordx4 a[52:55], v4, s[24:27], s45 offen offset:1024 sc1
  buffer_load_dwordx4 a[56:59], v4, s[24:27], s45 offen offset:2048 sc1
  buffer_load_dwordx4 a[60:63], v4, s[24:27], s45 offen offset:3072 sc1
  s_sub_i32 s13, s13, 1
  s_cmp_lt_i32 s13, 0
  s_waitcnt vmcnt(0)
  v_accvgpr_read_b32 v2, a48
  v_accvgpr_read_b32 v254, a50
  v_max_u32 v3, v2, v254
  v_accvgpr_read_b32 v2, a52
  v_accvgpr_read_b32 v254, a54
  v_max3_u32 v3, v2, v254, v3
  v_accvgpr_read_b32 v2, a56
  v_accvgpr_read_b32 v254, a58
  v_max3_u32 v3, v2, v254, v3
  v_accvgpr_read_b32 v2, a60
  v_accvgpr_read_b32 v254, a62
  v_max3_u32 v3, v2, v254, v3
  v_cmp_eq_u32 vcc, -1, v3
  s_cbranch_scc1 mm_l1_st56_b
  s_nop 3
  s_cbranch_vccnz mm_l1_st56
  s_branch mm_l1_st56_b
mm_l1_tw57:
  buffer_load_dword v252, v15, s[40:43], s36 offen sc1
  s_sub_i32 s13, s13, 1
  s_waitcnt vmcnt(0)
  v_cmp_eq_u32 vcc, 0, v252
  s_nop 0
  s_and_b32 s28, vcc_lo, 0xffff
  s_lshl_b32 s29, s28, 16
  s_or_b32 s28, s28, s29
  s_lshr_b32 s28, s28, s32
  s_cmp_lt_i32 s13, 0
  s_cbranch_scc1 mm_l1_tw57_b
  s_bitcmp1_b32 s28, 6
  s_cbranch_scc0 mm_l1_tw57
  s_branch mm_l1_tw57_b
mm_l1_st58:
  s_add_u32 s45, s33, 65536
  s_and_b32 s45, s45, 0x3ffff
  buffer_load_dwordx4 a[0:3], v4, s[24:27], s45 offen offset:0 sc1
  buffer_load_dwordx4 a[4:7], v4, s[24:27], s45 offen offset:1024 sc1
  buffer_load_dwordx4 a[8:11], v4, s[24:27], s45 offen offset:2048 sc1
  buffer_load_dwordx4 a[12:15], v4, s[24:27], s45 offen offset:3072 sc1
  s_sub_i32 s13, s13, 1
  s_cmp_lt_i32 s13, 0
  s_waitcnt vmcnt(0)
  v_accvgpr_read_b32 v2, a0
  v_accvgpr_read_b32 v254, a2
  v_max_u32 v3, v2, v254
  v_accvgpr_read_b32 v2, a4
  v_accvgpr_read_b32 v254, a6
  v_max3_u32 v3, v2, v254, v3
  v_accvgpr_read_b32 v2, a8
  v_accvgpr_read_b32 v254, a10
  v_max3_u32 v3, v2, v254, v3
  v_accvgpr_read_b32 v2, a12
  v_accvgpr_read_b32 v254, a14
  v_max3_u32 v3, v2, v254, v3
  v_cmp_eq_u32 vcc, -1, v3
  s_cbranch_scc1 mm_l1_st58_b
  s_nop 3
  s_cbranch_vccnz mm_l1_st58
  s_branch mm_l1_st58_b
mm_l1_tw59:
  buffer_load_dword v252, v15, s[40:43], s36 offen sc1
  s_sub_i32 s13, s13, 1
  s_waitcnt vmcnt(0)
  v_cmp_eq_u32 vcc, 0, v252
  s_nop 0
  s_and_b32 s28, vcc_lo, 0xffff
  s_lshl_b32 s29, s28, 16
  s_or_b32 s28, s28, s29
  s_lshr_b32 s28, s28, s32
  s_cmp_lt_i32 s13, 0
  s_cbranch_scc1 mm_l1_tw59_b
  s_bitcmp1_b32 s28, 7
  s_cbranch_scc0 mm_l1_tw59
  s_branch mm_l1_tw59_b
mm_l1_st60:
  s_add_u32 s45, s33, 81920
  s_and_b32 s45, s45, 0x3ffff
  buffer_load_dwordx4 a[16:19], v4, s[24:27], s45 offen offset:0 sc1
  buffer_load_dwordx4 a[20:23], v4, s[24:27], s45 offen offset:1024 sc1
  buffer_load_dwordx4 a[24:27], v4, s[24:27], s45 offen offset:2048 sc1
  buffer_load_dwordx4 a[28:31], v4, s[24:27], s45 offen offset:3072 sc1
  s_sub_i32 s13, s13, 1
  s_cmp_lt_i32 s13, 0
  s_waitcnt vmcnt(0)
  v_accvgpr_read_b32 v2, a16
  v_accvgpr_read_b32 v254, a18
  v_max_u32 v3, v2, v254
  v_accvgpr_read_b32 v2, a20
  v_accvgpr_read_b32 v254, a22
  v_max3_u32 v3, v2, v254, v3
  v_accvgpr_read_b32 v2, a24
  v_accvgpr_read_b32 v254, a26
  v_max3_u32 v3, v2, v254, v3
  v_accvgpr_read_b32 v2, a28
  v_accvgpr_read_b32 v254, a30
  v_max3_u32 v3, v2, v254, v3
  v_cmp_eq_u32 vcc, -1, v3
  s_cbranch_scc1 mm_l1_st60_b
  s_nop 3
  s_cbranch_vccnz mm_l1_st60
  s_branch mm_l1_st60_b
mm_l1_tw61:
  buffer_load_dword v252, v15, s[40:43], s36 offen sc1
  s_sub_i32 s13, s13, 1
  s_waitcnt vmcnt(0)
  v_cmp_eq_u32 vcc, 0, v252
  s_nop 0
  s_and_b32 s28, vcc_lo, 0xffff
  s_lshl_b32 s29, s28, 16
  s_or_b32 s28, s28, s29
  s_lshr_b32 s28, s28, s32
  s_cmp_lt_i32 s13, 0
  s_cbranch_scc1 mm_l1_tw61_b
  s_bitcmp1_b32 s28, 8
  s_cbranch_scc0 mm_l1_tw61
  s_branch mm_l1_tw61_b
mm_l1_tw62:
  buffer_load_dword v252, v15, s[40:43], s36 offen sc1
  s_sub_i32 s13, s13, 1
  s_waitcnt vmcnt(0)
  v_cmp_eq_u32 vcc, 0, v252
  s_nop 0
  s_and_b32 s28, vcc_lo, 0xffff
  s_lshl_b32 s29, s28, 16
  s_or_b32 s28, s28, s29
  s_lshr_b32 s28, s28, s32
  s_cmp_lt_i32 s13, 0
  s_cbranch_scc1 mm_l1_tw62_b
  s_bitcmp1_b32 s28, 9
  s_cbranch_scc0 mm_l1_tw62
  s_branch mm_l1_tw62_b
mm_l1_tw63:
  buffer_load_dword v252, v15, s[40:43], s36 offen sc1
  s_sub_i32 s13, s13, 1
  s_waitcnt vmcnt(0)
  v_cmp_eq_u32 vcc, 0, v252
  s_nop 0
  s_and_b32 s28, vcc_lo, 0xffff
  s_lshl_b32 s29, s28, 16
  s_or_b32 s28, s28, s29
  s_lshr_b32 s28, s28, s32
  s_cmp_lt_i32 s13, 0
  s_cbranch_scc1 mm_l1_tw63_b
  s_bitcmp1_b32 s28, 10
  s_cbranch_scc0 mm_l1_tw63
  s_branch mm_l1_tw63_b
mm_l1_tw64:
  buffer_load_dword v252, v15, s[40:43], s36 offen sc1
  s_sub_i32 s13, s13, 1
  s_waitcnt vmcnt(0)
  v_cmp_eq_u32 vcc, 0, v252
  s_nop 0
  s_and_b32 s28, vcc_lo, 0xffff
  s_lshl_b32 s29, s28, 16
  s_or_b32 s28, s28, s29
  s_lshr_b32 s28, s28, s32
  s_cmp_lt_i32 s13, 0
  s_cbranch_scc1 mm_l1_tw64_b
  s_bitcmp1_b32 s28, 11
  s_cbranch_scc0 mm_l1_tw64
  s_branch mm_l1_tw64_b
mm_l1_tw65:
  buffer_load_dword v252, v15, s[40:43], s36 offen sc1
  s_sub_i32 s13, s13, 1
  s_waitcnt vmcnt(0)
  v_cmp_eq_u32 vcc, 0, v252
  s_nop 0
  s_and_b32 s28, vcc_lo, 0xffff
  s_lshl_b32 s29, s28, 16
  s_or_b32 s28, s28, s29
  s_lshr_b32 s28, s28, s32
  s_cmp_lt_i32 s13, 0
  s_cbranch_scc1 mm_l1_tw65_b
  s_bitcmp1_b32 s28, 12
  s_cbranch_scc0 mm_l1_tw65
  s_branch mm_l1_tw65_b
mm_l1_tw66:
  buffer_load_dword v252, v15, s[40:43], s36 offen sc1
  s_sub_i32 s13, s13, 1
  s_waitcnt vmcnt(0)
  v_cmp_eq_u32 vcc, 0, v252
  s_nop 0
  s_and_b32 s28, vcc_lo, 0xffff
  s_lshl_b32 s29, s28, 16
  s_or_b32 s28, s28, s29
  s_lshr_b32 s28, s28, s32
  s_cmp_lt_i32 s13, 0
  s_cbranch_scc1 mm_l1_tw66_b
  s_bitcmp1_b32 s28, 13
  s_cbranch_scc0 mm_l1_tw66
  s_branch mm_l1_tw66_b
mm_l1_tw67:
  buffer_load_dword v252, v15, s[40:43], s36 offen sc1
  s_sub_i32 s13, s13, 1
  s_waitcnt vmcnt(0)
  v_cmp_eq_u32 vcc, 0, v252
  s_nop 0
  s_and_b32 s28, vcc_lo, 0xffff
  s_lshl_b32 s29, s28, 16
  s_or_b32 s28, s28, s29
  s_lshr_b32 s28, s28, s32
  s_cmp_lt_i32 s13, 0
  s_cbranch_scc1 mm_l1_tw67_b
  s_bitcmp1_b32 s28, 14
  s_cbranch_scc0 mm_l1_tw67
  s_branch mm_l1_tw67_b
mm_l1_tw68:
  buffer_load_dword v252, v15, s[40:43], s36 offen sc1
  s_sub_i32 s13, s13, 1
  s_waitcnt vmcnt(0)
  v_cmp_eq_u32 vcc, 0, v252
  s_nop 0
  s_and_b32 s28, vcc_lo, 0xffff
  s_lshl_b32 s29, s28, 16
  s_or_b32 s28, s28, s29
  s_lshr_b32 s28, s28, s32
  s_cmp_lt_i32 s13, 0
  s_cbranch_scc1 mm_l1_tw68_b
  s_bitcmp1_b32 s28, 15
  s_cbranch_scc0 mm_l1_tw68
  s_branch mm_l1_tw68_b
mm_l1_st70:
  s_add_u32 s15, s50, 0
  buffer_load_dwordx4 v[16:19], v4, s[40:43], s15 offen offset:0 sc1
  buffer_load_dwordx4 v[24:27], v4, s[40:43], s15 offen offset:1024 sc1
  buffer_load_dwordx4 v[32:35], v4, s[40:43], s15 offen offset:2048 sc1
  buffer_load_dwordx4 v[40:43], v4, s[40:43], s15 offen offset:3072 sc1
  s_add_u32 s15, s50, 4096
  buffer_load_dwordx4 v[48:51], v4, s[40:43], s15 offen offset:0 sc1
  buffer_load_dwordx4 v[56:59], v4, s[40:43], s15 offen offset:1024 sc1
  buffer_load_dwordx4 v[64:67], v4, s[40:43], s15 offen offset:2048 sc1
  buffer_load_dwordx4 v[72:75], v4, s[40:43], s15 offen offset:3072 sc1
  s_sub_i32 s13, s13, 1
  s_cmp_lt_i32 s13, 0
  s_waitcnt vmcnt(0)
  v_max_u32 v3, v16, v18
  v_max3_u32 v3, v24, v26, v3
  v_max3_u32 v3, v32, v34, v3
  v_max3_u32 v3, v40, v42, v3
  v_max3_u32 v3, v48, v50, v3
  v_max3_u32 v3, v56, v58, v3
  v_max3_u32 v3, v64, v66, v3
  v_max3_u32 v3, v72, v74, v3
  v_cmp_eq_u32 vcc, -1, v3
  s_cbranch_scc1 mm_l1_st70_b
  s_nop 3
  s_cbranch_vccnz mm_l1_st70
  s_branch mm_l1_st70_b
mm_l1_st72:
  s_add_u32 s15, s5, 0
  buffer_load_dwordx4 v[192:195], v4, s[40:43], s15 offen offset:0 sc1
  buffer_load_dwordx4 v[196:199], v4, s[40:43], s15 offen offset:1024 sc1
  s_sub_i32 s13, s13, 1
  s_cmp_lt_i32 s13, 0
  s_waitcnt vmcnt(0)
  v_max_u32 v3, v192, v194
  v_max3_u32 v3, v196, v198, v3
  v_cmp_eq_u32 vcc, -1, v3
  s_cbranch_scc1 mm_l1_st72_b
  s_nop 3
  s_cbranch_vccnz mm_l1_st72
  s_branch mm_l1_st72_b
mm_l1_st73:
  s_add_u32 s15, s5, 2048
  buffer_load_dwordx4 v[200:203], v4, s[40:43], s15 offen offset:0 sc1
  buffer_load_dwordx4 v[204:207], v4, s[40:43], s15 offen offset:1024 sc1
  s_sub_i32 s13, s13, 1
  s_cmp_lt_i32 s13, 0
  s_waitcnt vmcnt(0)
  v_max_u32 v3, v200, v202
  v_max3_u32 v3, v204, v206, v3
  v_cmp_eq_u32 vcc, -1, v3
  s_cbranch_scc1 mm_l1_st73_b
  s_nop 3
  s_cbranch_vccnz mm_l1_st73
  s_branch mm_l1_st73_b
mm_l1_st74:
  s_add_u32 s15, s5, 4096
  buffer_load_dwordx4 v[208:211], v4, s[40:43], s15 offen offset:0 sc1
  buffer_load_dwordx4 v[212:215], v4, s[40:43], s15 offen offset:1024 sc1
  s_sub_i32 s13, s13, 1
  s_cmp_lt_i32 s13, 0
  s_waitcnt vmcnt(0)
  v_max_u32 v3, v208, v210
  v_max3_u32 v3, v212, v214, v3
  v_cmp_eq_u32 vcc, -1, v3
  s_cbranch_scc1 mm_l1_st74_b
  s_nop 3
  s_cbranch_vccnz mm_l1_st74
  s_branch mm_l1_st74_b
mm_l1_st75:
  s_add_u32 s15, s5, 7168
  buffer_load_dwordx4 v[8:11], v4, s[40:43], s15 offen offset:0 sc1
  buffer_load_dwordx4 v[12:15], v4, s[40:43], s15 offen offset:1024 sc1
  s_sub_i32 s13, s13, 1
  s_cmp_lt_i32 s13, 0
  s_waitcnt vmcnt(0)
  v_max_u32 v3, v8, v10
  v_max3_u32 v3, v12, v14, v3
  v_cmp_eq_u32 vcc, -1, v3
  s_cbranch_scc1 mm_l1_st75_b
  s_nop 3
  s_cbranch_vccnz mm_l1_st75
  s_branch mm_l1_st75_b
mm_l1_st76:
  s_add_u32 s15, s5, 9216
  buffer_load_dwordx4 a[0:3], v4, s[40:43], s15 offen offset:0 sc1
  buffer_load_dwordx4 a[4:7], v4, s[40:43], s15 offen offset:1024 sc1
  s_sub_i32 s13, s13, 1
  s_cmp_lt_i32 s13, 0
  s_waitcnt vmcnt(0)
  v_accvgpr_read_b32 v2, a0
  v_accvgpr_read_b32 v7, a2
  v_max_u32 v3, v2, v7
  v_accvgpr_read_b32 v2, a4
  v_accvgpr_read_b32 v7, a6
  v_max3_u32 v3, v2, v7, v3
  v_cmp_eq_u32 vcc, -1, v3
  s_cbranch_scc1 mm_l1_st76_b
  s_nop 3
  s_cbranch_vccnz mm_l1_st76
  s_branch mm_l1_st76_b
mm_l1_st77:
  s_add_u32 s15, s5, 11264
  buffer_load_dwordx4 a[8:11], v4, s[40:43], s15 offen offset:0 sc1
  buffer_load_dwordx4 a[12:15], v4, s[40:43], s15 offen offset:1024 sc1
  s_sub_i32 s13, s13, 1
  s_cmp_lt_i32 s13, 0
  s_waitcnt vmcnt(0)
  v_accvgpr_read_b32 v2, a8
  v_accvgpr_read_b32 v7, a10
  v_max_u32 v3, v2, v7
  v_accvgpr_read_b32 v2, a12
  v_accvgpr_read_b32 v7, a14
  v_max3_u32 v3, v2, v7, v3
  v_cmp_eq_u32 vcc, -1, v3
  s_cbranch_scc1 mm_l1_st77_b
  s_nop 3
  s_cbranch_vccnz mm_l1_st77
  s_branch mm_l1_st77_b
mm_l1_st78:
  s_add_u32 s15, s5, 14336
  buffer_load_dwordx4 a[16:19], v4, s[40:43], s15 offen offset:0 sc1
  buffer_load_dwordx4 a[20:23], v4, s[40:43], s15 offen offset:1024 sc1
  s_sub_i32 s13, s13, 1
  s_cmp_lt_i32 s13, 0
  s_waitcnt vmcnt(0)
  v_accvgpr_read_b32 v2, a16
  v_accvgpr_read_b32 v7, a18
  v_max_u32 v3, v2, v7
  v_accvgpr_read_b32 v2, a20
  v_accvgpr_read_b32 v7, a22
  v_max3_u32 v3, v2, v7, v3
  v_cmp_eq_u32 vcc, -1, v3
  s_cbranch_scc1 mm_l1_st78_b
  s_nop 3
  s_cbranch_vccnz mm_l1_st78
  s_branch mm_l1_st78_b
mm_l1_st79:
  s_add_u32 s15, s5, 16384
  buffer_load_dwordx4 a[24:27], v4, s[40:43], s15 offen offset:0 sc1
  buffer_load_dwordx4 a[28:31], v4, s[40:43], s15 offen offset:1024 sc1
  s_sub_i32 s13, s13, 1
  s_cmp_lt_i32 s13, 0
  s_waitcnt vmcnt(0)
  v_accvgpr_read_b32 v2, a24
  v_accvgpr_read_b32 v7, a26
  v_max_u32 v3, v2, v7
  v_accvgpr_read_b32 v2, a28
  v_accvgpr_read_b32 v7, a30
  v_max3_u32 v3, v2, v7, v3
  v_cmp_eq_u32 vcc, -1, v3
  s_cbranch_scc1 mm_l1_st79_b
  s_nop 3
  s_cbranch_vccnz mm_l1_st79
  s_branch mm_l1_st79_b
mm_l1_st80:
  s_add_u32 s15, s5, 18432
  buffer_load_dwordx4 a[32:35], v4, s[40:43], s15 offen offset:0 sc1
  buffer_load_dwordx4 a[36:39], v4, s[40:43], s15 offen offset:1024 sc1
  s_sub_i32 s13, s13, 1
  s_cmp_lt_i32 s13, 0
  s_waitcnt vmcnt(0)
  v_accvgpr_read_b32 v2, a32
  v_accvgpr_read_b32 v7, a34
  v_max_u32 v3, v2, v7
  v_accvgpr_read_b32 v2, a36
  v_accvgpr_read_b32 v7, a38
  v_max3_u32 v3, v2, v7, v3
  v_cmp_eq_u32 vcc, -1, v3
  s_cbranch_scc1 mm_l1_st80_b
  s_nop 3
  s_cbranch_vccnz mm_l1_st80
  s_branch mm_l1_st80_b
mm_l1_st81:
  s_add_u32 s15, s7, 0
  buffer_load_dwordx4 v[160:163], v4, s[40:43], s15 offen offset:0 sc1
  buffer_load_dwordx4 v[164:167], v4, s[40:43], s15 offen offset:1024 sc1
  buffer_load_dwordx4 v[168:171], v4, s[40:43], s15 offen offset:2048 sc1
  s_mov_b32 exec_hi, 0
  buffer_load_dwordx4 v[172:175], v4, s[40:43], s15 offen offset:3072 sc1
  s_mov_b32 exec_hi, -1
  s_sub_i32 s13, s13, 1
  s_cmp_lt_i32 s13, 0
  s_waitcnt vmcnt(0)
  v_max_u32 v3, v160, v162
  v_max3_u32 v3, v164, v166, v3
  v_max3_u32 v3, v168, v170, v3
  v_max3_u32 v3, v172, v174, v3
  v_cmp_eq_u32 vcc, -1, v3
  s_cbranch_scc1 mm_l1_st81_b
  s_nop 3
  s_cbranch_vccnz mm_l1_st81
  s_branch mm_l1_st81_b
mm_l1_st82:
  s_add_u32 s15, s5, 21504
  buffer_load_dwordx4 a[40:43], v4, s[40:43], s15 offen offset:0 sc1
  buffer_load_dwordx4 a[44:47], v4, s[40:43], s15 offen offset:1024 sc1
  s_sub_i32 s13, s13, 1
  s_cmp_lt_i32 s13, 0
  s_waitcnt vmcnt(0)
  v_accvgpr_read_b32 v2, a40
  v_accvgpr_read_b32 v7, a42
  v_max_u32 v3, v2, v7
  v_accvgpr_read_b32 v2, a44
  v_accvgpr_read_b32 v7, a46
  v_max3_u32 v3, v2, v7, v3
  v_cmp_eq_u32 vcc, -1, v3
  s_cbranch_scc1 mm_l1_st82_b
  s_nop 3
  s_cbranch_vccnz mm_l1_st82
  s_branch mm_l1_st82_b
mm_l1_st83:
  s_add_u32 s15, s5, 23552
  buffer_load_dwordx4 a[48:51], v4, s[40:43], s15 offen offset:0 sc1
  buffer_load_dwordx4 a[52:55], v4, s[40:43], s15 offen offset:1024 sc1
  s_sub_i32 s13, s13, 1
  s_cmp_lt_i32 s13, 0
  s_waitcnt vmcnt(0)
  v_accvgpr_read_b32 v2, a48
  v_accvgpr_read_b32 v7, a50
  v_max_u32 v3, v2, v7
  v_accvgpr_read_b32 v2, a52
  v_accvgpr_read_b32 v7, a54
  v_max3_u32 v3, v2, v7, v3
  v_cmp_eq_u32 vcc, -1, v3
  s_cbranch_scc1 mm_l1_st83_b
  s_nop 3
  s_cbranch_vccnz mm_l1_st83
  s_branch mm_l1_st83_b
mm_l1_st84:
  s_add_u32 s15, s5, 25600
  buffer_load_dwordx4 a[56:59], v4, s[40:43], s15 offen offset:0 sc1
  buffer_load_dwordx4 a[60:63], v4, s[40:43], s15 offen offset:1024 sc1
  s_sub_i32 s13, s13, 1
  s_cmp_lt_i32 s13, 0
  s_waitcnt vmcnt(0)
  v_accvgpr_read_b32 v2, a56
  v_accvgpr_read_b32 v7, a58
  v_max_u32 v3, v2, v7
  v_accvgpr_read_b32 v2, a60
  v_accvgpr_read_b32 v7, a62
  v_max3_u32 v3, v2, v7, v3
  v_cmp_eq_u32 vcc, -1, v3
  s_cbranch_scc1 mm_l1_st84_b
  s_nop 3
  s_cbranch_vccnz mm_l1_st84
  s_branch mm_l1_st84_b
mm_l1_st85:
  s_add_u32 s15, s10, s52
  buffer_load_dwordx4 v[16:19], v4, s[68:71], s15 offen offset:0 sc1
  s_add_u32 s15, s11, s52
  buffer_load_dwordx4 v[20:23], v4, s[68:71], s15 offen offset:0 sc1
  s_sub_i32 s13, s13, 1
  s_cmp_lt_i32 s13, 0
  s_waitcnt vmcnt(0)
  v_max_u32 v3, v16, v18
  v_max3_u32 v3, v20, v22, v3
  v_cmp_eq_u32 vcc, -1, v3
  s_cbranch_scc1 mm_l1_st85_b
  s_nop 3
  s_cbranch_vccnz mm_l1_st85
  s_branch mm_l1_st85_b
mm_l1_st86:
  s_add_u32 s15, s10, s52
  s_add_u32 s15, s15, 1024
  buffer_load_dwordx4 v[24:27], v4, s[68:71], s15 offen offset:0 sc1
  s_add_u32 s15, s11, s52
  s_add_u32 s15, s15, 1024
  buffer_load_dwordx4 v[28:31], v4, s[68:71], s15 offen offset:0 sc1
  s_sub_i32 s13, s13, 1
  s_cmp_lt_i32 s13, 0
  s_waitcnt vmcnt(0)
  v_max_u32 v3, v24, v26
  v_max3_u32 v3, v28, v30, v3
  v_cmp_eq_u32 vcc, -1, v3
  s_cbranch_scc1 mm_l1_st86_b
  s_nop 3
  s_cbranch_vccnz mm_l1_st86
  s_branch mm_l1_st86_b
mm_l1_st87:
  s_add_u32 s15, s10, s52
  s_add_u32 s15, s15, 2048
  buffer_load_dwordx4 v[32:35], v4, s[68:71], s15 offen offset:0 sc1
  s_add_u32 s15, s11, s52
  s_add_u32 s15, s15, 2048
  buffer_load_dwordx4 v[36:39], v4, s[68:71], s15 offen offset:0 sc1
  s_sub_i32 s13, s13, 1
  s_cmp_lt_i32 s13, 0
  s_waitcnt vmcnt(0)
  v_max_u32 v3, v32, v34
  v_max3_u32 v3, v36, v38, v3
  v_cmp_eq_u32 vcc, -1, v3
  s_cbranch_scc1 mm_l1_st87_b
  s_nop 3
  s_cbranch_vccnz mm_l1_st87
  s_branch mm_l1_st87_b
mm_l1_st88:
  s_add_u32 s15, s10, s53
  buffer_load_dwordx4 v[40:43], v4, s[68:71], s15 offen offset:0 sc1
  s_add_u32 s15, s11, s53
  buffer_load_dwordx4 v[44:47], v4, s[68:71], s15 offen offset:0 sc1
  s_sub_i32 s13, s13, 1
  s_cmp_lt_i32 s13, 0
  s_waitcnt vmcnt(0)
  v_max_u32 v3, v40, v42
  v_max3_u32 v3, v44, v46, v3
  v_cmp_eq_u32 vcc, -1, v3
  s_cbranch_scc1 mm_l1_st88_b
  s_nop 3
  s_cbranch_vccnz mm_l1_st88
  s_branch mm_l1_st88_b
mm_l1_st89:
  s_add_u32 s15, s10, s53
  s_add_u32 s15, s15, 1024
  buffer_load_dwordx4 v[48:51], v4, s[68:71], s15 offen offset:0 sc1
  s_add_u32 s15, s11, s53
  s_add_u32 s15, s15, 1024
  buffer_load_dwordx4 v[52:55], v4, s[68:71], s15 offen offset:0 sc1
  s_sub_i32 s13, s13, 1
  s_cmp_lt_i32 s13, 0
  s_waitcnt vmcnt(0)
  v_max_u32 v3, v48, v50
  v_max3_u32 v3, v52, v54, v3
  v_cmp_eq_u32 vcc, -1, v3
  s_cbranch_scc1 mm_l1_st89_b
  s_nop 3
  s_cbranch_vccnz mm_l1_st89
  s_branch mm_l1_st89_b
mm_l1_st90:
  s_add_u32 s15, s10, s53
  s_add_u32 s15, s15, 2048
  buffer_load_dwordx4 v[56:59], v4, s[68:71], s15 offen offset:0 sc1
  s_add_u32 s15, s11, s53
  s_add_u32 s15, s15, 2048
  buffer_load_dwordx4 v[60:63], v4, s[68:71], s15 offen offset:0 sc1
  s_sub_i32 s13, s13, 1
  s_cmp_lt_i32 s13, 0
  s_waitcnt vmcnt(0)
  v_max_u32 v3, v56, v58
  v_max3_u32 v3, v60, v62, v3
  v_cmp_eq_u32 vcc, -1, v3
  s_cbranch_scc1 mm_l1_st90_b
  s_nop 3
  s_cbranch_vccnz mm_l1_st90
  s_branch mm_l1_st90_b
mm_l1_st91:
  s_add_u32 s15, s10, s54
  buffer_load_dwordx4 v[192:195], v4, s[68:71], s15 offen offset:0 sc1
  s_add_u32 s15, s11, s54
  buffer_load_dwordx4 v[196:199], v4, s[68:71], s15 offen offset:0 sc1
  s_sub_i32 s13, s13, 1
  s_cmp_lt_i32 s13, 0
  s_waitcnt vmcnt(0)
  v_max_u32 v3, v192, v194
  v_max3_u32 v3, v196, v198, v3
  v_cmp_eq_u32 vcc, -1, v3
  s_cbranch_scc1 mm_l1_st91_b
  s_nop 3
  s_cbranch_vccnz mm_l1_st91
  s_branch mm_l1_st91_b
mm_l1_st92:
  s_add_u32 s15, s10, s54
  s_add_u32 s15, s15, 1024
  buffer_load_dwordx4 v[200:203], v4, s[68:71], s15 offen offset:0 sc1
  s_add_u32 s15, s11, s54
  s_add_u32 s15, s15, 1024
  buffer_load_dwordx4 v[204:207], v4, s[68:71], s15 offen offset:0 sc1
  s_sub_i32 s13, s13, 1
  s_cmp_lt_i32 s13, 0
  s_waitcnt vmcnt(0)
  v_max_u32 v3, v200, v202
  v_max3_u32 v3, v204, v206, v3
  v_cmp_eq_u32 vcc, -1, v3
  s_cbranch_scc1 mm_l1_st92_b
  s_nop 3
  s_cbranch_vccnz mm_l1_st92
  s_branch mm_l1_st92_b
mm_l1_st93:
  s_add_u32 s15, s10, s54
  s_add_u32 s15, s15, 2048
  buffer_load_dwordx4 v[208:211], v4, s[68:71], s15 offen offset:0 sc1
  s_add_u32 s15, s11, s54
  s_add_u32 s15, s15, 2048
  buffer_load_dwordx4 v[212:215], v4, s[68:71], s15 offen offset:0 sc1
  s_sub_i32 s13, s13, 1
  s_cmp_lt_i32 s13, 0
  s_waitcnt vmcnt(0)
  v_max_u32 v3, v208, v210
  v_max3_u32 v3, v212, v214, v3
  v_cmp_eq_u32 vcc, -1, v3
  s_cbranch_scc1 mm_l1_st93_b
  s_nop 3
  s_cbranch_vccnz mm_l1_st93
  s_branch mm_l1_st93_b
mm_l1_st94:
  s_add_u32 s15, s10, s55
  buffer_load_dwordx4 v[176:179], v4, s[68:71], s15 offen offset:0 sc1
  s_add_u32 s15, s11, s55
  buffer_load_dwordx4 v[8:11], v4, s[68:71], s15 offen offset:0 sc1
  s_sub_i32 s13, s13, 1
  s_cmp_lt_i32 s13, 0
  s_waitcnt vmcnt(0)
  v_max_u32 v3, v176, v178
  v_max3_u32 v3, v8, v10, v3
  v_cmp_eq_u32 vcc, -1, v3
  s_cbranch_scc1 mm_l1_st94_b
  s_nop 3
  s_cbranch_vccnz mm_l1_st94
  s_branch mm_l1_st94_b
mm_l1_st95:
  s_add_u32 s15, s10, s55
  s_add_u32 s15, s15, 1024
  buffer_load_dwordx4 v[12:15], v4, s[68:71], s15 offen offset:0 sc1
  s_add_u32 s15, s11, s55
  s_add_u32 s15, s15, 1024
  buffer_load_dwordx4 a[0:3], v4, s[68:71], s15 offen offset:0 sc1
  s_sub_i32 s13, s13, 1
  s_cmp_lt_i32 s13, 0
  s_waitcnt vmcnt(0)
  v_max_u32 v3, v12, v14
  v_accvgpr_read_b32 v2, a0
  v_accvgpr_read_b32 v7, a2
  v_max3_u32 v3, v2, v7, v3
  v_cmp_eq_u32 vcc, -1, v3
  s_cbranch_scc1 mm_l1_st95_b
  s_nop 3
  s_cbranch_vccnz mm_l1_st95
  s_branch mm_l1_st95_b
mm_l1_st96:
  s_add_u32 s15, s10, s55
  s_add_u32 s15, s15, 2048
  buffer_load_dwordx4 a[4:7], v4, s[68:71], s15 offen offset:0 sc1
  s_add_u32 s15, s11, s55
  s_add_u32 s15, s15, 2048
  buffer_load_dwordx4 a[8:11], v4, s[68:71], s15 offen offset:0 sc1
  s_sub_i32 s13, s13, 1
  s_cmp_lt_i32 s13, 0
  s_waitcnt vmcnt(0)
  v_accvgpr_read_b32 v2, a4
  v_accvgpr_read_b32 v7, a6
  v_max_u32 v3, v2, v7
  v_accvgpr_read_b32 v2, a8
  v_accvgpr_read_b32 v7, a10
  v_max3_u32 v3, v2, v7, v3
  v_cmp_eq_u32 vcc, -1, v3
  s_cbranch_scc1 mm_l1_st96_b
  s_nop 3
  s_cbranch_vccnz mm_l1_st96
  s_branch mm_l1_st96_b
mm_l1_st97:
  s_add_u32 s15, s10, s52
  s_add_u32 s15, s15, 3072
  buffer_load_dwordx4 a[12:15], v4, s[68:71], s15 offen offset:0 sc1
  s_add_u32 s15, s11, s52
  s_add_u32 s15, s15, 3072
  buffer_load_dwordx4 v[180:183], v4, s[68:71], s15 offen offset:0 sc1
  s_sub_i32 s13, s13, 1
  s_cmp_lt_i32 s13, 0
  s_waitcnt vmcnt(0)
  v_accvgpr_read_b32 v2, a12
  v_accvgpr_read_b32 v7, a14
  v_max_u32 v3, v2, v7
  v_max3_u32 v3, v180, v182, v3
  v_cmp_eq_u32 vcc, -1, v3
  s_cbranch_scc1 mm_l1_st97_b
  s_nop 3
  s_cbranch_vccnz mm_l1_st97
  s_branch mm_l1_st97_b
mm_l1_st98:
  s_add_u32 s15, s10, s52
  s_add_u32 s15, s15, 4096
  buffer_load_dwordx4 a[16:19], v4, s[68:71], s15 offen offset:0 sc1
  s_add_u32 s15, s11, s52
  s_add_u32 s15, s15, 4096
  buffer_load_dwordx4 a[20:23], v4, s[68:71], s15 offen offset:0 sc1
  s_sub_i32 s13, s13, 1
  s_cmp_lt_i32 s13, 0
  s_waitcnt vmcnt(0)
  v_accvgpr_read_b32 v2, a16
  v_accvgpr_read_b32 v7, a18
  v_max_u32 v3, v2, v7
  v_accvgpr_read_b32 v2, a20
  v_accvgpr_read_b32 v7, a22
  v_max3_u32 v3, v2, v7, v3
  v_cmp_eq_u32 vcc, -1, v3
  s_cbranch_scc1 mm_l1_st98_b
  s_nop 3
  s_cbranch_vccnz mm_l1_st98
  s_branch mm_l1_st98_b
mm_l1_st99:
  s_add_u32 s15, s10, s53
  s_add_u32 s15, s15, 3072
  buffer_load_dwordx4 a[24:27], v4, s[68:71], s15 offen offset:0 sc1
  s_add_u32 s15, s11, s53
  s_add_u32 s15, s15, 3072
  buffer_load_dwordx4 a[28:31], v4, s[68:71], s15 offen offset:0 sc1
  s_sub_i32 s13, s13, 1
  s_cmp_lt_i32 s13, 0
  s_waitcnt vmcnt(0)
  v_accvgpr_read_b32 v2, a24
  v_accvgpr_read_b32 v7, a26
  v_max_u32 v3, v2, v7
  v_accvgpr_read_b32 v2, a28
  v_accvgpr_read_b32 v7, a30
  v_max3_u32 v3, v2, v7, v3
  v_cmp_eq_u32 vcc, -1, v3
  s_cbranch_scc1 mm_l1_st99_b
  s_nop 3
  s_cbranch_vccnz mm_l1_st99
  s_branch mm_l1_st99_b
mm_l1_st100:
  s_add_u32 s15, s10, s53
  s_add_u32 s15, s15, 4096
  buffer_load_dwordx4 a[32:35], v4, s[68:71], s15 offen offset:0 sc1
  s_add_u32 s15, s11, s53
  s_add_u32 s15, s15, 4096
  buffer_load_dwordx4 a[36:39], v4, s[68:71], s15 offen offset:0 sc1
  s_sub_i32 s13, s13, 1
  s_cmp_lt_i32 s13, 0
  s_waitcnt vmcnt(0)
  v_accvgpr_read_b32 v2, a32
  v_accvgpr_read_b32 v7, a34
  v_max_u32 v3, v2, v7
  v_accvgpr_read_b32 v2, a36
  v_accvgpr_read_b32 v7, a38
  v_max3_u32 v3, v2, v7, v3
  v_cmp_eq_u32 vcc, -1, v3
  s_cbranch_scc1 mm_l1_st100_b
  s_nop 3
  s_cbranch_vccnz mm_l1_st100
  s_branch mm_l1_st100_b
mm_l1_st101:
  s_add_u32 s15, s10, s54
  s_add_u32 s15, s15, 3072
  buffer_load_dwordx4 v[184:187], v4, s[68:71], s15 offen offset:0 sc1
  s_add_u32 s15, s11, s54
  s_add_u32 s15, s15, 3072
  buffer_load_dwordx4 a[40:43], v4, s[68:71], s15 offen offset:0 sc1
  s_sub_i32 s13, s13, 1
  s_cmp_lt_i32 s13, 0
  s_waitcnt vmcnt(0)
  v_max_u32 v3, v184, v186
  v_accvgpr_read_b32 v2, a40
  v_accvgpr_read_b32 v7, a42
  v_max3_u32 v3, v2, v7, v3
  v_cmp_eq_u32 vcc, -1, v3
  s_cbranch_scc1 mm_l1_st101_b
  s_nop 3
  s_cbranch_vccnz mm_l1_st101
  s_branch mm_l1_st101_b
mm_l1_st102:
  s_add_u32 s15, s10, s54
  s_add_u32 s15, s15, 4096
  buffer_load_dwordx4 a[44:47], v4, s[68:71], s15 offen offset:0 sc1
  s_add_u32 s15, s11, s54
  s_add_u32 s15, s15, 4096
  buffer_load_dwordx4 a[48:51], v4, s[68:71], s15 offen offset:0 sc1
  s_sub_i32 s13, s13, 1
  s_cmp_lt_i32 s13, 0
  s_waitcnt vmcnt(0)
  v_accvgpr_read_b32 v2, a44
  v_accvgpr_read_b32 v7, a46
  v_max_u32 v3, v2, v7
  v_accvgpr_read_b32 v2, a48
  v_accvgpr_read_b32 v7, a50
  v_max3_u32 v3, v2, v7, v3
  v_cmp_eq_u32 vcc, -1, v3
  s_cbranch_scc1 mm_l1_st102_b
  s_nop 3
  s_cbranch_vccnz mm_l1_st102
  s_branch mm_l1_st102_b
mm_l1_st103:
  s_add_u32 s15, s10, s55
  s_add_u32 s15, s15, 3072
  buffer_load_dwordx4 a[52:55], v4, s[68:71], s15 offen offset:0 sc1
  s_add_u32 s15, s11, s55
  s_add_u32 s15, s15, 3072
  buffer_load_dwordx4 a[56:59], v4, s[68:71], s15 offen offset:0 sc1
  s_sub_i32 s13, s13, 1
  s_cmp_lt_i32 s13, 0
  s_waitcnt vmcnt(0)
  v_accvgpr_read_b32 v2, a52
  v_accvgpr_read_b32 v7, a54
  v_max_u32 v3, v2, v7
  v_accvgpr_read_b32 v2, a56
  v_accvgpr_read_b32 v7, a58
  v_max3_u32 v3, v2, v7, v3
  v_cmp_eq_u32 vcc, -1, v3
  s_cbranch_scc1 mm_l1_st103_b
  s_nop 3
  s_cbranch_vccnz mm_l1_st103
  s_branch mm_l1_st103_b
mm_l1_st104:
  s_add_u32 s15, s10, s55
  s_add_u32 s15, s15, 4096
  buffer_load_dwordx4 a[60:63], v4, s[68:71], s15 offen offset:0 sc1
  s_add_u32 s15, s11, s55
  s_add_u32 s15, s15, 4096
  buffer_load_dwordx4 v[188:191], v4, s[68:71], s15 offen offset:0 sc1
  s_sub_i32 s13, s13, 1
  s_cmp_lt_i32 s13, 0
  s_waitcnt vmcnt(0)
  v_accvgpr_read_b32 v2, a60
  v_accvgpr_read_b32 v7, a62
  v_max_u32 v3, v2, v7
  v_max3_u32 v3, v188, v190, v3
  v_cmp_eq_u32 vcc, -1, v3
  s_cbranch_scc1 mm_l1_st104_b
  s_nop 3
  s_cbranch_vccnz mm_l1_st104
  s_branch mm_l1_st104_b
mm_l1_st105:
  s_add_u32 s15, s11, s52
  s_add_u32 s15, s15, 5120
  buffer_load_dwordx4 v[128:131], v4, s[68:71], s15 offen offset:0 sc1
  buffer_load_dwordx4 v[132:135], v4, s[68:71], s15 offen offset:1024 sc1
  s_sub_i32 s13, s13, 1
  s_cmp_lt_i32 s13, 0
  s_waitcnt vmcnt(0)
  v_max_u32 v3, v128, v130
  v_max3_u32 v3, v132, v134, v3
  v_cmp_eq_u32 vcc, -1, v3
  s_cbranch_scc1 mm_l1_st105_b
  s_nop 3
  s_cbranch_vccnz mm_l1_st105
  s_branch mm_l1_st105_b
mm_l1_st106:
  s_add_u32 s15, s11, s53
  s_add_u32 s15, s15, 5120
  buffer_load_dwordx4 v[136:139], v4, s[68:71], s15 offen offset:0 sc1
  buffer_load_dwordx4 v[140:143], v4, s[68:71], s15 offen offset:1024 sc1
  s_sub_i32 s13, s13, 1
  s_cmp_lt_i32 s13, 0
  s_waitcnt vmcnt(0)
  v_max_u32 v3, v136, v138
  v_max3_u32 v3, v140, v142, v3
  v_cmp_eq_u32 vcc, -1, v3
  s_cbranch_scc1 mm_l1_st106_b
  s_nop 3
  s_cbranch_vccnz mm_l1_st106
  s_branch mm_l1_st106_b
mm_l1_st107:
  s_add_u32 s15, s11, s54
  s_add_u32 s15, s15, 5120
  buffer_load_dwordx4 v[144:147], v4, s[68:71], s15 offen offset:0 sc1
  buffer_load_dwordx4 v[148:151], v4, s[68:71], s15 offen offset:1024 sc1
  s_sub_i32 s13, s13, 1
  s_cmp_lt_i32 s13, 0
  s_waitcnt vmcnt(0)
  v_max_u32 v3, v144, v146
  v_max3_u32 v3, v148, v150, v3
  v_cmp_eq_u32 vcc, -1, v3
  s_cbranch_scc1 mm_l1_st107_b
  s_nop 3
  s_cbranch_vccnz mm_l1_st107
  s_branch mm_l1_st107_b
mm_l1_st108:
  s_add_u32 s15, s11, s55
  s_add_u32 s15, s15, 5120
  buffer_load_dwordx4 v[152:155], v4, s[68:71], s15 offen offset:0 sc1
  buffer_load_dwordx4 v[156:159], v4, s[68:71], s15 offen offset:1024 sc1
  s_sub_i32 s13, s13, 1
  s_cmp_lt_i32 s13, 0
  s_waitcnt vmcnt(0)
  v_max_u32 v3, v152, v154
  v_max3_u32 v3, v156, v158, v3
  v_cmp_eq_u32 vcc, -1, v3
  s_cbranch_scc1 mm_l1_st108_b
  s_nop 3
  s_cbranch_vccnz mm_l1_st108
  s_branch mm_l1_st108_b
mm_l1_st109:
  s_add_u32 s15, s10, s52
  s_add_u32 s15, s15, 5120
  buffer_load_dwordx4 v[16:19], v4, s[68:71], s15 offen offset:0 sc1
  buffer_load_dwordx4 v[20:23], v4, s[68:71], s15 offen offset:1024 sc1
  s_sub_i32 s13, s13, 1
  s_cmp_lt_i32 s13, 0
  s_waitcnt vmcnt(0)
  v_max_u32 v3, v16, v18
  v_max3_u32 v3, v20, v22, v3
  v_cmp_eq_u32 vcc, -1, v3
  s_cbranch_scc1 mm_l1_st109_b
  s_nop 3
  s_cbranch_vccnz mm_l1_st109
  s_branch mm_l1_st109_b
mm_l1_st110:
  s_add_u32 s15, s10, s53
  s_add_u32 s15, s15, 5120
  buffer_load_dwordx4 v[24:27], v4, s[68:71], s15 offen offset:0 sc1
  buffer_load_dwordx4 v[28:31], v4, s[68:71], s15 offen offset:1024 sc1
  s_sub_i32 s13, s13, 1
  s_cmp_lt_i32 s13, 0
  s_waitcnt vmcnt(0)
  v_max_u32 v3, v24, v26
  v_max3_u32 v3, v28, v30, v3
  v_cmp_eq_u32 vcc, -1, v3
  s_cbranch_scc1 mm_l1_st110_b
  s_nop 3
  s_cbranch_vccnz mm_l1_st110
  s_branch mm_l1_st110_b
mm_l1_st111:
  s_add_u32 s15, s10, s54
  s_add_u32 s15, s15, 5120
  buffer_load_dwordx4 v[32:35], v4, s[68:71], s15 offen offset:0 sc1
  buffer_load_dwordx4 v[36:39], v4, s[68:71], s15 offen offset:1024 sc1
  s_sub_i32 s13, s13, 1
  s_cmp_lt_i32 s13, 0
  s_waitcnt vmcnt(0)
  v_max_u32 v3, v32, v34
  v_max3_u32 v3, v36, v38, v3
  v_cmp_eq_u32 vcc, -1, v3
  s_cbranch_scc1 mm_l1_st111_b
  s_nop 3
  s_cbranch_vccnz mm_l1_st111
  s_branch mm_l1_st111_b
mm_l1_st112:
  s_add_u32 s15, s10, s55
  s_add_u32 s15, s15, 5120
  buffer_load_dwordx4 v[40:43], v4, s[68:71], s15 offen offset:0 sc1
  buffer_load_dwordx4 v[44:47], v4, s[68:71], s15 offen offset:1024 sc1
  s_sub_i32 s13, s13, 1
  s_cmp_lt_i32 s13, 0
  s_waitcnt vmcnt(0)
  v_max_u32 v3, v40, v42
  v_max3_u32 v3, v44, v46, v3
  v_cmp_eq_u32 vcc, -1, v3
  s_cbranch_scc1 mm_l1_st112_b
  s_nop 3
  s_cbranch_vccnz mm_l1_st112
  s_branch mm_l1_st112_b
mm_l1_fb:
  v_mov_b32 v14, 0xff800000
  s_mov_b32 s9, 2359296
mm_l1_fb_l1:
  buffer_load_dwordx4 v[64:67], v4, s[40:43], s9 offen
  buffer_load_dwordx4 v[68:71], v4, s[40:43], s9 offen offset:1024
  s_waitcnt vmcnt(0)
  v_mfma_f32_32x32x16_bf16 v[80:95], v[64:67], v[16:19], 0
  v_mfma_f32_32x32x16_bf16 v[80:95], v[68:71], v[20:23], v[80:95]
  s_nop 11
  v_max3_f32 v14, v80, v81, v14
  v_max3_f32 v14, v82, v83, v14
  v_max3_f32 v14, v84, v85, v14
  v_max3_f32 v14, v86, v87, v14
  v_max3_f32 v14, v88, v89, v14
  v_max3_f32 v14, v90, v91, v14
  v_max3_f32 v14, v92, v93, v14
  v_max3_f32 v14, v94, v95, v14
  s_add_u32 s9, s9, 4096
  s_cmp_lt_u32 s9, 2621440
  s_cbranch_scc1 mm_l1_fb_l1
  v_mov_b32 v8, v14
  s_nop 1
  v_permlane32_swap_b32 v14, v8
  v_max_f32 v14, v14, v8
  v_mov_b32 v48, 0
  v_mov_b32 v49, 0
  v_mov_b32 v50, 0
  v_mov_b32 v51, 0
  v_mov_b32 v52, 0
  v_mov_b32 v53, 0
  v_mov_b32 v54, 0
  v_mov_b32 v55, 0
  v_mov_b32 v56, 0
  v_mov_b32 v57, 0
  v_mov_b32 v58, 0
  v_mov_b32 v59, 0
  v_mov_b32 v60, 0
  v_mov_b32 v61, 0
  v_mov_b32 v62, 0
  v_mov_b32 v63, 0
  s_mov_b32 s9, 2359296
mm_l1_fb_l2:
  buffer_load_dwordx4 v[64:67], v4, s[40:43], s9 offen
  buffer_load_dwordx4 v[68:71], v4, s[40:43], s9 offen offset:1024
  buffer_load_dwordx4 v[72:75], v4, s[40:43], s9 offen offset:2048
  buffer_load_dwordx4 v[76:79], v4, s[40:43], s9 offen offset:3072
  s_waitcnt vmcnt(0)
  v_mfma_f32_32x32x16_bf16 v[80:95], v[64:67], v[16:19], 0
  v_mfma_f32_32x32x16_bf16 v[80:95], v[68:71], v[20:23], v[80:95]
  s_nop 11
  v_sub_f32 v80, v80, v14
  v_sub_f32 v81, v81, v14
  v_sub_f32 v82, v82, v14
  v_sub_f32 v83, v83, v14
  v_sub_f32 v84, v84, v14
  v_sub_f32 v85, v85, v14
  v_sub_f32 v86, v86, v14
  v_sub_f32 v87, v87, v14
  v_sub_f32 v88, v88, v14
  v_sub_f32 v89, v89, v14
  v_sub_f32 v90, v90, v14
  v_sub_f32 v91, v91, v14
  v_sub_f32 v92, v92, v14
  v_sub_f32 v93, v93, v14
  v_sub_f32 v94, v94, v14
  v_sub_f32 v95, v95, v14
  v_exp_f32 v80, v80
  v_exp_f32 v81, v81
  v_exp_f32 v82, v82
  v_exp_f32 v83, v83
  v_exp_f32 v84, v84
  v_exp_f32 v85, v85
  v_exp_f32 v86, v86
  v_exp_f32 v87, v87
  v_exp_f32 v88, v88
  v_exp_f32 v89, v89
  v_exp_f32 v90, v90
  v_exp_f32 v91, v91
  v_exp_f32 v92, v92
  v_exp_f32 v93, v93
  v_exp_f32 v94, v94
  v_exp_f32 v95, v95
  v_cvt_pk_bf16_f32 v144, v80, v81
  v_cvt_pk_bf16_f32 v145, v82, v83
  v_cvt_pk_bf16_f32 v146, v84, v85
  v_cvt_pk_bf16_f32 v147, v86, v87
  v_cvt_pk_bf16_f32 v148, v88, v89
  v_cvt_pk_bf16_f32 v149, v90, v91
  v_cvt_pk_bf16_f32 v150, v92, v93
  v_cvt_pk_bf16_f32 v151, v94, v95
  v_mfma_f32_32x32x16_bf16 v[48:63], v[72:75], v[144:147], v[48:63]
  s_nop 0
  v_mfma_f32_32x32x16_bf16 v[48:63], v[76:79], v[148:151], v[48:63]
  s_add_u32 s9, s9, 4096
  s_cmp_lt_u32 s9, 2621440
  s_nop 7
  s_cbranch_scc1 mm_l1_fb_l2
  s_nop 7
  v_mov_b32 v9, v60
  v_mov_b32 v8, v60
  s_nop 1
  v_permlane32_swap_b32 v9, v8
  v_rcp_f32 v9, v8
  s_nop 1
  s_branch mm_l1_norm
mm_kernel_end:
  s_endpgm
.section .rodata,"a"
.p2align 6
.amdhsa_kernel mm_kernel
  .amdhsa_next_free_vgpr 512
  .amdhsa_next_free_sgpr 72
  .amdhsa_accum_offset 256
  .amdhsa_group_segment_fixed_size 0
  .amdhsa_kernarg_size 96
  .amdhsa_user_sgpr_count 2
  .amdhsa_user_sgpr_kernarg_segment_ptr 1
  .amdhsa_system_sgpr_workgroup_id_x 1
.end_amdhsa_kernel
```
